```python
import torch

def _softmax(x, axis=-1):
    return torch.softmax(x, dim=axis)

def _gelu(x):
    return torch.nn.functional.gelu(x, approximate='tanh')

def _silu(x):
    return torch.nn.functional.silu(x)

def _sigmoid(x):
    return torch.sigmoid(x)

def _layernorm(x, axis=-1, eps=1e-05):
    m = x.mean(dim=axis, keepdim=True)
    v = x.var(dim=axis, keepdim=True, unbiased=False)
    return (x - m) / torch.sqrt(v + eps)

def _scatter_add(tgt, idx, src, axis=0):
    return tgt.clone().index_add_(axis, idx, src)

def _segment_sum(src, seg, n):
    out = torch.zeros((n,) + src.shape[1:], dtype=src.dtype)
    return out.index_add_(0, seg, src)

def _pad(x, pw):
    flat = tuple((v for pair in reversed(pw) for v in pair))
    return torch.nn.functional.pad(x, flat)
kernel_name = 'adaLN_cond__gqa_block_cached__mixer_gmlp__prompt'

def setup_inputs():

    _w = lambda a: (lambda t: t.to(torch.bfloat16) if t.is_floating_point() else t)(torch.as_tensor(a))

    def _A_setup():
        B, Sq, D = (1, 2048, 576)
        Hq, Hkv, Sk, Dh = (32, 16, 2048, 128)
        assert Hq % Hkv == 0, (Hq, Hkv)
        return {'x': _w((lambda *s: torch.randn(*s, dtype=torch.bfloat16) * 0.05)(B, Sq, D)), 'k_cache': _w((lambda *s: torch.randn(*s, dtype=torch.bfloat16) * 3.2)(B, Hkv, Sk, Dh)), 'v_cache': _w((lambda *s: torch.randn(*s, dtype=torch.bfloat16) * 0.4)(B, Hkv, Sk, Dh)), 'wq': _w((lambda *s: torch.randn(*s, dtype=torch.bfloat16) * 3.2)(D, Hq * Dh) * D ** (-0.5)), 'wo': _w((lambda *s: torch.randn(*s, dtype=torch.bfloat16) * 0.4)(Hq * Dh, D) * (Hq * Dh) ** (-0.5))}
    _A_in = _A_setup()

    def _B_setup():
        B, S, D, F = (1, 2048, 576, 4608)
        Fh = F // 2
        return {'x': _w((lambda *s: torch.randn(*s, dtype=torch.bfloat16) * 0.05)(B, S, D)), 'w_in': _w((lambda *s: torch.randn(*s, dtype=torch.bfloat16) * 1.6)(D, 2 * Fh)), 'w_sp': _w(0.01 * (lambda *s: torch.randn(*s, dtype=torch.bfloat16) * 1.6)(S, S)), 'b_sp': _w(1.0 + 0.01 * (lambda *s: torch.randn(*s, dtype=torch.bfloat16) * 0.05)(S)), 'w_out': _w((lambda *s: torch.randn(*s, dtype=torch.bfloat16) * 0.05)(Fh, D))}
    _B_in = _B_setup()
    return {'A_x': _A_in['x'], 'A_k_cache': _A_in['k_cache'], 'A_v_cache': _A_in['v_cache'], 'A_wq': _A_in['wq'], 'A_wo': _A_in['wo'], 'B_x': _B_in['x'], 'B_w_in': _B_in['w_in'], 'B_w_sp': _B_in['w_sp'], 'B_b_sp': _B_in['b_sp'], 'B_w_out': _B_in['w_out'], 'c': _w((lambda *s: torch.randn(*s, dtype=torch.bfloat16) * 0.2)(1, 576) * 8.0), 'w_mod': _w((lambda *s: torch.randn(*s, dtype=torch.bfloat16) * 0.2)(576, 6 * 576) * 576 ** (-0.5) * 8.0)}

def reference(A_x, A_k_cache, A_v_cache, A_wq, A_wo, B_x, B_w_in, B_w_sp, B_b_sp, B_w_out, c, w_mod):

    def _A_ref(x, k_cache, v_cache, wq, wo):
        B, Sq, D = x.shape
        Hq, Dh = (32, 128)
        Hkv = k_cache.shape[1]
        rep = Hq // Hkv
        q = (lambda x, *d: x.permute(*d))((x @ wq).reshape(B, Sq, Hq, Dh), 0, 2, 1, 3)
        k = (lambda x, n, axis: torch.repeat_interleave(x, n, dim=axis))(k_cache, rep, axis=1)
        v = (lambda x, n, axis: torch.repeat_interleave(x, n, dim=axis))(v_cache, rep, axis=1)
        scores = torch.einsum('bhqd,bhkd->bhqk', q, k) * Dh ** (-0.5)
        p = _softmax(scores, axis=-1)
        o = torch.einsum('bhqk,bhkd->bhqd', p, v)
        return (lambda x, *d: x.permute(*d))(o, 0, 2, 1, 3).reshape(B, Sq, Hq * Dh) @ wo

    def _B_ref(x, w_in, w_sp, b_sp, w_out):
        B, S, D = x.shape
        F = w_in.shape[-1]
        Fh = F // 2
        z = _gelu(torch.einsum('bsd,df->bsf', x, w_in))
        z1 = z[..., :Fh].clone()
        z2 = _layernorm(z[..., Fh:], axis=-1)
        g = torch.einsum('ts,bsf->btf', w_sp, z2) + b_sp[None, :, None]
        return torch.einsum('bsf,fd->bsd', z1 * g, w_out)
    x = A_x
    mod = (_silu(c) @ w_mod).reshape(c.shape[0], 6, 1, -1)
    sa, ca, ga, sb, cb, gb = (mod[:, 0].clone(), mod[:, 1].clone(), mod[:, 2].clone(), mod[:, 3].clone(), mod[:, 4].clone(), mod[:, 5].clone())
    h = _layernorm(x, axis=-1) * (1 + ca) + sa
    x = x + ga * _A_ref(h, A_k_cache, A_v_cache, A_wq, A_wo)
    h = _layernorm(x, axis=-1) * (1 + cb) + sb
    x = x + gb * _B_ref(h, B_w_in, B_w_sp, B_b_sp, B_w_out)
    return x
```

```asm
; @launch kernel=k0_mod_kernel grid=(184,1,1) block=(256,1,1) lds=2048
; @launch kernel=k1_attn_kernel grid=(256,1,1) block=(256,1,1) lds=136192
; @launch kernel=k2_oproj_kernel grid=(256,1,1) block=(256,1,1) lds=131072
; @launch kernel=k3_win_kernel grid=(256,1,1) block=(512,1,1) lds=104448
; @launch kernel=k4_sp_kernel grid=(256,1,1) block=(512,1,1) lds=147456
; @launch kernel=k5_oproj_kernel grid=(240,1,1) block=(256,1,1) lds=131072
.amdgcn_target "amdgcn-amd-amdhsa--gfx950"
.text
.globl k0_mod_kernel
.p2align 8
.type k0_mod_kernel,@function
k0_mod_kernel:
    s_cmp_ge_u32 s2, 108
    s_cbranch_scc1 K0_ln
    s_load_dwordx2 s[4:5], s[0:1], 80
    s_load_dwordx2 s[6:7], s[0:1], 88
    s_load_dwordx2 s[8:9], s[0:1], 112
    v_and_b32 v1, 3, v0
    v_lshrrev_b32 v2, 2, v0
    s_waitcnt lgkmcnt(0)
    s_mov_b32 s12, s4
    s_mov_b32 s13, s5
    s_mov_b32 s14, 1152
    s_mov_b32 s15, 0x00020000
    s_mov_b32 s16, s6
    s_mov_b32 s17, s7
    s_mov_b32 s18, 3981312
    s_mov_b32 s19, 0x00020000
    s_add_u32 s20, s8, 0
    s_addc_u32 s21, s9, 0
    s_mov_b32 s22, 18432
    s_mov_b32 s23, 0x00020000
    s_mov_b32 s24, 6912
    v_mul_lo_u32 v3, v2, s24
    v_lshl_add_u32 v3, v1, 4, v3
    s_lshl_b32 s25, s2, 6
    v_add_u32 v3, s25, v3
    v_lshlrev_b32 v4, 1, v2
    s_mov_b32 s26, 0
    buffer_load_dwordx4 v[16:19], v3, s[16:19], s26 offen
    s_mov_b32 s26, 442368
    buffer_load_dwordx4 v[20:23], v3, s[16:19], s26 offen
    s_mov_b32 s26, 884736
    buffer_load_dwordx4 v[24:27], v3, s[16:19], s26 offen
    s_mov_b32 s26, 1327104
    buffer_load_dwordx4 v[28:31], v3, s[16:19], s26 offen
    s_mov_b32 s26, 1769472
    buffer_load_dwordx4 v[32:35], v3, s[16:19], s26 offen
    s_mov_b32 s26, 2211840
    buffer_load_dwordx4 v[36:39], v3, s[16:19], s26 offen
    s_mov_b32 s26, 2654208
    buffer_load_dwordx4 v[40:43], v3, s[16:19], s26 offen
    s_mov_b32 s26, 3096576
    buffer_load_dwordx4 v[44:47], v3, s[16:19], s26 offen
    s_mov_b32 s26, 3538944
    buffer_load_dwordx4 v[48:51], v3, s[16:19], s26 offen
    buffer_load_ushort v5, v4, s[12:15], 0 offen offset:0
    buffer_load_ushort v6, v4, s[12:15], 0 offen offset:128
    buffer_load_ushort v7, v4, s[12:15], 0 offen offset:256
    buffer_load_ushort v8, v4, s[12:15], 0 offen offset:384
    buffer_load_ushort v9, v4, s[12:15], 0 offen offset:512
    buffer_load_ushort v10, v4, s[12:15], 0 offen offset:640
    buffer_load_ushort v11, v4, s[12:15], 0 offen offset:768
    buffer_load_ushort v12, v4, s[12:15], 0 offen offset:896
    buffer_load_ushort v13, v4, s[12:15], 0 offen offset:1024
    v_mov_b32 v56, 0
    v_mov_b32 v57, 0
    v_mov_b32 v58, 0
    v_mov_b32 v59, 0
    v_mov_b32 v60, 0
    v_mov_b32 v61, 0
    v_mov_b32 v62, 0
    v_mov_b32 v63, 0
    s_waitcnt vmcnt(0)
    s_mov_b32 s27, 0xbfb8aa3b
    v_lshlrev_b32 v5, 16, v5
    v_mul_f32 v64, s27, v5
    v_exp_f32 v64, v64
    s_nop 0
    v_add_f32 v64, 1.0, v64
    v_rcp_f32 v64, v64
    s_nop 0
    v_mul_f32 v64, v5, v64
    v_cvt_pk_bf16_f32 v64, v64, v64
    v_lshlrev_b32 v5, 16, v64
    v_lshlrev_b32 v6, 16, v6
    v_mul_f32 v64, s27, v6
    v_exp_f32 v64, v64
    s_nop 0
    v_add_f32 v64, 1.0, v64
    v_rcp_f32 v64, v64
    s_nop 0
    v_mul_f32 v64, v6, v64
    v_cvt_pk_bf16_f32 v64, v64, v64
    v_lshlrev_b32 v6, 16, v64
    v_lshlrev_b32 v7, 16, v7
    v_mul_f32 v64, s27, v7
    v_exp_f32 v64, v64
    s_nop 0
    v_add_f32 v64, 1.0, v64
    v_rcp_f32 v64, v64
    s_nop 0
    v_mul_f32 v64, v7, v64
    v_cvt_pk_bf16_f32 v64, v64, v64
    v_lshlrev_b32 v7, 16, v64
    v_lshlrev_b32 v8, 16, v8
    v_mul_f32 v64, s27, v8
    v_exp_f32 v64, v64
    s_nop 0
    v_add_f32 v64, 1.0, v64
    v_rcp_f32 v64, v64
    s_nop 0
    v_mul_f32 v64, v8, v64
    v_cvt_pk_bf16_f32 v64, v64, v64
    v_lshlrev_b32 v8, 16, v64
    v_lshlrev_b32 v9, 16, v9
    v_mul_f32 v64, s27, v9
    v_exp_f32 v64, v64
    s_nop 0
    v_add_f32 v64, 1.0, v64
    v_rcp_f32 v64, v64
    s_nop 0
    v_mul_f32 v64, v9, v64
    v_cvt_pk_bf16_f32 v64, v64, v64
    v_lshlrev_b32 v9, 16, v64
    v_lshlrev_b32 v10, 16, v10
    v_mul_f32 v64, s27, v10
    v_exp_f32 v64, v64
    s_nop 0
    v_add_f32 v64, 1.0, v64
    v_rcp_f32 v64, v64
    s_nop 0
    v_mul_f32 v64, v10, v64
    v_cvt_pk_bf16_f32 v64, v64, v64
    v_lshlrev_b32 v10, 16, v64
    v_lshlrev_b32 v11, 16, v11
    v_mul_f32 v64, s27, v11
    v_exp_f32 v64, v64
    s_nop 0
    v_add_f32 v64, 1.0, v64
    v_rcp_f32 v64, v64
    s_nop 0
    v_mul_f32 v64, v11, v64
    v_cvt_pk_bf16_f32 v64, v64, v64
    v_lshlrev_b32 v11, 16, v64
    v_lshlrev_b32 v12, 16, v12
    v_mul_f32 v64, s27, v12
    v_exp_f32 v64, v64
    s_nop 0
    v_add_f32 v64, 1.0, v64
    v_rcp_f32 v64, v64
    s_nop 0
    v_mul_f32 v64, v12, v64
    v_cvt_pk_bf16_f32 v64, v64, v64
    v_lshlrev_b32 v12, 16, v64
    v_lshlrev_b32 v13, 16, v13
    v_mul_f32 v64, s27, v13
    v_exp_f32 v64, v64
    s_nop 0
    v_add_f32 v64, 1.0, v64
    v_rcp_f32 v64, v64
    s_nop 0
    v_mul_f32 v64, v13, v64
    v_cvt_pk_bf16_f32 v64, v64, v64
    v_lshlrev_b32 v13, 16, v64
    v_lshlrev_b32 v64, 16, v16
    v_and_b32 v65, 0xffff0000, v16
    v_fmac_f32 v56, v5, v64
    v_fmac_f32 v57, v5, v65
    v_lshlrev_b32 v64, 16, v17
    v_and_b32 v65, 0xffff0000, v17
    v_fmac_f32 v58, v5, v64
    v_fmac_f32 v59, v5, v65
    v_lshlrev_b32 v64, 16, v18
    v_and_b32 v65, 0xffff0000, v18
    v_fmac_f32 v60, v5, v64
    v_fmac_f32 v61, v5, v65
    v_lshlrev_b32 v64, 16, v19
    v_and_b32 v65, 0xffff0000, v19
    v_fmac_f32 v62, v5, v64
    v_fmac_f32 v63, v5, v65
    v_lshlrev_b32 v64, 16, v20
    v_and_b32 v65, 0xffff0000, v20
    v_fmac_f32 v56, v6, v64
    v_fmac_f32 v57, v6, v65
    v_lshlrev_b32 v64, 16, v21
    v_and_b32 v65, 0xffff0000, v21
    v_fmac_f32 v58, v6, v64
    v_fmac_f32 v59, v6, v65
    v_lshlrev_b32 v64, 16, v22
    v_and_b32 v65, 0xffff0000, v22
    v_fmac_f32 v60, v6, v64
    v_fmac_f32 v61, v6, v65
    v_lshlrev_b32 v64, 16, v23
    v_and_b32 v65, 0xffff0000, v23
    v_fmac_f32 v62, v6, v64
    v_fmac_f32 v63, v6, v65
    v_lshlrev_b32 v64, 16, v24
    v_and_b32 v65, 0xffff0000, v24
    v_fmac_f32 v56, v7, v64
    v_fmac_f32 v57, v7, v65
    v_lshlrev_b32 v64, 16, v25
    v_and_b32 v65, 0xffff0000, v25
    v_fmac_f32 v58, v7, v64
    v_fmac_f32 v59, v7, v65
    v_lshlrev_b32 v64, 16, v26
    v_and_b32 v65, 0xffff0000, v26
    v_fmac_f32 v60, v7, v64
    v_fmac_f32 v61, v7, v65
    v_lshlrev_b32 v64, 16, v27
    v_and_b32 v65, 0xffff0000, v27
    v_fmac_f32 v62, v7, v64
    v_fmac_f32 v63, v7, v65
    v_lshlrev_b32 v64, 16, v28
    v_and_b32 v65, 0xffff0000, v28
    v_fmac_f32 v56, v8, v64
    v_fmac_f32 v57, v8, v65
    v_lshlrev_b32 v64, 16, v29
    v_and_b32 v65, 0xffff0000, v29
    v_fmac_f32 v58, v8, v64
    v_fmac_f32 v59, v8, v65
    v_lshlrev_b32 v64, 16, v30
    v_and_b32 v65, 0xffff0000, v30
    v_fmac_f32 v60, v8, v64
    v_fmac_f32 v61, v8, v65
    v_lshlrev_b32 v64, 16, v31
    v_and_b32 v65, 0xffff0000, v31
    v_fmac_f32 v62, v8, v64
    v_fmac_f32 v63, v8, v65
    v_lshlrev_b32 v64, 16, v32
    v_and_b32 v65, 0xffff0000, v32
    v_fmac_f32 v56, v9, v64
    v_fmac_f32 v57, v9, v65
    v_lshlrev_b32 v64, 16, v33
    v_and_b32 v65, 0xffff0000, v33
    v_fmac_f32 v58, v9, v64
    v_fmac_f32 v59, v9, v65
    v_lshlrev_b32 v64, 16, v34
    v_and_b32 v65, 0xffff0000, v34
    v_fmac_f32 v60, v9, v64
    v_fmac_f32 v61, v9, v65
    v_lshlrev_b32 v64, 16, v35
    v_and_b32 v65, 0xffff0000, v35
    v_fmac_f32 v62, v9, v64
    v_fmac_f32 v63, v9, v65
    v_lshlrev_b32 v64, 16, v36
    v_and_b32 v65, 0xffff0000, v36
    v_fmac_f32 v56, v10, v64
    v_fmac_f32 v57, v10, v65
    v_lshlrev_b32 v64, 16, v37
    v_and_b32 v65, 0xffff0000, v37
    v_fmac_f32 v58, v10, v64
    v_fmac_f32 v59, v10, v65
    v_lshlrev_b32 v64, 16, v38
    v_and_b32 v65, 0xffff0000, v38
    v_fmac_f32 v60, v10, v64
    v_fmac_f32 v61, v10, v65
    v_lshlrev_b32 v64, 16, v39
    v_and_b32 v65, 0xffff0000, v39
    v_fmac_f32 v62, v10, v64
    v_fmac_f32 v63, v10, v65
    v_lshlrev_b32 v64, 16, v40
    v_and_b32 v65, 0xffff0000, v40
    v_fmac_f32 v56, v11, v64
    v_fmac_f32 v57, v11, v65
    v_lshlrev_b32 v64, 16, v41
    v_and_b32 v65, 0xffff0000, v41
    v_fmac_f32 v58, v11, v64
    v_fmac_f32 v59, v11, v65
    v_lshlrev_b32 v64, 16, v42
    v_and_b32 v65, 0xffff0000, v42
    v_fmac_f32 v60, v11, v64
    v_fmac_f32 v61, v11, v65
    v_lshlrev_b32 v64, 16, v43
    v_and_b32 v65, 0xffff0000, v43
    v_fmac_f32 v62, v11, v64
    v_fmac_f32 v63, v11, v65
    v_lshlrev_b32 v64, 16, v44
    v_and_b32 v65, 0xffff0000, v44
    v_fmac_f32 v56, v12, v64
    v_fmac_f32 v57, v12, v65
    v_lshlrev_b32 v64, 16, v45
    v_and_b32 v65, 0xffff0000, v45
    v_fmac_f32 v58, v12, v64
    v_fmac_f32 v59, v12, v65
    v_lshlrev_b32 v64, 16, v46
    v_and_b32 v65, 0xffff0000, v46
    v_fmac_f32 v60, v12, v64
    v_fmac_f32 v61, v12, v65
    v_lshlrev_b32 v64, 16, v47
    v_and_b32 v65, 0xffff0000, v47
    v_fmac_f32 v62, v12, v64
    v_fmac_f32 v63, v12, v65
    v_lshlrev_b32 v64, 16, v48
    v_and_b32 v65, 0xffff0000, v48
    v_fmac_f32 v56, v13, v64
    v_fmac_f32 v57, v13, v65
    v_lshlrev_b32 v64, 16, v49
    v_and_b32 v65, 0xffff0000, v49
    v_fmac_f32 v58, v13, v64
    v_fmac_f32 v59, v13, v65
    v_lshlrev_b32 v64, 16, v50
    v_and_b32 v65, 0xffff0000, v50
    v_fmac_f32 v60, v13, v64
    v_fmac_f32 v61, v13, v65
    v_lshlrev_b32 v64, 16, v51
    v_and_b32 v65, 0xffff0000, v51
    v_fmac_f32 v62, v13, v64
    v_fmac_f32 v63, v13, v65
    s_nop 1
    v_add_f32_dpp v56, v56, v56 row_ror:4 row_mask:0xf bank_mask:0xf
    v_add_f32_dpp v57, v57, v57 row_ror:4 row_mask:0xf bank_mask:0xf
    v_add_f32_dpp v58, v58, v58 row_ror:4 row_mask:0xf bank_mask:0xf
    v_add_f32_dpp v59, v59, v59 row_ror:4 row_mask:0xf bank_mask:0xf
    v_add_f32_dpp v60, v60, v60 row_ror:4 row_mask:0xf bank_mask:0xf
    v_add_f32_dpp v61, v61, v61 row_ror:4 row_mask:0xf bank_mask:0xf
    v_add_f32_dpp v62, v62, v62 row_ror:4 row_mask:0xf bank_mask:0xf
    v_add_f32_dpp v63, v63, v63 row_ror:4 row_mask:0xf bank_mask:0xf
    s_nop 1
    v_add_f32_dpp v56, v56, v56 row_ror:8 row_mask:0xf bank_mask:0xf
    v_add_f32_dpp v57, v57, v57 row_ror:8 row_mask:0xf bank_mask:0xf
    v_add_f32_dpp v58, v58, v58 row_ror:8 row_mask:0xf bank_mask:0xf
    v_add_f32_dpp v59, v59, v59 row_ror:8 row_mask:0xf bank_mask:0xf
    v_add_f32_dpp v60, v60, v60 row_ror:8 row_mask:0xf bank_mask:0xf
    v_add_f32_dpp v61, v61, v61 row_ror:8 row_mask:0xf bank_mask:0xf
    v_add_f32_dpp v62, v62, v62 row_ror:8 row_mask:0xf bank_mask:0xf
    v_add_f32_dpp v63, v63, v63 row_ror:8 row_mask:0xf bank_mask:0xf
    v_lshrrev_b32 v66, 4, v0
    v_lshlrev_b32 v66, 7, v66
    v_lshl_add_u32 v66, v1, 5, v66
    v_and_b32 v67, 15, v0
    v_cmp_gt_u32 vcc, 4, v67
    s_and_saveexec_b64 s[28:29], vcc
    ds_write_b128 v66, v[56:59]
    ds_write_b128 v66, v[60:63] offset:16
    s_or_b64 exec, exec, s[28:29]
    s_waitcnt lgkmcnt(0)
    s_barrier
    v_cmp_gt_u32 vcc, 32, v0
    s_and_saveexec_b64 s[28:29], vcc
    s_cbranch_execz K0_end
    v_lshlrev_b32 v66, 2, v0
    ds_read_b32 v16, v66 offset:0
    ds_read_b32 v17, v66 offset:128
    ds_read_b32 v18, v66 offset:256
    ds_read_b32 v19, v66 offset:384
    ds_read_b32 v20, v66 offset:512
    ds_read_b32 v21, v66 offset:640
    ds_read_b32 v22, v66 offset:768
    ds_read_b32 v23, v66 offset:896
    ds_read_b32 v24, v66 offset:1024
    ds_read_b32 v25, v66 offset:1152
    ds_read_b32 v26, v66 offset:1280
    ds_read_b32 v27, v66 offset:1408
    ds_read_b32 v28, v66 offset:1536
    ds_read_b32 v29, v66 offset:1664
    ds_read_b32 v30, v66 offset:1792
    ds_read_b32 v31, v66 offset:1920
    s_waitcnt lgkmcnt(0)
    v_add_f32 v16, v16, v24
    v_add_f32 v17, v17, v25
    v_add_f32 v18, v18, v26
    v_add_f32 v19, v19, v27
    v_add_f32 v20, v20, v28
    v_add_f32 v21, v21, v29
    v_add_f32 v22, v22, v30
    v_add_f32 v23, v23, v31
    v_add_f32 v16, v16, v20
    v_add_f32 v17, v17, v21
    v_add_f32 v18, v18, v22
    v_add_f32 v19, v19, v23
    v_add_f32 v16, v16, v18
    v_add_f32 v17, v17, v19
    v_add_f32 v16, v16, v17
    v_cvt_pk_bf16_f32 v16, v16, v16
    v_lshlrev_b32 v16, 16, v16
    v_add_f32 v17, 1.0, v16
    v_cvt_pk_bf16_f32 v17, v17, v17
    v_lshlrev_b32 v17, 16, v17
    s_cmp_ge_u32 s2, 18
    s_cselect_b32 s30, 1, 0
    s_cmp_lt_u32 s2, 36
    s_cselect_b32 s31, 1, 0
    s_and_b32 s30, s30, s31
    s_cmp_ge_u32 s2, 72
    s_cselect_b32 s32, 1, 0
    s_cmp_lt_u32 s2, 90
    s_cselect_b32 s31, 1, 0
    s_and_b32 s32, s32, s31
    s_or_b32 s30, s30, s32
    s_cmp_lg_u32 s30, 0
    s_cbranch_scc0 K0_nop1
    v_mov_b32 v16, v17
K0_nop1:
    s_lshl_b32 s25, s2, 7
    buffer_store_dword v16, v66, s[20:23], s25 offen
    s_cmp_ge_u32 s2, 36
    s_cbranch_scc1 K0_noq
    s_mov_b32 s30, 1040356334
    v_mul_f32 v17, s30, v16
    s_add_u32 s25, s25, 13824
    buffer_store_dword v17, v66, s[20:23], s25 offen sc0 sc1
K0_noq:
    s_waitcnt vmcnt(0)
K0_end:
    s_endpgm
K0_ln:
    s_cmp_ge_u32 s2, 172
    s_cbranch_scc1 K0_cpf
    s_load_dwordx2 s[4:5], s[0:1], 0
    s_load_dwordx2 s[8:9], s[0:1], 112
    s_sub_u32 s3, s2, 108
    v_lshrrev_b32 v1, 3, v0
    v_and_b32 v2, 7, v0
    s_waitcnt lgkmcnt(0)
    s_mov_b32 s12, s4
    s_mov_b32 s13, s5
    s_mov_b32 s14, 2359296
    s_mov_b32 s15, 0x00020000
    s_add_u32 s16, s8, 79691776
    s_addc_u32 s17, s9, 0
    s_mov_b32 s18, 2359296
    s_mov_b32 s19, 0x00020000
    s_mov_b32 s24, 1152
    v_mul_lo_u32 v3, v1, s24
    v_lshl_add_u32 v3, v2, 4, v3
    s_mul_i32 s25, s3, 36864
    buffer_load_dwordx4 v[8:11], v3, s[12:15], s25 offen offset:0
    buffer_load_dwordx4 v[12:15], v3, s[12:15], s25 offen offset:128
    buffer_load_dwordx4 v[16:19], v3, s[12:15], s25 offen offset:256
    buffer_load_dwordx4 v[20:23], v3, s[12:15], s25 offen offset:384
    buffer_load_dwordx4 v[24:27], v3, s[12:15], s25 offen offset:512
    buffer_load_dwordx4 v[28:31], v3, s[12:15], s25 offen offset:640
    buffer_load_dwordx4 v[32:35], v3, s[12:15], s25 offen offset:768
    buffer_load_dwordx4 v[36:39], v3, s[12:15], s25 offen offset:896
    buffer_load_dwordx4 v[40:43], v3, s[12:15], s25 offen offset:1024
    v_lshrrev_b32 v4, 4, v1
    v_mul_u32_u24 v4, 18, v4
    v_lshrrev_b32 v5, 2, v2
    v_add_u32 v4, v4, v5
    v_lshlrev_b32 v4, 10, v4
    v_and_b32 v5, 3, v2
    v_lshl_add_u32 v4, v5, 8, v4
    v_and_b32 v5, 15, v1
    v_lshl_add_u32 v4, v5, 4, v4
    v_mov_b32 v6, 0
    v_mov_b32 v7, 0
    s_mov_b32 s26, 0x3f803f80
    s_waitcnt vmcnt(0)
    v_dot2c_f32_bf16 v6, s26, v8
    v_dot2c_f32_bf16 v7, v8, v8
    v_dot2c_f32_bf16 v6, s26, v9
    v_dot2c_f32_bf16 v7, v9, v9
    v_dot2c_f32_bf16 v6, s26, v10
    v_dot2c_f32_bf16 v7, v10, v10
    v_dot2c_f32_bf16 v6, s26, v11
    v_dot2c_f32_bf16 v7, v11, v11
    v_dot2c_f32_bf16 v6, s26, v12
    v_dot2c_f32_bf16 v7, v12, v12
    v_dot2c_f32_bf16 v6, s26, v13
    v_dot2c_f32_bf16 v7, v13, v13
    v_dot2c_f32_bf16 v6, s26, v14
    v_dot2c_f32_bf16 v7, v14, v14
    v_dot2c_f32_bf16 v6, s26, v15
    v_dot2c_f32_bf16 v7, v15, v15
    v_dot2c_f32_bf16 v6, s26, v16
    v_dot2c_f32_bf16 v7, v16, v16
    v_dot2c_f32_bf16 v6, s26, v17
    v_dot2c_f32_bf16 v7, v17, v17
    v_dot2c_f32_bf16 v6, s26, v18
    v_dot2c_f32_bf16 v7, v18, v18
    v_dot2c_f32_bf16 v6, s26, v19
    v_dot2c_f32_bf16 v7, v19, v19
    v_dot2c_f32_bf16 v6, s26, v20
    v_dot2c_f32_bf16 v7, v20, v20
    v_dot2c_f32_bf16 v6, s26, v21
    v_dot2c_f32_bf16 v7, v21, v21
    v_dot2c_f32_bf16 v6, s26, v22
    v_dot2c_f32_bf16 v7, v22, v22
    v_dot2c_f32_bf16 v6, s26, v23
    v_dot2c_f32_bf16 v7, v23, v23
    v_dot2c_f32_bf16 v6, s26, v24
    v_dot2c_f32_bf16 v7, v24, v24
    v_dot2c_f32_bf16 v6, s26, v25
    v_dot2c_f32_bf16 v7, v25, v25
    v_dot2c_f32_bf16 v6, s26, v26
    v_dot2c_f32_bf16 v7, v26, v26
    v_dot2c_f32_bf16 v6, s26, v27
    v_dot2c_f32_bf16 v7, v27, v27
    v_dot2c_f32_bf16 v6, s26, v28
    v_dot2c_f32_bf16 v7, v28, v28
    v_dot2c_f32_bf16 v6, s26, v29
    v_dot2c_f32_bf16 v7, v29, v29
    v_dot2c_f32_bf16 v6, s26, v30
    v_dot2c_f32_bf16 v7, v30, v30
    v_dot2c_f32_bf16 v6, s26, v31
    v_dot2c_f32_bf16 v7, v31, v31
    v_dot2c_f32_bf16 v6, s26, v32
    v_dot2c_f32_bf16 v7, v32, v32
    v_dot2c_f32_bf16 v6, s26, v33
    v_dot2c_f32_bf16 v7, v33, v33
    v_dot2c_f32_bf16 v6, s26, v34
    v_dot2c_f32_bf16 v7, v34, v34
    v_dot2c_f32_bf16 v6, s26, v35
    v_dot2c_f32_bf16 v7, v35, v35
    v_dot2c_f32_bf16 v6, s26, v36
    v_dot2c_f32_bf16 v7, v36, v36
    v_dot2c_f32_bf16 v6, s26, v37
    v_dot2c_f32_bf16 v7, v37, v37
    v_dot2c_f32_bf16 v6, s26, v38
    v_dot2c_f32_bf16 v7, v38, v38
    v_dot2c_f32_bf16 v6, s26, v39
    v_dot2c_f32_bf16 v7, v39, v39
    v_dot2c_f32_bf16 v6, s26, v40
    v_dot2c_f32_bf16 v7, v40, v40
    v_dot2c_f32_bf16 v6, s26, v41
    v_dot2c_f32_bf16 v7, v41, v41
    v_dot2c_f32_bf16 v6, s26, v42
    v_dot2c_f32_bf16 v7, v42, v42
    v_dot2c_f32_bf16 v6, s26, v43
    v_dot2c_f32_bf16 v7, v43, v43
    s_nop 3
    v_add_f32_dpp v6, v6, v6 quad_perm:[1,0,3,2] row_mask:0xf bank_mask:0xf
    v_add_f32_dpp v7, v7, v7 quad_perm:[1,0,3,2] row_mask:0xf bank_mask:0xf
    s_nop 1
    v_add_f32_dpp v6, v6, v6 quad_perm:[2,3,0,1] row_mask:0xf bank_mask:0xf
    v_add_f32_dpp v7, v7, v7 quad_perm:[2,3,0,1] row_mask:0xf bank_mask:0xf
    s_nop 1
    v_add_f32_dpp v6, v6, v6 row_half_mirror row_mask:0xf bank_mask:0xf
    v_add_f32_dpp v7, v7, v7 row_half_mirror row_mask:0xf bank_mask:0xf
    s_nop 1
    s_mov_b32 s26, 987991609
    v_mul_f32 v6, s26, v6
    v_mul_f32 v7, s26, v7
    v_fma_f32 v7, -v6, v6, v7
    v_max_f32 v7, 0, v7
    v_add_f32 v7, 925353388, v7
    v_rsq_f32 v7, v7
    s_nop 0
    v_mul_f32 v6, v6, v7
    v_lshlrev_b32 v44, 16, v8
    v_and_b32 v45, 0xffff0000, v8
    v_fma_f32 v44, v44, v7, -v6
    v_fma_f32 v45, v45, v7, -v6
    v_cvt_pk_bf16_f32 v8, v44, v45
    v_lshlrev_b32 v44, 16, v9
    v_and_b32 v45, 0xffff0000, v9
    v_fma_f32 v44, v44, v7, -v6
    v_fma_f32 v45, v45, v7, -v6
    v_cvt_pk_bf16_f32 v9, v44, v45
    v_lshlrev_b32 v44, 16, v10
    v_and_b32 v45, 0xffff0000, v10
    v_fma_f32 v44, v44, v7, -v6
    v_fma_f32 v45, v45, v7, -v6
    v_cvt_pk_bf16_f32 v10, v44, v45
    v_lshlrev_b32 v44, 16, v11
    v_and_b32 v45, 0xffff0000, v11
    v_fma_f32 v44, v44, v7, -v6
    v_fma_f32 v45, v45, v7, -v6
    v_cvt_pk_bf16_f32 v11, v44, v45
    v_lshlrev_b32 v44, 16, v12
    v_and_b32 v45, 0xffff0000, v12
    v_fma_f32 v44, v44, v7, -v6
    v_fma_f32 v45, v45, v7, -v6
    v_cvt_pk_bf16_f32 v12, v44, v45
    v_lshlrev_b32 v44, 16, v13
    v_and_b32 v45, 0xffff0000, v13
    v_fma_f32 v44, v44, v7, -v6
    v_fma_f32 v45, v45, v7, -v6
    v_cvt_pk_bf16_f32 v13, v44, v45
    v_lshlrev_b32 v44, 16, v14
    v_and_b32 v45, 0xffff0000, v14
    v_fma_f32 v44, v44, v7, -v6
    v_fma_f32 v45, v45, v7, -v6
    v_cvt_pk_bf16_f32 v14, v44, v45
    v_lshlrev_b32 v44, 16, v15
    v_and_b32 v45, 0xffff0000, v15
    v_fma_f32 v44, v44, v7, -v6
    v_fma_f32 v45, v45, v7, -v6
    v_cvt_pk_bf16_f32 v15, v44, v45
    v_lshlrev_b32 v44, 16, v16
    v_and_b32 v45, 0xffff0000, v16
    v_fma_f32 v44, v44, v7, -v6
    v_fma_f32 v45, v45, v7, -v6
    v_cvt_pk_bf16_f32 v16, v44, v45
    v_lshlrev_b32 v44, 16, v17
    v_and_b32 v45, 0xffff0000, v17
    v_fma_f32 v44, v44, v7, -v6
    v_fma_f32 v45, v45, v7, -v6
    v_cvt_pk_bf16_f32 v17, v44, v45
    v_lshlrev_b32 v44, 16, v18
    v_and_b32 v45, 0xffff0000, v18
    v_fma_f32 v44, v44, v7, -v6
    v_fma_f32 v45, v45, v7, -v6
    v_cvt_pk_bf16_f32 v18, v44, v45
    v_lshlrev_b32 v44, 16, v19
    v_and_b32 v45, 0xffff0000, v19
    v_fma_f32 v44, v44, v7, -v6
    v_fma_f32 v45, v45, v7, -v6
    v_cvt_pk_bf16_f32 v19, v44, v45
    v_lshlrev_b32 v44, 16, v20
    v_and_b32 v45, 0xffff0000, v20
    v_fma_f32 v44, v44, v7, -v6
    v_fma_f32 v45, v45, v7, -v6
    v_cvt_pk_bf16_f32 v20, v44, v45
    v_lshlrev_b32 v44, 16, v21
    v_and_b32 v45, 0xffff0000, v21
    v_fma_f32 v44, v44, v7, -v6
    v_fma_f32 v45, v45, v7, -v6
    v_cvt_pk_bf16_f32 v21, v44, v45
    v_lshlrev_b32 v44, 16, v22
    v_and_b32 v45, 0xffff0000, v22
    v_fma_f32 v44, v44, v7, -v6
    v_fma_f32 v45, v45, v7, -v6
    v_cvt_pk_bf16_f32 v22, v44, v45
    v_lshlrev_b32 v44, 16, v23
    v_and_b32 v45, 0xffff0000, v23
    v_fma_f32 v44, v44, v7, -v6
    v_fma_f32 v45, v45, v7, -v6
    v_cvt_pk_bf16_f32 v23, v44, v45
    v_lshlrev_b32 v44, 16, v24
    v_and_b32 v45, 0xffff0000, v24
    v_fma_f32 v44, v44, v7, -v6
    v_fma_f32 v45, v45, v7, -v6
    v_cvt_pk_bf16_f32 v24, v44, v45
    v_lshlrev_b32 v44, 16, v25
    v_and_b32 v45, 0xffff0000, v25
    v_fma_f32 v44, v44, v7, -v6
    v_fma_f32 v45, v45, v7, -v6
    v_cvt_pk_bf16_f32 v25, v44, v45
    v_lshlrev_b32 v44, 16, v26
    v_and_b32 v45, 0xffff0000, v26
    v_fma_f32 v44, v44, v7, -v6
    v_fma_f32 v45, v45, v7, -v6
    v_cvt_pk_bf16_f32 v26, v44, v45
    v_lshlrev_b32 v44, 16, v27
    v_and_b32 v45, 0xffff0000, v27
    v_fma_f32 v44, v44, v7, -v6
    v_fma_f32 v45, v45, v7, -v6
    v_cvt_pk_bf16_f32 v27, v44, v45
    v_lshlrev_b32 v44, 16, v28
    v_and_b32 v45, 0xffff0000, v28
    v_fma_f32 v44, v44, v7, -v6
    v_fma_f32 v45, v45, v7, -v6
    v_cvt_pk_bf16_f32 v28, v44, v45
    v_lshlrev_b32 v44, 16, v29
    v_and_b32 v45, 0xffff0000, v29
    v_fma_f32 v44, v44, v7, -v6
    v_fma_f32 v45, v45, v7, -v6
    v_cvt_pk_bf16_f32 v29, v44, v45
    v_lshlrev_b32 v44, 16, v30
    v_and_b32 v45, 0xffff0000, v30
    v_fma_f32 v44, v44, v7, -v6
    v_fma_f32 v45, v45, v7, -v6
    v_cvt_pk_bf16_f32 v30, v44, v45
    v_lshlrev_b32 v44, 16, v31
    v_and_b32 v45, 0xffff0000, v31
    v_fma_f32 v44, v44, v7, -v6
    v_fma_f32 v45, v45, v7, -v6
    v_cvt_pk_bf16_f32 v31, v44, v45
    v_lshlrev_b32 v44, 16, v32
    v_and_b32 v45, 0xffff0000, v32
    v_fma_f32 v44, v44, v7, -v6
    v_fma_f32 v45, v45, v7, -v6
    v_cvt_pk_bf16_f32 v32, v44, v45
    v_lshlrev_b32 v44, 16, v33
    v_and_b32 v45, 0xffff0000, v33
    v_fma_f32 v44, v44, v7, -v6
    v_fma_f32 v45, v45, v7, -v6
    v_cvt_pk_bf16_f32 v33, v44, v45
    v_lshlrev_b32 v44, 16, v34
    v_and_b32 v45, 0xffff0000, v34
    v_fma_f32 v44, v44, v7, -v6
    v_fma_f32 v45, v45, v7, -v6
    v_cvt_pk_bf16_f32 v34, v44, v45
    v_lshlrev_b32 v44, 16, v35
    v_and_b32 v45, 0xffff0000, v35
    v_fma_f32 v44, v44, v7, -v6
    v_fma_f32 v45, v45, v7, -v6
    v_cvt_pk_bf16_f32 v35, v44, v45
    v_lshlrev_b32 v44, 16, v36
    v_and_b32 v45, 0xffff0000, v36
    v_fma_f32 v44, v44, v7, -v6
    v_fma_f32 v45, v45, v7, -v6
    v_cvt_pk_bf16_f32 v36, v44, v45
    v_lshlrev_b32 v44, 16, v37
    v_and_b32 v45, 0xffff0000, v37
    v_fma_f32 v44, v44, v7, -v6
    v_fma_f32 v45, v45, v7, -v6
    v_cvt_pk_bf16_f32 v37, v44, v45
    v_lshlrev_b32 v44, 16, v38
    v_and_b32 v45, 0xffff0000, v38
    v_fma_f32 v44, v44, v7, -v6
    v_fma_f32 v45, v45, v7, -v6
    v_cvt_pk_bf16_f32 v38, v44, v45
    v_lshlrev_b32 v44, 16, v39
    v_and_b32 v45, 0xffff0000, v39
    v_fma_f32 v44, v44, v7, -v6
    v_fma_f32 v45, v45, v7, -v6
    v_cvt_pk_bf16_f32 v39, v44, v45
    v_lshlrev_b32 v44, 16, v40
    v_and_b32 v45, 0xffff0000, v40
    v_fma_f32 v44, v44, v7, -v6
    v_fma_f32 v45, v45, v7, -v6
    v_cvt_pk_bf16_f32 v40, v44, v45
    v_lshlrev_b32 v44, 16, v41
    v_and_b32 v45, 0xffff0000, v41
    v_fma_f32 v44, v44, v7, -v6
    v_fma_f32 v45, v45, v7, -v6
    v_cvt_pk_bf16_f32 v41, v44, v45
    v_lshlrev_b32 v44, 16, v42
    v_and_b32 v45, 0xffff0000, v42
    v_fma_f32 v44, v44, v7, -v6
    v_fma_f32 v45, v45, v7, -v6
    v_cvt_pk_bf16_f32 v42, v44, v45
    v_lshlrev_b32 v44, 16, v43
    v_and_b32 v45, 0xffff0000, v43
    v_fma_f32 v44, v44, v7, -v6
    v_fma_f32 v45, v45, v7, -v6
    v_cvt_pk_bf16_f32 v43, v44, v45
    s_mul_i32 s25, s3, 36864
    buffer_store_dwordx4 v[8:11], v4, s[16:19], s25 offen sc0 sc1
    s_add_u32 s25, s25, 2048
    buffer_store_dwordx4 v[12:15], v4, s[16:19], s25 offen sc0 sc1
    s_add_u32 s25, s25, 2048
    buffer_store_dwordx4 v[16:19], v4, s[16:19], s25 offen sc0 sc1
    s_add_u32 s25, s25, 2048
    buffer_store_dwordx4 v[20:23], v4, s[16:19], s25 offen sc0 sc1
    s_add_u32 s25, s25, 2048
    buffer_store_dwordx4 v[24:27], v4, s[16:19], s25 offen sc0 sc1
    s_add_u32 s25, s25, 2048
    buffer_store_dwordx4 v[28:31], v4, s[16:19], s25 offen sc0 sc1
    s_add_u32 s25, s25, 2048
    buffer_store_dwordx4 v[32:35], v4, s[16:19], s25 offen sc0 sc1
    s_add_u32 s25, s25, 2048
    buffer_store_dwordx4 v[36:39], v4, s[16:19], s25 offen sc0 sc1
    s_add_u32 s25, s25, 2048
    buffer_store_dwordx4 v[40:43], v4, s[16:19], s25 offen sc0 sc1
    s_waitcnt vmcnt(0)
K0_end2:
    s_endpgm
K0_cpf:
    s_cmp_ge_u32 s2, 184
    s_cbranch_scc1 K0_dpf
    s_getpc_b64 s[4:5]
K0_pcref:
    s_sub_u32 s3, s2, 172
    s_lshl_b32 s3, s3, 14
    s_add_u32 s3, s3, k1_attn_kernel-K0_pcref
    s_add_u32 s4, s4, s3
    s_addc_u32 s5, s5, 0
    v_lshlrev_b32 v1, 4, v0
    s_sub_u32 s6, s2, 172
    s_lshl_b32 s6, s6, 14
    v_add_u32 v2, 0, v1
    v_add_u32 v3, s6, v2
    v_cmp_gt_u32 vcc, CODE_END-k1_attn_kernel-16, v3
    s_and_saveexec_b64 s[8:9], vcc
    s_cbranch_execz K0_cskip0
    global_load_dwordx4 v[8:11], v2, s[4:5]
K0_cskip0:
    s_or_b64 exec, exec, s[8:9]
    v_add_u32 v2, 4096, v1
    v_add_u32 v3, s6, v2
    v_cmp_gt_u32 vcc, CODE_END-k1_attn_kernel-16, v3
    s_and_saveexec_b64 s[8:9], vcc
    s_cbranch_execz K0_cskip1
    global_load_dwordx4 v[12:15], v2, s[4:5]
K0_cskip1:
    s_or_b64 exec, exec, s[8:9]
    v_add_u32 v2, 8192, v1
    v_add_u32 v3, s6, v2
    v_cmp_gt_u32 vcc, CODE_END-k1_attn_kernel-16, v3
    s_and_saveexec_b64 s[8:9], vcc
    s_cbranch_execz K0_cskip2
    global_load_dwordx4 v[16:19], v2, s[4:5]
K0_cskip2:
    s_or_b64 exec, exec, s[8:9]
    v_add_u32 v2, 12288, v1
    v_add_u32 v3, s6, v2
    v_cmp_gt_u32 vcc, CODE_END-k1_attn_kernel-16, v3
    s_and_saveexec_b64 s[8:9], vcc
    s_cbranch_execz K0_cskip3
    global_load_dwordx4 v[20:23], v2, s[4:5]
K0_cskip3:
    s_or_b64 exec, exec, s[8:9]
    s_waitcnt vmcnt(0)
K0_end3:
    s_endpgm
K0_dpf:
    s_cmp_ge_u32 s2, 184
    s_cbranch_scc1 K0_end4
    s_load_dwordx2 s[4:5], s[0:1], 24
    s_load_dwordx2 s[6:7], s[0:1], 8
    s_load_dwordx2 s[8:9], s[0:1], 16
    s_sub_u32 s3, s2, 184
    v_lshlrev_b32 v1, 4, v0
    s_waitcnt lgkmcnt(0)
    s_mov_b32 s12, s4
    s_mov_b32 s13, s5
    s_mov_b32 s14, 4718592
    s_mov_b32 s15, 0x00020000
    s_mov_b32 s16, s6
    s_mov_b32 s17, s7
    s_mov_b32 s18, 8388608
    s_mov_b32 s19, 0x00020000
    s_mov_b32 s20, s8
    s_mov_b32 s21, s9
    s_mov_b32 s22, 8388608
    s_mov_b32 s23, 0x00020000
    s_cmp_ge_u32 s3, 72
    s_cbranch_scc1 K0_dkv
    s_lshl_b32 s24, s3, 16
    buffer_load_dwordx4 v[4:7], v1, s[12:15], s24 offen
    s_add_u32 s24, s24, 4096
    buffer_load_dwordx4 v[8:11], v1, s[12:15], s24 offen
    s_add_u32 s24, s24, 4096
    buffer_load_dwordx4 v[12:15], v1, s[12:15], s24 offen
    s_add_u32 s24, s24, 4096
    buffer_load_dwordx4 v[16:19], v1, s[12:15], s24 offen
    s_add_u32 s24, s24, 4096
    buffer_load_dwordx4 v[20:23], v1, s[12:15], s24 offen
    s_add_u32 s24, s24, 4096
    buffer_load_dwordx4 v[24:27], v1, s[12:15], s24 offen
    s_add_u32 s24, s24, 4096
    buffer_load_dwordx4 v[28:31], v1, s[12:15], s24 offen
    s_add_u32 s24, s24, 4096
    buffer_load_dwordx4 v[32:35], v1, s[12:15], s24 offen
    s_add_u32 s24, s24, 4096
    buffer_load_dwordx4 v[36:39], v1, s[12:15], s24 offen
    s_add_u32 s24, s24, 4096
    buffer_load_dwordx4 v[40:43], v1, s[12:15], s24 offen
    s_add_u32 s24, s24, 4096
    buffer_load_dwordx4 v[44:47], v1, s[12:15], s24 offen
    s_add_u32 s24, s24, 4096
    buffer_load_dwordx4 v[48:51], v1, s[12:15], s24 offen
    s_add_u32 s24, s24, 4096
    buffer_load_dwordx4 v[52:55], v1, s[12:15], s24 offen
    s_add_u32 s24, s24, 4096
    buffer_load_dwordx4 v[56:59], v1, s[12:15], s24 offen
    s_add_u32 s24, s24, 4096
    buffer_load_dwordx4 v[60:63], v1, s[12:15], s24 offen
    s_add_u32 s24, s24, 4096
    buffer_load_dwordx4 v[64:67], v1, s[12:15], s24 offen
    s_add_u32 s24, s24, 4096
    s_waitcnt vmcnt(0)
    s_endpgm
K0_dkv:
    s_sub_u32 s3, s3, 72
    s_and_b32 s24, s3, 15
    s_lshl_b32 s24, s24, 19
    s_lshr_b32 s25, s3, 4
    s_lshl_b32 s25, s25, 15
    s_add_u32 s24, s24, s25
    buffer_load_dwordx4 v[4:7], v1, s[16:19], s24 offen
    buffer_load_dwordx4 v[8:11], v1, s[20:23], s24 offen
    s_add_u32 s24, s24, 4096
    buffer_load_dwordx4 v[12:15], v1, s[16:19], s24 offen
    buffer_load_dwordx4 v[16:19], v1, s[20:23], s24 offen
    s_add_u32 s24, s24, 4096
    buffer_load_dwordx4 v[20:23], v1, s[16:19], s24 offen
    buffer_load_dwordx4 v[24:27], v1, s[20:23], s24 offen
    s_add_u32 s24, s24, 4096
    buffer_load_dwordx4 v[28:31], v1, s[16:19], s24 offen
    buffer_load_dwordx4 v[32:35], v1, s[20:23], s24 offen
    s_add_u32 s24, s24, 4096
    buffer_load_dwordx4 v[36:39], v1, s[16:19], s24 offen
    buffer_load_dwordx4 v[40:43], v1, s[20:23], s24 offen
    s_add_u32 s24, s24, 4096
    buffer_load_dwordx4 v[44:47], v1, s[16:19], s24 offen
    buffer_load_dwordx4 v[48:51], v1, s[20:23], s24 offen
    s_add_u32 s24, s24, 4096
    buffer_load_dwordx4 v[52:55], v1, s[16:19], s24 offen
    buffer_load_dwordx4 v[56:59], v1, s[20:23], s24 offen
    s_add_u32 s24, s24, 4096
    buffer_load_dwordx4 v[60:63], v1, s[16:19], s24 offen
    buffer_load_dwordx4 v[64:67], v1, s[20:23], s24 offen
    s_add_u32 s24, s24, 4096
    s_waitcnt vmcnt(0)
K0_end4:
    s_endpgm
.text
.globl k1_attn_kernel
.p2align 8
.type k1_attn_kernel,@function
k1_attn_kernel:
    s_cmp_ge_u32 s2, 256
    s_cbranch_scc1 K1_end
    s_load_dwordx2 s[10:11], s[0:1], 112
    s_load_dwordx2 s[8:9], s[0:1], 24
    s_load_dwordx2 s[4:5], s[0:1], 8
    s_load_dwordx2 s[6:7], s[0:1], 16
    v_and_b32 v1, 63, v0
    v_lshrrev_b32 v2, 6, v0
    v_lshlrev_b32 v3, 4, v1
    v_readfirstlane_b32 s3, v2
    s_and_b32 s42, s2, 7
    s_lshl_b32 s42, s42, 1
    s_bfe_u32 s43, s2, 0x10003
    s_add_u32 s42, s42, s43
    s_lshr_b32 s43, s2, 4
    v_and_b32 v4, 15, v1
    v_lshrrev_b32 v5, 4, v1
    v_lshlrev_b32 v6, 2, v5
    v_xor_b32 v6, v6, v4
    v_xor_b32 v7, 2, v6
    v_lshlrev_b32 v6, 4, v6
    v_lshlrev_b32 v7, 4, v7
    s_lshl_b32 s39, s3, 4
    v_add_u32 v2, s39, v5
    v_lshl_add_u32 v24, v2, 13, v6
    v_lshl_add_u32 v25, v2, 13, v7
    s_lshl_b32 s39, s3, 3
    v_add_u32 v2, s39, v5
    v_lshl_add_u32 v22, v2, 8, v6
    v_lshl_add_u32 v23, v2, 8, v7
    v_and_b32 v6, 15, v2
    v_xor_b32 v6, v6, v4
    v_lshlrev_b32 v6, 4, v6
    v_lshl_add_u32 v20, v2, 8, v6
    v_add_u32 v6, 4, v2
    v_and_b32 v6, 15, v6
    v_xor_b32 v6, v6, v4
    v_lshlrev_b32 v6, 4, v6
    v_lshl_add_u32 v21, v2, 8, v6
    s_lshl_b32 s44, s3, 12
    s_lshl_b32 s45, s3, 11
    s_lshl_b32 s49, s43, 3
    s_lshl_b32 s39, s3, 1
    s_add_u32 s49, s49, s39
    s_mul_i32 s48, s49, 18432
    v_add_u32 v43, 18432, v3
    s_waitcnt lgkmcnt(0)
    s_add_u32 s24, s10, 79691776
    s_addc_u32 s25, s11, 0
    s_mov_b32 s26, 2359296
    s_mov_b32 s27, 0x00020000
    s_add_u32 s28, s10, 13824
    s_addc_u32 s29, s11, 0
    s_mov_b32 s30, 4608
    s_mov_b32 s31, 0x00020000
    s_lshl_b32 s39, s42, 9
    s_add_u32 s20, s8, s39
    s_addc_u32 s21, s9, 0
    s_mov_b32 s22, 4710912
    s_mov_b32 s23, 0x00020000
    s_lshl_b32 s39, s3, 10
    s_add_u32 m0, s39, 131072
    s_nop 0
    buffer_load_dwordx4 v3, s[28:31], s39 offen lds
    s_mov_b32 m0, 135168
    s_mov_b32 s39, 4096
    buffer_load_dwordx4 v3, s[28:31], s39 offen lds
    buffer_load_dwordx4 v[64:67], v3, s[24:27], s48 offen offset:0
    buffer_load_dwordx4 v[68:71], v43, s[24:27], s48 offen offset:0
    buffer_load_dwordx4 v[72:75], v3, s[24:27], s48 offen offset:1024
    buffer_load_dwordx4 v[76:79], v43, s[24:27], s48 offen offset:1024
    s_add_u32 s48, s48, 2048
    s_add_u32 m0, s44, 0
    s_mov_b32 s39, 0
    buffer_load_dwordx4 v24, s[20:23], s39 offen lds
    s_add_u32 m0, s44, 1024
    s_mov_b32 s39, 32768
    buffer_load_dwordx4 v24, s[20:23], s39 offen lds
    s_add_u32 m0, s44, 2048
    s_mov_b32 s39, 65536
    buffer_load_dwordx4 v25, s[20:23], s39 offen lds
    s_add_u32 m0, s44, 3072
    s_mov_b32 s39, 98304
    buffer_load_dwordx4 v25, s[20:23], s39 offen lds
    s_add_u32 m0, s44, 16384
    s_mov_b32 s39, 256
    buffer_load_dwordx4 v24, s[20:23], s39 offen lds
    s_add_u32 m0, s44, 17408
    s_mov_b32 s39, 33024
    buffer_load_dwordx4 v24, s[20:23], s39 offen lds
    s_add_u32 m0, s44, 18432
    s_mov_b32 s39, 65792
    buffer_load_dwordx4 v25, s[20:23], s39 offen lds
    s_add_u32 m0, s44, 19456
    s_mov_b32 s39, 98560
    buffer_load_dwordx4 v25, s[20:23], s39 offen lds
    buffer_load_dwordx4 v[80:83], v3, s[24:27], s48 offen offset:0
    buffer_load_dwordx4 v[84:87], v43, s[24:27], s48 offen offset:0
    buffer_load_dwordx4 v[88:91], v3, s[24:27], s48 offen offset:1024
    buffer_load_dwordx4 v[92:95], v43, s[24:27], s48 offen offset:1024
    s_add_u32 s48, s48, 2048
    s_add_u32 m0, s44, 32768
    s_mov_b32 s39, 524288
    buffer_load_dwordx4 v24, s[20:23], s39 offen lds
    s_add_u32 m0, s44, 33792
    s_mov_b32 s39, 557056
    buffer_load_dwordx4 v24, s[20:23], s39 offen lds
    s_add_u32 m0, s44, 34816
    s_mov_b32 s39, 589824
    buffer_load_dwordx4 v25, s[20:23], s39 offen lds
    s_add_u32 m0, s44, 35840
    s_mov_b32 s39, 622592
    buffer_load_dwordx4 v25, s[20:23], s39 offen lds
    s_add_u32 m0, s44, 49152
    s_mov_b32 s39, 524544
    buffer_load_dwordx4 v24, s[20:23], s39 offen lds
    s_add_u32 m0, s44, 50176
    s_mov_b32 s39, 557312
    buffer_load_dwordx4 v24, s[20:23], s39 offen lds
    s_add_u32 m0, s44, 51200
    s_mov_b32 s39, 590080
    buffer_load_dwordx4 v25, s[20:23], s39 offen lds
    s_add_u32 m0, s44, 52224
    s_mov_b32 s39, 622848
    buffer_load_dwordx4 v25, s[20:23], s39 offen lds
    buffer_load_dwordx4 v[96:99], v3, s[24:27], s48 offen offset:0
    buffer_load_dwordx4 v[100:103], v43, s[24:27], s48 offen offset:0
    buffer_load_dwordx4 v[104:107], v3, s[24:27], s48 offen offset:1024
    buffer_load_dwordx4 v[108:111], v43, s[24:27], s48 offen offset:1024
    s_add_u32 s48, s48, 2048
    s_add_u32 m0, s44, 65536
    s_mov_b32 s39, 1048576
    buffer_load_dwordx4 v24, s[20:23], s39 offen lds
    s_add_u32 m0, s44, 66560
    s_mov_b32 s39, 1081344
    buffer_load_dwordx4 v24, s[20:23], s39 offen lds
    s_add_u32 m0, s44, 67584
    s_mov_b32 s39, 1114112
    buffer_load_dwordx4 v25, s[20:23], s39 offen lds
    s_add_u32 m0, s44, 68608
    s_mov_b32 s39, 1146880
    buffer_load_dwordx4 v25, s[20:23], s39 offen lds
    s_add_u32 m0, s44, 81920
    s_mov_b32 s39, 1048832
    buffer_load_dwordx4 v24, s[20:23], s39 offen lds
    s_add_u32 m0, s44, 82944
    s_mov_b32 s39, 1081600
    buffer_load_dwordx4 v24, s[20:23], s39 offen lds
    s_add_u32 m0, s44, 83968
    s_mov_b32 s39, 1114368
    buffer_load_dwordx4 v25, s[20:23], s39 offen lds
    s_add_u32 m0, s44, 84992
    s_mov_b32 s39, 1147136
    buffer_load_dwordx4 v25, s[20:23], s39 offen lds
    s_lshl_b32 s39, s42, 19
    s_add_u32 s12, s4, s39
    s_addc_u32 s13, s5, 0
    s_mov_b32 s14, 524288
    s_mov_b32 s15, 0x00020000
    s_add_u32 s16, s6, s39
    s_addc_u32 s17, s7, 0
    s_mov_b32 s18, 524288
    s_mov_b32 s19, 0x00020000
    s_add_u32 s32, s10, 1048576
    s_addc_u32 s33, s11, 0
    s_mov_b32 s34, 16777216
    s_mov_b32 s35, 0x00020000
    s_load_dwordx2 s[50:51], s[0:1], 32
    s_load_dwordx2 s[52:53], s[0:1], 48
    s_load_dwordx2 s[54:55], s[0:1], 56
    s_load_dwordx2 s[56:57], s[0:1], 72
    s_mov_b32 s36, 0
    s_mov_b32 s37, 0
    v_xor_b32 v6, v4, v5
    v_xor_b32 v7, 0, v6
    v_lshlrev_b32 v7, 4, v7
    v_lshl_add_u32 v8, v4, 8, v7
    v_xor_b32 v7, 4, v6
    v_lshlrev_b32 v7, 4, v7
    v_lshl_add_u32 v9, v4, 8, v7
    v_xor_b32 v7, 8, v6
    v_lshlrev_b32 v7, 4, v7
    v_lshl_add_u32 v10, v4, 8, v7
    v_xor_b32 v7, 12, v6
    v_lshlrev_b32 v7, 4, v7
    v_lshl_add_u32 v11, v4, 8, v7
    v_bfe_u32 v4, v1, 2, 2
    v_and_b32 v7, 3, v1
    v_lshlrev_b32 v7, 3, v7
    v_and_b32 v6, 1, v5
    v_lshl_add_u32 v7, v6, 5, v7
    v_lshl_add_u32 v6, v5, 2, v4
    v_lshlrev_b32 v6, 8, v6
    v_add_u32 v6, 65536, v6
    v_lshl_add_u32 v2, v5, 3, v4
    v_lshlrev_b32 v2, 8, v2
    v_xor_b32 v44, 0, v4
    v_lshlrev_b32 v44, 6, v44
    v_xor_b32 v45, 0, v7
    v_add_u32 v44, v44, v45
    v_add_u32 v12, v44, v6
    v_add_u32 v26, v44, v2
    v_add_u32 v34, 65536, v26
    v_xor_b32 v44, 0, v4
    v_lshlrev_b32 v44, 6, v44
    v_xor_b32 v45, 32, v7
    v_add_u32 v44, v44, v45
    v_add_u32 v13, v44, v6
    v_add_u32 v27, v44, v2
    v_add_u32 v35, 65536, v27
    v_xor_b32 v44, 1, v4
    v_lshlrev_b32 v44, 6, v44
    v_xor_b32 v45, 0, v7
    v_add_u32 v44, v44, v45
    v_add_u32 v14, v44, v6
    v_add_u32 v28, v44, v2
    v_add_u32 v36, 65536, v28
    v_xor_b32 v44, 1, v4
    v_lshlrev_b32 v44, 6, v44
    v_xor_b32 v45, 32, v7
    v_add_u32 v44, v44, v45
    v_add_u32 v15, v44, v6
    v_add_u32 v29, v44, v2
    v_add_u32 v37, 65536, v29
    v_xor_b32 v44, 2, v4
    v_lshlrev_b32 v44, 6, v44
    v_xor_b32 v45, 0, v7
    v_add_u32 v44, v44, v45
    v_add_u32 v16, v44, v6
    v_add_u32 v30, v44, v2
    v_add_u32 v38, 65536, v30
    v_xor_b32 v44, 2, v4
    v_lshlrev_b32 v44, 6, v44
    v_xor_b32 v45, 32, v7
    v_add_u32 v44, v44, v45
    v_add_u32 v17, v44, v6
    v_add_u32 v31, v44, v2
    v_add_u32 v39, 65536, v31
    v_xor_b32 v44, 3, v4
    v_lshlrev_b32 v44, 6, v44
    v_xor_b32 v45, 0, v7
    v_add_u32 v44, v44, v45
    v_add_u32 v18, v44, v6
    v_add_u32 v32, v44, v2
    v_add_u32 v40, 65536, v32
    v_xor_b32 v44, 3, v4
    v_lshlrev_b32 v44, 6, v44
    v_xor_b32 v45, 32, v7
    v_add_u32 v44, v44, v45
    v_add_u32 v19, v44, v6
    v_add_u32 v33, v44, v2
    v_add_u32 v41, 65536, v33
    v_lshlrev_b32 v42, 5, v5
    v_add_u32 v42, 131072, v42
    v_accvgpr_write_b32 a0, 0
    v_accvgpr_write_b32 a1, 0
    v_accvgpr_write_b32 a2, 0
    v_accvgpr_write_b32 a3, 0
    v_accvgpr_write_b32 a4, 0
    v_accvgpr_write_b32 a5, 0
    v_accvgpr_write_b32 a6, 0
    v_accvgpr_write_b32 a7, 0
    v_accvgpr_write_b32 a8, 0
    v_accvgpr_write_b32 a9, 0
    v_accvgpr_write_b32 a10, 0
    v_accvgpr_write_b32 a11, 0
    v_accvgpr_write_b32 a12, 0
    v_accvgpr_write_b32 a13, 0
    v_accvgpr_write_b32 a14, 0
    v_accvgpr_write_b32 a15, 0
    v_accvgpr_write_b32 a16, 0
    v_accvgpr_write_b32 a17, 0
    v_accvgpr_write_b32 a18, 0
    v_accvgpr_write_b32 a19, 0
    v_accvgpr_write_b32 a20, 0
    v_accvgpr_write_b32 a21, 0
    v_accvgpr_write_b32 a22, 0
    v_accvgpr_write_b32 a23, 0
    v_accvgpr_write_b32 a24, 0
    v_accvgpr_write_b32 a25, 0
    v_accvgpr_write_b32 a26, 0
    v_accvgpr_write_b32 a27, 0
    v_accvgpr_write_b32 a28, 0
    v_accvgpr_write_b32 a29, 0
    v_accvgpr_write_b32 a30, 0
    v_accvgpr_write_b32 a31, 0
    v_accvgpr_write_b32 a32, 0
    v_accvgpr_write_b32 a33, 0
    v_accvgpr_write_b32 a34, 0
    v_accvgpr_write_b32 a35, 0
    v_accvgpr_write_b32 a36, 0
    v_accvgpr_write_b32 a37, 0
    v_accvgpr_write_b32 a38, 0
    v_accvgpr_write_b32 a39, 0
    v_accvgpr_write_b32 a40, 0
    v_accvgpr_write_b32 a41, 0
    v_accvgpr_write_b32 a42, 0
    v_accvgpr_write_b32 a43, 0
    v_accvgpr_write_b32 a44, 0
    v_accvgpr_write_b32 a45, 0
    v_accvgpr_write_b32 a46, 0
    v_accvgpr_write_b32 a47, 0
    v_accvgpr_write_b32 a48, 0
    v_accvgpr_write_b32 a49, 0
    v_accvgpr_write_b32 a50, 0
    v_accvgpr_write_b32 a51, 0
    v_accvgpr_write_b32 a52, 0
    v_accvgpr_write_b32 a53, 0
    v_accvgpr_write_b32 a54, 0
    v_accvgpr_write_b32 a55, 0
    v_accvgpr_write_b32 a56, 0
    v_accvgpr_write_b32 a57, 0
    v_accvgpr_write_b32 a58, 0
    v_accvgpr_write_b32 a59, 0
    v_accvgpr_write_b32 a60, 0
    v_accvgpr_write_b32 a61, 0
    v_accvgpr_write_b32 a62, 0
    v_accvgpr_write_b32 a63, 0
    v_accvgpr_write_b32 a64, 0
    v_accvgpr_write_b32 a65, 0
    v_accvgpr_write_b32 a66, 0
    v_accvgpr_write_b32 a67, 0
    v_accvgpr_write_b32 a68, 0
    v_accvgpr_write_b32 a69, 0
    v_accvgpr_write_b32 a70, 0
    v_accvgpr_write_b32 a71, 0
    v_accvgpr_write_b32 a72, 0
    v_accvgpr_write_b32 a73, 0
    v_accvgpr_write_b32 a74, 0
    v_accvgpr_write_b32 a75, 0
    v_accvgpr_write_b32 a76, 0
    v_accvgpr_write_b32 a77, 0
    v_accvgpr_write_b32 a78, 0
    v_accvgpr_write_b32 a79, 0
    v_accvgpr_write_b32 a80, 0
    v_accvgpr_write_b32 a81, 0
    v_accvgpr_write_b32 a82, 0
    v_accvgpr_write_b32 a83, 0
    v_accvgpr_write_b32 a84, 0
    v_accvgpr_write_b32 a85, 0
    v_accvgpr_write_b32 a86, 0
    v_accvgpr_write_b32 a87, 0
    v_accvgpr_write_b32 a88, 0
    v_accvgpr_write_b32 a89, 0
    v_accvgpr_write_b32 a90, 0
    v_accvgpr_write_b32 a91, 0
    v_accvgpr_write_b32 a92, 0
    v_accvgpr_write_b32 a93, 0
    v_accvgpr_write_b32 a94, 0
    v_accvgpr_write_b32 a95, 0
    v_accvgpr_write_b32 a96, 0
    v_accvgpr_write_b32 a97, 0
    v_accvgpr_write_b32 a98, 0
    v_accvgpr_write_b32 a99, 0
    v_accvgpr_write_b32 a100, 0
    v_accvgpr_write_b32 a101, 0
    v_accvgpr_write_b32 a102, 0
    v_accvgpr_write_b32 a103, 0
    v_accvgpr_write_b32 a104, 0
    v_accvgpr_write_b32 a105, 0
    v_accvgpr_write_b32 a106, 0
    v_accvgpr_write_b32 a107, 0
    v_accvgpr_write_b32 a108, 0
    v_accvgpr_write_b32 a109, 0
    v_accvgpr_write_b32 a110, 0
    v_accvgpr_write_b32 a111, 0
    v_accvgpr_write_b32 a112, 0
    v_accvgpr_write_b32 a113, 0
    v_accvgpr_write_b32 a114, 0
    v_accvgpr_write_b32 a115, 0
    v_accvgpr_write_b32 a116, 0
    v_accvgpr_write_b32 a117, 0
    v_accvgpr_write_b32 a118, 0
    v_accvgpr_write_b32 a119, 0
    v_accvgpr_write_b32 a120, 0
    v_accvgpr_write_b32 a121, 0
    v_accvgpr_write_b32 a122, 0
    v_accvgpr_write_b32 a123, 0
    v_accvgpr_write_b32 a124, 0
    v_accvgpr_write_b32 a125, 0
    v_accvgpr_write_b32 a126, 0
    v_accvgpr_write_b32 a127, 0
    s_waitcnt vmcnt(24) lgkmcnt(0)
    s_barrier
    ds_read_b128 v[208:211], v42 offset:0
    ds_read_b128 v[212:215], v42 offset:16
    ds_read_b128 v[216:219], v42 offset:2304
    ds_read_b128 v[220:223], v42 offset:2320
    ds_read_b128 v[224:227], v42 offset:128
    ds_read_b128 v[228:231], v42 offset:144
    ds_read_b128 v[232:235], v42 offset:2432
    ds_read_b128 v[236:239], v42 offset:2448
    ds_read_b64_tr_b16 a[192:193], v26 offset:0
    ds_read_b64_tr_b16 a[194:195], v26 offset:1024
    ds_read_b64_tr_b16 a[196:197], v27 offset:0
    ds_read_b64_tr_b16 a[198:199], v27 offset:1024
    ds_read_b64_tr_b16 a[200:201], v28 offset:0
    ds_read_b64_tr_b16 a[202:203], v28 offset:1024
    ds_read_b64_tr_b16 a[204:205], v29 offset:0
    ds_read_b64_tr_b16 a[206:207], v29 offset:1024
    ds_read_b64_tr_b16 a[208:209], v30 offset:0
    ds_read_b64_tr_b16 a[210:211], v30 offset:1024
    ds_read_b64_tr_b16 a[212:213], v31 offset:0
    ds_read_b64_tr_b16 a[214:215], v31 offset:1024
    ds_read_b64_tr_b16 a[216:217], v32 offset:0
    ds_read_b64_tr_b16 a[218:219], v32 offset:1024
    ds_read_b64_tr_b16 a[220:221], v33 offset:0
    ds_read_b64_tr_b16 a[222:223], v33 offset:1024
    s_waitcnt lgkmcnt(15)
    v_lshlrev_b32 v240, 16, v64
    v_and_b32 v241, 0xffff0000, v64
    v_fma_f32 v240, v240, v216, v208
    v_fma_f32 v241, v241, v217, v209
    v_cvt_pk_bf16_f32 v64, v240, v241
    v_lshlrev_b32 v242, 16, v65
    v_and_b32 v243, 0xffff0000, v65
    v_fma_f32 v242, v242, v218, v210
    v_fma_f32 v243, v243, v219, v211
    v_cvt_pk_bf16_f32 v65, v242, v243
    v_lshlrev_b32 v240, 16, v66
    v_and_b32 v241, 0xffff0000, v66
    v_fma_f32 v240, v240, v220, v212
    v_fma_f32 v241, v241, v221, v213
    v_cvt_pk_bf16_f32 v66, v240, v241
    v_lshlrev_b32 v242, 16, v67
    v_and_b32 v243, 0xffff0000, v67
    v_fma_f32 v242, v242, v222, v214
    v_fma_f32 v243, v243, v223, v215
    v_cvt_pk_bf16_f32 v67, v242, v243
    v_lshlrev_b32 v240, 16, v68
    v_and_b32 v241, 0xffff0000, v68
    v_fma_f32 v240, v240, v216, v208
    v_fma_f32 v241, v241, v217, v209
    v_cvt_pk_bf16_f32 v68, v240, v241
    v_lshlrev_b32 v242, 16, v69
    v_and_b32 v243, 0xffff0000, v69
    v_fma_f32 v242, v242, v218, v210
    v_fma_f32 v243, v243, v219, v211
    v_cvt_pk_bf16_f32 v69, v242, v243
    v_lshlrev_b32 v240, 16, v70
    v_and_b32 v241, 0xffff0000, v70
    v_fma_f32 v240, v240, v220, v212
    v_fma_f32 v241, v241, v221, v213
    v_cvt_pk_bf16_f32 v70, v240, v241
    v_lshlrev_b32 v242, 16, v71
    v_and_b32 v243, 0xffff0000, v71
    v_fma_f32 v242, v242, v222, v214
    v_fma_f32 v243, v243, v223, v215
    v_cvt_pk_bf16_f32 v71, v242, v243
    v_lshlrev_b32 v240, 16, v72
    v_and_b32 v241, 0xffff0000, v72
    v_fma_f32 v240, v240, v232, v224
    v_fma_f32 v241, v241, v233, v225
    v_cvt_pk_bf16_f32 v72, v240, v241
    v_lshlrev_b32 v242, 16, v73
    v_and_b32 v243, 0xffff0000, v73
    v_fma_f32 v242, v242, v234, v226
    v_fma_f32 v243, v243, v235, v227
    v_cvt_pk_bf16_f32 v73, v242, v243
    v_lshlrev_b32 v240, 16, v74
    v_and_b32 v241, 0xffff0000, v74
    v_fma_f32 v240, v240, v236, v228
    v_fma_f32 v241, v241, v237, v229
    v_cvt_pk_bf16_f32 v74, v240, v241
    v_lshlrev_b32 v242, 16, v75
    v_and_b32 v243, 0xffff0000, v75
    v_fma_f32 v242, v242, v238, v230
    v_fma_f32 v243, v243, v239, v231
    v_cvt_pk_bf16_f32 v75, v242, v243
    v_lshlrev_b32 v240, 16, v76
    v_and_b32 v241, 0xffff0000, v76
    v_fma_f32 v240, v240, v232, v224
    v_fma_f32 v241, v241, v233, v225
    v_cvt_pk_bf16_f32 v76, v240, v241
    v_lshlrev_b32 v242, 16, v77
    v_and_b32 v243, 0xffff0000, v77
    v_fma_f32 v242, v242, v234, v226
    v_fma_f32 v243, v243, v235, v227
    v_cvt_pk_bf16_f32 v77, v242, v243
    v_lshlrev_b32 v240, 16, v78
    v_and_b32 v241, 0xffff0000, v78
    v_fma_f32 v240, v240, v236, v228
    v_fma_f32 v241, v241, v237, v229
    v_cvt_pk_bf16_f32 v78, v240, v241
    v_lshlrev_b32 v242, 16, v79
    v_and_b32 v243, 0xffff0000, v79
    v_fma_f32 v242, v242, v238, v230
    v_fma_f32 v243, v243, v239, v231
    v_cvt_pk_bf16_f32 v79, v242, v243
    ds_read_b128 v[208:211], v42 offset:256
    ds_read_b128 v[212:215], v42 offset:272
    ds_read_b128 v[216:219], v42 offset:2560
    ds_read_b128 v[220:223], v42 offset:2576
    s_waitcnt lgkmcnt(0)
    s_waitcnt vmcnt(20)
    v_mfma_f32_16x16x32_bf16 a[0:3], a[192:195], v[64:67], a[0:3]
    ds_read_b64_tr_b16 a[224:225], v26 offset:8192
    ds_read_b64_tr_b16 a[226:227], v26 offset:9216
    v_lshlrev_b32 v240, 16, v80
    v_mfma_f32_16x16x32_bf16 a[4:7], a[192:195], v[68:71], a[4:7]
    ds_read_b64_tr_b16 a[228:229], v27 offset:8192
    ds_read_b64_tr_b16 a[230:231], v27 offset:9216
    v_and_b32 v241, 0xffff0000, v80
    v_mfma_f32_16x16x32_bf16 a[16:19], a[196:199], v[64:67], a[16:19]
    ds_read_b64_tr_b16 a[232:233], v28 offset:8192
    v_fma_f32 v240, v240, v216, v208
    v_fma_f32 v241, v241, v217, v209
    v_mfma_f32_16x16x32_bf16 a[20:23], a[196:199], v[68:71], a[20:23]
    ds_read_b64_tr_b16 a[234:235], v28 offset:9216
    ds_read_b64_tr_b16 a[236:237], v29 offset:8192
    v_cvt_pk_bf16_f32 v80, v240, v241
    v_mfma_f32_16x16x32_bf16 a[32:35], a[200:203], v[64:67], a[32:35]
    ds_read_b64_tr_b16 a[238:239], v29 offset:9216
    ds_read_b64_tr_b16 a[240:241], v30 offset:8192
    v_lshlrev_b32 v242, 16, v81
    v_mfma_f32_16x16x32_bf16 a[36:39], a[200:203], v[68:71], a[36:39]
    ds_read_b64_tr_b16 a[242:243], v30 offset:9216
    v_and_b32 v243, 0xffff0000, v81
    v_fma_f32 v242, v242, v218, v210
    v_mfma_f32_16x16x32_bf16 a[48:51], a[204:207], v[64:67], a[48:51]
    ds_read_b64_tr_b16 a[244:245], v31 offset:8192
    ds_read_b64_tr_b16 a[246:247], v31 offset:9216
    v_fma_f32 v243, v243, v219, v211
    v_mfma_f32_16x16x32_bf16 a[52:55], a[204:207], v[68:71], a[52:55]
    ds_read_b64_tr_b16 a[248:249], v32 offset:8192
    ds_read_b64_tr_b16 a[250:251], v32 offset:9216
    v_cvt_pk_bf16_f32 v81, v242, v243
    v_mfma_f32_16x16x32_bf16 a[64:67], a[208:211], v[64:67], a[64:67]
    ds_read_b64_tr_b16 a[252:253], v33 offset:8192
    v_lshlrev_b32 v244, 16, v82
    v_and_b32 v245, 0xffff0000, v82
    v_mfma_f32_16x16x32_bf16 a[68:71], a[208:211], v[68:71], a[68:71]
    ds_read_b64_tr_b16 a[254:255], v33 offset:9216
    ds_read_b128 v[224:227], v42 offset:384
    v_fma_f32 v244, v244, v220, v212
    v_mfma_f32_16x16x32_bf16 a[80:83], a[212:215], v[64:67], a[80:83]
    ds_read_b128 v[228:231], v42 offset:400
    ds_read_b128 v[232:235], v42 offset:2688
    v_fma_f32 v245, v245, v221, v213
    v_mfma_f32_16x16x32_bf16 a[84:87], a[212:215], v[68:71], a[84:87]
    ds_read_b128 v[236:239], v42 offset:2704
    v_cvt_pk_bf16_f32 v82, v244, v245
    v_mfma_f32_16x16x32_bf16 a[96:99], a[216:219], v[64:67], a[96:99]
    buffer_load_dwordx4 v[112:115], v3, s[24:27], s48 offen offset:0
    v_lshlrev_b32 v246, 16, v83
    v_and_b32 v247, 0xffff0000, v83
    v_mfma_f32_16x16x32_bf16 a[100:103], a[216:219], v[68:71], a[100:103]
    buffer_load_dwordx4 v[116:119], v43, s[24:27], s48 offen offset:0
    v_fma_f32 v246, v246, v222, v214
    v_mfma_f32_16x16x32_bf16 a[112:115], a[220:223], v[64:67], a[112:115]
    buffer_load_dwordx4 v[120:123], v3, s[24:27], s48 offen offset:1024
    v_fma_f32 v247, v247, v223, v215
    v_cvt_pk_bf16_f32 v83, v246, v247
    v_mfma_f32_16x16x32_bf16 a[116:119], a[220:223], v[68:71], a[116:119]
    buffer_load_dwordx4 v[124:127], v43, s[24:27], s48 offen offset:1024
    s_add_u32 s48, s48, 2048
    s_waitcnt lgkmcnt(0)
    v_mfma_f32_16x16x32_bf16 a[0:3], a[224:227], v[72:75], a[0:3]
    ds_read_b64_tr_b16 a[192:193], v26 offset:16384
    ds_read_b64_tr_b16 a[194:195], v26 offset:17408
    v_lshlrev_b32 v240, 16, v84
    v_mfma_f32_16x16x32_bf16 a[4:7], a[224:227], v[76:79], a[4:7]
    ds_read_b64_tr_b16 a[196:197], v27 offset:16384
    v_and_b32 v241, 0xffff0000, v84
    v_fma_f32 v240, v240, v216, v208
    v_mfma_f32_16x16x32_bf16 a[16:19], a[228:231], v[72:75], a[16:19]
    ds_read_b64_tr_b16 a[198:199], v27 offset:17408
    v_fma_f32 v241, v241, v217, v209
    v_cvt_pk_bf16_f32 v84, v240, v241
    v_mfma_f32_16x16x32_bf16 a[20:23], a[228:231], v[76:79], a[20:23]
    ds_read_b64_tr_b16 a[200:201], v28 offset:16384
    ds_read_b64_tr_b16 a[202:203], v28 offset:17408
    v_lshlrev_b32 v242, 16, v85
    v_mfma_f32_16x16x32_bf16 a[32:35], a[232:235], v[72:75], a[32:35]
    ds_read_b64_tr_b16 a[204:205], v29 offset:16384
    v_and_b32 v243, 0xffff0000, v85
    v_fma_f32 v242, v242, v218, v210
    v_mfma_f32_16x16x32_bf16 a[36:39], a[232:235], v[76:79], a[36:39]
    ds_read_b64_tr_b16 a[206:207], v29 offset:17408
    v_fma_f32 v243, v243, v219, v211
    v_cvt_pk_bf16_f32 v85, v242, v243
    v_mfma_f32_16x16x32_bf16 a[48:51], a[236:239], v[72:75], a[48:51]
    ds_read_b64_tr_b16 a[208:209], v30 offset:16384
    ds_read_b64_tr_b16 a[210:211], v30 offset:17408
    v_lshlrev_b32 v244, 16, v86
    v_mfma_f32_16x16x32_bf16 a[52:55], a[236:239], v[76:79], a[52:55]
    ds_read_b64_tr_b16 a[212:213], v31 offset:16384
    v_and_b32 v245, 0xffff0000, v86
    v_fma_f32 v244, v244, v220, v212
    v_mfma_f32_16x16x32_bf16 a[64:67], a[240:243], v[72:75], a[64:67]
    ds_read_b64_tr_b16 a[214:215], v31 offset:17408
    v_fma_f32 v245, v245, v221, v213
    v_cvt_pk_bf16_f32 v86, v244, v245
    v_mfma_f32_16x16x32_bf16 a[68:71], a[240:243], v[76:79], a[68:71]
    ds_read_b64_tr_b16 a[216:217], v32 offset:16384
    ds_read_b64_tr_b16 a[218:219], v32 offset:17408
    v_mfma_f32_16x16x32_bf16 a[80:83], a[244:247], v[72:75], a[80:83]
    ds_read_b64_tr_b16 a[220:221], v33 offset:16384
    v_lshlrev_b32 v246, 16, v87
    v_and_b32 v247, 0xffff0000, v87
    v_mfma_f32_16x16x32_bf16 a[84:87], a[244:247], v[76:79], a[84:87]
    ds_read_b64_tr_b16 a[222:223], v33 offset:17408
    s_add_u32 m0, s44, 98304
    s_mov_b32 s39, 1572864
    v_mfma_f32_16x16x32_bf16 a[96:99], a[248:251], v[72:75], a[96:99]
    buffer_load_dwordx4 v24, s[20:23], s39 offen lds
    v_fma_f32 v246, v246, v222, v214
    s_add_u32 m0, s44, 99328
    s_mov_b32 s39, 1605632
    v_mfma_f32_16x16x32_bf16 a[100:103], a[248:251], v[76:79], a[100:103]
    buffer_load_dwordx4 v24, s[20:23], s39 offen lds
    s_add_u32 m0, s44, 100352
    s_mov_b32 s39, 1638400
    v_mfma_f32_16x16x32_bf16 a[112:115], a[252:255], v[72:75], a[112:115]
    buffer_load_dwordx4 v25, s[20:23], s39 offen lds
    v_fma_f32 v247, v247, v223, v215
    s_add_u32 m0, s44, 101376
    s_mov_b32 s39, 1671168
    v_mfma_f32_16x16x32_bf16 a[116:119], a[252:255], v[76:79], a[116:119]
    buffer_load_dwordx4 v25, s[20:23], s39 offen lds
    v_cvt_pk_bf16_f32 v87, v246, v247
    s_waitcnt lgkmcnt(0)
    v_mfma_f32_16x16x32_bf16 a[8:11], a[192:195], v[64:67], a[8:11]
    ds_read_b64_tr_b16 a[224:225], v26 offset:24576
    ds_read_b64_tr_b16 a[226:227], v26 offset:25600
    v_lshlrev_b32 v240, 16, v88
    v_mfma_f32_16x16x32_bf16 a[12:15], a[192:195], v[68:71], a[12:15]
    ds_read_b64_tr_b16 a[228:229], v27 offset:24576
    ds_read_b64_tr_b16 a[230:231], v27 offset:25600
    v_and_b32 v241, 0xffff0000, v88
    v_mfma_f32_16x16x32_bf16 a[24:27], a[196:199], v[64:67], a[24:27]
    ds_read_b64_tr_b16 a[232:233], v28 offset:24576
    v_fma_f32 v240, v240, v232, v224
    v_fma_f32 v241, v241, v233, v225
    v_mfma_f32_16x16x32_bf16 a[28:31], a[196:199], v[68:71], a[28:31]
    ds_read_b64_tr_b16 a[234:235], v28 offset:25600
    ds_read_b64_tr_b16 a[236:237], v29 offset:24576
    v_cvt_pk_bf16_f32 v88, v240, v241
    v_mfma_f32_16x16x32_bf16 a[40:43], a[200:203], v[64:67], a[40:43]
    ds_read_b64_tr_b16 a[238:239], v29 offset:25600
    ds_read_b64_tr_b16 a[240:241], v30 offset:24576
    v_lshlrev_b32 v242, 16, v89
    v_mfma_f32_16x16x32_bf16 a[44:47], a[200:203], v[68:71], a[44:47]
    ds_read_b64_tr_b16 a[242:243], v30 offset:25600
    v_and_b32 v243, 0xffff0000, v89
    v_fma_f32 v242, v242, v234, v226
    v_mfma_f32_16x16x32_bf16 a[56:59], a[204:207], v[64:67], a[56:59]
    ds_read_b64_tr_b16 a[244:245], v31 offset:24576
    ds_read_b64_tr_b16 a[246:247], v31 offset:25600
    v_fma_f32 v243, v243, v235, v227
    v_mfma_f32_16x16x32_bf16 a[60:63], a[204:207], v[68:71], a[60:63]
    ds_read_b64_tr_b16 a[248:249], v32 offset:24576
    ds_read_b64_tr_b16 a[250:251], v32 offset:25600
    v_cvt_pk_bf16_f32 v89, v242, v243
    v_mfma_f32_16x16x32_bf16 a[72:75], a[208:211], v[64:67], a[72:75]
    ds_read_b64_tr_b16 a[252:253], v33 offset:24576
    v_lshlrev_b32 v244, 16, v90
    v_and_b32 v245, 0xffff0000, v90
    v_mfma_f32_16x16x32_bf16 a[76:79], a[208:211], v[68:71], a[76:79]
    ds_read_b64_tr_b16 a[254:255], v33 offset:25600
    ds_read_b128 v[208:211], v42 offset:512
    v_fma_f32 v244, v244, v236, v228
    v_mfma_f32_16x16x32_bf16 a[88:91], a[212:215], v[64:67], a[88:91]
    ds_read_b128 v[212:215], v42 offset:528
    ds_read_b128 v[216:219], v42 offset:2816
    v_fma_f32 v245, v245, v237, v229
    v_mfma_f32_16x16x32_bf16 a[92:95], a[212:215], v[68:71], a[92:95]
    ds_read_b128 v[220:223], v42 offset:2832
    v_cvt_pk_bf16_f32 v90, v244, v245
    s_add_u32 m0, s44, 114688
    s_mov_b32 s39, 1573120
    v_mfma_f32_16x16x32_bf16 a[104:107], a[216:219], v[64:67], a[104:107]
    buffer_load_dwordx4 v24, s[20:23], s39 offen lds
    v_lshlrev_b32 v246, 16, v91
    s_add_u32 m0, s44, 115712
    s_mov_b32 s39, 1605888
    v_mfma_f32_16x16x32_bf16 a[108:111], a[216:219], v[68:71], a[108:111]
    buffer_load_dwordx4 v24, s[20:23], s39 offen lds
    v_and_b32 v247, 0xffff0000, v91
    s_add_u32 m0, s44, 116736
    s_mov_b32 s39, 1638656
    v_mfma_f32_16x16x32_bf16 a[120:123], a[220:223], v[64:67], a[120:123]
    buffer_load_dwordx4 v25, s[20:23], s39 offen lds
    v_fma_f32 v246, v246, v238, v230
    s_add_u32 m0, s44, 117760
    s_mov_b32 s39, 1671424
    v_mfma_f32_16x16x32_bf16 a[124:127], a[220:223], v[68:71], a[124:127]
    buffer_load_dwordx4 v25, s[20:23], s39 offen lds
    v_fma_f32 v247, v247, v239, v231
    v_cvt_pk_bf16_f32 v91, v246, v247
    s_waitcnt lgkmcnt(0)
    s_waitcnt vmcnt(24)
    s_barrier
    v_mfma_f32_16x16x32_bf16 a[8:11], a[224:227], v[72:75], a[8:11]
    ds_read_b64_tr_b16 a[192:193], v26 offset:32768
    ds_read_b64_tr_b16 a[194:195], v26 offset:33792
    v_lshlrev_b32 v240, 16, v92
    v_mfma_f32_16x16x32_bf16 a[12:15], a[224:227], v[76:79], a[12:15]
    ds_read_b64_tr_b16 a[196:197], v27 offset:32768
    v_and_b32 v241, 0xffff0000, v92
    v_mfma_f32_16x16x32_bf16 a[24:27], a[228:231], v[72:75], a[24:27]
    ds_read_b64_tr_b16 a[198:199], v27 offset:33792
    v_fma_f32 v240, v240, v232, v224
    v_fma_f32 v241, v241, v233, v225
    v_mfma_f32_16x16x32_bf16 a[28:31], a[228:231], v[76:79], a[28:31]
    ds_read_b64_tr_b16 a[200:201], v28 offset:32768
    ds_read_b64_tr_b16 a[202:203], v28 offset:33792
    v_mfma_f32_16x16x32_bf16 a[40:43], a[232:235], v[72:75], a[40:43]
    ds_read_b64_tr_b16 a[204:205], v29 offset:32768
    v_cvt_pk_bf16_f32 v92, v240, v241
    v_lshlrev_b32 v242, 16, v93
    v_mfma_f32_16x16x32_bf16 a[44:47], a[232:235], v[76:79], a[44:47]
    ds_read_b64_tr_b16 a[206:207], v29 offset:33792
    v_and_b32 v243, 0xffff0000, v93
    v_mfma_f32_16x16x32_bf16 a[56:59], a[236:239], v[72:75], a[56:59]
    ds_read_b64_tr_b16 a[208:209], v30 offset:32768
    ds_read_b64_tr_b16 a[210:211], v30 offset:33792
    v_fma_f32 v242, v242, v234, v226
    v_mfma_f32_16x16x32_bf16 a[60:63], a[236:239], v[76:79], a[60:63]
    ds_read_b64_tr_b16 a[212:213], v31 offset:32768
    v_fma_f32 v243, v243, v235, v227
    v_mfma_f32_16x16x32_bf16 a[72:75], a[240:243], v[72:75], a[72:75]
    ds_read_b64_tr_b16 a[214:215], v31 offset:33792
    v_cvt_pk_bf16_f32 v93, v242, v243
    v_mfma_f32_16x16x32_bf16 a[76:79], a[240:243], v[76:79], a[76:79]
    ds_read_b64_tr_b16 a[216:217], v32 offset:32768
    ds_read_b64_tr_b16 a[218:219], v32 offset:33792
    v_mfma_f32_16x16x32_bf16 a[88:91], a[244:247], v[72:75], a[88:91]
    ds_read_b64_tr_b16 a[220:221], v33 offset:32768
    v_lshlrev_b32 v244, 16, v94
    v_mfma_f32_16x16x32_bf16 a[92:95], a[244:247], v[76:79], a[92:95]
    ds_read_b64_tr_b16 a[222:223], v33 offset:33792
    v_and_b32 v245, 0xffff0000, v94
    v_mfma_f32_16x16x32_bf16 a[104:107], a[248:251], v[72:75], a[104:107]
    v_fma_f32 v244, v244, v236, v228
    v_fma_f32 v245, v245, v237, v229
    v_mfma_f32_16x16x32_bf16 a[108:111], a[248:251], v[76:79], a[108:111]
    v_cvt_pk_bf16_f32 v94, v244, v245
    v_lshlrev_b32 v246, 16, v95
    v_mfma_f32_16x16x32_bf16 a[120:123], a[252:255], v[72:75], a[120:123]
    v_and_b32 v247, 0xffff0000, v95
    v_fma_f32 v246, v246, v238, v230
    v_mfma_f32_16x16x32_bf16 a[124:127], a[252:255], v[76:79], a[124:127]
    v_fma_f32 v247, v247, v239, v231
    v_cvt_pk_bf16_f32 v95, v246, v247
    s_waitcnt lgkmcnt(0)
    s_waitcnt vmcnt(20)
    v_mfma_f32_16x16x32_bf16 a[0:3], a[192:195], v[80:83], a[0:3]
    ds_read_b64_tr_b16 a[224:225], v26 offset:40960
    ds_read_b64_tr_b16 a[226:227], v26 offset:41984
    v_lshlrev_b32 v240, 16, v96
    v_mfma_f32_16x16x32_bf16 a[4:7], a[192:195], v[84:87], a[4:7]
    ds_read_b64_tr_b16 a[228:229], v27 offset:40960
    ds_read_b64_tr_b16 a[230:231], v27 offset:41984
    v_and_b32 v241, 0xffff0000, v96
    v_mfma_f32_16x16x32_bf16 a[16:19], a[196:199], v[80:83], a[16:19]
    ds_read_b64_tr_b16 a[232:233], v28 offset:40960
    v_fma_f32 v240, v240, v216, v208
    v_fma_f32 v241, v241, v217, v209
    v_mfma_f32_16x16x32_bf16 a[20:23], a[196:199], v[84:87], a[20:23]
    ds_read_b64_tr_b16 a[234:235], v28 offset:41984
    ds_read_b64_tr_b16 a[236:237], v29 offset:40960
    v_cvt_pk_bf16_f32 v96, v240, v241
    v_mfma_f32_16x16x32_bf16 a[32:35], a[200:203], v[80:83], a[32:35]
    ds_read_b64_tr_b16 a[238:239], v29 offset:41984
    ds_read_b64_tr_b16 a[240:241], v30 offset:40960
    v_lshlrev_b32 v242, 16, v97
    v_mfma_f32_16x16x32_bf16 a[36:39], a[200:203], v[84:87], a[36:39]
    ds_read_b64_tr_b16 a[242:243], v30 offset:41984
    v_and_b32 v243, 0xffff0000, v97
    v_fma_f32 v242, v242, v218, v210
    v_mfma_f32_16x16x32_bf16 a[48:51], a[204:207], v[80:83], a[48:51]
    ds_read_b64_tr_b16 a[244:245], v31 offset:40960
    ds_read_b64_tr_b16 a[246:247], v31 offset:41984
    v_fma_f32 v243, v243, v219, v211
    v_mfma_f32_16x16x32_bf16 a[52:55], a[204:207], v[84:87], a[52:55]
    ds_read_b64_tr_b16 a[248:249], v32 offset:40960
    ds_read_b64_tr_b16 a[250:251], v32 offset:41984
    v_cvt_pk_bf16_f32 v97, v242, v243
    v_mfma_f32_16x16x32_bf16 a[64:67], a[208:211], v[80:83], a[64:67]
    ds_read_b64_tr_b16 a[252:253], v33 offset:40960
    v_lshlrev_b32 v244, 16, v98
    v_and_b32 v245, 0xffff0000, v98
    v_mfma_f32_16x16x32_bf16 a[68:71], a[208:211], v[84:87], a[68:71]
    ds_read_b64_tr_b16 a[254:255], v33 offset:41984
    ds_read_b128 v[224:227], v42 offset:640
    v_fma_f32 v244, v244, v220, v212
    v_mfma_f32_16x16x32_bf16 a[80:83], a[212:215], v[80:83], a[80:83]
    ds_read_b128 v[228:231], v42 offset:656
    ds_read_b128 v[232:235], v42 offset:2944
    v_fma_f32 v245, v245, v221, v213
    v_mfma_f32_16x16x32_bf16 a[84:87], a[212:215], v[84:87], a[84:87]
    ds_read_b128 v[236:239], v42 offset:2960
    v_cvt_pk_bf16_f32 v98, v244, v245
    v_mfma_f32_16x16x32_bf16 a[96:99], a[216:219], v[80:83], a[96:99]
    buffer_load_dwordx4 v[128:131], v3, s[24:27], s48 offen offset:0
    v_lshlrev_b32 v246, 16, v99
    v_and_b32 v247, 0xffff0000, v99
    v_mfma_f32_16x16x32_bf16 a[100:103], a[216:219], v[84:87], a[100:103]
    buffer_load_dwordx4 v[132:135], v43, s[24:27], s48 offen offset:0
    v_fma_f32 v246, v246, v222, v214
    v_mfma_f32_16x16x32_bf16 a[112:115], a[220:223], v[80:83], a[112:115]
    buffer_load_dwordx4 v[136:139], v3, s[24:27], s48 offen offset:1024
    v_fma_f32 v247, v247, v223, v215
    v_cvt_pk_bf16_f32 v99, v246, v247
    v_mfma_f32_16x16x32_bf16 a[116:119], a[220:223], v[84:87], a[116:119]
    buffer_load_dwordx4 v[140:143], v43, s[24:27], s48 offen offset:1024
    s_add_u32 s48, s48, 2048
    s_waitcnt lgkmcnt(0)
    v_mfma_f32_16x16x32_bf16 a[0:3], a[224:227], v[88:91], a[0:3]
    ds_read_b64_tr_b16 a[192:193], v26 offset:49152
    ds_read_b64_tr_b16 a[194:195], v26 offset:50176
    v_lshlrev_b32 v240, 16, v100
    v_mfma_f32_16x16x32_bf16 a[4:7], a[224:227], v[92:95], a[4:7]
    ds_read_b64_tr_b16 a[196:197], v27 offset:49152
    v_and_b32 v241, 0xffff0000, v100
    v_fma_f32 v240, v240, v216, v208
    v_mfma_f32_16x16x32_bf16 a[16:19], a[228:231], v[88:91], a[16:19]
    ds_read_b64_tr_b16 a[198:199], v27 offset:50176
    v_fma_f32 v241, v241, v217, v209
    v_cvt_pk_bf16_f32 v100, v240, v241
    v_mfma_f32_16x16x32_bf16 a[20:23], a[228:231], v[92:95], a[20:23]
    ds_read_b64_tr_b16 a[200:201], v28 offset:49152
    ds_read_b64_tr_b16 a[202:203], v28 offset:50176
    v_lshlrev_b32 v242, 16, v101
    v_mfma_f32_16x16x32_bf16 a[32:35], a[232:235], v[88:91], a[32:35]
    ds_read_b64_tr_b16 a[204:205], v29 offset:49152
    v_and_b32 v243, 0xffff0000, v101
    v_fma_f32 v242, v242, v218, v210
    v_mfma_f32_16x16x32_bf16 a[36:39], a[232:235], v[92:95], a[36:39]
    ds_read_b64_tr_b16 a[206:207], v29 offset:50176
    v_fma_f32 v243, v243, v219, v211
    v_cvt_pk_bf16_f32 v101, v242, v243
    v_mfma_f32_16x16x32_bf16 a[48:51], a[236:239], v[88:91], a[48:51]
    ds_read_b64_tr_b16 a[208:209], v30 offset:49152
    ds_read_b64_tr_b16 a[210:211], v30 offset:50176
    v_lshlrev_b32 v244, 16, v102
    v_mfma_f32_16x16x32_bf16 a[52:55], a[236:239], v[92:95], a[52:55]
    ds_read_b64_tr_b16 a[212:213], v31 offset:49152
    v_and_b32 v245, 0xffff0000, v102
    v_fma_f32 v244, v244, v220, v212
    v_mfma_f32_16x16x32_bf16 a[64:67], a[240:243], v[88:91], a[64:67]
    ds_read_b64_tr_b16 a[214:215], v31 offset:50176
    v_fma_f32 v245, v245, v221, v213
    v_cvt_pk_bf16_f32 v102, v244, v245
    v_mfma_f32_16x16x32_bf16 a[68:71], a[240:243], v[92:95], a[68:71]
    ds_read_b64_tr_b16 a[216:217], v32 offset:49152
    ds_read_b64_tr_b16 a[218:219], v32 offset:50176
    v_mfma_f32_16x16x32_bf16 a[80:83], a[244:247], v[88:91], a[80:83]
    ds_read_b64_tr_b16 a[220:221], v33 offset:49152
    v_lshlrev_b32 v246, 16, v103
    v_and_b32 v247, 0xffff0000, v103
    v_mfma_f32_16x16x32_bf16 a[84:87], a[244:247], v[92:95], a[84:87]
    ds_read_b64_tr_b16 a[222:223], v33 offset:50176
    s_add_u32 m0, s44, 0
    s_mov_b32 s39, 2097152
    v_mfma_f32_16x16x32_bf16 a[96:99], a[248:251], v[88:91], a[96:99]
    buffer_load_dwordx4 v24, s[20:23], s39 offen lds
    v_fma_f32 v246, v246, v222, v214
    s_add_u32 m0, s44, 1024
    s_mov_b32 s39, 2129920
    v_mfma_f32_16x16x32_bf16 a[100:103], a[248:251], v[92:95], a[100:103]
    buffer_load_dwordx4 v24, s[20:23], s39 offen lds
    s_add_u32 m0, s44, 2048
    s_mov_b32 s39, 2162688
    v_mfma_f32_16x16x32_bf16 a[112:115], a[252:255], v[88:91], a[112:115]
    buffer_load_dwordx4 v25, s[20:23], s39 offen lds
    v_fma_f32 v247, v247, v223, v215
    s_add_u32 m0, s44, 3072
    s_mov_b32 s39, 2195456
    v_mfma_f32_16x16x32_bf16 a[116:119], a[252:255], v[92:95], a[116:119]
    buffer_load_dwordx4 v25, s[20:23], s39 offen lds
    v_cvt_pk_bf16_f32 v103, v246, v247
    s_waitcnt lgkmcnt(0)
    v_mfma_f32_16x16x32_bf16 a[8:11], a[192:195], v[80:83], a[8:11]
    ds_read_b64_tr_b16 a[224:225], v26 offset:57344
    ds_read_b64_tr_b16 a[226:227], v26 offset:58368
    v_lshlrev_b32 v240, 16, v104
    v_mfma_f32_16x16x32_bf16 a[12:15], a[192:195], v[84:87], a[12:15]
    ds_read_b64_tr_b16 a[228:229], v27 offset:57344
    ds_read_b64_tr_b16 a[230:231], v27 offset:58368
    v_and_b32 v241, 0xffff0000, v104
    v_mfma_f32_16x16x32_bf16 a[24:27], a[196:199], v[80:83], a[24:27]
    ds_read_b64_tr_b16 a[232:233], v28 offset:57344
    v_fma_f32 v240, v240, v232, v224
    v_fma_f32 v241, v241, v233, v225
    v_mfma_f32_16x16x32_bf16 a[28:31], a[196:199], v[84:87], a[28:31]
    ds_read_b64_tr_b16 a[234:235], v28 offset:58368
    ds_read_b64_tr_b16 a[236:237], v29 offset:57344
    v_cvt_pk_bf16_f32 v104, v240, v241
    v_mfma_f32_16x16x32_bf16 a[40:43], a[200:203], v[80:83], a[40:43]
    ds_read_b64_tr_b16 a[238:239], v29 offset:58368
    ds_read_b64_tr_b16 a[240:241], v30 offset:57344
    v_lshlrev_b32 v242, 16, v105
    v_mfma_f32_16x16x32_bf16 a[44:47], a[200:203], v[84:87], a[44:47]
    ds_read_b64_tr_b16 a[242:243], v30 offset:58368
    v_and_b32 v243, 0xffff0000, v105
    v_fma_f32 v242, v242, v234, v226
    v_mfma_f32_16x16x32_bf16 a[56:59], a[204:207], v[80:83], a[56:59]
    ds_read_b64_tr_b16 a[244:245], v31 offset:57344
    ds_read_b64_tr_b16 a[246:247], v31 offset:58368
    v_fma_f32 v243, v243, v235, v227
    v_mfma_f32_16x16x32_bf16 a[60:63], a[204:207], v[84:87], a[60:63]
    ds_read_b64_tr_b16 a[248:249], v32 offset:57344
    ds_read_b64_tr_b16 a[250:251], v32 offset:58368
    v_cvt_pk_bf16_f32 v105, v242, v243
    v_mfma_f32_16x16x32_bf16 a[72:75], a[208:211], v[80:83], a[72:75]
    ds_read_b64_tr_b16 a[252:253], v33 offset:57344
    v_lshlrev_b32 v244, 16, v106
    v_and_b32 v245, 0xffff0000, v106
    v_mfma_f32_16x16x32_bf16 a[76:79], a[208:211], v[84:87], a[76:79]
    ds_read_b64_tr_b16 a[254:255], v33 offset:58368
    ds_read_b128 v[208:211], v42 offset:768
    v_fma_f32 v244, v244, v236, v228
    v_mfma_f32_16x16x32_bf16 a[88:91], a[212:215], v[80:83], a[88:91]
    ds_read_b128 v[212:215], v42 offset:784
    ds_read_b128 v[216:219], v42 offset:3072
    v_fma_f32 v245, v245, v237, v229
    v_mfma_f32_16x16x32_bf16 a[92:95], a[212:215], v[84:87], a[92:95]
    ds_read_b128 v[220:223], v42 offset:3088
    v_cvt_pk_bf16_f32 v106, v244, v245
    s_add_u32 m0, s44, 16384
    s_mov_b32 s39, 2097408
    v_mfma_f32_16x16x32_bf16 a[104:107], a[216:219], v[80:83], a[104:107]
    buffer_load_dwordx4 v24, s[20:23], s39 offen lds
    v_lshlrev_b32 v246, 16, v107
    s_add_u32 m0, s44, 17408
    s_mov_b32 s39, 2130176
    v_mfma_f32_16x16x32_bf16 a[108:111], a[216:219], v[84:87], a[108:111]
    buffer_load_dwordx4 v24, s[20:23], s39 offen lds
    v_and_b32 v247, 0xffff0000, v107
    s_add_u32 m0, s44, 18432
    s_mov_b32 s39, 2162944
    v_mfma_f32_16x16x32_bf16 a[120:123], a[220:223], v[80:83], a[120:123]
    buffer_load_dwordx4 v25, s[20:23], s39 offen lds
    v_fma_f32 v246, v246, v238, v230
    s_add_u32 m0, s44, 19456
    s_mov_b32 s39, 2195712
    v_mfma_f32_16x16x32_bf16 a[124:127], a[220:223], v[84:87], a[124:127]
    buffer_load_dwordx4 v25, s[20:23], s39 offen lds
    v_fma_f32 v247, v247, v239, v231
    v_cvt_pk_bf16_f32 v107, v246, v247
    s_waitcnt lgkmcnt(0)
    s_waitcnt vmcnt(24)
    s_barrier
    v_mfma_f32_16x16x32_bf16 a[8:11], a[224:227], v[88:91], a[8:11]
    ds_read_b64_tr_b16 a[192:193], v34 offset:0
    ds_read_b64_tr_b16 a[194:195], v34 offset:1024
    v_lshlrev_b32 v240, 16, v108
    v_mfma_f32_16x16x32_bf16 a[12:15], a[224:227], v[92:95], a[12:15]
    ds_read_b64_tr_b16 a[196:197], v35 offset:0
    v_and_b32 v241, 0xffff0000, v108
    v_mfma_f32_16x16x32_bf16 a[24:27], a[228:231], v[88:91], a[24:27]
    ds_read_b64_tr_b16 a[198:199], v35 offset:1024
    v_fma_f32 v240, v240, v232, v224
    v_fma_f32 v241, v241, v233, v225
    v_mfma_f32_16x16x32_bf16 a[28:31], a[228:231], v[92:95], a[28:31]
    ds_read_b64_tr_b16 a[200:201], v36 offset:0
    ds_read_b64_tr_b16 a[202:203], v36 offset:1024
    v_mfma_f32_16x16x32_bf16 a[40:43], a[232:235], v[88:91], a[40:43]
    ds_read_b64_tr_b16 a[204:205], v37 offset:0
    v_cvt_pk_bf16_f32 v108, v240, v241
    v_lshlrev_b32 v242, 16, v109
    v_mfma_f32_16x16x32_bf16 a[44:47], a[232:235], v[92:95], a[44:47]
    ds_read_b64_tr_b16 a[206:207], v37 offset:1024
    v_and_b32 v243, 0xffff0000, v109
    v_mfma_f32_16x16x32_bf16 a[56:59], a[236:239], v[88:91], a[56:59]
    ds_read_b64_tr_b16 a[208:209], v38 offset:0
    ds_read_b64_tr_b16 a[210:211], v38 offset:1024
    v_fma_f32 v242, v242, v234, v226
    v_mfma_f32_16x16x32_bf16 a[60:63], a[236:239], v[92:95], a[60:63]
    ds_read_b64_tr_b16 a[212:213], v39 offset:0
    v_fma_f32 v243, v243, v235, v227
    v_mfma_f32_16x16x32_bf16 a[72:75], a[240:243], v[88:91], a[72:75]
    ds_read_b64_tr_b16 a[214:215], v39 offset:1024
    v_cvt_pk_bf16_f32 v109, v242, v243
    v_mfma_f32_16x16x32_bf16 a[76:79], a[240:243], v[92:95], a[76:79]
    ds_read_b64_tr_b16 a[216:217], v40 offset:0
    ds_read_b64_tr_b16 a[218:219], v40 offset:1024
    v_mfma_f32_16x16x32_bf16 a[88:91], a[244:247], v[88:91], a[88:91]
    ds_read_b64_tr_b16 a[220:221], v41 offset:0
    v_lshlrev_b32 v244, 16, v110
    v_mfma_f32_16x16x32_bf16 a[92:95], a[244:247], v[92:95], a[92:95]
    ds_read_b64_tr_b16 a[222:223], v41 offset:1024
    v_and_b32 v245, 0xffff0000, v110
    v_mfma_f32_16x16x32_bf16 a[104:107], a[248:251], v[88:91], a[104:107]
    v_fma_f32 v244, v244, v236, v228
    v_fma_f32 v245, v245, v237, v229
    v_mfma_f32_16x16x32_bf16 a[108:111], a[248:251], v[92:95], a[108:111]
    v_cvt_pk_bf16_f32 v110, v244, v245
    v_lshlrev_b32 v246, 16, v111
    v_mfma_f32_16x16x32_bf16 a[120:123], a[252:255], v[88:91], a[120:123]
    v_and_b32 v247, 0xffff0000, v111
    v_fma_f32 v246, v246, v238, v230
    v_mfma_f32_16x16x32_bf16 a[124:127], a[252:255], v[92:95], a[124:127]
    v_fma_f32 v247, v247, v239, v231
    v_cvt_pk_bf16_f32 v111, v246, v247
    s_waitcnt lgkmcnt(0)
    s_waitcnt vmcnt(20)
    v_mfma_f32_16x16x32_bf16 a[0:3], a[192:195], v[96:99], a[0:3]
    ds_read_b64_tr_b16 a[224:225], v34 offset:8192
    ds_read_b64_tr_b16 a[226:227], v34 offset:9216
    v_lshlrev_b32 v240, 16, v112
    v_mfma_f32_16x16x32_bf16 a[4:7], a[192:195], v[100:103], a[4:7]
    ds_read_b64_tr_b16 a[228:229], v35 offset:8192
    ds_read_b64_tr_b16 a[230:231], v35 offset:9216
    v_and_b32 v241, 0xffff0000, v112
    v_mfma_f32_16x16x32_bf16 a[16:19], a[196:199], v[96:99], a[16:19]
    ds_read_b64_tr_b16 a[232:233], v36 offset:8192
    v_fma_f32 v240, v240, v216, v208
    v_fma_f32 v241, v241, v217, v209
    v_mfma_f32_16x16x32_bf16 a[20:23], a[196:199], v[100:103], a[20:23]
    ds_read_b64_tr_b16 a[234:235], v36 offset:9216
    ds_read_b64_tr_b16 a[236:237], v37 offset:8192
    v_cvt_pk_bf16_f32 v112, v240, v241
    v_mfma_f32_16x16x32_bf16 a[32:35], a[200:203], v[96:99], a[32:35]
    ds_read_b64_tr_b16 a[238:239], v37 offset:9216
    ds_read_b64_tr_b16 a[240:241], v38 offset:8192
    v_lshlrev_b32 v242, 16, v113
    v_mfma_f32_16x16x32_bf16 a[36:39], a[200:203], v[100:103], a[36:39]
    ds_read_b64_tr_b16 a[242:243], v38 offset:9216
    v_and_b32 v243, 0xffff0000, v113
    v_fma_f32 v242, v242, v218, v210
    v_mfma_f32_16x16x32_bf16 a[48:51], a[204:207], v[96:99], a[48:51]
    ds_read_b64_tr_b16 a[244:245], v39 offset:8192
    ds_read_b64_tr_b16 a[246:247], v39 offset:9216
    v_fma_f32 v243, v243, v219, v211
    v_mfma_f32_16x16x32_bf16 a[52:55], a[204:207], v[100:103], a[52:55]
    ds_read_b64_tr_b16 a[248:249], v40 offset:8192
    ds_read_b64_tr_b16 a[250:251], v40 offset:9216
    v_cvt_pk_bf16_f32 v113, v242, v243
    v_mfma_f32_16x16x32_bf16 a[64:67], a[208:211], v[96:99], a[64:67]
    ds_read_b64_tr_b16 a[252:253], v41 offset:8192
    v_lshlrev_b32 v244, 16, v114
    v_and_b32 v245, 0xffff0000, v114
    v_mfma_f32_16x16x32_bf16 a[68:71], a[208:211], v[100:103], a[68:71]
    ds_read_b64_tr_b16 a[254:255], v41 offset:9216
    ds_read_b128 v[224:227], v42 offset:896
    v_fma_f32 v244, v244, v220, v212
    v_mfma_f32_16x16x32_bf16 a[80:83], a[212:215], v[96:99], a[80:83]
    ds_read_b128 v[228:231], v42 offset:912
    ds_read_b128 v[232:235], v42 offset:3200
    v_fma_f32 v245, v245, v221, v213
    v_mfma_f32_16x16x32_bf16 a[84:87], a[212:215], v[100:103], a[84:87]
    ds_read_b128 v[236:239], v42 offset:3216
    v_cvt_pk_bf16_f32 v114, v244, v245
    v_mfma_f32_16x16x32_bf16 a[96:99], a[216:219], v[96:99], a[96:99]
    buffer_load_dwordx4 v[144:147], v3, s[24:27], s48 offen offset:0
    v_lshlrev_b32 v246, 16, v115
    v_and_b32 v247, 0xffff0000, v115
    v_mfma_f32_16x16x32_bf16 a[100:103], a[216:219], v[100:103], a[100:103]
    buffer_load_dwordx4 v[148:151], v43, s[24:27], s48 offen offset:0
    v_fma_f32 v246, v246, v222, v214
    v_mfma_f32_16x16x32_bf16 a[112:115], a[220:223], v[96:99], a[112:115]
    buffer_load_dwordx4 v[152:155], v3, s[24:27], s48 offen offset:1024
    v_fma_f32 v247, v247, v223, v215
    v_cvt_pk_bf16_f32 v115, v246, v247
    v_mfma_f32_16x16x32_bf16 a[116:119], a[220:223], v[100:103], a[116:119]
    buffer_load_dwordx4 v[156:159], v43, s[24:27], s48 offen offset:1024
    s_add_u32 s48, s48, 2048
    s_waitcnt lgkmcnt(0)
    v_mfma_f32_16x16x32_bf16 a[0:3], a[224:227], v[104:107], a[0:3]
    ds_read_b64_tr_b16 a[192:193], v34 offset:16384
    ds_read_b64_tr_b16 a[194:195], v34 offset:17408
    v_lshlrev_b32 v240, 16, v116
    v_mfma_f32_16x16x32_bf16 a[4:7], a[224:227], v[108:111], a[4:7]
    ds_read_b64_tr_b16 a[196:197], v35 offset:16384
    v_and_b32 v241, 0xffff0000, v116
    v_fma_f32 v240, v240, v216, v208
    v_mfma_f32_16x16x32_bf16 a[16:19], a[228:231], v[104:107], a[16:19]
    ds_read_b64_tr_b16 a[198:199], v35 offset:17408
    v_fma_f32 v241, v241, v217, v209
    v_cvt_pk_bf16_f32 v116, v240, v241
    v_mfma_f32_16x16x32_bf16 a[20:23], a[228:231], v[108:111], a[20:23]
    ds_read_b64_tr_b16 a[200:201], v36 offset:16384
    ds_read_b64_tr_b16 a[202:203], v36 offset:17408
    v_lshlrev_b32 v242, 16, v117
    v_mfma_f32_16x16x32_bf16 a[32:35], a[232:235], v[104:107], a[32:35]
    ds_read_b64_tr_b16 a[204:205], v37 offset:16384
    v_and_b32 v243, 0xffff0000, v117
    v_fma_f32 v242, v242, v218, v210
    v_mfma_f32_16x16x32_bf16 a[36:39], a[232:235], v[108:111], a[36:39]
    ds_read_b64_tr_b16 a[206:207], v37 offset:17408
    v_fma_f32 v243, v243, v219, v211
    v_cvt_pk_bf16_f32 v117, v242, v243
    v_mfma_f32_16x16x32_bf16 a[48:51], a[236:239], v[104:107], a[48:51]
    ds_read_b64_tr_b16 a[208:209], v38 offset:16384
    ds_read_b64_tr_b16 a[210:211], v38 offset:17408
    v_lshlrev_b32 v244, 16, v118
    v_mfma_f32_16x16x32_bf16 a[52:55], a[236:239], v[108:111], a[52:55]
    ds_read_b64_tr_b16 a[212:213], v39 offset:16384
    v_and_b32 v245, 0xffff0000, v118
    v_fma_f32 v244, v244, v220, v212
    v_mfma_f32_16x16x32_bf16 a[64:67], a[240:243], v[104:107], a[64:67]
    ds_read_b64_tr_b16 a[214:215], v39 offset:17408
    v_fma_f32 v245, v245, v221, v213
    v_cvt_pk_bf16_f32 v118, v244, v245
    v_mfma_f32_16x16x32_bf16 a[68:71], a[240:243], v[108:111], a[68:71]
    ds_read_b64_tr_b16 a[216:217], v40 offset:16384
    ds_read_b64_tr_b16 a[218:219], v40 offset:17408
    v_mfma_f32_16x16x32_bf16 a[80:83], a[244:247], v[104:107], a[80:83]
    ds_read_b64_tr_b16 a[220:221], v41 offset:16384
    v_lshlrev_b32 v246, 16, v119
    v_and_b32 v247, 0xffff0000, v119
    v_mfma_f32_16x16x32_bf16 a[84:87], a[244:247], v[108:111], a[84:87]
    ds_read_b64_tr_b16 a[222:223], v41 offset:17408
    s_add_u32 m0, s44, 32768
    s_mov_b32 s39, 2621440
    v_mfma_f32_16x16x32_bf16 a[96:99], a[248:251], v[104:107], a[96:99]
    buffer_load_dwordx4 v24, s[20:23], s39 offen lds
    v_fma_f32 v246, v246, v222, v214
    s_add_u32 m0, s44, 33792
    s_mov_b32 s39, 2654208
    v_mfma_f32_16x16x32_bf16 a[100:103], a[248:251], v[108:111], a[100:103]
    buffer_load_dwordx4 v24, s[20:23], s39 offen lds
    s_add_u32 m0, s44, 34816
    s_mov_b32 s39, 2686976
    v_mfma_f32_16x16x32_bf16 a[112:115], a[252:255], v[104:107], a[112:115]
    buffer_load_dwordx4 v25, s[20:23], s39 offen lds
    v_fma_f32 v247, v247, v223, v215
    s_add_u32 m0, s44, 35840
    s_mov_b32 s39, 2719744
    v_mfma_f32_16x16x32_bf16 a[116:119], a[252:255], v[108:111], a[116:119]
    buffer_load_dwordx4 v25, s[20:23], s39 offen lds
    v_cvt_pk_bf16_f32 v119, v246, v247
    s_waitcnt lgkmcnt(0)
    v_mfma_f32_16x16x32_bf16 a[8:11], a[192:195], v[96:99], a[8:11]
    ds_read_b64_tr_b16 a[224:225], v34 offset:24576
    ds_read_b64_tr_b16 a[226:227], v34 offset:25600
    v_lshlrev_b32 v240, 16, v120
    v_mfma_f32_16x16x32_bf16 a[12:15], a[192:195], v[100:103], a[12:15]
    ds_read_b64_tr_b16 a[228:229], v35 offset:24576
    ds_read_b64_tr_b16 a[230:231], v35 offset:25600
    v_and_b32 v241, 0xffff0000, v120
    v_mfma_f32_16x16x32_bf16 a[24:27], a[196:199], v[96:99], a[24:27]
    ds_read_b64_tr_b16 a[232:233], v36 offset:24576
    v_fma_f32 v240, v240, v232, v224
    v_fma_f32 v241, v241, v233, v225
    v_mfma_f32_16x16x32_bf16 a[28:31], a[196:199], v[100:103], a[28:31]
    ds_read_b64_tr_b16 a[234:235], v36 offset:25600
    ds_read_b64_tr_b16 a[236:237], v37 offset:24576
    v_cvt_pk_bf16_f32 v120, v240, v241
    v_mfma_f32_16x16x32_bf16 a[40:43], a[200:203], v[96:99], a[40:43]
    ds_read_b64_tr_b16 a[238:239], v37 offset:25600
    ds_read_b64_tr_b16 a[240:241], v38 offset:24576
    v_lshlrev_b32 v242, 16, v121
    v_mfma_f32_16x16x32_bf16 a[44:47], a[200:203], v[100:103], a[44:47]
    ds_read_b64_tr_b16 a[242:243], v38 offset:25600
    v_and_b32 v243, 0xffff0000, v121
    v_fma_f32 v242, v242, v234, v226
    v_mfma_f32_16x16x32_bf16 a[56:59], a[204:207], v[96:99], a[56:59]
    ds_read_b64_tr_b16 a[244:245], v39 offset:24576
    ds_read_b64_tr_b16 a[246:247], v39 offset:25600
    v_fma_f32 v243, v243, v235, v227
    v_mfma_f32_16x16x32_bf16 a[60:63], a[204:207], v[100:103], a[60:63]
    ds_read_b64_tr_b16 a[248:249], v40 offset:24576
    ds_read_b64_tr_b16 a[250:251], v40 offset:25600
    v_cvt_pk_bf16_f32 v121, v242, v243
    v_mfma_f32_16x16x32_bf16 a[72:75], a[208:211], v[96:99], a[72:75]
    ds_read_b64_tr_b16 a[252:253], v41 offset:24576
    v_lshlrev_b32 v244, 16, v122
    v_and_b32 v245, 0xffff0000, v122
    v_mfma_f32_16x16x32_bf16 a[76:79], a[208:211], v[100:103], a[76:79]
    ds_read_b64_tr_b16 a[254:255], v41 offset:25600
    ds_read_b128 v[208:211], v42 offset:1024
    v_fma_f32 v244, v244, v236, v228
    v_mfma_f32_16x16x32_bf16 a[88:91], a[212:215], v[96:99], a[88:91]
    ds_read_b128 v[212:215], v42 offset:1040
    ds_read_b128 v[216:219], v42 offset:3328
    v_fma_f32 v245, v245, v237, v229
    v_mfma_f32_16x16x32_bf16 a[92:95], a[212:215], v[100:103], a[92:95]
    ds_read_b128 v[220:223], v42 offset:3344
    v_cvt_pk_bf16_f32 v122, v244, v245
    s_add_u32 m0, s44, 49152
    s_mov_b32 s39, 2621696
    v_mfma_f32_16x16x32_bf16 a[104:107], a[216:219], v[96:99], a[104:107]
    buffer_load_dwordx4 v24, s[20:23], s39 offen lds
    v_lshlrev_b32 v246, 16, v123
    s_add_u32 m0, s44, 50176
    s_mov_b32 s39, 2654464
    v_mfma_f32_16x16x32_bf16 a[108:111], a[216:219], v[100:103], a[108:111]
    buffer_load_dwordx4 v24, s[20:23], s39 offen lds
    v_and_b32 v247, 0xffff0000, v123
    s_add_u32 m0, s44, 51200
    s_mov_b32 s39, 2687232
    v_mfma_f32_16x16x32_bf16 a[120:123], a[220:223], v[96:99], a[120:123]
    buffer_load_dwordx4 v25, s[20:23], s39 offen lds
    v_fma_f32 v246, v246, v238, v230
    s_add_u32 m0, s44, 52224
    s_mov_b32 s39, 2720000
    v_mfma_f32_16x16x32_bf16 a[124:127], a[220:223], v[100:103], a[124:127]
    buffer_load_dwordx4 v25, s[20:23], s39 offen lds
    v_fma_f32 v247, v247, v239, v231
    v_cvt_pk_bf16_f32 v123, v246, v247
    s_waitcnt lgkmcnt(0)
    s_waitcnt vmcnt(24)
    s_barrier
    v_mfma_f32_16x16x32_bf16 a[8:11], a[224:227], v[104:107], a[8:11]
    ds_read_b64_tr_b16 a[192:193], v34 offset:32768
    ds_read_b64_tr_b16 a[194:195], v34 offset:33792
    v_lshlrev_b32 v240, 16, v124
    v_mfma_f32_16x16x32_bf16 a[12:15], a[224:227], v[108:111], a[12:15]
    ds_read_b64_tr_b16 a[196:197], v35 offset:32768
    v_and_b32 v241, 0xffff0000, v124
    v_mfma_f32_16x16x32_bf16 a[24:27], a[228:231], v[104:107], a[24:27]
    ds_read_b64_tr_b16 a[198:199], v35 offset:33792
    v_fma_f32 v240, v240, v232, v224
    v_fma_f32 v241, v241, v233, v225
    v_mfma_f32_16x16x32_bf16 a[28:31], a[228:231], v[108:111], a[28:31]
    ds_read_b64_tr_b16 a[200:201], v36 offset:32768
    ds_read_b64_tr_b16 a[202:203], v36 offset:33792
    v_mfma_f32_16x16x32_bf16 a[40:43], a[232:235], v[104:107], a[40:43]
    ds_read_b64_tr_b16 a[204:205], v37 offset:32768
    v_cvt_pk_bf16_f32 v124, v240, v241
    v_lshlrev_b32 v242, 16, v125
    v_mfma_f32_16x16x32_bf16 a[44:47], a[232:235], v[108:111], a[44:47]
    ds_read_b64_tr_b16 a[206:207], v37 offset:33792
    v_and_b32 v243, 0xffff0000, v125
    v_mfma_f32_16x16x32_bf16 a[56:59], a[236:239], v[104:107], a[56:59]
    ds_read_b64_tr_b16 a[208:209], v38 offset:32768
    ds_read_b64_tr_b16 a[210:211], v38 offset:33792
    v_fma_f32 v242, v242, v234, v226
    v_mfma_f32_16x16x32_bf16 a[60:63], a[236:239], v[108:111], a[60:63]
    ds_read_b64_tr_b16 a[212:213], v39 offset:32768
    v_fma_f32 v243, v243, v235, v227
    v_mfma_f32_16x16x32_bf16 a[72:75], a[240:243], v[104:107], a[72:75]
    ds_read_b64_tr_b16 a[214:215], v39 offset:33792
    v_cvt_pk_bf16_f32 v125, v242, v243
    v_mfma_f32_16x16x32_bf16 a[76:79], a[240:243], v[108:111], a[76:79]
    ds_read_b64_tr_b16 a[216:217], v40 offset:32768
    ds_read_b64_tr_b16 a[218:219], v40 offset:33792
    v_mfma_f32_16x16x32_bf16 a[88:91], a[244:247], v[104:107], a[88:91]
    ds_read_b64_tr_b16 a[220:221], v41 offset:32768
    v_lshlrev_b32 v244, 16, v126
    v_mfma_f32_16x16x32_bf16 a[92:95], a[244:247], v[108:111], a[92:95]
    ds_read_b64_tr_b16 a[222:223], v41 offset:33792
    v_and_b32 v245, 0xffff0000, v126
    v_mfma_f32_16x16x32_bf16 a[104:107], a[248:251], v[104:107], a[104:107]
    v_fma_f32 v244, v244, v236, v228
    v_fma_f32 v245, v245, v237, v229
    v_mfma_f32_16x16x32_bf16 a[108:111], a[248:251], v[108:111], a[108:111]
    v_cvt_pk_bf16_f32 v126, v244, v245
    v_lshlrev_b32 v246, 16, v127
    v_mfma_f32_16x16x32_bf16 a[120:123], a[252:255], v[104:107], a[120:123]
    v_and_b32 v247, 0xffff0000, v127
    v_fma_f32 v246, v246, v238, v230
    v_mfma_f32_16x16x32_bf16 a[124:127], a[252:255], v[108:111], a[124:127]
    v_fma_f32 v247, v247, v239, v231
    v_cvt_pk_bf16_f32 v127, v246, v247
    s_waitcnt lgkmcnt(0)
    s_waitcnt vmcnt(20)
    v_mfma_f32_16x16x32_bf16 a[0:3], a[192:195], v[112:115], a[0:3]
    ds_read_b64_tr_b16 a[224:225], v34 offset:40960
    ds_read_b64_tr_b16 a[226:227], v34 offset:41984
    v_lshlrev_b32 v240, 16, v128
    v_mfma_f32_16x16x32_bf16 a[4:7], a[192:195], v[116:119], a[4:7]
    ds_read_b64_tr_b16 a[228:229], v35 offset:40960
    ds_read_b64_tr_b16 a[230:231], v35 offset:41984
    v_and_b32 v241, 0xffff0000, v128
    v_mfma_f32_16x16x32_bf16 a[16:19], a[196:199], v[112:115], a[16:19]
    ds_read_b64_tr_b16 a[232:233], v36 offset:40960
    v_fma_f32 v240, v240, v216, v208
    v_fma_f32 v241, v241, v217, v209
    v_mfma_f32_16x16x32_bf16 a[20:23], a[196:199], v[116:119], a[20:23]
    ds_read_b64_tr_b16 a[234:235], v36 offset:41984
    ds_read_b64_tr_b16 a[236:237], v37 offset:40960
    v_cvt_pk_bf16_f32 v128, v240, v241
    v_mfma_f32_16x16x32_bf16 a[32:35], a[200:203], v[112:115], a[32:35]
    ds_read_b64_tr_b16 a[238:239], v37 offset:41984
    ds_read_b64_tr_b16 a[240:241], v38 offset:40960
    v_lshlrev_b32 v242, 16, v129
    v_mfma_f32_16x16x32_bf16 a[36:39], a[200:203], v[116:119], a[36:39]
    ds_read_b64_tr_b16 a[242:243], v38 offset:41984
    v_and_b32 v243, 0xffff0000, v129
    v_fma_f32 v242, v242, v218, v210
    v_mfma_f32_16x16x32_bf16 a[48:51], a[204:207], v[112:115], a[48:51]
    ds_read_b64_tr_b16 a[244:245], v39 offset:40960
    ds_read_b64_tr_b16 a[246:247], v39 offset:41984
    v_fma_f32 v243, v243, v219, v211
    v_mfma_f32_16x16x32_bf16 a[52:55], a[204:207], v[116:119], a[52:55]
    ds_read_b64_tr_b16 a[248:249], v40 offset:40960
    ds_read_b64_tr_b16 a[250:251], v40 offset:41984
    v_cvt_pk_bf16_f32 v129, v242, v243
    v_mfma_f32_16x16x32_bf16 a[64:67], a[208:211], v[112:115], a[64:67]
    ds_read_b64_tr_b16 a[252:253], v41 offset:40960
    v_lshlrev_b32 v244, 16, v130
    v_and_b32 v245, 0xffff0000, v130
    v_mfma_f32_16x16x32_bf16 a[68:71], a[208:211], v[116:119], a[68:71]
    ds_read_b64_tr_b16 a[254:255], v41 offset:41984
    ds_read_b128 v[224:227], v42 offset:1152
    v_fma_f32 v244, v244, v220, v212
    v_mfma_f32_16x16x32_bf16 a[80:83], a[212:215], v[112:115], a[80:83]
    ds_read_b128 v[228:231], v42 offset:1168
    ds_read_b128 v[232:235], v42 offset:3456
    v_fma_f32 v245, v245, v221, v213
    v_mfma_f32_16x16x32_bf16 a[84:87], a[212:215], v[116:119], a[84:87]
    ds_read_b128 v[236:239], v42 offset:3472
    v_cvt_pk_bf16_f32 v130, v244, v245
    v_mfma_f32_16x16x32_bf16 a[96:99], a[216:219], v[112:115], a[96:99]
    buffer_load_dwordx4 v[160:163], v3, s[24:27], s48 offen offset:0
    v_lshlrev_b32 v246, 16, v131
    v_and_b32 v247, 0xffff0000, v131
    v_mfma_f32_16x16x32_bf16 a[100:103], a[216:219], v[116:119], a[100:103]
    buffer_load_dwordx4 v[164:167], v43, s[24:27], s48 offen offset:0
    v_fma_f32 v246, v246, v222, v214
    v_mfma_f32_16x16x32_bf16 a[112:115], a[220:223], v[112:115], a[112:115]
    buffer_load_dwordx4 v[168:171], v3, s[24:27], s48 offen offset:1024
    v_fma_f32 v247, v247, v223, v215
    v_cvt_pk_bf16_f32 v131, v246, v247
    v_mfma_f32_16x16x32_bf16 a[116:119], a[220:223], v[116:119], a[116:119]
    buffer_load_dwordx4 v[172:175], v43, s[24:27], s48 offen offset:1024
    s_add_u32 s48, s48, 2048
    s_waitcnt lgkmcnt(0)
    v_mfma_f32_16x16x32_bf16 a[0:3], a[224:227], v[120:123], a[0:3]
    ds_read_b64_tr_b16 a[192:193], v34 offset:49152
    ds_read_b64_tr_b16 a[194:195], v34 offset:50176
    v_lshlrev_b32 v240, 16, v132
    v_mfma_f32_16x16x32_bf16 a[4:7], a[224:227], v[124:127], a[4:7]
    ds_read_b64_tr_b16 a[196:197], v35 offset:49152
    v_and_b32 v241, 0xffff0000, v132
    v_fma_f32 v240, v240, v216, v208
    v_mfma_f32_16x16x32_bf16 a[16:19], a[228:231], v[120:123], a[16:19]
    ds_read_b64_tr_b16 a[198:199], v35 offset:50176
    v_fma_f32 v241, v241, v217, v209
    v_cvt_pk_bf16_f32 v132, v240, v241
    v_mfma_f32_16x16x32_bf16 a[20:23], a[228:231], v[124:127], a[20:23]
    ds_read_b64_tr_b16 a[200:201], v36 offset:49152
    ds_read_b64_tr_b16 a[202:203], v36 offset:50176
    v_lshlrev_b32 v242, 16, v133
    v_mfma_f32_16x16x32_bf16 a[32:35], a[232:235], v[120:123], a[32:35]
    ds_read_b64_tr_b16 a[204:205], v37 offset:49152
    v_and_b32 v243, 0xffff0000, v133
    v_fma_f32 v242, v242, v218, v210
    v_mfma_f32_16x16x32_bf16 a[36:39], a[232:235], v[124:127], a[36:39]
    ds_read_b64_tr_b16 a[206:207], v37 offset:50176
    v_fma_f32 v243, v243, v219, v211
    v_cvt_pk_bf16_f32 v133, v242, v243
    v_mfma_f32_16x16x32_bf16 a[48:51], a[236:239], v[120:123], a[48:51]
    ds_read_b64_tr_b16 a[208:209], v38 offset:49152
    ds_read_b64_tr_b16 a[210:211], v38 offset:50176
    v_lshlrev_b32 v244, 16, v134
    v_mfma_f32_16x16x32_bf16 a[52:55], a[236:239], v[124:127], a[52:55]
    ds_read_b64_tr_b16 a[212:213], v39 offset:49152
    v_and_b32 v245, 0xffff0000, v134
    v_fma_f32 v244, v244, v220, v212
    v_mfma_f32_16x16x32_bf16 a[64:67], a[240:243], v[120:123], a[64:67]
    ds_read_b64_tr_b16 a[214:215], v39 offset:50176
    v_fma_f32 v245, v245, v221, v213
    v_cvt_pk_bf16_f32 v134, v244, v245
    v_mfma_f32_16x16x32_bf16 a[68:71], a[240:243], v[124:127], a[68:71]
    ds_read_b64_tr_b16 a[216:217], v40 offset:49152
    ds_read_b64_tr_b16 a[218:219], v40 offset:50176
    v_mfma_f32_16x16x32_bf16 a[80:83], a[244:247], v[120:123], a[80:83]
    ds_read_b64_tr_b16 a[220:221], v41 offset:49152
    v_lshlrev_b32 v246, 16, v135
    v_and_b32 v247, 0xffff0000, v135
    v_mfma_f32_16x16x32_bf16 a[84:87], a[244:247], v[124:127], a[84:87]
    ds_read_b64_tr_b16 a[222:223], v41 offset:50176
    s_add_u32 m0, s44, 65536
    s_mov_b32 s39, 3145728
    v_mfma_f32_16x16x32_bf16 a[96:99], a[248:251], v[120:123], a[96:99]
    buffer_load_dwordx4 v24, s[20:23], s39 offen lds
    v_fma_f32 v246, v246, v222, v214
    s_add_u32 m0, s44, 66560
    s_mov_b32 s39, 3178496
    v_mfma_f32_16x16x32_bf16 a[100:103], a[248:251], v[124:127], a[100:103]
    buffer_load_dwordx4 v24, s[20:23], s39 offen lds
    s_add_u32 m0, s44, 67584
    s_mov_b32 s39, 3211264
    v_mfma_f32_16x16x32_bf16 a[112:115], a[252:255], v[120:123], a[112:115]
    buffer_load_dwordx4 v25, s[20:23], s39 offen lds
    v_fma_f32 v247, v247, v223, v215
    s_add_u32 m0, s44, 68608
    s_mov_b32 s39, 3244032
    v_mfma_f32_16x16x32_bf16 a[116:119], a[252:255], v[124:127], a[116:119]
    buffer_load_dwordx4 v25, s[20:23], s39 offen lds
    v_cvt_pk_bf16_f32 v135, v246, v247
    s_waitcnt lgkmcnt(0)
    v_mfma_f32_16x16x32_bf16 a[8:11], a[192:195], v[112:115], a[8:11]
    ds_read_b64_tr_b16 a[224:225], v34 offset:57344
    ds_read_b64_tr_b16 a[226:227], v34 offset:58368
    v_lshlrev_b32 v240, 16, v136
    v_mfma_f32_16x16x32_bf16 a[12:15], a[192:195], v[116:119], a[12:15]
    ds_read_b64_tr_b16 a[228:229], v35 offset:57344
    ds_read_b64_tr_b16 a[230:231], v35 offset:58368
    v_and_b32 v241, 0xffff0000, v136
    v_mfma_f32_16x16x32_bf16 a[24:27], a[196:199], v[112:115], a[24:27]
    ds_read_b64_tr_b16 a[232:233], v36 offset:57344
    v_fma_f32 v240, v240, v232, v224
    v_fma_f32 v241, v241, v233, v225
    v_mfma_f32_16x16x32_bf16 a[28:31], a[196:199], v[116:119], a[28:31]
    ds_read_b64_tr_b16 a[234:235], v36 offset:58368
    ds_read_b64_tr_b16 a[236:237], v37 offset:57344
    v_cvt_pk_bf16_f32 v136, v240, v241
    v_mfma_f32_16x16x32_bf16 a[40:43], a[200:203], v[112:115], a[40:43]
    ds_read_b64_tr_b16 a[238:239], v37 offset:58368
    ds_read_b64_tr_b16 a[240:241], v38 offset:57344
    v_lshlrev_b32 v242, 16, v137
    v_mfma_f32_16x16x32_bf16 a[44:47], a[200:203], v[116:119], a[44:47]
    ds_read_b64_tr_b16 a[242:243], v38 offset:58368
    v_and_b32 v243, 0xffff0000, v137
    v_fma_f32 v242, v242, v234, v226
    v_mfma_f32_16x16x32_bf16 a[56:59], a[204:207], v[112:115], a[56:59]
    ds_read_b64_tr_b16 a[244:245], v39 offset:57344
    ds_read_b64_tr_b16 a[246:247], v39 offset:58368
    v_fma_f32 v243, v243, v235, v227
    v_mfma_f32_16x16x32_bf16 a[60:63], a[204:207], v[116:119], a[60:63]
    ds_read_b64_tr_b16 a[248:249], v40 offset:57344
    ds_read_b64_tr_b16 a[250:251], v40 offset:58368
    v_cvt_pk_bf16_f32 v137, v242, v243
    v_mfma_f32_16x16x32_bf16 a[72:75], a[208:211], v[112:115], a[72:75]
    ds_read_b64_tr_b16 a[252:253], v41 offset:57344
    v_lshlrev_b32 v244, 16, v138
    v_and_b32 v245, 0xffff0000, v138
    v_mfma_f32_16x16x32_bf16 a[76:79], a[208:211], v[116:119], a[76:79]
    ds_read_b64_tr_b16 a[254:255], v41 offset:58368
    ds_read_b128 v[208:211], v42 offset:1280
    v_fma_f32 v244, v244, v236, v228
    v_mfma_f32_16x16x32_bf16 a[88:91], a[212:215], v[112:115], a[88:91]
    ds_read_b128 v[212:215], v42 offset:1296
    ds_read_b128 v[216:219], v42 offset:3584
    v_fma_f32 v245, v245, v237, v229
    v_mfma_f32_16x16x32_bf16 a[92:95], a[212:215], v[116:119], a[92:95]
    ds_read_b128 v[220:223], v42 offset:3600
    v_cvt_pk_bf16_f32 v138, v244, v245
    s_add_u32 m0, s44, 81920
    s_mov_b32 s39, 3145984
    v_mfma_f32_16x16x32_bf16 a[104:107], a[216:219], v[112:115], a[104:107]
    buffer_load_dwordx4 v24, s[20:23], s39 offen lds
    v_lshlrev_b32 v246, 16, v139
    s_add_u32 m0, s44, 82944
    s_mov_b32 s39, 3178752
    v_mfma_f32_16x16x32_bf16 a[108:111], a[216:219], v[116:119], a[108:111]
    buffer_load_dwordx4 v24, s[20:23], s39 offen lds
    v_and_b32 v247, 0xffff0000, v139
    s_add_u32 m0, s44, 83968
    s_mov_b32 s39, 3211520
    v_mfma_f32_16x16x32_bf16 a[120:123], a[220:223], v[112:115], a[120:123]
    buffer_load_dwordx4 v25, s[20:23], s39 offen lds
    v_fma_f32 v246, v246, v238, v230
    s_add_u32 m0, s44, 84992
    s_mov_b32 s39, 3244288
    v_mfma_f32_16x16x32_bf16 a[124:127], a[220:223], v[116:119], a[124:127]
    buffer_load_dwordx4 v25, s[20:23], s39 offen lds
    v_fma_f32 v247, v247, v239, v231
    v_cvt_pk_bf16_f32 v139, v246, v247
    s_waitcnt lgkmcnt(0)
    s_waitcnt vmcnt(24)
    s_barrier
    v_mfma_f32_16x16x32_bf16 a[8:11], a[224:227], v[120:123], a[8:11]
    ds_read_b64_tr_b16 a[192:193], v26 offset:0
    ds_read_b64_tr_b16 a[194:195], v26 offset:1024
    v_lshlrev_b32 v240, 16, v140
    v_mfma_f32_16x16x32_bf16 a[12:15], a[224:227], v[124:127], a[12:15]
    ds_read_b64_tr_b16 a[196:197], v27 offset:0
    v_and_b32 v241, 0xffff0000, v140
    v_mfma_f32_16x16x32_bf16 a[24:27], a[228:231], v[120:123], a[24:27]
    ds_read_b64_tr_b16 a[198:199], v27 offset:1024
    v_fma_f32 v240, v240, v232, v224
    v_fma_f32 v241, v241, v233, v225
    v_mfma_f32_16x16x32_bf16 a[28:31], a[228:231], v[124:127], a[28:31]
    ds_read_b64_tr_b16 a[200:201], v28 offset:0
    ds_read_b64_tr_b16 a[202:203], v28 offset:1024
    v_mfma_f32_16x16x32_bf16 a[40:43], a[232:235], v[120:123], a[40:43]
    ds_read_b64_tr_b16 a[204:205], v29 offset:0
    v_cvt_pk_bf16_f32 v140, v240, v241
    v_lshlrev_b32 v242, 16, v141
    v_mfma_f32_16x16x32_bf16 a[44:47], a[232:235], v[124:127], a[44:47]
    ds_read_b64_tr_b16 a[206:207], v29 offset:1024
    v_and_b32 v243, 0xffff0000, v141
    v_mfma_f32_16x16x32_bf16 a[56:59], a[236:239], v[120:123], a[56:59]
    ds_read_b64_tr_b16 a[208:209], v30 offset:0
    ds_read_b64_tr_b16 a[210:211], v30 offset:1024
    v_fma_f32 v242, v242, v234, v226
    v_mfma_f32_16x16x32_bf16 a[60:63], a[236:239], v[124:127], a[60:63]
    ds_read_b64_tr_b16 a[212:213], v31 offset:0
    v_fma_f32 v243, v243, v235, v227
    v_mfma_f32_16x16x32_bf16 a[72:75], a[240:243], v[120:123], a[72:75]
    ds_read_b64_tr_b16 a[214:215], v31 offset:1024
    v_cvt_pk_bf16_f32 v141, v242, v243
    v_mfma_f32_16x16x32_bf16 a[76:79], a[240:243], v[124:127], a[76:79]
    ds_read_b64_tr_b16 a[216:217], v32 offset:0
    ds_read_b64_tr_b16 a[218:219], v32 offset:1024
    v_mfma_f32_16x16x32_bf16 a[88:91], a[244:247], v[120:123], a[88:91]
    ds_read_b64_tr_b16 a[220:221], v33 offset:0
    v_lshlrev_b32 v244, 16, v142
    v_mfma_f32_16x16x32_bf16 a[92:95], a[244:247], v[124:127], a[92:95]
    ds_read_b64_tr_b16 a[222:223], v33 offset:1024
    v_and_b32 v245, 0xffff0000, v142
    v_mfma_f32_16x16x32_bf16 a[104:107], a[248:251], v[120:123], a[104:107]
    v_fma_f32 v244, v244, v236, v228
    v_fma_f32 v245, v245, v237, v229
    v_mfma_f32_16x16x32_bf16 a[108:111], a[248:251], v[124:127], a[108:111]
    v_cvt_pk_bf16_f32 v142, v244, v245
    v_lshlrev_b32 v246, 16, v143
    v_mfma_f32_16x16x32_bf16 a[120:123], a[252:255], v[120:123], a[120:123]
    v_and_b32 v247, 0xffff0000, v143
    v_fma_f32 v246, v246, v238, v230
    v_mfma_f32_16x16x32_bf16 a[124:127], a[252:255], v[124:127], a[124:127]
    v_fma_f32 v247, v247, v239, v231
    v_cvt_pk_bf16_f32 v143, v246, v247
    s_waitcnt lgkmcnt(0)
    s_waitcnt vmcnt(20)
    v_mfma_f32_16x16x32_bf16 a[0:3], a[192:195], v[128:131], a[0:3]
    ds_read_b64_tr_b16 a[224:225], v26 offset:8192
    ds_read_b64_tr_b16 a[226:227], v26 offset:9216
    v_lshlrev_b32 v240, 16, v144
    v_mfma_f32_16x16x32_bf16 a[4:7], a[192:195], v[132:135], a[4:7]
    ds_read_b64_tr_b16 a[228:229], v27 offset:8192
    ds_read_b64_tr_b16 a[230:231], v27 offset:9216
    v_and_b32 v241, 0xffff0000, v144
    v_mfma_f32_16x16x32_bf16 a[16:19], a[196:199], v[128:131], a[16:19]
    ds_read_b64_tr_b16 a[232:233], v28 offset:8192
    v_fma_f32 v240, v240, v216, v208
    v_fma_f32 v241, v241, v217, v209
    v_mfma_f32_16x16x32_bf16 a[20:23], a[196:199], v[132:135], a[20:23]
    ds_read_b64_tr_b16 a[234:235], v28 offset:9216
    ds_read_b64_tr_b16 a[236:237], v29 offset:8192
    v_cvt_pk_bf16_f32 v144, v240, v241
    v_mfma_f32_16x16x32_bf16 a[32:35], a[200:203], v[128:131], a[32:35]
    ds_read_b64_tr_b16 a[238:239], v29 offset:9216
    ds_read_b64_tr_b16 a[240:241], v30 offset:8192
    v_lshlrev_b32 v242, 16, v145
    v_mfma_f32_16x16x32_bf16 a[36:39], a[200:203], v[132:135], a[36:39]
    ds_read_b64_tr_b16 a[242:243], v30 offset:9216
    v_and_b32 v243, 0xffff0000, v145
    v_fma_f32 v242, v242, v218, v210
    v_mfma_f32_16x16x32_bf16 a[48:51], a[204:207], v[128:131], a[48:51]
    ds_read_b64_tr_b16 a[244:245], v31 offset:8192
    ds_read_b64_tr_b16 a[246:247], v31 offset:9216
    v_fma_f32 v243, v243, v219, v211
    v_mfma_f32_16x16x32_bf16 a[52:55], a[204:207], v[132:135], a[52:55]
    ds_read_b64_tr_b16 a[248:249], v32 offset:8192
    ds_read_b64_tr_b16 a[250:251], v32 offset:9216
    v_cvt_pk_bf16_f32 v145, v242, v243
    v_mfma_f32_16x16x32_bf16 a[64:67], a[208:211], v[128:131], a[64:67]
    ds_read_b64_tr_b16 a[252:253], v33 offset:8192
    v_lshlrev_b32 v244, 16, v146
    v_and_b32 v245, 0xffff0000, v146
    v_mfma_f32_16x16x32_bf16 a[68:71], a[208:211], v[132:135], a[68:71]
    ds_read_b64_tr_b16 a[254:255], v33 offset:9216
    ds_read_b128 v[224:227], v42 offset:1408
    v_fma_f32 v244, v244, v220, v212
    v_mfma_f32_16x16x32_bf16 a[80:83], a[212:215], v[128:131], a[80:83]
    ds_read_b128 v[228:231], v42 offset:1424
    ds_read_b128 v[232:235], v42 offset:3712
    v_fma_f32 v245, v245, v221, v213
    v_mfma_f32_16x16x32_bf16 a[84:87], a[212:215], v[132:135], a[84:87]
    ds_read_b128 v[236:239], v42 offset:3728
    v_cvt_pk_bf16_f32 v146, v244, v245
    v_mfma_f32_16x16x32_bf16 a[96:99], a[216:219], v[128:131], a[96:99]
    buffer_load_dwordx4 v[176:179], v3, s[24:27], s48 offen offset:0
    v_lshlrev_b32 v246, 16, v147
    v_and_b32 v247, 0xffff0000, v147
    v_mfma_f32_16x16x32_bf16 a[100:103], a[216:219], v[132:135], a[100:103]
    buffer_load_dwordx4 v[180:183], v43, s[24:27], s48 offen offset:0
    v_fma_f32 v246, v246, v222, v214
    v_mfma_f32_16x16x32_bf16 a[112:115], a[220:223], v[128:131], a[112:115]
    buffer_load_dwordx4 v[184:187], v3, s[24:27], s48 offen offset:1024
    v_fma_f32 v247, v247, v223, v215
    v_cvt_pk_bf16_f32 v147, v246, v247
    v_mfma_f32_16x16x32_bf16 a[116:119], a[220:223], v[132:135], a[116:119]
    buffer_load_dwordx4 v[188:191], v43, s[24:27], s48 offen offset:1024
    s_add_u32 s48, s48, 2048
    s_waitcnt lgkmcnt(0)
    v_mfma_f32_16x16x32_bf16 a[0:3], a[224:227], v[136:139], a[0:3]
    ds_read_b64_tr_b16 a[192:193], v26 offset:16384
    ds_read_b64_tr_b16 a[194:195], v26 offset:17408
    v_lshlrev_b32 v240, 16, v148
    v_mfma_f32_16x16x32_bf16 a[4:7], a[224:227], v[140:143], a[4:7]
    ds_read_b64_tr_b16 a[196:197], v27 offset:16384
    v_and_b32 v241, 0xffff0000, v148
    v_fma_f32 v240, v240, v216, v208
    v_mfma_f32_16x16x32_bf16 a[16:19], a[228:231], v[136:139], a[16:19]
    ds_read_b64_tr_b16 a[198:199], v27 offset:17408
    v_fma_f32 v241, v241, v217, v209
    v_cvt_pk_bf16_f32 v148, v240, v241
    v_mfma_f32_16x16x32_bf16 a[20:23], a[228:231], v[140:143], a[20:23]
    ds_read_b64_tr_b16 a[200:201], v28 offset:16384
    ds_read_b64_tr_b16 a[202:203], v28 offset:17408
    v_lshlrev_b32 v242, 16, v149
    v_mfma_f32_16x16x32_bf16 a[32:35], a[232:235], v[136:139], a[32:35]
    ds_read_b64_tr_b16 a[204:205], v29 offset:16384
    v_and_b32 v243, 0xffff0000, v149
    v_fma_f32 v242, v242, v218, v210
    v_mfma_f32_16x16x32_bf16 a[36:39], a[232:235], v[140:143], a[36:39]
    ds_read_b64_tr_b16 a[206:207], v29 offset:17408
    v_fma_f32 v243, v243, v219, v211
    v_cvt_pk_bf16_f32 v149, v242, v243
    v_mfma_f32_16x16x32_bf16 a[48:51], a[236:239], v[136:139], a[48:51]
    ds_read_b64_tr_b16 a[208:209], v30 offset:16384
    ds_read_b64_tr_b16 a[210:211], v30 offset:17408
    v_lshlrev_b32 v244, 16, v150
    v_mfma_f32_16x16x32_bf16 a[52:55], a[236:239], v[140:143], a[52:55]
    ds_read_b64_tr_b16 a[212:213], v31 offset:16384
    v_and_b32 v245, 0xffff0000, v150
    v_fma_f32 v244, v244, v220, v212
    v_mfma_f32_16x16x32_bf16 a[64:67], a[240:243], v[136:139], a[64:67]
    ds_read_b64_tr_b16 a[214:215], v31 offset:17408
    v_fma_f32 v245, v245, v221, v213
    v_cvt_pk_bf16_f32 v150, v244, v245
    v_mfma_f32_16x16x32_bf16 a[68:71], a[240:243], v[140:143], a[68:71]
    ds_read_b64_tr_b16 a[216:217], v32 offset:16384
    ds_read_b64_tr_b16 a[218:219], v32 offset:17408
    v_mfma_f32_16x16x32_bf16 a[80:83], a[244:247], v[136:139], a[80:83]
    ds_read_b64_tr_b16 a[220:221], v33 offset:16384
    v_lshlrev_b32 v246, 16, v151
    v_and_b32 v247, 0xffff0000, v151
    v_mfma_f32_16x16x32_bf16 a[84:87], a[244:247], v[140:143], a[84:87]
    ds_read_b64_tr_b16 a[222:223], v33 offset:17408
    s_add_u32 m0, s44, 98304
    s_mov_b32 s39, 3670016
    v_mfma_f32_16x16x32_bf16 a[96:99], a[248:251], v[136:139], a[96:99]
    buffer_load_dwordx4 v24, s[20:23], s39 offen lds
    v_fma_f32 v246, v246, v222, v214
    s_add_u32 m0, s44, 99328
    s_mov_b32 s39, 3702784
    v_mfma_f32_16x16x32_bf16 a[100:103], a[248:251], v[140:143], a[100:103]
    buffer_load_dwordx4 v24, s[20:23], s39 offen lds
    s_add_u32 m0, s44, 100352
    s_mov_b32 s39, 3735552
    v_mfma_f32_16x16x32_bf16 a[112:115], a[252:255], v[136:139], a[112:115]
    buffer_load_dwordx4 v25, s[20:23], s39 offen lds
    v_fma_f32 v247, v247, v223, v215
    s_add_u32 m0, s44, 101376
    s_mov_b32 s39, 3768320
    v_mfma_f32_16x16x32_bf16 a[116:119], a[252:255], v[140:143], a[116:119]
    buffer_load_dwordx4 v25, s[20:23], s39 offen lds
    v_cvt_pk_bf16_f32 v151, v246, v247
    s_waitcnt lgkmcnt(0)
    v_mfma_f32_16x16x32_bf16 a[8:11], a[192:195], v[128:131], a[8:11]
    ds_read_b64_tr_b16 a[224:225], v26 offset:24576
    ds_read_b64_tr_b16 a[226:227], v26 offset:25600
    v_lshlrev_b32 v240, 16, v152
    v_mfma_f32_16x16x32_bf16 a[12:15], a[192:195], v[132:135], a[12:15]
    ds_read_b64_tr_b16 a[228:229], v27 offset:24576
    ds_read_b64_tr_b16 a[230:231], v27 offset:25600
    v_and_b32 v241, 0xffff0000, v152
    v_mfma_f32_16x16x32_bf16 a[24:27], a[196:199], v[128:131], a[24:27]
    ds_read_b64_tr_b16 a[232:233], v28 offset:24576
    v_fma_f32 v240, v240, v232, v224
    v_fma_f32 v241, v241, v233, v225
    v_mfma_f32_16x16x32_bf16 a[28:31], a[196:199], v[132:135], a[28:31]
    ds_read_b64_tr_b16 a[234:235], v28 offset:25600
    ds_read_b64_tr_b16 a[236:237], v29 offset:24576
    v_cvt_pk_bf16_f32 v152, v240, v241
    v_mfma_f32_16x16x32_bf16 a[40:43], a[200:203], v[128:131], a[40:43]
    ds_read_b64_tr_b16 a[238:239], v29 offset:25600
    ds_read_b64_tr_b16 a[240:241], v30 offset:24576
    v_lshlrev_b32 v242, 16, v153
    v_mfma_f32_16x16x32_bf16 a[44:47], a[200:203], v[132:135], a[44:47]
    ds_read_b64_tr_b16 a[242:243], v30 offset:25600
    v_and_b32 v243, 0xffff0000, v153
    v_fma_f32 v242, v242, v234, v226
    v_mfma_f32_16x16x32_bf16 a[56:59], a[204:207], v[128:131], a[56:59]
    ds_read_b64_tr_b16 a[244:245], v31 offset:24576
    ds_read_b64_tr_b16 a[246:247], v31 offset:25600
    v_fma_f32 v243, v243, v235, v227
    v_mfma_f32_16x16x32_bf16 a[60:63], a[204:207], v[132:135], a[60:63]
    ds_read_b64_tr_b16 a[248:249], v32 offset:24576
    ds_read_b64_tr_b16 a[250:251], v32 offset:25600
    v_cvt_pk_bf16_f32 v153, v242, v243
    v_mfma_f32_16x16x32_bf16 a[72:75], a[208:211], v[128:131], a[72:75]
    ds_read_b64_tr_b16 a[252:253], v33 offset:24576
    v_lshlrev_b32 v244, 16, v154
    v_and_b32 v245, 0xffff0000, v154
    v_mfma_f32_16x16x32_bf16 a[76:79], a[208:211], v[132:135], a[76:79]
    ds_read_b64_tr_b16 a[254:255], v33 offset:25600
    ds_read_b128 v[208:211], v42 offset:1536
    v_fma_f32 v244, v244, v236, v228
    v_mfma_f32_16x16x32_bf16 a[88:91], a[212:215], v[128:131], a[88:91]
    ds_read_b128 v[212:215], v42 offset:1552
    ds_read_b128 v[216:219], v42 offset:3840
    v_fma_f32 v245, v245, v237, v229
    v_mfma_f32_16x16x32_bf16 a[92:95], a[212:215], v[132:135], a[92:95]
    ds_read_b128 v[220:223], v42 offset:3856
    v_cvt_pk_bf16_f32 v154, v244, v245
    s_add_u32 m0, s44, 114688
    s_mov_b32 s39, 3670272
    v_mfma_f32_16x16x32_bf16 a[104:107], a[216:219], v[128:131], a[104:107]
    buffer_load_dwordx4 v24, s[20:23], s39 offen lds
    v_lshlrev_b32 v246, 16, v155
    s_add_u32 m0, s44, 115712
    s_mov_b32 s39, 3703040
    v_mfma_f32_16x16x32_bf16 a[108:111], a[216:219], v[132:135], a[108:111]
    buffer_load_dwordx4 v24, s[20:23], s39 offen lds
    v_and_b32 v247, 0xffff0000, v155
    s_add_u32 m0, s44, 116736
    s_mov_b32 s39, 3735808
    v_mfma_f32_16x16x32_bf16 a[120:123], a[220:223], v[128:131], a[120:123]
    buffer_load_dwordx4 v25, s[20:23], s39 offen lds
    v_fma_f32 v246, v246, v238, v230
    s_add_u32 m0, s44, 117760
    s_mov_b32 s39, 3768576
    v_mfma_f32_16x16x32_bf16 a[124:127], a[220:223], v[132:135], a[124:127]
    buffer_load_dwordx4 v25, s[20:23], s39 offen lds
    v_fma_f32 v247, v247, v239, v231
    v_cvt_pk_bf16_f32 v155, v246, v247
    s_waitcnt lgkmcnt(0)
    s_waitcnt vmcnt(24)
    s_barrier
    v_mfma_f32_16x16x32_bf16 a[8:11], a[224:227], v[136:139], a[8:11]
    ds_read_b64_tr_b16 a[192:193], v26 offset:32768
    ds_read_b64_tr_b16 a[194:195], v26 offset:33792
    v_lshlrev_b32 v240, 16, v156
    v_mfma_f32_16x16x32_bf16 a[12:15], a[224:227], v[140:143], a[12:15]
    ds_read_b64_tr_b16 a[196:197], v27 offset:32768
    v_and_b32 v241, 0xffff0000, v156
    v_mfma_f32_16x16x32_bf16 a[24:27], a[228:231], v[136:139], a[24:27]
    ds_read_b64_tr_b16 a[198:199], v27 offset:33792
    v_fma_f32 v240, v240, v232, v224
    v_fma_f32 v241, v241, v233, v225
    v_mfma_f32_16x16x32_bf16 a[28:31], a[228:231], v[140:143], a[28:31]
    ds_read_b64_tr_b16 a[200:201], v28 offset:32768
    ds_read_b64_tr_b16 a[202:203], v28 offset:33792
    v_mfma_f32_16x16x32_bf16 a[40:43], a[232:235], v[136:139], a[40:43]
    ds_read_b64_tr_b16 a[204:205], v29 offset:32768
    v_cvt_pk_bf16_f32 v156, v240, v241
    v_lshlrev_b32 v242, 16, v157
    v_mfma_f32_16x16x32_bf16 a[44:47], a[232:235], v[140:143], a[44:47]
    ds_read_b64_tr_b16 a[206:207], v29 offset:33792
    v_and_b32 v243, 0xffff0000, v157
    v_mfma_f32_16x16x32_bf16 a[56:59], a[236:239], v[136:139], a[56:59]
    ds_read_b64_tr_b16 a[208:209], v30 offset:32768
    ds_read_b64_tr_b16 a[210:211], v30 offset:33792
    v_fma_f32 v242, v242, v234, v226
    v_mfma_f32_16x16x32_bf16 a[60:63], a[236:239], v[140:143], a[60:63]
    ds_read_b64_tr_b16 a[212:213], v31 offset:32768
    v_fma_f32 v243, v243, v235, v227
    v_mfma_f32_16x16x32_bf16 a[72:75], a[240:243], v[136:139], a[72:75]
    ds_read_b64_tr_b16 a[214:215], v31 offset:33792
    v_cvt_pk_bf16_f32 v157, v242, v243
    v_mfma_f32_16x16x32_bf16 a[76:79], a[240:243], v[140:143], a[76:79]
    ds_read_b64_tr_b16 a[216:217], v32 offset:32768
    ds_read_b64_tr_b16 a[218:219], v32 offset:33792
    v_mfma_f32_16x16x32_bf16 a[88:91], a[244:247], v[136:139], a[88:91]
    ds_read_b64_tr_b16 a[220:221], v33 offset:32768
    v_lshlrev_b32 v244, 16, v158
    v_mfma_f32_16x16x32_bf16 a[92:95], a[244:247], v[140:143], a[92:95]
    ds_read_b64_tr_b16 a[222:223], v33 offset:33792
    v_and_b32 v245, 0xffff0000, v158
    v_mfma_f32_16x16x32_bf16 a[104:107], a[248:251], v[136:139], a[104:107]
    v_fma_f32 v244, v244, v236, v228
    v_fma_f32 v245, v245, v237, v229
    v_mfma_f32_16x16x32_bf16 a[108:111], a[248:251], v[140:143], a[108:111]
    v_cvt_pk_bf16_f32 v158, v244, v245
    v_lshlrev_b32 v246, 16, v159
    v_mfma_f32_16x16x32_bf16 a[120:123], a[252:255], v[136:139], a[120:123]
    v_and_b32 v247, 0xffff0000, v159
    v_fma_f32 v246, v246, v238, v230
    v_mfma_f32_16x16x32_bf16 a[124:127], a[252:255], v[140:143], a[124:127]
    v_fma_f32 v247, v247, v239, v231
    v_cvt_pk_bf16_f32 v159, v246, v247
    s_waitcnt lgkmcnt(0)
    s_waitcnt vmcnt(20)
    v_mfma_f32_16x16x32_bf16 a[0:3], a[192:195], v[144:147], a[0:3]
    ds_read_b64_tr_b16 a[224:225], v26 offset:40960
    ds_read_b64_tr_b16 a[226:227], v26 offset:41984
    v_lshlrev_b32 v240, 16, v160
    v_mfma_f32_16x16x32_bf16 a[4:7], a[192:195], v[148:151], a[4:7]
    ds_read_b64_tr_b16 a[228:229], v27 offset:40960
    ds_read_b64_tr_b16 a[230:231], v27 offset:41984
    v_and_b32 v241, 0xffff0000, v160
    v_mfma_f32_16x16x32_bf16 a[16:19], a[196:199], v[144:147], a[16:19]
    ds_read_b64_tr_b16 a[232:233], v28 offset:40960
    v_fma_f32 v240, v240, v216, v208
    v_fma_f32 v241, v241, v217, v209
    v_mfma_f32_16x16x32_bf16 a[20:23], a[196:199], v[148:151], a[20:23]
    ds_read_b64_tr_b16 a[234:235], v28 offset:41984
    ds_read_b64_tr_b16 a[236:237], v29 offset:40960
    v_cvt_pk_bf16_f32 v160, v240, v241
    v_mfma_f32_16x16x32_bf16 a[32:35], a[200:203], v[144:147], a[32:35]
    ds_read_b64_tr_b16 a[238:239], v29 offset:41984
    ds_read_b64_tr_b16 a[240:241], v30 offset:40960
    v_lshlrev_b32 v242, 16, v161
    v_mfma_f32_16x16x32_bf16 a[36:39], a[200:203], v[148:151], a[36:39]
    ds_read_b64_tr_b16 a[242:243], v30 offset:41984
    v_and_b32 v243, 0xffff0000, v161
    v_fma_f32 v242, v242, v218, v210
    v_mfma_f32_16x16x32_bf16 a[48:51], a[204:207], v[144:147], a[48:51]
    ds_read_b64_tr_b16 a[244:245], v31 offset:40960
    ds_read_b64_tr_b16 a[246:247], v31 offset:41984
    v_fma_f32 v243, v243, v219, v211
    v_mfma_f32_16x16x32_bf16 a[52:55], a[204:207], v[148:151], a[52:55]
    ds_read_b64_tr_b16 a[248:249], v32 offset:40960
    ds_read_b64_tr_b16 a[250:251], v32 offset:41984
    v_cvt_pk_bf16_f32 v161, v242, v243
    v_mfma_f32_16x16x32_bf16 a[64:67], a[208:211], v[144:147], a[64:67]
    ds_read_b64_tr_b16 a[252:253], v33 offset:40960
    v_lshlrev_b32 v244, 16, v162
    v_and_b32 v245, 0xffff0000, v162
    v_mfma_f32_16x16x32_bf16 a[68:71], a[208:211], v[148:151], a[68:71]
    ds_read_b64_tr_b16 a[254:255], v33 offset:41984
    ds_read_b128 v[224:227], v42 offset:1664
    v_fma_f32 v244, v244, v220, v212
    v_mfma_f32_16x16x32_bf16 a[80:83], a[212:215], v[144:147], a[80:83]
    ds_read_b128 v[228:231], v42 offset:1680
    ds_read_b128 v[232:235], v42 offset:3968
    v_fma_f32 v245, v245, v221, v213
    v_mfma_f32_16x16x32_bf16 a[84:87], a[212:215], v[148:151], a[84:87]
    ds_read_b128 v[236:239], v42 offset:3984
    v_cvt_pk_bf16_f32 v162, v244, v245
    v_mfma_f32_16x16x32_bf16 a[96:99], a[216:219], v[144:147], a[96:99]
    buffer_load_dwordx4 v[192:195], v3, s[24:27], s48 offen offset:0
    v_lshlrev_b32 v246, 16, v163
    v_and_b32 v247, 0xffff0000, v163
    v_mfma_f32_16x16x32_bf16 a[100:103], a[216:219], v[148:151], a[100:103]
    buffer_load_dwordx4 v[196:199], v43, s[24:27], s48 offen offset:0
    v_fma_f32 v246, v246, v222, v214
    v_mfma_f32_16x16x32_bf16 a[112:115], a[220:223], v[144:147], a[112:115]
    buffer_load_dwordx4 v[200:203], v3, s[24:27], s48 offen offset:1024
    v_fma_f32 v247, v247, v223, v215
    v_cvt_pk_bf16_f32 v163, v246, v247
    v_mfma_f32_16x16x32_bf16 a[116:119], a[220:223], v[148:151], a[116:119]
    buffer_load_dwordx4 v[204:207], v43, s[24:27], s48 offen offset:1024
    s_add_u32 s48, s48, 2048
    s_waitcnt lgkmcnt(0)
    v_mfma_f32_16x16x32_bf16 a[0:3], a[224:227], v[152:155], a[0:3]
    ds_read_b64_tr_b16 a[192:193], v26 offset:49152
    ds_read_b64_tr_b16 a[194:195], v26 offset:50176
    v_lshlrev_b32 v240, 16, v164
    v_mfma_f32_16x16x32_bf16 a[4:7], a[224:227], v[156:159], a[4:7]
    ds_read_b64_tr_b16 a[196:197], v27 offset:49152
    v_and_b32 v241, 0xffff0000, v164
    v_fma_f32 v240, v240, v216, v208
    v_mfma_f32_16x16x32_bf16 a[16:19], a[228:231], v[152:155], a[16:19]
    ds_read_b64_tr_b16 a[198:199], v27 offset:50176
    v_fma_f32 v241, v241, v217, v209
    v_cvt_pk_bf16_f32 v164, v240, v241
    v_mfma_f32_16x16x32_bf16 a[20:23], a[228:231], v[156:159], a[20:23]
    ds_read_b64_tr_b16 a[200:201], v28 offset:49152
    ds_read_b64_tr_b16 a[202:203], v28 offset:50176
    v_lshlrev_b32 v242, 16, v165
    v_mfma_f32_16x16x32_bf16 a[32:35], a[232:235], v[152:155], a[32:35]
    ds_read_b64_tr_b16 a[204:205], v29 offset:49152
    v_and_b32 v243, 0xffff0000, v165
    v_fma_f32 v242, v242, v218, v210
    v_mfma_f32_16x16x32_bf16 a[36:39], a[232:235], v[156:159], a[36:39]
    ds_read_b64_tr_b16 a[206:207], v29 offset:50176
    v_fma_f32 v243, v243, v219, v211
    v_cvt_pk_bf16_f32 v165, v242, v243
    v_mfma_f32_16x16x32_bf16 a[48:51], a[236:239], v[152:155], a[48:51]
    ds_read_b64_tr_b16 a[208:209], v30 offset:49152
    ds_read_b64_tr_b16 a[210:211], v30 offset:50176
    v_lshlrev_b32 v244, 16, v166
    v_mfma_f32_16x16x32_bf16 a[52:55], a[236:239], v[156:159], a[52:55]
    ds_read_b64_tr_b16 a[212:213], v31 offset:49152
    v_and_b32 v245, 0xffff0000, v166
    v_fma_f32 v244, v244, v220, v212
    v_mfma_f32_16x16x32_bf16 a[64:67], a[240:243], v[152:155], a[64:67]
    ds_read_b64_tr_b16 a[214:215], v31 offset:50176
    v_fma_f32 v245, v245, v221, v213
    v_cvt_pk_bf16_f32 v166, v244, v245
    v_mfma_f32_16x16x32_bf16 a[68:71], a[240:243], v[156:159], a[68:71]
    ds_read_b64_tr_b16 a[216:217], v32 offset:49152
    ds_read_b64_tr_b16 a[218:219], v32 offset:50176
    v_mfma_f32_16x16x32_bf16 a[80:83], a[244:247], v[152:155], a[80:83]
    ds_read_b64_tr_b16 a[220:221], v33 offset:49152
    v_lshlrev_b32 v246, 16, v167
    v_and_b32 v247, 0xffff0000, v167
    v_mfma_f32_16x16x32_bf16 a[84:87], a[244:247], v[156:159], a[84:87]
    ds_read_b64_tr_b16 a[222:223], v33 offset:50176
    s_add_u32 m0, s44, 0
    s_mov_b32 s39, 4194304
    v_mfma_f32_16x16x32_bf16 a[96:99], a[248:251], v[152:155], a[96:99]
    buffer_load_dwordx4 v24, s[20:23], s39 offen lds
    v_fma_f32 v246, v246, v222, v214
    s_add_u32 m0, s44, 1024
    s_mov_b32 s39, 4227072
    v_mfma_f32_16x16x32_bf16 a[100:103], a[248:251], v[156:159], a[100:103]
    buffer_load_dwordx4 v24, s[20:23], s39 offen lds
    s_add_u32 m0, s44, 2048
    s_mov_b32 s39, 4259840
    v_mfma_f32_16x16x32_bf16 a[112:115], a[252:255], v[152:155], a[112:115]
    buffer_load_dwordx4 v25, s[20:23], s39 offen lds
    v_fma_f32 v247, v247, v223, v215
    s_add_u32 m0, s44, 3072
    s_mov_b32 s39, 4292608
    v_mfma_f32_16x16x32_bf16 a[116:119], a[252:255], v[156:159], a[116:119]
    buffer_load_dwordx4 v25, s[20:23], s39 offen lds
    v_cvt_pk_bf16_f32 v167, v246, v247
    s_waitcnt lgkmcnt(0)
    v_mfma_f32_16x16x32_bf16 a[8:11], a[192:195], v[144:147], a[8:11]
    ds_read_b64_tr_b16 a[224:225], v26 offset:57344
    ds_read_b64_tr_b16 a[226:227], v26 offset:58368
    v_lshlrev_b32 v240, 16, v168
    v_mfma_f32_16x16x32_bf16 a[12:15], a[192:195], v[148:151], a[12:15]
    ds_read_b64_tr_b16 a[228:229], v27 offset:57344
    ds_read_b64_tr_b16 a[230:231], v27 offset:58368
    v_and_b32 v241, 0xffff0000, v168
    v_mfma_f32_16x16x32_bf16 a[24:27], a[196:199], v[144:147], a[24:27]
    ds_read_b64_tr_b16 a[232:233], v28 offset:57344
    v_fma_f32 v240, v240, v232, v224
    v_fma_f32 v241, v241, v233, v225
    v_mfma_f32_16x16x32_bf16 a[28:31], a[196:199], v[148:151], a[28:31]
    ds_read_b64_tr_b16 a[234:235], v28 offset:58368
    ds_read_b64_tr_b16 a[236:237], v29 offset:57344
    v_cvt_pk_bf16_f32 v168, v240, v241
    v_mfma_f32_16x16x32_bf16 a[40:43], a[200:203], v[144:147], a[40:43]
    ds_read_b64_tr_b16 a[238:239], v29 offset:58368
    ds_read_b64_tr_b16 a[240:241], v30 offset:57344
    v_lshlrev_b32 v242, 16, v169
    v_mfma_f32_16x16x32_bf16 a[44:47], a[200:203], v[148:151], a[44:47]
    ds_read_b64_tr_b16 a[242:243], v30 offset:58368
    v_and_b32 v243, 0xffff0000, v169
    v_fma_f32 v242, v242, v234, v226
    v_mfma_f32_16x16x32_bf16 a[56:59], a[204:207], v[144:147], a[56:59]
    ds_read_b64_tr_b16 a[244:245], v31 offset:57344
    ds_read_b64_tr_b16 a[246:247], v31 offset:58368
    v_fma_f32 v243, v243, v235, v227
    v_mfma_f32_16x16x32_bf16 a[60:63], a[204:207], v[148:151], a[60:63]
    ds_read_b64_tr_b16 a[248:249], v32 offset:57344
    ds_read_b64_tr_b16 a[250:251], v32 offset:58368
    v_cvt_pk_bf16_f32 v169, v242, v243
    v_mfma_f32_16x16x32_bf16 a[72:75], a[208:211], v[144:147], a[72:75]
    ds_read_b64_tr_b16 a[252:253], v33 offset:57344
    v_lshlrev_b32 v244, 16, v170
    v_and_b32 v245, 0xffff0000, v170
    v_mfma_f32_16x16x32_bf16 a[76:79], a[208:211], v[148:151], a[76:79]
    ds_read_b64_tr_b16 a[254:255], v33 offset:58368
    ds_read_b128 v[208:211], v42 offset:1792
    v_fma_f32 v244, v244, v236, v228
    v_mfma_f32_16x16x32_bf16 a[88:91], a[212:215], v[144:147], a[88:91]
    ds_read_b128 v[212:215], v42 offset:1808
    ds_read_b128 v[216:219], v42 offset:4096
    v_fma_f32 v245, v245, v237, v229
    v_mfma_f32_16x16x32_bf16 a[92:95], a[212:215], v[148:151], a[92:95]
    ds_read_b128 v[220:223], v42 offset:4112
    v_cvt_pk_bf16_f32 v170, v244, v245
    s_add_u32 m0, s44, 16384
    s_mov_b32 s39, 4194560
    v_mfma_f32_16x16x32_bf16 a[104:107], a[216:219], v[144:147], a[104:107]
    buffer_load_dwordx4 v24, s[20:23], s39 offen lds
    v_lshlrev_b32 v246, 16, v171
    s_add_u32 m0, s44, 17408
    s_mov_b32 s39, 4227328
    v_mfma_f32_16x16x32_bf16 a[108:111], a[216:219], v[148:151], a[108:111]
    buffer_load_dwordx4 v24, s[20:23], s39 offen lds
    v_and_b32 v247, 0xffff0000, v171
    s_add_u32 m0, s44, 18432
    s_mov_b32 s39, 4260096
    v_mfma_f32_16x16x32_bf16 a[120:123], a[220:223], v[144:147], a[120:123]
    buffer_load_dwordx4 v25, s[20:23], s39 offen lds
    v_fma_f32 v246, v246, v238, v230
    s_add_u32 m0, s44, 19456
    s_mov_b32 s39, 4292864
    v_mfma_f32_16x16x32_bf16 a[124:127], a[220:223], v[148:151], a[124:127]
    buffer_load_dwordx4 v25, s[20:23], s39 offen lds
    v_fma_f32 v247, v247, v239, v231
    v_cvt_pk_bf16_f32 v171, v246, v247
    s_waitcnt lgkmcnt(0)
    s_waitcnt vmcnt(24)
    s_barrier
    v_mfma_f32_16x16x32_bf16 a[8:11], a[224:227], v[152:155], a[8:11]
    ds_read_b64_tr_b16 a[192:193], v34 offset:0
    ds_read_b64_tr_b16 a[194:195], v34 offset:1024
    v_lshlrev_b32 v240, 16, v172
    v_mfma_f32_16x16x32_bf16 a[12:15], a[224:227], v[156:159], a[12:15]
    ds_read_b64_tr_b16 a[196:197], v35 offset:0
    v_and_b32 v241, 0xffff0000, v172
    v_mfma_f32_16x16x32_bf16 a[24:27], a[228:231], v[152:155], a[24:27]
    ds_read_b64_tr_b16 a[198:199], v35 offset:1024
    v_fma_f32 v240, v240, v232, v224
    v_fma_f32 v241, v241, v233, v225
    v_mfma_f32_16x16x32_bf16 a[28:31], a[228:231], v[156:159], a[28:31]
    ds_read_b64_tr_b16 a[200:201], v36 offset:0
    ds_read_b64_tr_b16 a[202:203], v36 offset:1024
    v_mfma_f32_16x16x32_bf16 a[40:43], a[232:235], v[152:155], a[40:43]
    ds_read_b64_tr_b16 a[204:205], v37 offset:0
    v_cvt_pk_bf16_f32 v172, v240, v241
    v_lshlrev_b32 v242, 16, v173
    v_mfma_f32_16x16x32_bf16 a[44:47], a[232:235], v[156:159], a[44:47]
    ds_read_b64_tr_b16 a[206:207], v37 offset:1024
    v_and_b32 v243, 0xffff0000, v173
    v_mfma_f32_16x16x32_bf16 a[56:59], a[236:239], v[152:155], a[56:59]
    ds_read_b64_tr_b16 a[208:209], v38 offset:0
    ds_read_b64_tr_b16 a[210:211], v38 offset:1024
    v_fma_f32 v242, v242, v234, v226
    v_mfma_f32_16x16x32_bf16 a[60:63], a[236:239], v[156:159], a[60:63]
    ds_read_b64_tr_b16 a[212:213], v39 offset:0
    v_fma_f32 v243, v243, v235, v227
    v_mfma_f32_16x16x32_bf16 a[72:75], a[240:243], v[152:155], a[72:75]
    ds_read_b64_tr_b16 a[214:215], v39 offset:1024
    v_cvt_pk_bf16_f32 v173, v242, v243
    v_mfma_f32_16x16x32_bf16 a[76:79], a[240:243], v[156:159], a[76:79]
    ds_read_b64_tr_b16 a[216:217], v40 offset:0
    ds_read_b64_tr_b16 a[218:219], v40 offset:1024
    v_mfma_f32_16x16x32_bf16 a[88:91], a[244:247], v[152:155], a[88:91]
    ds_read_b64_tr_b16 a[220:221], v41 offset:0
    v_lshlrev_b32 v244, 16, v174
    v_mfma_f32_16x16x32_bf16 a[92:95], a[244:247], v[156:159], a[92:95]
    ds_read_b64_tr_b16 a[222:223], v41 offset:1024
    v_and_b32 v245, 0xffff0000, v174
    v_mfma_f32_16x16x32_bf16 a[104:107], a[248:251], v[152:155], a[104:107]
    v_fma_f32 v244, v244, v236, v228
    v_fma_f32 v245, v245, v237, v229
    v_mfma_f32_16x16x32_bf16 a[108:111], a[248:251], v[156:159], a[108:111]
    v_cvt_pk_bf16_f32 v174, v244, v245
    v_lshlrev_b32 v246, 16, v175
    v_mfma_f32_16x16x32_bf16 a[120:123], a[252:255], v[152:155], a[120:123]
    v_and_b32 v247, 0xffff0000, v175
    v_fma_f32 v246, v246, v238, v230
    v_mfma_f32_16x16x32_bf16 a[124:127], a[252:255], v[156:159], a[124:127]
    v_fma_f32 v247, v247, v239, v231
    v_cvt_pk_bf16_f32 v175, v246, v247
    s_waitcnt lgkmcnt(0)
    s_waitcnt vmcnt(20)
    v_mfma_f32_16x16x32_bf16 a[0:3], a[192:195], v[160:163], a[0:3]
    ds_read_b64_tr_b16 a[224:225], v34 offset:8192
    ds_read_b64_tr_b16 a[226:227], v34 offset:9216
    v_lshlrev_b32 v240, 16, v176
    v_mfma_f32_16x16x32_bf16 a[4:7], a[192:195], v[164:167], a[4:7]
    ds_read_b64_tr_b16 a[228:229], v35 offset:8192
    ds_read_b64_tr_b16 a[230:231], v35 offset:9216
    v_and_b32 v241, 0xffff0000, v176
    v_mfma_f32_16x16x32_bf16 a[16:19], a[196:199], v[160:163], a[16:19]
    ds_read_b64_tr_b16 a[232:233], v36 offset:8192
    v_fma_f32 v240, v240, v216, v208
    v_fma_f32 v241, v241, v217, v209
    v_mfma_f32_16x16x32_bf16 a[20:23], a[196:199], v[164:167], a[20:23]
    ds_read_b64_tr_b16 a[234:235], v36 offset:9216
    ds_read_b64_tr_b16 a[236:237], v37 offset:8192
    v_cvt_pk_bf16_f32 v176, v240, v241
    v_mfma_f32_16x16x32_bf16 a[32:35], a[200:203], v[160:163], a[32:35]
    ds_read_b64_tr_b16 a[238:239], v37 offset:9216
    ds_read_b64_tr_b16 a[240:241], v38 offset:8192
    v_lshlrev_b32 v242, 16, v177
    v_mfma_f32_16x16x32_bf16 a[36:39], a[200:203], v[164:167], a[36:39]
    ds_read_b64_tr_b16 a[242:243], v38 offset:9216
    v_and_b32 v243, 0xffff0000, v177
    v_fma_f32 v242, v242, v218, v210
    v_mfma_f32_16x16x32_bf16 a[48:51], a[204:207], v[160:163], a[48:51]
    ds_read_b64_tr_b16 a[244:245], v39 offset:8192
    ds_read_b64_tr_b16 a[246:247], v39 offset:9216
    v_fma_f32 v243, v243, v219, v211
    v_mfma_f32_16x16x32_bf16 a[52:55], a[204:207], v[164:167], a[52:55]
    ds_read_b64_tr_b16 a[248:249], v40 offset:8192
    ds_read_b64_tr_b16 a[250:251], v40 offset:9216
    v_cvt_pk_bf16_f32 v177, v242, v243
    v_mfma_f32_16x16x32_bf16 a[64:67], a[208:211], v[160:163], a[64:67]
    ds_read_b64_tr_b16 a[252:253], v41 offset:8192
    v_lshlrev_b32 v244, 16, v178
    v_and_b32 v245, 0xffff0000, v178
    v_mfma_f32_16x16x32_bf16 a[68:71], a[208:211], v[164:167], a[68:71]
    ds_read_b64_tr_b16 a[254:255], v41 offset:9216
    ds_read_b128 v[224:227], v42 offset:1920
    v_fma_f32 v244, v244, v220, v212
    v_mfma_f32_16x16x32_bf16 a[80:83], a[212:215], v[160:163], a[80:83]
    ds_read_b128 v[228:231], v42 offset:1936
    ds_read_b128 v[232:235], v42 offset:4224
    v_fma_f32 v245, v245, v221, v213
    v_mfma_f32_16x16x32_bf16 a[84:87], a[212:215], v[164:167], a[84:87]
    ds_read_b128 v[236:239], v42 offset:4240
    v_cvt_pk_bf16_f32 v178, v244, v245
    s_add_u32 m0, s45, 32768
    v_mfma_f32_16x16x32_bf16 a[96:99], a[216:219], v[160:163], a[96:99]
    buffer_load_dwordx4 v20, s[12:15], s36 offen lds
    v_lshlrev_b32 v246, 16, v179
    v_and_b32 v247, 0xffff0000, v179
    v_mfma_f32_16x16x32_bf16 a[100:103], a[216:219], v[164:167], a[100:103]
    buffer_load_dwordx4 v21, s[12:15], s36 offen offset:1024 lds
    s_add_u32 s36, s36, 8192
    v_fma_f32 v246, v246, v222, v214
    s_add_u32 m0, s45, 40960
    v_mfma_f32_16x16x32_bf16 a[112:115], a[220:223], v[160:163], a[112:115]
    buffer_load_dwordx4 v20, s[12:15], s36 offen lds
    v_fma_f32 v247, v247, v223, v215
    v_cvt_pk_bf16_f32 v179, v246, v247
    v_mfma_f32_16x16x32_bf16 a[116:119], a[220:223], v[164:167], a[116:119]
    buffer_load_dwordx4 v21, s[12:15], s36 offen offset:1024 lds
    s_add_u32 s36, s36, 8192
    s_waitcnt lgkmcnt(0)
    v_mfma_f32_16x16x32_bf16 a[0:3], a[224:227], v[168:171], a[0:3]
    ds_read_b64_tr_b16 a[192:193], v34 offset:16384
    ds_read_b64_tr_b16 a[194:195], v34 offset:17408
    v_lshlrev_b32 v240, 16, v180
    v_mfma_f32_16x16x32_bf16 a[4:7], a[224:227], v[172:175], a[4:7]
    ds_read_b64_tr_b16 a[196:197], v35 offset:16384
    v_and_b32 v241, 0xffff0000, v180
    v_fma_f32 v240, v240, v216, v208
    v_mfma_f32_16x16x32_bf16 a[16:19], a[228:231], v[168:171], a[16:19]
    ds_read_b64_tr_b16 a[198:199], v35 offset:17408
    v_fma_f32 v241, v241, v217, v209
    v_cvt_pk_bf16_f32 v180, v240, v241
    v_mfma_f32_16x16x32_bf16 a[20:23], a[228:231], v[172:175], a[20:23]
    ds_read_b64_tr_b16 a[200:201], v36 offset:16384
    ds_read_b64_tr_b16 a[202:203], v36 offset:17408
    v_lshlrev_b32 v242, 16, v181
    v_mfma_f32_16x16x32_bf16 a[32:35], a[232:235], v[168:171], a[32:35]
    ds_read_b64_tr_b16 a[204:205], v37 offset:16384
    v_and_b32 v243, 0xffff0000, v181
    v_fma_f32 v242, v242, v218, v210
    v_mfma_f32_16x16x32_bf16 a[36:39], a[232:235], v[172:175], a[36:39]
    ds_read_b64_tr_b16 a[206:207], v37 offset:17408
    v_fma_f32 v243, v243, v219, v211
    v_cvt_pk_bf16_f32 v181, v242, v243
    v_mfma_f32_16x16x32_bf16 a[48:51], a[236:239], v[168:171], a[48:51]
    ds_read_b64_tr_b16 a[208:209], v38 offset:16384
    ds_read_b64_tr_b16 a[210:211], v38 offset:17408
    v_lshlrev_b32 v244, 16, v182
    v_mfma_f32_16x16x32_bf16 a[52:55], a[236:239], v[172:175], a[52:55]
    ds_read_b64_tr_b16 a[212:213], v39 offset:16384
    v_and_b32 v245, 0xffff0000, v182
    v_mfma_f32_16x16x32_bf16 a[64:67], a[240:243], v[168:171], a[64:67]
    ds_read_b64_tr_b16 a[214:215], v39 offset:17408
    v_fma_f32 v244, v244, v220, v212
    v_fma_f32 v245, v245, v221, v213
    v_mfma_f32_16x16x32_bf16 a[68:71], a[240:243], v[172:175], a[68:71]
    ds_read_b64_tr_b16 a[216:217], v40 offset:16384
    ds_read_b64_tr_b16 a[218:219], v40 offset:17408
    v_mfma_f32_16x16x32_bf16 a[80:83], a[244:247], v[168:171], a[80:83]
    ds_read_b64_tr_b16 a[220:221], v41 offset:16384
    v_cvt_pk_bf16_f32 v182, v244, v245
    v_lshlrev_b32 v246, 16, v183
    v_mfma_f32_16x16x32_bf16 a[84:87], a[244:247], v[172:175], a[84:87]
    ds_read_b64_tr_b16 a[222:223], v41 offset:17408
    s_add_u32 m0, s45, 49152
    v_mfma_f32_16x16x32_bf16 a[96:99], a[248:251], v[168:171], a[96:99]
    buffer_load_dwordx4 v20, s[12:15], s36 offen lds
    v_and_b32 v247, 0xffff0000, v183
    v_fma_f32 v246, v246, v222, v214
    v_mfma_f32_16x16x32_bf16 a[100:103], a[248:251], v[172:175], a[100:103]
    buffer_load_dwordx4 v21, s[12:15], s36 offen offset:1024 lds
    s_add_u32 s36, s36, 8192
    s_add_u32 m0, s45, 57344
    v_mfma_f32_16x16x32_bf16 a[112:115], a[252:255], v[168:171], a[112:115]
    buffer_load_dwordx4 v20, s[12:15], s36 offen lds
    v_fma_f32 v247, v247, v223, v215
    v_cvt_pk_bf16_f32 v183, v246, v247
    v_mfma_f32_16x16x32_bf16 a[116:119], a[252:255], v[172:175], a[116:119]
    buffer_load_dwordx4 v21, s[12:15], s36 offen offset:1024 lds
    s_add_u32 s36, s36, 8192
    s_waitcnt lgkmcnt(0)
    v_mfma_f32_16x16x32_bf16 a[8:11], a[192:195], v[160:163], a[8:11]
    ds_read_b64_tr_b16 a[224:225], v34 offset:24576
    ds_read_b64_tr_b16 a[226:227], v34 offset:25600
    v_lshlrev_b32 v240, 16, v184
    v_mfma_f32_16x16x32_bf16 a[12:15], a[192:195], v[164:167], a[12:15]
    ds_read_b64_tr_b16 a[228:229], v35 offset:24576
    ds_read_b64_tr_b16 a[230:231], v35 offset:25600
    v_mfma_f32_16x16x32_bf16 a[24:27], a[196:199], v[160:163], a[24:27]
    ds_read_b64_tr_b16 a[232:233], v36 offset:24576
    v_and_b32 v241, 0xffff0000, v184
    v_fma_f32 v240, v240, v232, v224
    v_mfma_f32_16x16x32_bf16 a[28:31], a[196:199], v[164:167], a[28:31]
    ds_read_b64_tr_b16 a[234:235], v36 offset:25600
    ds_read_b64_tr_b16 a[236:237], v37 offset:24576
    v_mfma_f32_16x16x32_bf16 a[40:43], a[200:203], v[160:163], a[40:43]
    ds_read_b64_tr_b16 a[238:239], v37 offset:25600
    ds_read_b64_tr_b16 a[240:241], v38 offset:24576
    v_fma_f32 v241, v241, v233, v225
    v_mfma_f32_16x16x32_bf16 a[44:47], a[200:203], v[164:167], a[44:47]
    ds_read_b64_tr_b16 a[242:243], v38 offset:25600
    v_cvt_pk_bf16_f32 v184, v240, v241
    v_mfma_f32_16x16x32_bf16 a[56:59], a[204:207], v[160:163], a[56:59]
    ds_read_b64_tr_b16 a[244:245], v39 offset:24576
    ds_read_b64_tr_b16 a[246:247], v39 offset:25600
    v_lshlrev_b32 v242, 16, v185
    v_mfma_f32_16x16x32_bf16 a[60:63], a[204:207], v[164:167], a[60:63]
    ds_read_b64_tr_b16 a[248:249], v40 offset:24576
    ds_read_b64_tr_b16 a[250:251], v40 offset:25600
    v_mfma_f32_16x16x32_bf16 a[72:75], a[208:211], v[160:163], a[72:75]
    ds_read_b64_tr_b16 a[252:253], v41 offset:24576
    v_and_b32 v243, 0xffff0000, v185
    v_fma_f32 v242, v242, v234, v226
    v_mfma_f32_16x16x32_bf16 a[76:79], a[208:211], v[164:167], a[76:79]
    ds_read_b64_tr_b16 a[254:255], v41 offset:25600
    ds_read_b128 v[208:211], v42 offset:2048
    v_mfma_f32_16x16x32_bf16 a[88:91], a[212:215], v[160:163], a[88:91]
    ds_read_b128 v[212:215], v42 offset:2064
    ds_read_b128 v[216:219], v42 offset:4352
    v_fma_f32 v243, v243, v235, v227
    v_mfma_f32_16x16x32_bf16 a[92:95], a[212:215], v[164:167], a[92:95]
    ds_read_b128 v[220:223], v42 offset:4368
    v_cvt_pk_bf16_f32 v185, v242, v243
    v_mfma_f32_16x16x32_bf16 a[104:107], a[216:219], v[160:163], a[104:107]
    v_lshlrev_b32 v244, 16, v186
    v_and_b32 v245, 0xffff0000, v186
    v_fma_f32 v244, v244, v236, v228
    v_mfma_f32_16x16x32_bf16 a[108:111], a[216:219], v[164:167], a[108:111]
    v_fma_f32 v245, v245, v237, v229
    v_cvt_pk_bf16_f32 v186, v244, v245
    v_mfma_f32_16x16x32_bf16 a[120:123], a[220:223], v[160:163], a[120:123]
    v_lshlrev_b32 v246, 16, v187
    v_and_b32 v247, 0xffff0000, v187
    v_fma_f32 v246, v246, v238, v230
    v_mfma_f32_16x16x32_bf16 a[124:127], a[220:223], v[164:167], a[124:127]
    v_fma_f32 v247, v247, v239, v231
    v_cvt_pk_bf16_f32 v187, v246, v247
    s_waitcnt lgkmcnt(0)
    s_waitcnt vmcnt(20)
    s_barrier
    v_mfma_f32_16x16x32_bf16 a[8:11], a[224:227], v[168:171], a[8:11]
    ds_read_b64_tr_b16 a[192:193], v34 offset:32768
    ds_read_b64_tr_b16 a[194:195], v34 offset:33792
    v_lshlrev_b32 v240, 16, v188
    v_mfma_f32_16x16x32_bf16 a[12:15], a[224:227], v[172:175], a[12:15]
    ds_read_b64_tr_b16 a[196:197], v35 offset:32768
    v_and_b32 v241, 0xffff0000, v188
    v_mfma_f32_16x16x32_bf16 a[24:27], a[228:231], v[168:171], a[24:27]
    ds_read_b64_tr_b16 a[198:199], v35 offset:33792
    v_fma_f32 v240, v240, v232, v224
    v_fma_f32 v241, v241, v233, v225
    v_mfma_f32_16x16x32_bf16 a[28:31], a[228:231], v[172:175], a[28:31]
    ds_read_b64_tr_b16 a[200:201], v36 offset:32768
    ds_read_b64_tr_b16 a[202:203], v36 offset:33792
    v_mfma_f32_16x16x32_bf16 a[40:43], a[232:235], v[168:171], a[40:43]
    ds_read_b64_tr_b16 a[204:205], v37 offset:32768
    v_cvt_pk_bf16_f32 v188, v240, v241
    v_lshlrev_b32 v242, 16, v189
    v_mfma_f32_16x16x32_bf16 a[44:47], a[232:235], v[172:175], a[44:47]
    ds_read_b64_tr_b16 a[206:207], v37 offset:33792
    v_and_b32 v243, 0xffff0000, v189
    v_mfma_f32_16x16x32_bf16 a[56:59], a[236:239], v[168:171], a[56:59]
    ds_read_b64_tr_b16 a[208:209], v38 offset:32768
    ds_read_b64_tr_b16 a[210:211], v38 offset:33792
    v_fma_f32 v242, v242, v234, v226
    v_mfma_f32_16x16x32_bf16 a[60:63], a[236:239], v[172:175], a[60:63]
    ds_read_b64_tr_b16 a[212:213], v39 offset:32768
    v_fma_f32 v243, v243, v235, v227
    v_mfma_f32_16x16x32_bf16 a[72:75], a[240:243], v[168:171], a[72:75]
    ds_read_b64_tr_b16 a[214:215], v39 offset:33792
    v_cvt_pk_bf16_f32 v189, v242, v243
    v_mfma_f32_16x16x32_bf16 a[76:79], a[240:243], v[172:175], a[76:79]
    ds_read_b64_tr_b16 a[216:217], v40 offset:32768
    ds_read_b64_tr_b16 a[218:219], v40 offset:33792
    v_mfma_f32_16x16x32_bf16 a[88:91], a[244:247], v[168:171], a[88:91]
    ds_read_b64_tr_b16 a[220:221], v41 offset:32768
    v_lshlrev_b32 v244, 16, v190
    v_mfma_f32_16x16x32_bf16 a[92:95], a[244:247], v[172:175], a[92:95]
    ds_read_b64_tr_b16 a[222:223], v41 offset:33792
    v_and_b32 v245, 0xffff0000, v190
    v_mfma_f32_16x16x32_bf16 a[104:107], a[248:251], v[168:171], a[104:107]
    v_fma_f32 v244, v244, v236, v228
    v_fma_f32 v245, v245, v237, v229
    v_mfma_f32_16x16x32_bf16 a[108:111], a[248:251], v[172:175], a[108:111]
    v_cvt_pk_bf16_f32 v190, v244, v245
    v_lshlrev_b32 v246, 16, v191
    v_mfma_f32_16x16x32_bf16 a[120:123], a[252:255], v[168:171], a[120:123]
    v_and_b32 v247, 0xffff0000, v191
    v_fma_f32 v246, v246, v238, v230
    v_mfma_f32_16x16x32_bf16 a[124:127], a[252:255], v[172:175], a[124:127]
    v_fma_f32 v247, v247, v239, v231
    v_cvt_pk_bf16_f32 v191, v246, v247
    s_waitcnt lgkmcnt(0)
    s_waitcnt vmcnt(16)
    v_mfma_f32_16x16x32_bf16 a[0:3], a[192:195], v[176:179], a[0:3]
    ds_read_b64_tr_b16 a[224:225], v34 offset:40960
    ds_read_b64_tr_b16 a[226:227], v34 offset:41984
    v_lshlrev_b32 v240, 16, v192
    v_mfma_f32_16x16x32_bf16 a[4:7], a[192:195], v[180:183], a[4:7]
    ds_read_b64_tr_b16 a[228:229], v35 offset:40960
    ds_read_b64_tr_b16 a[230:231], v35 offset:41984
    v_and_b32 v241, 0xffff0000, v192
    v_mfma_f32_16x16x32_bf16 a[16:19], a[196:199], v[176:179], a[16:19]
    ds_read_b64_tr_b16 a[232:233], v36 offset:40960
    v_fma_f32 v240, v240, v216, v208
    v_fma_f32 v241, v241, v217, v209
    v_mfma_f32_16x16x32_bf16 a[20:23], a[196:199], v[180:183], a[20:23]
    ds_read_b64_tr_b16 a[234:235], v36 offset:41984
    ds_read_b64_tr_b16 a[236:237], v37 offset:40960
    v_cvt_pk_bf16_f32 v192, v240, v241
    v_mfma_f32_16x16x32_bf16 a[32:35], a[200:203], v[176:179], a[32:35]
    ds_read_b64_tr_b16 a[238:239], v37 offset:41984
    ds_read_b64_tr_b16 a[240:241], v38 offset:40960
    v_lshlrev_b32 v242, 16, v193
    v_mfma_f32_16x16x32_bf16 a[36:39], a[200:203], v[180:183], a[36:39]
    ds_read_b64_tr_b16 a[242:243], v38 offset:41984
    v_and_b32 v243, 0xffff0000, v193
    v_fma_f32 v242, v242, v218, v210
    v_mfma_f32_16x16x32_bf16 a[48:51], a[204:207], v[176:179], a[48:51]
    ds_read_b64_tr_b16 a[244:245], v39 offset:40960
    ds_read_b64_tr_b16 a[246:247], v39 offset:41984
    v_fma_f32 v243, v243, v219, v211
    v_mfma_f32_16x16x32_bf16 a[52:55], a[204:207], v[180:183], a[52:55]
    ds_read_b64_tr_b16 a[248:249], v40 offset:40960
    ds_read_b64_tr_b16 a[250:251], v40 offset:41984
    v_cvt_pk_bf16_f32 v193, v242, v243
    v_mfma_f32_16x16x32_bf16 a[64:67], a[208:211], v[176:179], a[64:67]
    ds_read_b64_tr_b16 a[252:253], v41 offset:40960
    v_lshlrev_b32 v244, 16, v194
    v_and_b32 v245, 0xffff0000, v194
    v_mfma_f32_16x16x32_bf16 a[68:71], a[208:211], v[180:183], a[68:71]
    ds_read_b64_tr_b16 a[254:255], v41 offset:41984
    ds_read_b128 v[224:227], v42 offset:2176
    v_mfma_f32_16x16x32_bf16 a[80:83], a[212:215], v[176:179], a[80:83]
    ds_read_b128 v[228:231], v42 offset:2192
    ds_read_b128 v[232:235], v42 offset:4480
    v_fma_f32 v244, v244, v220, v212
    v_mfma_f32_16x16x32_bf16 a[84:87], a[212:215], v[180:183], a[84:87]
    ds_read_b128 v[236:239], v42 offset:4496
    s_add_u32 m0, s45, 65536
    v_mfma_f32_16x16x32_bf16 a[96:99], a[216:219], v[176:179], a[96:99]
    buffer_load_dwordx4 v22, s[16:19], s37 offen lds
    v_fma_f32 v245, v245, v221, v213
    v_cvt_pk_bf16_f32 v194, v244, v245
    v_mfma_f32_16x16x32_bf16 a[100:103], a[216:219], v[180:183], a[100:103]
    buffer_load_dwordx4 v23, s[16:19], s37 offen offset:1024 lds
    s_add_u32 s37, s37, 8192
    v_mfma_f32_16x16x32_bf16 a[112:115], a[220:223], v[176:179], a[112:115]
    v_lshlrev_b32 v246, 16, v195
    v_and_b32 v247, 0xffff0000, v195
    v_fma_f32 v246, v246, v222, v214
    v_mfma_f32_16x16x32_bf16 a[116:119], a[220:223], v[180:183], a[116:119]
    v_fma_f32 v247, v247, v223, v215
    v_cvt_pk_bf16_f32 v195, v246, v247
    s_waitcnt lgkmcnt(0)
    v_mfma_f32_16x16x32_bf16 a[0:3], a[224:227], v[184:187], a[0:3]
    ds_read_b64_tr_b16 a[192:193], v34 offset:49152
    ds_read_b64_tr_b16 a[194:195], v34 offset:50176
    v_lshlrev_b32 v240, 16, v196
    v_mfma_f32_16x16x32_bf16 a[4:7], a[224:227], v[188:191], a[4:7]
    ds_read_b64_tr_b16 a[196:197], v35 offset:49152
    v_and_b32 v241, 0xffff0000, v196
    v_mfma_f32_16x16x32_bf16 a[16:19], a[228:231], v[184:187], a[16:19]
    ds_read_b64_tr_b16 a[198:199], v35 offset:50176
    v_fma_f32 v240, v240, v216, v208
    v_fma_f32 v241, v241, v217, v209
    v_mfma_f32_16x16x32_bf16 a[20:23], a[228:231], v[188:191], a[20:23]
    ds_read_b64_tr_b16 a[200:201], v36 offset:49152
    ds_read_b64_tr_b16 a[202:203], v36 offset:50176
    v_mfma_f32_16x16x32_bf16 a[32:35], a[232:235], v[184:187], a[32:35]
    ds_read_b64_tr_b16 a[204:205], v37 offset:49152
    v_cvt_pk_bf16_f32 v196, v240, v241
    v_lshlrev_b32 v242, 16, v197
    v_mfma_f32_16x16x32_bf16 a[36:39], a[232:235], v[188:191], a[36:39]
    ds_read_b64_tr_b16 a[206:207], v37 offset:50176
    v_and_b32 v243, 0xffff0000, v197
    v_mfma_f32_16x16x32_bf16 a[48:51], a[236:239], v[184:187], a[48:51]
    ds_read_b64_tr_b16 a[208:209], v38 offset:49152
    ds_read_b64_tr_b16 a[210:211], v38 offset:50176
    v_fma_f32 v242, v242, v218, v210
    v_mfma_f32_16x16x32_bf16 a[52:55], a[236:239], v[188:191], a[52:55]
    ds_read_b64_tr_b16 a[212:213], v39 offset:49152
    v_fma_f32 v243, v243, v219, v211
    v_mfma_f32_16x16x32_bf16 a[64:67], a[240:243], v[184:187], a[64:67]
    ds_read_b64_tr_b16 a[214:215], v39 offset:50176
    v_cvt_pk_bf16_f32 v197, v242, v243
    v_lshlrev_b32 v244, 16, v198
    v_mfma_f32_16x16x32_bf16 a[68:71], a[240:243], v[188:191], a[68:71]
    ds_read_b64_tr_b16 a[216:217], v40 offset:49152
    ds_read_b64_tr_b16 a[218:219], v40 offset:50176
    v_mfma_f32_16x16x32_bf16 a[80:83], a[244:247], v[184:187], a[80:83]
    ds_read_b64_tr_b16 a[220:221], v41 offset:49152
    v_and_b32 v245, 0xffff0000, v198
    v_fma_f32 v244, v244, v220, v212
    v_mfma_f32_16x16x32_bf16 a[84:87], a[244:247], v[188:191], a[84:87]
    ds_read_b64_tr_b16 a[222:223], v41 offset:50176
    s_add_u32 m0, s45, 73728
    v_mfma_f32_16x16x32_bf16 a[96:99], a[248:251], v[184:187], a[96:99]
    buffer_load_dwordx4 v22, s[16:19], s37 offen lds
    v_fma_f32 v245, v245, v221, v213
    v_cvt_pk_bf16_f32 v198, v244, v245
    v_mfma_f32_16x16x32_bf16 a[100:103], a[248:251], v[188:191], a[100:103]
    buffer_load_dwordx4 v23, s[16:19], s37 offen offset:1024 lds
    s_add_u32 s37, s37, 8192
    v_mfma_f32_16x16x32_bf16 a[112:115], a[252:255], v[184:187], a[112:115]
    v_lshlrev_b32 v246, 16, v199
    v_and_b32 v247, 0xffff0000, v199
    v_fma_f32 v246, v246, v222, v214
    v_mfma_f32_16x16x32_bf16 a[116:119], a[252:255], v[188:191], a[116:119]
    v_fma_f32 v247, v247, v223, v215
    v_cvt_pk_bf16_f32 v199, v246, v247
    s_waitcnt lgkmcnt(0)
    v_mfma_f32_16x16x32_bf16 a[8:11], a[192:195], v[176:179], a[8:11]
    ds_read_b64_tr_b16 a[224:225], v34 offset:57344
    ds_read_b64_tr_b16 a[226:227], v34 offset:58368
    v_lshlrev_b32 v240, 16, v200
    v_mfma_f32_16x16x32_bf16 a[12:15], a[192:195], v[180:183], a[12:15]
    ds_read_b64_tr_b16 a[228:229], v35 offset:57344
    v_and_b32 v241, 0xffff0000, v200
    v_mfma_f32_16x16x32_bf16 a[24:27], a[196:199], v[176:179], a[24:27]
    ds_read_b64_tr_b16 a[230:231], v35 offset:58368
    v_fma_f32 v240, v240, v232, v224
    v_fma_f32 v241, v241, v233, v225
    v_mfma_f32_16x16x32_bf16 a[28:31], a[196:199], v[180:183], a[28:31]
    ds_read_b64_tr_b16 a[232:233], v36 offset:57344
    ds_read_b64_tr_b16 a[234:235], v36 offset:58368
    v_mfma_f32_16x16x32_bf16 a[40:43], a[200:203], v[176:179], a[40:43]
    ds_read_b64_tr_b16 a[236:237], v37 offset:57344
    v_cvt_pk_bf16_f32 v200, v240, v241
    v_lshlrev_b32 v242, 16, v201
    v_mfma_f32_16x16x32_bf16 a[44:47], a[200:203], v[180:183], a[44:47]
    ds_read_b64_tr_b16 a[238:239], v37 offset:58368
    v_and_b32 v243, 0xffff0000, v201
    v_mfma_f32_16x16x32_bf16 a[56:59], a[204:207], v[176:179], a[56:59]
    ds_read_b64_tr_b16 a[240:241], v38 offset:57344
    ds_read_b64_tr_b16 a[242:243], v38 offset:58368
    v_fma_f32 v242, v242, v234, v226
    v_mfma_f32_16x16x32_bf16 a[60:63], a[204:207], v[180:183], a[60:63]
    ds_read_b64_tr_b16 a[244:245], v39 offset:57344
    v_fma_f32 v243, v243, v235, v227
    v_mfma_f32_16x16x32_bf16 a[72:75], a[208:211], v[176:179], a[72:75]
    ds_read_b64_tr_b16 a[246:247], v39 offset:58368
    v_cvt_pk_bf16_f32 v201, v242, v243
    v_mfma_f32_16x16x32_bf16 a[76:79], a[208:211], v[180:183], a[76:79]
    ds_read_b64_tr_b16 a[248:249], v40 offset:57344
    ds_read_b64_tr_b16 a[250:251], v40 offset:58368
    v_mfma_f32_16x16x32_bf16 a[88:91], a[212:215], v[176:179], a[88:91]
    ds_read_b64_tr_b16 a[252:253], v41 offset:57344
    v_lshlrev_b32 v244, 16, v202
    v_mfma_f32_16x16x32_bf16 a[92:95], a[212:215], v[180:183], a[92:95]
    ds_read_b64_tr_b16 a[254:255], v41 offset:58368
    v_and_b32 v245, 0xffff0000, v202
    v_mfma_f32_16x16x32_bf16 a[104:107], a[216:219], v[176:179], a[104:107]
    v_fma_f32 v244, v244, v236, v228
    v_fma_f32 v245, v245, v237, v229
    v_mfma_f32_16x16x32_bf16 a[108:111], a[216:219], v[180:183], a[108:111]
    v_cvt_pk_bf16_f32 v202, v244, v245
    v_lshlrev_b32 v246, 16, v203
    v_mfma_f32_16x16x32_bf16 a[120:123], a[220:223], v[176:179], a[120:123]
    v_and_b32 v247, 0xffff0000, v203
    v_fma_f32 v246, v246, v238, v230
    v_mfma_f32_16x16x32_bf16 a[124:127], a[220:223], v[180:183], a[124:127]
    v_fma_f32 v247, v247, v239, v231
    v_cvt_pk_bf16_f32 v203, v246, v247
    s_waitcnt lgkmcnt(0)
    s_waitcnt vmcnt(12)
    s_barrier
    v_mfma_f32_16x16x32_bf16 a[8:11], a[224:227], v[184:187], a[8:11]
    ds_read_b64_tr_b16 a[192:193], v26 offset:0
    ds_read_b64_tr_b16 a[194:195], v26 offset:1024
    v_lshlrev_b32 v240, 16, v204
    v_mfma_f32_16x16x32_bf16 a[12:15], a[224:227], v[188:191], a[12:15]
    ds_read_b64_tr_b16 a[196:197], v27 offset:0
    v_and_b32 v241, 0xffff0000, v204
    v_mfma_f32_16x16x32_bf16 a[24:27], a[228:231], v[184:187], a[24:27]
    ds_read_b64_tr_b16 a[198:199], v27 offset:1024
    v_fma_f32 v240, v240, v232, v224
    v_fma_f32 v241, v241, v233, v225
    v_mfma_f32_16x16x32_bf16 a[28:31], a[228:231], v[188:191], a[28:31]
    ds_read_b64_tr_b16 a[200:201], v28 offset:0
    ds_read_b64_tr_b16 a[202:203], v28 offset:1024
    v_mfma_f32_16x16x32_bf16 a[40:43], a[232:235], v[184:187], a[40:43]
    ds_read_b64_tr_b16 a[204:205], v29 offset:0
    v_cvt_pk_bf16_f32 v204, v240, v241
    v_lshlrev_b32 v242, 16, v205
    v_mfma_f32_16x16x32_bf16 a[44:47], a[232:235], v[188:191], a[44:47]
    ds_read_b64_tr_b16 a[206:207], v29 offset:1024
    v_and_b32 v243, 0xffff0000, v205
    v_mfma_f32_16x16x32_bf16 a[56:59], a[236:239], v[184:187], a[56:59]
    ds_read_b64_tr_b16 a[208:209], v30 offset:0
    ds_read_b64_tr_b16 a[210:211], v30 offset:1024
    v_fma_f32 v242, v242, v234, v226
    v_mfma_f32_16x16x32_bf16 a[60:63], a[236:239], v[188:191], a[60:63]
    ds_read_b64_tr_b16 a[212:213], v31 offset:0
    v_fma_f32 v243, v243, v235, v227
    v_mfma_f32_16x16x32_bf16 a[72:75], a[240:243], v[184:187], a[72:75]
    ds_read_b64_tr_b16 a[214:215], v31 offset:1024
    v_cvt_pk_bf16_f32 v205, v242, v243
    v_mfma_f32_16x16x32_bf16 a[76:79], a[240:243], v[188:191], a[76:79]
    ds_read_b64_tr_b16 a[216:217], v32 offset:0
    ds_read_b64_tr_b16 a[218:219], v32 offset:1024
    v_mfma_f32_16x16x32_bf16 a[88:91], a[244:247], v[184:187], a[88:91]
    ds_read_b64_tr_b16 a[220:221], v33 offset:0
    v_lshlrev_b32 v244, 16, v206
    v_mfma_f32_16x16x32_bf16 a[92:95], a[244:247], v[188:191], a[92:95]
    ds_read_b64_tr_b16 a[222:223], v33 offset:1024
    v_and_b32 v245, 0xffff0000, v206
    v_mfma_f32_16x16x32_bf16 a[104:107], a[248:251], v[184:187], a[104:107]
    v_fma_f32 v244, v244, v236, v228
    v_fma_f32 v245, v245, v237, v229
    v_mfma_f32_16x16x32_bf16 a[108:111], a[248:251], v[188:191], a[108:111]
    v_cvt_pk_bf16_f32 v206, v244, v245
    v_lshlrev_b32 v246, 16, v207
    v_mfma_f32_16x16x32_bf16 a[120:123], a[252:255], v[184:187], a[120:123]
    v_and_b32 v247, 0xffff0000, v207
    v_fma_f32 v246, v246, v238, v230
    v_mfma_f32_16x16x32_bf16 a[124:127], a[252:255], v[188:191], a[124:127]
    v_fma_f32 v247, v247, v239, v231
    v_cvt_pk_bf16_f32 v207, v246, v247
    s_waitcnt lgkmcnt(0)
    v_mfma_f32_16x16x32_bf16 a[0:3], a[192:195], v[192:195], a[0:3]
    ds_read_b64_tr_b16 a[224:225], v26 offset:8192
    ds_read_b64_tr_b16 a[226:227], v26 offset:9216
    v_mfma_f32_16x16x32_bf16 a[4:7], a[192:195], v[196:199], a[4:7]
    ds_read_b64_tr_b16 a[228:229], v27 offset:8192
    v_mfma_f32_16x16x32_bf16 a[16:19], a[196:199], v[192:195], a[16:19]
    ds_read_b64_tr_b16 a[230:231], v27 offset:9216
    v_mfma_f32_16x16x32_bf16 a[20:23], a[196:199], v[196:199], a[20:23]
    ds_read_b64_tr_b16 a[232:233], v28 offset:8192
    ds_read_b64_tr_b16 a[234:235], v28 offset:9216
    v_mfma_f32_16x16x32_bf16 a[32:35], a[200:203], v[192:195], a[32:35]
    ds_read_b64_tr_b16 a[236:237], v29 offset:8192
    v_mfma_f32_16x16x32_bf16 a[36:39], a[200:203], v[196:199], a[36:39]
    ds_read_b64_tr_b16 a[238:239], v29 offset:9216
    v_mfma_f32_16x16x32_bf16 a[48:51], a[204:207], v[192:195], a[48:51]
    ds_read_b64_tr_b16 a[240:241], v30 offset:8192
    ds_read_b64_tr_b16 a[242:243], v30 offset:9216
    v_mfma_f32_16x16x32_bf16 a[52:55], a[204:207], v[196:199], a[52:55]
    ds_read_b64_tr_b16 a[244:245], v31 offset:8192
    v_mfma_f32_16x16x32_bf16 a[64:67], a[208:211], v[192:195], a[64:67]
    ds_read_b64_tr_b16 a[246:247], v31 offset:9216
    v_mfma_f32_16x16x32_bf16 a[68:71], a[208:211], v[196:199], a[68:71]
    ds_read_b64_tr_b16 a[248:249], v32 offset:8192
    ds_read_b64_tr_b16 a[250:251], v32 offset:9216
    v_mfma_f32_16x16x32_bf16 a[80:83], a[212:215], v[192:195], a[80:83]
    ds_read_b64_tr_b16 a[252:253], v33 offset:8192
    v_mfma_f32_16x16x32_bf16 a[84:87], a[212:215], v[196:199], a[84:87]
    ds_read_b64_tr_b16 a[254:255], v33 offset:9216
    s_add_u32 m0, s45, 81920
    v_mfma_f32_16x16x32_bf16 a[96:99], a[216:219], v[192:195], a[96:99]
    buffer_load_dwordx4 v22, s[16:19], s37 offen lds
    v_mfma_f32_16x16x32_bf16 a[100:103], a[216:219], v[196:199], a[100:103]
    buffer_load_dwordx4 v23, s[16:19], s37 offen offset:1024 lds
    s_add_u32 s37, s37, 8192
    v_mfma_f32_16x16x32_bf16 a[112:115], a[220:223], v[192:195], a[112:115]
    v_mfma_f32_16x16x32_bf16 a[116:119], a[220:223], v[196:199], a[116:119]
    s_waitcnt lgkmcnt(0)
    v_mfma_f32_16x16x32_bf16 a[0:3], a[224:227], v[200:203], a[0:3]
    ds_read_b64_tr_b16 a[192:193], v26 offset:16384
    ds_read_b64_tr_b16 a[194:195], v26 offset:17408
    v_mfma_f32_16x16x32_bf16 a[4:7], a[224:227], v[204:207], a[4:7]
    ds_read_b64_tr_b16 a[196:197], v27 offset:16384
    v_mfma_f32_16x16x32_bf16 a[16:19], a[228:231], v[200:203], a[16:19]
    ds_read_b64_tr_b16 a[198:199], v27 offset:17408
    v_mfma_f32_16x16x32_bf16 a[20:23], a[228:231], v[204:207], a[20:23]
    ds_read_b64_tr_b16 a[200:201], v28 offset:16384
    ds_read_b64_tr_b16 a[202:203], v28 offset:17408
    v_mfma_f32_16x16x32_bf16 a[32:35], a[232:235], v[200:203], a[32:35]
    ds_read_b64_tr_b16 a[204:205], v29 offset:16384
    v_mfma_f32_16x16x32_bf16 a[36:39], a[232:235], v[204:207], a[36:39]
    ds_read_b64_tr_b16 a[206:207], v29 offset:17408
    v_mfma_f32_16x16x32_bf16 a[48:51], a[236:239], v[200:203], a[48:51]
    ds_read_b64_tr_b16 a[208:209], v30 offset:16384
    ds_read_b64_tr_b16 a[210:211], v30 offset:17408
    v_mfma_f32_16x16x32_bf16 a[52:55], a[236:239], v[204:207], a[52:55]
    ds_read_b64_tr_b16 a[212:213], v31 offset:16384
    v_mfma_f32_16x16x32_bf16 a[64:67], a[240:243], v[200:203], a[64:67]
    ds_read_b64_tr_b16 a[214:215], v31 offset:17408
    v_mfma_f32_16x16x32_bf16 a[68:71], a[240:243], v[204:207], a[68:71]
    ds_read_b64_tr_b16 a[216:217], v32 offset:16384
    ds_read_b64_tr_b16 a[218:219], v32 offset:17408
    v_mfma_f32_16x16x32_bf16 a[80:83], a[244:247], v[200:203], a[80:83]
    ds_read_b64_tr_b16 a[220:221], v33 offset:16384
    v_mfma_f32_16x16x32_bf16 a[84:87], a[244:247], v[204:207], a[84:87]
    ds_read_b64_tr_b16 a[222:223], v33 offset:17408
    s_add_u32 m0, s45, 90112
    v_mfma_f32_16x16x32_bf16 a[96:99], a[248:251], v[200:203], a[96:99]
    buffer_load_dwordx4 v22, s[16:19], s37 offen lds
    v_mfma_f32_16x16x32_bf16 a[100:103], a[248:251], v[204:207], a[100:103]
    buffer_load_dwordx4 v23, s[16:19], s37 offen offset:1024 lds
    s_add_u32 s37, s37, 8192
    v_mfma_f32_16x16x32_bf16 a[112:115], a[252:255], v[200:203], a[112:115]
    v_mfma_f32_16x16x32_bf16 a[116:119], a[252:255], v[204:207], a[116:119]
    s_waitcnt lgkmcnt(0)
    v_mfma_f32_16x16x32_bf16 a[8:11], a[192:195], v[192:195], a[8:11]
    ds_read_b64_tr_b16 a[224:225], v26 offset:24576
    ds_read_b64_tr_b16 a[226:227], v26 offset:25600
    v_mfma_f32_16x16x32_bf16 a[12:15], a[192:195], v[196:199], a[12:15]
    ds_read_b64_tr_b16 a[228:229], v27 offset:24576
    v_mfma_f32_16x16x32_bf16 a[24:27], a[196:199], v[192:195], a[24:27]
    ds_read_b64_tr_b16 a[230:231], v27 offset:25600
    v_mfma_f32_16x16x32_bf16 a[28:31], a[196:199], v[196:199], a[28:31]
    ds_read_b64_tr_b16 a[232:233], v28 offset:24576
    ds_read_b64_tr_b16 a[234:235], v28 offset:25600
    v_mfma_f32_16x16x32_bf16 a[40:43], a[200:203], v[192:195], a[40:43]
    ds_read_b64_tr_b16 a[236:237], v29 offset:24576
    v_mfma_f32_16x16x32_bf16 a[44:47], a[200:203], v[196:199], a[44:47]
    ds_read_b64_tr_b16 a[238:239], v29 offset:25600
    v_mfma_f32_16x16x32_bf16 a[56:59], a[204:207], v[192:195], a[56:59]
    ds_read_b64_tr_b16 a[240:241], v30 offset:24576
    ds_read_b64_tr_b16 a[242:243], v30 offset:25600
    v_mfma_f32_16x16x32_bf16 a[60:63], a[204:207], v[196:199], a[60:63]
    ds_read_b64_tr_b16 a[244:245], v31 offset:24576
    v_mfma_f32_16x16x32_bf16 a[72:75], a[208:211], v[192:195], a[72:75]
    ds_read_b64_tr_b16 a[246:247], v31 offset:25600
    v_mfma_f32_16x16x32_bf16 a[76:79], a[208:211], v[196:199], a[76:79]
    ds_read_b64_tr_b16 a[248:249], v32 offset:24576
    ds_read_b64_tr_b16 a[250:251], v32 offset:25600
    v_mfma_f32_16x16x32_bf16 a[88:91], a[212:215], v[192:195], a[88:91]
    ds_read_b64_tr_b16 a[252:253], v33 offset:24576
    v_mfma_f32_16x16x32_bf16 a[92:95], a[212:215], v[196:199], a[92:95]
    ds_read_b64_tr_b16 a[254:255], v33 offset:25600
    v_mfma_f32_16x16x32_bf16 a[104:107], a[216:219], v[192:195], a[104:107]
    v_mfma_f32_16x16x32_bf16 a[108:111], a[216:219], v[196:199], a[108:111]
    v_mfma_f32_16x16x32_bf16 a[120:123], a[220:223], v[192:195], a[120:123]
    v_mfma_f32_16x16x32_bf16 a[124:127], a[220:223], v[196:199], a[124:127]
    s_waitcnt lgkmcnt(0)
    s_barrier
    v_mfma_f32_16x16x32_bf16 a[8:11], a[224:227], v[200:203], a[8:11]
    v_mfma_f32_16x16x32_bf16 a[12:15], a[224:227], v[204:207], a[12:15]
    v_mfma_f32_16x16x32_bf16 a[24:27], a[228:231], v[200:203], a[24:27]
    v_mfma_f32_16x16x32_bf16 a[28:31], a[228:231], v[204:207], a[28:31]
    v_mfma_f32_16x16x32_bf16 a[40:43], a[232:235], v[200:203], a[40:43]
    v_mfma_f32_16x16x32_bf16 a[44:47], a[232:235], v[204:207], a[44:47]
    v_mfma_f32_16x16x32_bf16 a[56:59], a[236:239], v[200:203], a[56:59]
    v_mfma_f32_16x16x32_bf16 a[60:63], a[236:239], v[204:207], a[60:63]
    v_mfma_f32_16x16x32_bf16 a[72:75], a[240:243], v[200:203], a[72:75]
    v_mfma_f32_16x16x32_bf16 a[76:79], a[240:243], v[204:207], a[76:79]
    v_mfma_f32_16x16x32_bf16 a[88:91], a[244:247], v[200:203], a[88:91]
    v_mfma_f32_16x16x32_bf16 a[92:95], a[244:247], v[204:207], a[92:95]
    s_add_u32 m0, s45, 0
    v_mfma_f32_16x16x32_bf16 a[104:107], a[248:251], v[200:203], a[104:107]
    buffer_load_dwordx4 v20, s[12:15], s36 offen lds
    v_mfma_f32_16x16x32_bf16 a[108:111], a[248:251], v[204:207], a[108:111]
    buffer_load_dwordx4 v21, s[12:15], s36 offen offset:1024 lds
    s_add_u32 s36, s36, 8192
    s_add_u32 m0, s45, 8192
    v_mfma_f32_16x16x32_bf16 a[120:123], a[252:255], v[200:203], a[120:123]
    buffer_load_dwordx4 v20, s[12:15], s36 offen lds
    v_mfma_f32_16x16x32_bf16 a[124:127], a[252:255], v[204:207], a[124:127]
    buffer_load_dwordx4 v21, s[12:15], s36 offen offset:1024 lds
    s_add_u32 s36, s36, 8192
    s_nop 7
    v_accvgpr_read_b32 v64, a0
    v_accvgpr_read_b32 v65, a1
    v_accvgpr_read_b32 v66, a2
    v_accvgpr_read_b32 v67, a3
    v_accvgpr_read_b32 v68, a16
    v_accvgpr_read_b32 v69, a17
    v_accvgpr_read_b32 v70, a18
    v_accvgpr_read_b32 v71, a19
    v_cvt_pk_bf16_f32 v72, v64, v65
    v_cvt_pk_bf16_f32 v73, v66, v67
    v_cvt_pk_bf16_f32 v74, v68, v69
    v_cvt_pk_bf16_f32 v75, v70, v71
    s_nop 0
    v_permlane32_swap_b32 v72, v74
    v_permlane32_swap_b32 v73, v75
    s_nop 0
    v_permlane16_swap_b32 v72, v74
    v_permlane16_swap_b32 v73, v75
    v_accvgpr_write_b32 a0, 0
    v_accvgpr_write_b32 a1, 0
    v_accvgpr_write_b32 a2, 0
    v_accvgpr_write_b32 a3, 0
    v_accvgpr_write_b32 a16, 0
    v_accvgpr_write_b32 a17, 0
    v_accvgpr_write_b32 a18, 0
    v_accvgpr_write_b32 a19, 0
    v_accvgpr_write_b32 a128, v72
    v_accvgpr_write_b32 a129, v73
    v_accvgpr_write_b32 a130, v74
    v_accvgpr_write_b32 a131, v75
    v_accvgpr_read_b32 v76, a32
    v_accvgpr_read_b32 v77, a33
    v_accvgpr_read_b32 v78, a34
    v_accvgpr_read_b32 v79, a35
    v_accvgpr_read_b32 v80, a48
    v_accvgpr_read_b32 v81, a49
    v_accvgpr_read_b32 v82, a50
    v_accvgpr_read_b32 v83, a51
    v_cvt_pk_bf16_f32 v84, v76, v77
    v_cvt_pk_bf16_f32 v85, v78, v79
    v_cvt_pk_bf16_f32 v86, v80, v81
    v_cvt_pk_bf16_f32 v87, v82, v83
    s_nop 0
    v_permlane32_swap_b32 v84, v86
    v_permlane32_swap_b32 v85, v87
    s_nop 0
    v_permlane16_swap_b32 v84, v86
    v_permlane16_swap_b32 v85, v87
    v_accvgpr_write_b32 a32, 0
    v_accvgpr_write_b32 a33, 0
    v_accvgpr_write_b32 a34, 0
    v_accvgpr_write_b32 a35, 0
    v_accvgpr_write_b32 a48, 0
    v_accvgpr_write_b32 a49, 0
    v_accvgpr_write_b32 a50, 0
    v_accvgpr_write_b32 a51, 0
    v_accvgpr_write_b32 a132, v84
    v_accvgpr_write_b32 a133, v85
    v_accvgpr_write_b32 a134, v86
    v_accvgpr_write_b32 a135, v87
    v_accvgpr_read_b32 v88, a64
    v_accvgpr_read_b32 v89, a65
    v_accvgpr_read_b32 v90, a66
    v_accvgpr_read_b32 v91, a67
    v_accvgpr_read_b32 v92, a80
    v_accvgpr_read_b32 v93, a81
    v_accvgpr_read_b32 v94, a82
    v_accvgpr_read_b32 v95, a83
    v_cvt_pk_bf16_f32 v96, v88, v89
    v_cvt_pk_bf16_f32 v97, v90, v91
    v_cvt_pk_bf16_f32 v98, v92, v93
    v_cvt_pk_bf16_f32 v99, v94, v95
    s_nop 0
    v_permlane32_swap_b32 v96, v98
    v_permlane32_swap_b32 v97, v99
    s_nop 0
    v_permlane16_swap_b32 v96, v98
    v_permlane16_swap_b32 v97, v99
    v_accvgpr_write_b32 a64, 0
    v_accvgpr_write_b32 a65, 0
    v_accvgpr_write_b32 a66, 0
    v_accvgpr_write_b32 a67, 0
    v_accvgpr_write_b32 a80, 0
    v_accvgpr_write_b32 a81, 0
    v_accvgpr_write_b32 a82, 0
    v_accvgpr_write_b32 a83, 0
    v_accvgpr_write_b32 a136, v96
    v_accvgpr_write_b32 a137, v97
    v_accvgpr_write_b32 a138, v98
    v_accvgpr_write_b32 a139, v99
    v_accvgpr_read_b32 v100, a96
    v_accvgpr_read_b32 v101, a97
    v_accvgpr_read_b32 v102, a98
    v_accvgpr_read_b32 v103, a99
    v_accvgpr_read_b32 v104, a112
    v_accvgpr_read_b32 v105, a113
    v_accvgpr_read_b32 v106, a114
    v_accvgpr_read_b32 v107, a115
    v_cvt_pk_bf16_f32 v108, v100, v101
    v_cvt_pk_bf16_f32 v109, v102, v103
    v_cvt_pk_bf16_f32 v110, v104, v105
    v_cvt_pk_bf16_f32 v111, v106, v107
    s_nop 0
    v_permlane32_swap_b32 v108, v110
    v_permlane32_swap_b32 v109, v111
    s_nop 0
    v_permlane16_swap_b32 v108, v110
    v_permlane16_swap_b32 v109, v111
    v_accvgpr_write_b32 a96, 0
    v_accvgpr_write_b32 a97, 0
    v_accvgpr_write_b32 a98, 0
    v_accvgpr_write_b32 a99, 0
    v_accvgpr_write_b32 a112, 0
    v_accvgpr_write_b32 a113, 0
    v_accvgpr_write_b32 a114, 0
    v_accvgpr_write_b32 a115, 0
    v_accvgpr_write_b32 a140, v108
    v_accvgpr_write_b32 a141, v109
    v_accvgpr_write_b32 a142, v110
    v_accvgpr_write_b32 a143, v111
    v_accvgpr_read_b32 v64, a4
    v_accvgpr_read_b32 v65, a5
    v_accvgpr_read_b32 v66, a6
    v_accvgpr_read_b32 v67, a7
    v_accvgpr_read_b32 v68, a20
    v_accvgpr_read_b32 v69, a21
    v_accvgpr_read_b32 v70, a22
    v_accvgpr_read_b32 v71, a23
    v_cvt_pk_bf16_f32 v72, v64, v65
    v_cvt_pk_bf16_f32 v73, v66, v67
    v_cvt_pk_bf16_f32 v74, v68, v69
    v_cvt_pk_bf16_f32 v75, v70, v71
    s_nop 0
    v_permlane32_swap_b32 v72, v74
    v_permlane32_swap_b32 v73, v75
    s_nop 0
    v_permlane16_swap_b32 v72, v74
    v_permlane16_swap_b32 v73, v75
    v_accvgpr_write_b32 a4, 0
    v_accvgpr_write_b32 a5, 0
    v_accvgpr_write_b32 a6, 0
    v_accvgpr_write_b32 a7, 0
    v_accvgpr_write_b32 a20, 0
    v_accvgpr_write_b32 a21, 0
    v_accvgpr_write_b32 a22, 0
    v_accvgpr_write_b32 a23, 0
    v_accvgpr_write_b32 a144, v72
    v_accvgpr_write_b32 a145, v73
    v_accvgpr_write_b32 a146, v74
    v_accvgpr_write_b32 a147, v75
    v_accvgpr_read_b32 v76, a36
    v_accvgpr_read_b32 v77, a37
    v_accvgpr_read_b32 v78, a38
    v_accvgpr_read_b32 v79, a39
    v_accvgpr_read_b32 v80, a52
    v_accvgpr_read_b32 v81, a53
    v_accvgpr_read_b32 v82, a54
    v_accvgpr_read_b32 v83, a55
    v_cvt_pk_bf16_f32 v84, v76, v77
    v_cvt_pk_bf16_f32 v85, v78, v79
    v_cvt_pk_bf16_f32 v86, v80, v81
    v_cvt_pk_bf16_f32 v87, v82, v83
    s_nop 0
    v_permlane32_swap_b32 v84, v86
    v_permlane32_swap_b32 v85, v87
    s_nop 0
    v_permlane16_swap_b32 v84, v86
    v_permlane16_swap_b32 v85, v87
    v_accvgpr_write_b32 a36, 0
    v_accvgpr_write_b32 a37, 0
    v_accvgpr_write_b32 a38, 0
    v_accvgpr_write_b32 a39, 0
    v_accvgpr_write_b32 a52, 0
    v_accvgpr_write_b32 a53, 0
    v_accvgpr_write_b32 a54, 0
    v_accvgpr_write_b32 a55, 0
    v_accvgpr_write_b32 a148, v84
    v_accvgpr_write_b32 a149, v85
    v_accvgpr_write_b32 a150, v86
    v_accvgpr_write_b32 a151, v87
    v_accvgpr_read_b32 v88, a68
    v_accvgpr_read_b32 v89, a69
    v_accvgpr_read_b32 v90, a70
    v_accvgpr_read_b32 v91, a71
    v_accvgpr_read_b32 v92, a84
    v_accvgpr_read_b32 v93, a85
    v_accvgpr_read_b32 v94, a86
    v_accvgpr_read_b32 v95, a87
    v_cvt_pk_bf16_f32 v96, v88, v89
    v_cvt_pk_bf16_f32 v97, v90, v91
    v_cvt_pk_bf16_f32 v98, v92, v93
    v_cvt_pk_bf16_f32 v99, v94, v95
    s_nop 0
    v_permlane32_swap_b32 v96, v98
    v_permlane32_swap_b32 v97, v99
    s_nop 0
    v_permlane16_swap_b32 v96, v98
    v_permlane16_swap_b32 v97, v99
    v_accvgpr_write_b32 a68, 0
    v_accvgpr_write_b32 a69, 0
    v_accvgpr_write_b32 a70, 0
    v_accvgpr_write_b32 a71, 0
    v_accvgpr_write_b32 a84, 0
    v_accvgpr_write_b32 a85, 0
    v_accvgpr_write_b32 a86, 0
    v_accvgpr_write_b32 a87, 0
    v_accvgpr_write_b32 a152, v96
    v_accvgpr_write_b32 a153, v97
    v_accvgpr_write_b32 a154, v98
    v_accvgpr_write_b32 a155, v99
    v_accvgpr_read_b32 v100, a100
    v_accvgpr_read_b32 v101, a101
    v_accvgpr_read_b32 v102, a102
    v_accvgpr_read_b32 v103, a103
    v_accvgpr_read_b32 v104, a116
    v_accvgpr_read_b32 v105, a117
    v_accvgpr_read_b32 v106, a118
    v_accvgpr_read_b32 v107, a119
    v_cvt_pk_bf16_f32 v108, v100, v101
    v_cvt_pk_bf16_f32 v109, v102, v103
    v_cvt_pk_bf16_f32 v110, v104, v105
    v_cvt_pk_bf16_f32 v111, v106, v107
    s_nop 0
    v_permlane32_swap_b32 v108, v110
    v_permlane32_swap_b32 v109, v111
    s_nop 0
    v_permlane16_swap_b32 v108, v110
    v_permlane16_swap_b32 v109, v111
    v_accvgpr_write_b32 a100, 0
    v_accvgpr_write_b32 a101, 0
    v_accvgpr_write_b32 a102, 0
    v_accvgpr_write_b32 a103, 0
    v_accvgpr_write_b32 a116, 0
    v_accvgpr_write_b32 a117, 0
    v_accvgpr_write_b32 a118, 0
    v_accvgpr_write_b32 a119, 0
    v_accvgpr_write_b32 a156, v108
    v_accvgpr_write_b32 a157, v109
    v_accvgpr_write_b32 a158, v110
    v_accvgpr_write_b32 a159, v111
    v_accvgpr_read_b32 v64, a8
    v_accvgpr_read_b32 v65, a9
    v_accvgpr_read_b32 v66, a10
    v_accvgpr_read_b32 v67, a11
    v_accvgpr_read_b32 v68, a24
    v_accvgpr_read_b32 v69, a25
    v_accvgpr_read_b32 v70, a26
    v_accvgpr_read_b32 v71, a27
    v_cvt_pk_bf16_f32 v72, v64, v65
    v_cvt_pk_bf16_f32 v73, v66, v67
    v_cvt_pk_bf16_f32 v74, v68, v69
    v_cvt_pk_bf16_f32 v75, v70, v71
    s_nop 0
    v_permlane32_swap_b32 v72, v74
    v_permlane32_swap_b32 v73, v75
    s_nop 0
    v_permlane16_swap_b32 v72, v74
    v_permlane16_swap_b32 v73, v75
    v_accvgpr_write_b32 a8, 0
    v_accvgpr_write_b32 a9, 0
    v_accvgpr_write_b32 a10, 0
    v_accvgpr_write_b32 a11, 0
    v_accvgpr_write_b32 a24, 0
    v_accvgpr_write_b32 a25, 0
    v_accvgpr_write_b32 a26, 0
    v_accvgpr_write_b32 a27, 0
    v_accvgpr_write_b32 a160, v72
    v_accvgpr_write_b32 a161, v73
    v_accvgpr_write_b32 a162, v74
    v_accvgpr_write_b32 a163, v75
    v_accvgpr_read_b32 v76, a40
    v_accvgpr_read_b32 v77, a41
    v_accvgpr_read_b32 v78, a42
    v_accvgpr_read_b32 v79, a43
    v_accvgpr_read_b32 v80, a56
    v_accvgpr_read_b32 v81, a57
    v_accvgpr_read_b32 v82, a58
    v_accvgpr_read_b32 v83, a59
    v_cvt_pk_bf16_f32 v84, v76, v77
    v_cvt_pk_bf16_f32 v85, v78, v79
    v_cvt_pk_bf16_f32 v86, v80, v81
    v_cvt_pk_bf16_f32 v87, v82, v83
    s_nop 0
    v_permlane32_swap_b32 v84, v86
    v_permlane32_swap_b32 v85, v87
    s_nop 0
    v_permlane16_swap_b32 v84, v86
    v_permlane16_swap_b32 v85, v87
    v_accvgpr_write_b32 a40, 0
    v_accvgpr_write_b32 a41, 0
    v_accvgpr_write_b32 a42, 0
    v_accvgpr_write_b32 a43, 0
    v_accvgpr_write_b32 a56, 0
    v_accvgpr_write_b32 a57, 0
    v_accvgpr_write_b32 a58, 0
    v_accvgpr_write_b32 a59, 0
    v_accvgpr_write_b32 a164, v84
    v_accvgpr_write_b32 a165, v85
    v_accvgpr_write_b32 a166, v86
    v_accvgpr_write_b32 a167, v87
    v_accvgpr_read_b32 v88, a72
    v_accvgpr_read_b32 v89, a73
    v_accvgpr_read_b32 v90, a74
    v_accvgpr_read_b32 v91, a75
    v_accvgpr_read_b32 v92, a88
    v_accvgpr_read_b32 v93, a89
    v_accvgpr_read_b32 v94, a90
    v_accvgpr_read_b32 v95, a91
    v_cvt_pk_bf16_f32 v96, v88, v89
    v_cvt_pk_bf16_f32 v97, v90, v91
    v_cvt_pk_bf16_f32 v98, v92, v93
    v_cvt_pk_bf16_f32 v99, v94, v95
    s_nop 0
    v_permlane32_swap_b32 v96, v98
    v_permlane32_swap_b32 v97, v99
    s_nop 0
    v_permlane16_swap_b32 v96, v98
    v_permlane16_swap_b32 v97, v99
    v_accvgpr_write_b32 a72, 0
    v_accvgpr_write_b32 a73, 0
    v_accvgpr_write_b32 a74, 0
    v_accvgpr_write_b32 a75, 0
    v_accvgpr_write_b32 a88, 0
    v_accvgpr_write_b32 a89, 0
    v_accvgpr_write_b32 a90, 0
    v_accvgpr_write_b32 a91, 0
    v_accvgpr_write_b32 a168, v96
    v_accvgpr_write_b32 a169, v97
    v_accvgpr_write_b32 a170, v98
    v_accvgpr_write_b32 a171, v99
    v_accvgpr_read_b32 v100, a104
    v_accvgpr_read_b32 v101, a105
    v_accvgpr_read_b32 v102, a106
    v_accvgpr_read_b32 v103, a107
    v_accvgpr_read_b32 v104, a120
    v_accvgpr_read_b32 v105, a121
    v_accvgpr_read_b32 v106, a122
    v_accvgpr_read_b32 v107, a123
    v_cvt_pk_bf16_f32 v108, v100, v101
    v_cvt_pk_bf16_f32 v109, v102, v103
    v_cvt_pk_bf16_f32 v110, v104, v105
    v_cvt_pk_bf16_f32 v111, v106, v107
    s_nop 0
    v_permlane32_swap_b32 v108, v110
    v_permlane32_swap_b32 v109, v111
    s_nop 0
    v_permlane16_swap_b32 v108, v110
    v_permlane16_swap_b32 v109, v111
    v_accvgpr_write_b32 a104, 0
    v_accvgpr_write_b32 a105, 0
    v_accvgpr_write_b32 a106, 0
    v_accvgpr_write_b32 a107, 0
    v_accvgpr_write_b32 a120, 0
    v_accvgpr_write_b32 a121, 0
    v_accvgpr_write_b32 a122, 0
    v_accvgpr_write_b32 a123, 0
    v_accvgpr_write_b32 a172, v108
    v_accvgpr_write_b32 a173, v109
    v_accvgpr_write_b32 a174, v110
    v_accvgpr_write_b32 a175, v111
    v_accvgpr_read_b32 v64, a12
    v_accvgpr_read_b32 v65, a13
    v_accvgpr_read_b32 v66, a14
    v_accvgpr_read_b32 v67, a15
    v_accvgpr_read_b32 v68, a28
    v_accvgpr_read_b32 v69, a29
    v_accvgpr_read_b32 v70, a30
    v_accvgpr_read_b32 v71, a31
    v_cvt_pk_bf16_f32 v72, v64, v65
    v_cvt_pk_bf16_f32 v73, v66, v67
    v_cvt_pk_bf16_f32 v74, v68, v69
    v_cvt_pk_bf16_f32 v75, v70, v71
    s_nop 0
    v_permlane32_swap_b32 v72, v74
    v_permlane32_swap_b32 v73, v75
    s_nop 0
    v_permlane16_swap_b32 v72, v74
    v_permlane16_swap_b32 v73, v75
    v_accvgpr_write_b32 a12, 0
    v_accvgpr_write_b32 a13, 0
    v_accvgpr_write_b32 a14, 0
    v_accvgpr_write_b32 a15, 0
    v_accvgpr_write_b32 a28, 0
    v_accvgpr_write_b32 a29, 0
    v_accvgpr_write_b32 a30, 0
    v_accvgpr_write_b32 a31, 0
    v_accvgpr_write_b32 a176, v72
    v_accvgpr_write_b32 a177, v73
    v_accvgpr_write_b32 a178, v74
    v_accvgpr_write_b32 a179, v75
    v_accvgpr_read_b32 v76, a44
    v_accvgpr_read_b32 v77, a45
    v_accvgpr_read_b32 v78, a46
    v_accvgpr_read_b32 v79, a47
    v_accvgpr_read_b32 v80, a60
    v_accvgpr_read_b32 v81, a61
    v_accvgpr_read_b32 v82, a62
    v_accvgpr_read_b32 v83, a63
    v_cvt_pk_bf16_f32 v84, v76, v77
    v_cvt_pk_bf16_f32 v85, v78, v79
    v_cvt_pk_bf16_f32 v86, v80, v81
    v_cvt_pk_bf16_f32 v87, v82, v83
    s_nop 0
    v_permlane32_swap_b32 v84, v86
    v_permlane32_swap_b32 v85, v87
    s_nop 0
    v_permlane16_swap_b32 v84, v86
    v_permlane16_swap_b32 v85, v87
    v_accvgpr_write_b32 a44, 0
    v_accvgpr_write_b32 a45, 0
    v_accvgpr_write_b32 a46, 0
    v_accvgpr_write_b32 a47, 0
    v_accvgpr_write_b32 a60, 0
    v_accvgpr_write_b32 a61, 0
    v_accvgpr_write_b32 a62, 0
    v_accvgpr_write_b32 a63, 0
    v_accvgpr_write_b32 a180, v84
    v_accvgpr_write_b32 a181, v85
    v_accvgpr_write_b32 a182, v86
    v_accvgpr_write_b32 a183, v87
    v_accvgpr_read_b32 v88, a76
    v_accvgpr_read_b32 v89, a77
    v_accvgpr_read_b32 v90, a78
    v_accvgpr_read_b32 v91, a79
    v_accvgpr_read_b32 v92, a92
    v_accvgpr_read_b32 v93, a93
    v_accvgpr_read_b32 v94, a94
    v_accvgpr_read_b32 v95, a95
    v_cvt_pk_bf16_f32 v96, v88, v89
    v_cvt_pk_bf16_f32 v97, v90, v91
    v_cvt_pk_bf16_f32 v98, v92, v93
    v_cvt_pk_bf16_f32 v99, v94, v95
    s_nop 0
    v_permlane32_swap_b32 v96, v98
    v_permlane32_swap_b32 v97, v99
    s_nop 0
    v_permlane16_swap_b32 v96, v98
    v_permlane16_swap_b32 v97, v99
    v_accvgpr_write_b32 a76, 0
    v_accvgpr_write_b32 a77, 0
    v_accvgpr_write_b32 a78, 0
    v_accvgpr_write_b32 a79, 0
    v_accvgpr_write_b32 a92, 0
    v_accvgpr_write_b32 a93, 0
    v_accvgpr_write_b32 a94, 0
    v_accvgpr_write_b32 a95, 0
    v_accvgpr_write_b32 a184, v96
    v_accvgpr_write_b32 a185, v97
    v_accvgpr_write_b32 a186, v98
    v_accvgpr_write_b32 a187, v99
    v_accvgpr_read_b32 v100, a108
    v_accvgpr_read_b32 v101, a109
    v_accvgpr_read_b32 v102, a110
    v_accvgpr_read_b32 v103, a111
    v_accvgpr_read_b32 v104, a124
    v_accvgpr_read_b32 v105, a125
    v_accvgpr_read_b32 v106, a126
    v_accvgpr_read_b32 v107, a127
    v_cvt_pk_bf16_f32 v108, v100, v101
    v_cvt_pk_bf16_f32 v109, v102, v103
    v_cvt_pk_bf16_f32 v110, v104, v105
    v_cvt_pk_bf16_f32 v111, v106, v107
    s_nop 0
    v_permlane32_swap_b32 v108, v110
    v_permlane32_swap_b32 v109, v111
    s_nop 0
    v_permlane16_swap_b32 v108, v110
    v_permlane16_swap_b32 v109, v111
    v_accvgpr_write_b32 a108, 0
    v_accvgpr_write_b32 a109, 0
    v_accvgpr_write_b32 a110, 0
    v_accvgpr_write_b32 a111, 0
    v_accvgpr_write_b32 a124, 0
    v_accvgpr_write_b32 a125, 0
    v_accvgpr_write_b32 a126, 0
    v_accvgpr_write_b32 a127, 0
    v_accvgpr_write_b32 a188, v108
    v_accvgpr_write_b32 a189, v109
    v_accvgpr_write_b32 a190, v110
    v_accvgpr_write_b32 a191, v111
    v_mov_b32 v160, 0
    v_mov_b32 v161, 0
    v_mov_b32 v162, 0
    v_mov_b32 v163, 0
    v_mov_b32 v164, 0
    v_mov_b32 v165, 0
    v_mov_b32 v166, 0
    v_mov_b32 v167, 0
    v_mov_b32 v168, 0
    v_mov_b32 v169, 0
    v_mov_b32 v170, 0
    v_mov_b32 v171, 0
    v_mov_b32 v172, 0
    v_mov_b32 v173, 0
    v_mov_b32 v174, 0
    v_mov_b32 v175, 0
    v_mov_b32 v188, 0
    v_mov_b32 v189, 0
    v_mov_b32 v190, 0
    v_mov_b32 v191, 0
    s_mov_b32 s46, 1115684864
    s_mov_b32 s47, 1870659584
    s_waitcnt vmcnt(4)
    s_barrier
    ds_read_b128 a[192:195], v8 offset:32768
    ds_read_b128 a[196:199], v9 offset:32768
    ds_read_b128 a[200:203], v10 offset:32768
    ds_read_b128 a[204:207], v11 offset:32768
    ds_read_b128 a[208:211], v8 offset:36864
    ds_read_b128 a[212:215], v9 offset:36864
    ds_read_b128 a[216:219], v10 offset:36864
    ds_read_b128 a[220:223], v11 offset:36864
    s_waitcnt lgkmcnt(0)
    v_mfma_f32_16x16x32_bf16 v[64:67], a[192:195], a[128:131], v[160:163]
    v_mfma_f32_16x16x32_bf16 v[72:75], a[192:195], a[144:147], v[164:167]
    v_mfma_f32_16x16x32_bf16 v[80:83], a[192:195], a[160:163], v[168:171]
    v_mfma_f32_16x16x32_bf16 v[88:91], a[192:195], a[176:179], v[172:175]
    v_mfma_f32_16x16x32_bf16 v[64:67], a[196:199], a[132:135], v[64:67]
    v_mfma_f32_16x16x32_bf16 v[72:75], a[196:199], a[148:151], v[72:75]
    v_mfma_f32_16x16x32_bf16 v[80:83], a[196:199], a[164:167], v[80:83]
    v_mfma_f32_16x16x32_bf16 v[88:91], a[196:199], a[180:183], v[88:91]
    v_mfma_f32_16x16x32_bf16 v[64:67], a[200:203], a[136:139], v[64:67]
    v_mfma_f32_16x16x32_bf16 v[72:75], a[200:203], a[152:155], v[72:75]
    v_mfma_f32_16x16x32_bf16 v[80:83], a[200:203], a[168:171], v[80:83]
    v_mfma_f32_16x16x32_bf16 v[88:91], a[200:203], a[184:187], v[88:91]
    v_mfma_f32_16x16x32_bf16 v[64:67], a[204:207], a[140:143], v[64:67]
    v_mfma_f32_16x16x32_bf16 v[72:75], a[204:207], a[156:159], v[72:75]
    v_mfma_f32_16x16x32_bf16 v[80:83], a[204:207], a[172:175], v[80:83]
    v_mfma_f32_16x16x32_bf16 v[88:91], a[204:207], a[188:191], v[88:91]
    v_mfma_f32_16x16x32_bf16 v[68:71], a[208:211], a[128:131], v[160:163]
    v_mfma_f32_16x16x32_bf16 v[76:79], a[208:211], a[144:147], v[164:167]
    v_mfma_f32_16x16x32_bf16 v[84:87], a[208:211], a[160:163], v[168:171]
    v_mfma_f32_16x16x32_bf16 v[92:95], a[208:211], a[176:179], v[172:175]
    v_mfma_f32_16x16x32_bf16 v[68:71], a[212:215], a[132:135], v[68:71]
    v_mfma_f32_16x16x32_bf16 v[76:79], a[212:215], a[148:151], v[76:79]
    v_mfma_f32_16x16x32_bf16 v[84:87], a[212:215], a[164:167], v[84:87]
    v_mfma_f32_16x16x32_bf16 v[92:95], a[212:215], a[180:183], v[92:95]
    v_mfma_f32_16x16x32_bf16 v[68:71], a[216:219], a[136:139], v[68:71]
    v_mfma_f32_16x16x32_bf16 v[76:79], a[216:219], a[152:155], v[76:79]
    v_mfma_f32_16x16x32_bf16 v[84:87], a[216:219], a[168:171], v[84:87]
    v_mfma_f32_16x16x32_bf16 v[92:95], a[216:219], a[184:187], v[92:95]
    v_mfma_f32_16x16x32_bf16 v[68:71], a[220:223], a[140:143], v[68:71]
    v_mfma_f32_16x16x32_bf16 v[76:79], a[220:223], a[156:159], v[76:79]
    v_mfma_f32_16x16x32_bf16 v[84:87], a[220:223], a[172:175], v[84:87]
    v_mfma_f32_16x16x32_bf16 v[92:95], a[220:223], a[188:191], v[92:95]
    ds_read_b128 a[192:195], v8 offset:40960
    ds_read_b128 a[196:199], v9 offset:40960
    ds_read_b128 a[200:203], v10 offset:40960
    ds_read_b128 a[204:207], v11 offset:40960
    ds_read_b128 a[208:211], v8 offset:45056
    ds_read_b128 a[212:215], v9 offset:45056
    ds_read_b128 a[216:219], v10 offset:45056
    ds_read_b128 a[220:223], v11 offset:45056
    s_nop 15
    v_max3_f32 v192, v64, v65, v66
    v_max3_f32 v192, v192, v67, v68
    v_max3_f32 v192, v192, v69, v70
    v_max_f32 v192, v192, v71
    v_mov_b32 v196, v192
    s_nop 1
    v_permlane16_swap_b32 v192, v196
    v_max_f32 v192, v192, v196
    v_mov_b32 v196, v192
    s_nop 1
    v_permlane32_swap_b32 v192, v196
    v_max_f32 v192, v192, v196
    v_add_f32 v192, s46, v192
    v_max3_f32 v193, v72, v73, v74
    v_max3_f32 v193, v193, v75, v76
    v_max3_f32 v193, v193, v77, v78
    v_max_f32 v193, v193, v79
    v_mov_b32 v196, v193
    s_nop 1
    v_permlane16_swap_b32 v193, v196
    v_max_f32 v193, v193, v196
    v_mov_b32 v196, v193
    s_nop 1
    v_permlane32_swap_b32 v193, v196
    v_max_f32 v193, v193, v196
    v_add_f32 v193, s46, v193
    v_max3_f32 v194, v80, v81, v82
    v_max3_f32 v194, v194, v83, v84
    v_max3_f32 v194, v194, v85, v86
    v_max_f32 v194, v194, v87
    v_mov_b32 v196, v194
    s_nop 1
    v_permlane16_swap_b32 v194, v196
    v_max_f32 v194, v194, v196
    v_mov_b32 v196, v194
    s_nop 1
    v_permlane32_swap_b32 v194, v196
    v_max_f32 v194, v194, v196
    v_add_f32 v194, s46, v194
    v_max3_f32 v195, v88, v89, v90
    v_max3_f32 v195, v195, v91, v92
    v_max3_f32 v195, v195, v93, v94
    v_max_f32 v195, v195, v95
    v_mov_b32 v196, v195
    s_nop 1
    v_permlane16_swap_b32 v195, v196
    v_max_f32 v195, v195, v196
    v_mov_b32 v196, v195
    s_nop 1
    v_permlane32_swap_b32 v195, v196
    v_max_f32 v195, v195, v196
    v_add_f32 v195, s46, v195
    v_sub_f32 v64, v64, v192
    v_sub_f32 v65, v65, v192
    v_sub_f32 v66, v66, v192
    v_sub_f32 v67, v67, v192
    v_sub_f32 v68, v68, v192
    v_sub_f32 v69, v69, v192
    v_sub_f32 v70, v70, v192
    v_sub_f32 v71, v71, v192
    v_sub_f32 v160, v160, v192
    v_sub_f32 v161, v161, v192
    v_sub_f32 v162, v162, v192
    v_sub_f32 v163, v163, v192
    v_sub_f32 v72, v72, v193
    v_sub_f32 v73, v73, v193
    v_sub_f32 v74, v74, v193
    v_sub_f32 v75, v75, v193
    v_sub_f32 v76, v76, v193
    v_sub_f32 v77, v77, v193
    v_sub_f32 v78, v78, v193
    v_sub_f32 v79, v79, v193
    v_sub_f32 v164, v164, v193
    v_sub_f32 v165, v165, v193
    v_sub_f32 v166, v166, v193
    v_sub_f32 v167, v167, v193
    v_sub_f32 v80, v80, v194
    v_sub_f32 v81, v81, v194
    v_sub_f32 v82, v82, v194
    v_sub_f32 v83, v83, v194
    v_sub_f32 v84, v84, v194
    v_sub_f32 v85, v85, v194
    v_sub_f32 v86, v86, v194
    v_sub_f32 v87, v87, v194
    v_sub_f32 v168, v168, v194
    v_sub_f32 v169, v169, v194
    v_sub_f32 v170, v170, v194
    v_sub_f32 v171, v171, v194
    v_sub_f32 v88, v88, v195
    v_sub_f32 v89, v89, v195
    v_sub_f32 v90, v90, v195
    v_sub_f32 v91, v91, v195
    v_sub_f32 v92, v92, v195
    v_sub_f32 v93, v93, v195
    v_sub_f32 v94, v94, v195
    v_sub_f32 v95, v95, v195
    v_sub_f32 v172, v172, v195
    v_sub_f32 v173, v173, v195
    v_sub_f32 v174, v174, v195
    v_sub_f32 v175, v175, v195
    v_exp_f32 v232, v64
    v_exp_f32 v233, v65
    v_exp_f32 v234, v66
    v_exp_f32 v235, v67
    v_exp_f32 v236, v68
    v_exp_f32 v237, v69
    v_exp_f32 v238, v70
    v_exp_f32 v239, v71
    s_nop 0
    v_cvt_pk_bf16_f32 v128, v232, v233
    v_cvt_pk_bf16_f32 v129, v234, v235
    v_cvt_pk_bf16_f32 v130, v236, v237
    v_cvt_pk_bf16_f32 v131, v238, v239
    v_exp_f32 v232, v72
    v_exp_f32 v233, v73
    v_exp_f32 v234, v74
    v_exp_f32 v235, v75
    v_exp_f32 v236, v76
    v_exp_f32 v237, v77
    v_exp_f32 v238, v78
    v_exp_f32 v239, v79
    s_nop 0
    v_cvt_pk_bf16_f32 v132, v232, v233
    v_cvt_pk_bf16_f32 v133, v234, v235
    v_cvt_pk_bf16_f32 v134, v236, v237
    v_cvt_pk_bf16_f32 v135, v238, v239
    s_nop 1
    s_mov_b32 s72, s50
    s_mov_b32 s73, s51
    s_mov_b32 s74, 4718592
    s_mov_b32 s75, 0x00020000
    s_mov_b32 s76, s52
    s_mov_b32 s77, s53
    s_mov_b32 s78, 5308416
    s_mov_b32 s79, 0x00020000
    s_mov_b32 s80, s54
    s_mov_b32 s81, s55
    s_mov_b32 s82, 8388608
    s_mov_b32 s83, 0x00020000
    s_mov_b32 s84, s56
    s_mov_b32 s85, s57
    s_mov_b32 s86, 2654208
    s_mov_b32 s87, 0x00020000
    s_lshl_b32 s58, s2, 2
    s_add_u32 s58, s58, s3
    s_lshl_b32 s58, s58, 10
    s_add_u32 s88, s10, 83886080
    s_addc_u32 s89, s11, 0
    s_mov_b32 s90, 8388608
    s_mov_b32 s91, 0x00020000
    s_lshr_b32 s59, s58, 16
    s_lshl_b32 s59, s59, 16
    s_bfe_u32 s39, s58, 0x6000a
    s_lshl_b32 s39, s39, 6
    s_add_u32 s59, s59, s39
    v_lshrrev_b32 v46, 2, v1
    v_and_b32 v47, 3, v1
    v_lshlrev_b32 v44, 12, v46
    v_lshl_add_u32 v44, v47, 4, v44
    v_lshlrev_b32 v45, 8, v47
    v_lshl_add_u32 v45, v46, 4, v45
    s_lshr_b32 s92, s58, 16
    s_mul_i32 s92, s92, 65536
    s_and_b32 s39, s58, 0xffff
    s_add_u32 s92, s92, s39
    s_sub_u32 s92, s92, 1048576
    v_mov_b32 v52, 0x3f803f80
    v_mov_b32 v53, 0x3f803f80
    v_mov_b32 v54, 0x3f803f80
    v_mov_b32 v55, 0x3f803f80
    v_mov_b32 v200, 0
    v_mov_b32 v201, 0
    v_mov_b32 v202, 0
    v_mov_b32 v203, 0
    v_mov_b32 v204, 0
    v_mov_b32 v205, 0
    v_mov_b32 v206, 0
    v_mov_b32 v207, 0
    v_mov_b32 v208, 0
    v_mov_b32 v209, 0
    v_mov_b32 v210, 0
    v_mov_b32 v211, 0
    v_mov_b32 v212, 0
    v_mov_b32 v213, 0
    v_mov_b32 v214, 0
    v_mov_b32 v215, 0
    v_mov_b32 v216, 0
    v_mov_b32 v217, 0
    v_mov_b32 v218, 0
    v_mov_b32 v219, 0
    v_mov_b32 v220, 0
    v_mov_b32 v221, 0
    v_mov_b32 v222, 0
    v_mov_b32 v223, 0
    v_mov_b32 v224, 0
    v_mov_b32 v225, 0
    v_mov_b32 v226, 0
    v_mov_b32 v227, 0
    v_mov_b32 v228, 0
    v_mov_b32 v229, 0
    v_mov_b32 v230, 0
    v_mov_b32 v231, 0
    s_waitcnt vmcnt(0)
    s_mov_b32 s38, 8
    s_branch K1_loop
K1_rare00:
    s_nop 15
    v_max3_f32 v192, v64, v65, v66
    v_max3_f32 v192, v192, v67, v68
    v_max3_f32 v192, v192, v69, v70
    v_max_f32 v192, v192, v71
    v_mov_b32 v196, v192
    s_nop 1
    v_permlane16_swap_b32 v192, v196
    v_max_f32 v192, v192, v196
    v_mov_b32 v196, v192
    s_nop 1
    v_permlane32_swap_b32 v192, v196
    v_max_f32 v192, v192, v196
    v_add_f32 v192, s46, v192
    v_max_f32 v192, 0, v192
    v_ceil_f32 v192, v192
    v_max3_f32 v193, v72, v73, v74
    v_max3_f32 v193, v193, v75, v76
    v_max3_f32 v193, v193, v77, v78
    v_max_f32 v193, v193, v79
    v_mov_b32 v196, v193
    s_nop 1
    v_permlane16_swap_b32 v193, v196
    v_max_f32 v193, v193, v196
    v_mov_b32 v196, v193
    s_nop 1
    v_permlane32_swap_b32 v193, v196
    v_max_f32 v193, v193, v196
    v_add_f32 v193, s46, v193
    v_max_f32 v193, 0, v193
    v_ceil_f32 v193, v193
    v_sub_f32 v64, v64, v192
    v_sub_f32 v96, v96, v192
    v_sub_f32 v65, v65, v192
    v_sub_f32 v97, v97, v192
    v_sub_f32 v66, v66, v192
    v_sub_f32 v98, v98, v192
    v_sub_f32 v67, v67, v192
    v_sub_f32 v99, v99, v192
    v_sub_f32 v68, v68, v192
    v_sub_f32 v100, v100, v192
    v_sub_f32 v69, v69, v192
    v_sub_f32 v101, v101, v192
    v_sub_f32 v70, v70, v192
    v_sub_f32 v102, v102, v192
    v_sub_f32 v71, v71, v192
    v_sub_f32 v103, v103, v192
    v_sub_f32 v160, v160, v192
    v_sub_f32 v161, v161, v192
    v_sub_f32 v162, v162, v192
    v_sub_f32 v163, v163, v192
    v_sub_f32 v196, 0, v192
    v_cvt_i32_f32 v196, v196
    v_ldexp_f32 v216, v216, v196
    v_ldexp_f32 v217, v217, v196
    v_ldexp_f32 v218, v218, v196
    v_ldexp_f32 v219, v219, v196
    v_accvgpr_read_b32 v232, a0
    v_accvgpr_read_b32 v233, a1
    v_accvgpr_read_b32 v234, a2
    v_accvgpr_read_b32 v235, a3
    v_accvgpr_read_b32 v236, a16
    v_accvgpr_read_b32 v237, a17
    v_accvgpr_read_b32 v238, a18
    v_accvgpr_read_b32 v239, a19
    v_ldexp_f32 v232, v232, v196
    v_ldexp_f32 v233, v233, v196
    v_ldexp_f32 v234, v234, v196
    v_ldexp_f32 v235, v235, v196
    v_ldexp_f32 v236, v236, v196
    v_ldexp_f32 v237, v237, v196
    v_ldexp_f32 v238, v238, v196
    v_ldexp_f32 v239, v239, v196
    v_accvgpr_write_b32 a0, v232
    v_accvgpr_write_b32 a1, v233
    v_accvgpr_write_b32 a2, v234
    v_accvgpr_write_b32 a3, v235
    v_accvgpr_write_b32 a16, v236
    v_accvgpr_write_b32 a17, v237
    v_accvgpr_write_b32 a18, v238
    v_accvgpr_write_b32 a19, v239
    v_accvgpr_read_b32 v232, a32
    v_accvgpr_read_b32 v233, a33
    v_accvgpr_read_b32 v234, a34
    v_accvgpr_read_b32 v235, a35
    v_accvgpr_read_b32 v236, a48
    v_accvgpr_read_b32 v237, a49
    v_accvgpr_read_b32 v238, a50
    v_accvgpr_read_b32 v239, a51
    v_ldexp_f32 v232, v232, v196
    v_ldexp_f32 v233, v233, v196
    v_ldexp_f32 v234, v234, v196
    v_ldexp_f32 v235, v235, v196
    v_ldexp_f32 v236, v236, v196
    v_ldexp_f32 v237, v237, v196
    v_ldexp_f32 v238, v238, v196
    v_ldexp_f32 v239, v239, v196
    v_accvgpr_write_b32 a32, v232
    v_accvgpr_write_b32 a33, v233
    v_accvgpr_write_b32 a34, v234
    v_accvgpr_write_b32 a35, v235
    v_accvgpr_write_b32 a48, v236
    v_accvgpr_write_b32 a49, v237
    v_accvgpr_write_b32 a50, v238
    v_accvgpr_write_b32 a51, v239
    v_accvgpr_read_b32 v232, a64
    v_accvgpr_read_b32 v233, a65
    v_accvgpr_read_b32 v234, a66
    v_accvgpr_read_b32 v235, a67
    v_accvgpr_read_b32 v236, a80
    v_accvgpr_read_b32 v237, a81
    v_accvgpr_read_b32 v238, a82
    v_accvgpr_read_b32 v239, a83
    v_ldexp_f32 v232, v232, v196
    v_ldexp_f32 v233, v233, v196
    v_ldexp_f32 v234, v234, v196
    v_ldexp_f32 v235, v235, v196
    v_ldexp_f32 v236, v236, v196
    v_ldexp_f32 v237, v237, v196
    v_ldexp_f32 v238, v238, v196
    v_ldexp_f32 v239, v239, v196
    v_accvgpr_write_b32 a64, v232
    v_accvgpr_write_b32 a65, v233
    v_accvgpr_write_b32 a66, v234
    v_accvgpr_write_b32 a67, v235
    v_accvgpr_write_b32 a80, v236
    v_accvgpr_write_b32 a81, v237
    v_accvgpr_write_b32 a82, v238
    v_accvgpr_write_b32 a83, v239
    v_accvgpr_read_b32 v232, a96
    v_accvgpr_read_b32 v233, a97
    v_accvgpr_read_b32 v234, a98
    v_accvgpr_read_b32 v235, a99
    v_accvgpr_read_b32 v236, a112
    v_accvgpr_read_b32 v237, a113
    v_accvgpr_read_b32 v238, a114
    v_accvgpr_read_b32 v239, a115
    v_ldexp_f32 v232, v232, v196
    v_ldexp_f32 v233, v233, v196
    v_ldexp_f32 v234, v234, v196
    v_ldexp_f32 v235, v235, v196
    v_ldexp_f32 v236, v236, v196
    v_ldexp_f32 v237, v237, v196
    v_ldexp_f32 v238, v238, v196
    v_ldexp_f32 v239, v239, v196
    v_accvgpr_write_b32 a96, v232
    v_accvgpr_write_b32 a97, v233
    v_accvgpr_write_b32 a98, v234
    v_accvgpr_write_b32 a99, v235
    v_accvgpr_write_b32 a112, v236
    v_accvgpr_write_b32 a113, v237
    v_accvgpr_write_b32 a114, v238
    v_accvgpr_write_b32 a115, v239
    v_sub_f32 v72, v72, v193
    v_sub_f32 v104, v104, v193
    v_sub_f32 v73, v73, v193
    v_sub_f32 v105, v105, v193
    v_sub_f32 v74, v74, v193
    v_sub_f32 v106, v106, v193
    v_sub_f32 v75, v75, v193
    v_sub_f32 v107, v107, v193
    v_sub_f32 v76, v76, v193
    v_sub_f32 v108, v108, v193
    v_sub_f32 v77, v77, v193
    v_sub_f32 v109, v109, v193
    v_sub_f32 v78, v78, v193
    v_sub_f32 v110, v110, v193
    v_sub_f32 v79, v79, v193
    v_sub_f32 v111, v111, v193
    v_sub_f32 v164, v164, v193
    v_sub_f32 v165, v165, v193
    v_sub_f32 v166, v166, v193
    v_sub_f32 v167, v167, v193
    v_sub_f32 v196, 0, v193
    v_cvt_i32_f32 v196, v196
    v_ldexp_f32 v220, v220, v196
    v_ldexp_f32 v221, v221, v196
    v_ldexp_f32 v222, v222, v196
    v_ldexp_f32 v223, v223, v196
    v_accvgpr_read_b32 v232, a4
    v_accvgpr_read_b32 v233, a5
    v_accvgpr_read_b32 v234, a6
    v_accvgpr_read_b32 v235, a7
    v_accvgpr_read_b32 v236, a20
    v_accvgpr_read_b32 v237, a21
    v_accvgpr_read_b32 v238, a22
    v_accvgpr_read_b32 v239, a23
    v_ldexp_f32 v232, v232, v196
    v_ldexp_f32 v233, v233, v196
    v_ldexp_f32 v234, v234, v196
    v_ldexp_f32 v235, v235, v196
    v_ldexp_f32 v236, v236, v196
    v_ldexp_f32 v237, v237, v196
    v_ldexp_f32 v238, v238, v196
    v_ldexp_f32 v239, v239, v196
    v_accvgpr_write_b32 a4, v232
    v_accvgpr_write_b32 a5, v233
    v_accvgpr_write_b32 a6, v234
    v_accvgpr_write_b32 a7, v235
    v_accvgpr_write_b32 a20, v236
    v_accvgpr_write_b32 a21, v237
    v_accvgpr_write_b32 a22, v238
    v_accvgpr_write_b32 a23, v239
    v_accvgpr_read_b32 v232, a36
    v_accvgpr_read_b32 v233, a37
    v_accvgpr_read_b32 v234, a38
    v_accvgpr_read_b32 v235, a39
    v_accvgpr_read_b32 v236, a52
    v_accvgpr_read_b32 v237, a53
    v_accvgpr_read_b32 v238, a54
    v_accvgpr_read_b32 v239, a55
    v_ldexp_f32 v232, v232, v196
    v_ldexp_f32 v233, v233, v196
    v_ldexp_f32 v234, v234, v196
    v_ldexp_f32 v235, v235, v196
    v_ldexp_f32 v236, v236, v196
    v_ldexp_f32 v237, v237, v196
    v_ldexp_f32 v238, v238, v196
    v_ldexp_f32 v239, v239, v196
    v_accvgpr_write_b32 a36, v232
    v_accvgpr_write_b32 a37, v233
    v_accvgpr_write_b32 a38, v234
    v_accvgpr_write_b32 a39, v235
    v_accvgpr_write_b32 a52, v236
    v_accvgpr_write_b32 a53, v237
    v_accvgpr_write_b32 a54, v238
    v_accvgpr_write_b32 a55, v239
    v_accvgpr_read_b32 v232, a68
    v_accvgpr_read_b32 v233, a69
    v_accvgpr_read_b32 v234, a70
    v_accvgpr_read_b32 v235, a71
    v_accvgpr_read_b32 v236, a84
    v_accvgpr_read_b32 v237, a85
    v_accvgpr_read_b32 v238, a86
    v_accvgpr_read_b32 v239, a87
    v_ldexp_f32 v232, v232, v196
    v_ldexp_f32 v233, v233, v196
    v_ldexp_f32 v234, v234, v196
    v_ldexp_f32 v235, v235, v196
    v_ldexp_f32 v236, v236, v196
    v_ldexp_f32 v237, v237, v196
    v_ldexp_f32 v238, v238, v196
    v_ldexp_f32 v239, v239, v196
    v_accvgpr_write_b32 a68, v232
    v_accvgpr_write_b32 a69, v233
    v_accvgpr_write_b32 a70, v234
    v_accvgpr_write_b32 a71, v235
    v_accvgpr_write_b32 a84, v236
    v_accvgpr_write_b32 a85, v237
    v_accvgpr_write_b32 a86, v238
    v_accvgpr_write_b32 a87, v239
    v_accvgpr_read_b32 v232, a100
    v_accvgpr_read_b32 v233, a101
    v_accvgpr_read_b32 v234, a102
    v_accvgpr_read_b32 v235, a103
    v_accvgpr_read_b32 v236, a116
    v_accvgpr_read_b32 v237, a117
    v_accvgpr_read_b32 v238, a118
    v_accvgpr_read_b32 v239, a119
    v_ldexp_f32 v232, v232, v196
    v_ldexp_f32 v233, v233, v196
    v_ldexp_f32 v234, v234, v196
    v_ldexp_f32 v235, v235, v196
    v_ldexp_f32 v236, v236, v196
    v_ldexp_f32 v237, v237, v196
    v_ldexp_f32 v238, v238, v196
    v_ldexp_f32 v239, v239, v196
    v_accvgpr_write_b32 a100, v232
    v_accvgpr_write_b32 a101, v233
    v_accvgpr_write_b32 a102, v234
    v_accvgpr_write_b32 a103, v235
    v_accvgpr_write_b32 a116, v236
    v_accvgpr_write_b32 a117, v237
    v_accvgpr_write_b32 a118, v238
    v_accvgpr_write_b32 a119, v239
    v_exp_f32 v232, v64
    v_exp_f32 v233, v65
    v_exp_f32 v234, v66
    v_exp_f32 v235, v67
    v_exp_f32 v236, v68
    v_exp_f32 v237, v69
    v_exp_f32 v238, v70
    v_exp_f32 v239, v71
    s_nop 0
    v_cvt_pk_bf16_f32 v128, v232, v233
    v_cvt_pk_bf16_f32 v129, v234, v235
    v_cvt_pk_bf16_f32 v130, v236, v237
    v_cvt_pk_bf16_f32 v131, v238, v239
    v_exp_f32 v232, v72
    v_exp_f32 v233, v73
    v_exp_f32 v234, v74
    v_exp_f32 v235, v75
    v_exp_f32 v236, v76
    v_exp_f32 v237, v77
    v_exp_f32 v238, v78
    v_exp_f32 v239, v79
    s_nop 0
    v_cvt_pk_bf16_f32 v132, v232, v233
    v_cvt_pk_bf16_f32 v133, v234, v235
    v_cvt_pk_bf16_f32 v134, v236, v237
    v_cvt_pk_bf16_f32 v135, v238, v239
    s_nop 1
    v_mfma_f32_16x16x32_bf16 v[200:203], v[52:55], v[128:131], v[216:219]
    v_mfma_f32_16x16x32_bf16 v[204:207], v[52:55], v[132:135], v[220:223]
    s_nop 7
    s_setpc_b64 s[40:41]
K1_rare01:
    s_nop 15
    v_max3_f32 v194, v80, v81, v82
    v_max3_f32 v194, v194, v83, v84
    v_max3_f32 v194, v194, v85, v86
    v_max_f32 v194, v194, v87
    v_mov_b32 v196, v194
    s_nop 1
    v_permlane16_swap_b32 v194, v196
    v_max_f32 v194, v194, v196
    v_mov_b32 v196, v194
    s_nop 1
    v_permlane32_swap_b32 v194, v196
    v_max_f32 v194, v194, v196
    v_add_f32 v194, s46, v194
    v_max_f32 v194, 0, v194
    v_ceil_f32 v194, v194
    v_max3_f32 v195, v88, v89, v90
    v_max3_f32 v195, v195, v91, v92
    v_max3_f32 v195, v195, v93, v94
    v_max_f32 v195, v195, v95
    v_mov_b32 v196, v195
    s_nop 1
    v_permlane16_swap_b32 v195, v196
    v_max_f32 v195, v195, v196
    v_mov_b32 v196, v195
    s_nop 1
    v_permlane32_swap_b32 v195, v196
    v_max_f32 v195, v195, v196
    v_add_f32 v195, s46, v195
    v_max_f32 v195, 0, v195
    v_ceil_f32 v195, v195
    v_sub_f32 v80, v80, v194
    v_sub_f32 v112, v112, v194
    v_sub_f32 v81, v81, v194
    v_sub_f32 v113, v113, v194
    v_sub_f32 v82, v82, v194
    v_sub_f32 v114, v114, v194
    v_sub_f32 v83, v83, v194
    v_sub_f32 v115, v115, v194
    v_sub_f32 v84, v84, v194
    v_sub_f32 v116, v116, v194
    v_sub_f32 v85, v85, v194
    v_sub_f32 v117, v117, v194
    v_sub_f32 v86, v86, v194
    v_sub_f32 v118, v118, v194
    v_sub_f32 v87, v87, v194
    v_sub_f32 v119, v119, v194
    v_sub_f32 v168, v168, v194
    v_sub_f32 v169, v169, v194
    v_sub_f32 v170, v170, v194
    v_sub_f32 v171, v171, v194
    v_sub_f32 v196, 0, v194
    v_cvt_i32_f32 v196, v196
    v_ldexp_f32 v224, v224, v196
    v_ldexp_f32 v225, v225, v196
    v_ldexp_f32 v226, v226, v196
    v_ldexp_f32 v227, v227, v196
    v_accvgpr_read_b32 v232, a8
    v_accvgpr_read_b32 v233, a9
    v_accvgpr_read_b32 v234, a10
    v_accvgpr_read_b32 v235, a11
    v_accvgpr_read_b32 v236, a24
    v_accvgpr_read_b32 v237, a25
    v_accvgpr_read_b32 v238, a26
    v_accvgpr_read_b32 v239, a27
    v_ldexp_f32 v232, v232, v196
    v_ldexp_f32 v233, v233, v196
    v_ldexp_f32 v234, v234, v196
    v_ldexp_f32 v235, v235, v196
    v_ldexp_f32 v236, v236, v196
    v_ldexp_f32 v237, v237, v196
    v_ldexp_f32 v238, v238, v196
    v_ldexp_f32 v239, v239, v196
    v_accvgpr_write_b32 a8, v232
    v_accvgpr_write_b32 a9, v233
    v_accvgpr_write_b32 a10, v234
    v_accvgpr_write_b32 a11, v235
    v_accvgpr_write_b32 a24, v236
    v_accvgpr_write_b32 a25, v237
    v_accvgpr_write_b32 a26, v238
    v_accvgpr_write_b32 a27, v239
    v_accvgpr_read_b32 v232, a40
    v_accvgpr_read_b32 v233, a41
    v_accvgpr_read_b32 v234, a42
    v_accvgpr_read_b32 v235, a43
    v_accvgpr_read_b32 v236, a56
    v_accvgpr_read_b32 v237, a57
    v_accvgpr_read_b32 v238, a58
    v_accvgpr_read_b32 v239, a59
    v_ldexp_f32 v232, v232, v196
    v_ldexp_f32 v233, v233, v196
    v_ldexp_f32 v234, v234, v196
    v_ldexp_f32 v235, v235, v196
    v_ldexp_f32 v236, v236, v196
    v_ldexp_f32 v237, v237, v196
    v_ldexp_f32 v238, v238, v196
    v_ldexp_f32 v239, v239, v196
    v_accvgpr_write_b32 a40, v232
    v_accvgpr_write_b32 a41, v233
    v_accvgpr_write_b32 a42, v234
    v_accvgpr_write_b32 a43, v235
    v_accvgpr_write_b32 a56, v236
    v_accvgpr_write_b32 a57, v237
    v_accvgpr_write_b32 a58, v238
    v_accvgpr_write_b32 a59, v239
    v_accvgpr_read_b32 v232, a72
    v_accvgpr_read_b32 v233, a73
    v_accvgpr_read_b32 v234, a74
    v_accvgpr_read_b32 v235, a75
    v_accvgpr_read_b32 v236, a88
    v_accvgpr_read_b32 v237, a89
    v_accvgpr_read_b32 v238, a90
    v_accvgpr_read_b32 v239, a91
    v_ldexp_f32 v232, v232, v196
    v_ldexp_f32 v233, v233, v196
    v_ldexp_f32 v234, v234, v196
    v_ldexp_f32 v235, v235, v196
    v_ldexp_f32 v236, v236, v196
    v_ldexp_f32 v237, v237, v196
    v_ldexp_f32 v238, v238, v196
    v_ldexp_f32 v239, v239, v196
    v_accvgpr_write_b32 a72, v232
    v_accvgpr_write_b32 a73, v233
    v_accvgpr_write_b32 a74, v234
    v_accvgpr_write_b32 a75, v235
    v_accvgpr_write_b32 a88, v236
    v_accvgpr_write_b32 a89, v237
    v_accvgpr_write_b32 a90, v238
    v_accvgpr_write_b32 a91, v239
    v_accvgpr_read_b32 v232, a104
    v_accvgpr_read_b32 v233, a105
    v_accvgpr_read_b32 v234, a106
    v_accvgpr_read_b32 v235, a107
    v_accvgpr_read_b32 v236, a120
    v_accvgpr_read_b32 v237, a121
    v_accvgpr_read_b32 v238, a122
    v_accvgpr_read_b32 v239, a123
    v_ldexp_f32 v232, v232, v196
    v_ldexp_f32 v233, v233, v196
    v_ldexp_f32 v234, v234, v196
    v_ldexp_f32 v235, v235, v196
    v_ldexp_f32 v236, v236, v196
    v_ldexp_f32 v237, v237, v196
    v_ldexp_f32 v238, v238, v196
    v_ldexp_f32 v239, v239, v196
    v_accvgpr_write_b32 a104, v232
    v_accvgpr_write_b32 a105, v233
    v_accvgpr_write_b32 a106, v234
    v_accvgpr_write_b32 a107, v235
    v_accvgpr_write_b32 a120, v236
    v_accvgpr_write_b32 a121, v237
    v_accvgpr_write_b32 a122, v238
    v_accvgpr_write_b32 a123, v239
    v_sub_f32 v88, v88, v195
    v_sub_f32 v120, v120, v195
    v_sub_f32 v89, v89, v195
    v_sub_f32 v121, v121, v195
    v_sub_f32 v90, v90, v195
    v_sub_f32 v122, v122, v195
    v_sub_f32 v91, v91, v195
    v_sub_f32 v123, v123, v195
    v_sub_f32 v92, v92, v195
    v_sub_f32 v124, v124, v195
    v_sub_f32 v93, v93, v195
    v_sub_f32 v125, v125, v195
    v_sub_f32 v94, v94, v195
    v_sub_f32 v126, v126, v195
    v_sub_f32 v95, v95, v195
    v_sub_f32 v127, v127, v195
    v_sub_f32 v172, v172, v195
    v_sub_f32 v173, v173, v195
    v_sub_f32 v174, v174, v195
    v_sub_f32 v175, v175, v195
    v_sub_f32 v196, 0, v195
    v_cvt_i32_f32 v196, v196
    v_ldexp_f32 v228, v228, v196
    v_ldexp_f32 v229, v229, v196
    v_ldexp_f32 v230, v230, v196
    v_ldexp_f32 v231, v231, v196
    v_accvgpr_read_b32 v232, a12
    v_accvgpr_read_b32 v233, a13
    v_accvgpr_read_b32 v234, a14
    v_accvgpr_read_b32 v235, a15
    v_accvgpr_read_b32 v236, a28
    v_accvgpr_read_b32 v237, a29
    v_accvgpr_read_b32 v238, a30
    v_accvgpr_read_b32 v239, a31
    v_ldexp_f32 v232, v232, v196
    v_ldexp_f32 v233, v233, v196
    v_ldexp_f32 v234, v234, v196
    v_ldexp_f32 v235, v235, v196
    v_ldexp_f32 v236, v236, v196
    v_ldexp_f32 v237, v237, v196
    v_ldexp_f32 v238, v238, v196
    v_ldexp_f32 v239, v239, v196
    v_accvgpr_write_b32 a12, v232
    v_accvgpr_write_b32 a13, v233
    v_accvgpr_write_b32 a14, v234
    v_accvgpr_write_b32 a15, v235
    v_accvgpr_write_b32 a28, v236
    v_accvgpr_write_b32 a29, v237
    v_accvgpr_write_b32 a30, v238
    v_accvgpr_write_b32 a31, v239
    v_accvgpr_read_b32 v232, a44
    v_accvgpr_read_b32 v233, a45
    v_accvgpr_read_b32 v234, a46
    v_accvgpr_read_b32 v235, a47
    v_accvgpr_read_b32 v236, a60
    v_accvgpr_read_b32 v237, a61
    v_accvgpr_read_b32 v238, a62
    v_accvgpr_read_b32 v239, a63
    v_ldexp_f32 v232, v232, v196
    v_ldexp_f32 v233, v233, v196
    v_ldexp_f32 v234, v234, v196
    v_ldexp_f32 v235, v235, v196
    v_ldexp_f32 v236, v236, v196
    v_ldexp_f32 v237, v237, v196
    v_ldexp_f32 v238, v238, v196
    v_ldexp_f32 v239, v239, v196
    v_accvgpr_write_b32 a44, v232
    v_accvgpr_write_b32 a45, v233
    v_accvgpr_write_b32 a46, v234
    v_accvgpr_write_b32 a47, v235
    v_accvgpr_write_b32 a60, v236
    v_accvgpr_write_b32 a61, v237
    v_accvgpr_write_b32 a62, v238
    v_accvgpr_write_b32 a63, v239
    v_accvgpr_read_b32 v232, a76
    v_accvgpr_read_b32 v233, a77
    v_accvgpr_read_b32 v234, a78
    v_accvgpr_read_b32 v235, a79
    v_accvgpr_read_b32 v236, a92
    v_accvgpr_read_b32 v237, a93
    v_accvgpr_read_b32 v238, a94
    v_accvgpr_read_b32 v239, a95
    v_ldexp_f32 v232, v232, v196
    v_ldexp_f32 v233, v233, v196
    v_ldexp_f32 v234, v234, v196
    v_ldexp_f32 v235, v235, v196
    v_ldexp_f32 v236, v236, v196
    v_ldexp_f32 v237, v237, v196
    v_ldexp_f32 v238, v238, v196
    v_ldexp_f32 v239, v239, v196
    v_accvgpr_write_b32 a76, v232
    v_accvgpr_write_b32 a77, v233
    v_accvgpr_write_b32 a78, v234
    v_accvgpr_write_b32 a79, v235
    v_accvgpr_write_b32 a92, v236
    v_accvgpr_write_b32 a93, v237
    v_accvgpr_write_b32 a94, v238
    v_accvgpr_write_b32 a95, v239
    v_accvgpr_read_b32 v232, a108
    v_accvgpr_read_b32 v233, a109
    v_accvgpr_read_b32 v234, a110
    v_accvgpr_read_b32 v235, a111
    v_accvgpr_read_b32 v236, a124
    v_accvgpr_read_b32 v237, a125
    v_accvgpr_read_b32 v238, a126
    v_accvgpr_read_b32 v239, a127
    v_ldexp_f32 v232, v232, v196
    v_ldexp_f32 v233, v233, v196
    v_ldexp_f32 v234, v234, v196
    v_ldexp_f32 v235, v235, v196
    v_ldexp_f32 v236, v236, v196
    v_ldexp_f32 v237, v237, v196
    v_ldexp_f32 v238, v238, v196
    v_ldexp_f32 v239, v239, v196
    v_accvgpr_write_b32 a108, v232
    v_accvgpr_write_b32 a109, v233
    v_accvgpr_write_b32 a110, v234
    v_accvgpr_write_b32 a111, v235
    v_accvgpr_write_b32 a124, v236
    v_accvgpr_write_b32 a125, v237
    v_accvgpr_write_b32 a126, v238
    v_accvgpr_write_b32 a127, v239
    v_exp_f32 v232, v80
    v_exp_f32 v233, v81
    v_exp_f32 v234, v82
    v_exp_f32 v235, v83
    v_exp_f32 v236, v84
    v_exp_f32 v237, v85
    v_exp_f32 v238, v86
    v_exp_f32 v239, v87
    s_nop 0
    v_cvt_pk_bf16_f32 v136, v232, v233
    v_cvt_pk_bf16_f32 v137, v234, v235
    v_cvt_pk_bf16_f32 v138, v236, v237
    v_cvt_pk_bf16_f32 v139, v238, v239
    v_exp_f32 v232, v88
    v_exp_f32 v233, v89
    v_exp_f32 v234, v90
    v_exp_f32 v235, v91
    v_exp_f32 v236, v92
    v_exp_f32 v237, v93
    v_exp_f32 v238, v94
    v_exp_f32 v239, v95
    s_nop 0
    v_cvt_pk_bf16_f32 v140, v232, v233
    v_cvt_pk_bf16_f32 v141, v234, v235
    v_cvt_pk_bf16_f32 v142, v236, v237
    v_cvt_pk_bf16_f32 v143, v238, v239
    s_nop 1
    v_mfma_f32_16x16x32_bf16 v[208:211], v[52:55], v[136:139], v[224:227]
    v_mfma_f32_16x16x32_bf16 v[212:215], v[52:55], v[140:143], v[228:231]
    s_nop 7
    s_setpc_b64 s[40:41]
K1_rare10:
    s_nop 15
    v_max3_f32 v192, v96, v97, v98
    v_max3_f32 v192, v192, v99, v100
    v_max3_f32 v192, v192, v101, v102
    v_max_f32 v192, v192, v103
    v_mov_b32 v196, v192
    s_nop 1
    v_permlane16_swap_b32 v192, v196
    v_max_f32 v192, v192, v196
    v_mov_b32 v196, v192
    s_nop 1
    v_permlane32_swap_b32 v192, v196
    v_max_f32 v192, v192, v196
    v_add_f32 v192, s46, v192
    v_max_f32 v192, 0, v192
    v_ceil_f32 v192, v192
    v_max3_f32 v193, v104, v105, v106
    v_max3_f32 v193, v193, v107, v108
    v_max3_f32 v193, v193, v109, v110
    v_max_f32 v193, v193, v111
    v_mov_b32 v196, v193
    s_nop 1
    v_permlane16_swap_b32 v193, v196
    v_max_f32 v193, v193, v196
    v_mov_b32 v196, v193
    s_nop 1
    v_permlane32_swap_b32 v193, v196
    v_max_f32 v193, v193, v196
    v_add_f32 v193, s46, v193
    v_max_f32 v193, 0, v193
    v_ceil_f32 v193, v193
    v_sub_f32 v96, v96, v192
    v_sub_f32 v64, v64, v192
    v_sub_f32 v97, v97, v192
    v_sub_f32 v65, v65, v192
    v_sub_f32 v98, v98, v192
    v_sub_f32 v66, v66, v192
    v_sub_f32 v99, v99, v192
    v_sub_f32 v67, v67, v192
    v_sub_f32 v100, v100, v192
    v_sub_f32 v68, v68, v192
    v_sub_f32 v101, v101, v192
    v_sub_f32 v69, v69, v192
    v_sub_f32 v102, v102, v192
    v_sub_f32 v70, v70, v192
    v_sub_f32 v103, v103, v192
    v_sub_f32 v71, v71, v192
    v_sub_f32 v160, v160, v192
    v_sub_f32 v161, v161, v192
    v_sub_f32 v162, v162, v192
    v_sub_f32 v163, v163, v192
    v_sub_f32 v196, 0, v192
    v_cvt_i32_f32 v196, v196
    v_ldexp_f32 v200, v200, v196
    v_ldexp_f32 v201, v201, v196
    v_ldexp_f32 v202, v202, v196
    v_ldexp_f32 v203, v203, v196
    v_accvgpr_read_b32 v232, a0
    v_accvgpr_read_b32 v233, a1
    v_accvgpr_read_b32 v234, a2
    v_accvgpr_read_b32 v235, a3
    v_accvgpr_read_b32 v236, a16
    v_accvgpr_read_b32 v237, a17
    v_accvgpr_read_b32 v238, a18
    v_accvgpr_read_b32 v239, a19
    v_ldexp_f32 v232, v232, v196
    v_ldexp_f32 v233, v233, v196
    v_ldexp_f32 v234, v234, v196
    v_ldexp_f32 v235, v235, v196
    v_ldexp_f32 v236, v236, v196
    v_ldexp_f32 v237, v237, v196
    v_ldexp_f32 v238, v238, v196
    v_ldexp_f32 v239, v239, v196
    v_accvgpr_write_b32 a0, v232
    v_accvgpr_write_b32 a1, v233
    v_accvgpr_write_b32 a2, v234
    v_accvgpr_write_b32 a3, v235
    v_accvgpr_write_b32 a16, v236
    v_accvgpr_write_b32 a17, v237
    v_accvgpr_write_b32 a18, v238
    v_accvgpr_write_b32 a19, v239
    v_accvgpr_read_b32 v232, a32
    v_accvgpr_read_b32 v233, a33
    v_accvgpr_read_b32 v234, a34
    v_accvgpr_read_b32 v235, a35
    v_accvgpr_read_b32 v236, a48
    v_accvgpr_read_b32 v237, a49
    v_accvgpr_read_b32 v238, a50
    v_accvgpr_read_b32 v239, a51
    v_ldexp_f32 v232, v232, v196
    v_ldexp_f32 v233, v233, v196
    v_ldexp_f32 v234, v234, v196
    v_ldexp_f32 v235, v235, v196
    v_ldexp_f32 v236, v236, v196
    v_ldexp_f32 v237, v237, v196
    v_ldexp_f32 v238, v238, v196
    v_ldexp_f32 v239, v239, v196
    v_accvgpr_write_b32 a32, v232
    v_accvgpr_write_b32 a33, v233
    v_accvgpr_write_b32 a34, v234
    v_accvgpr_write_b32 a35, v235
    v_accvgpr_write_b32 a48, v236
    v_accvgpr_write_b32 a49, v237
    v_accvgpr_write_b32 a50, v238
    v_accvgpr_write_b32 a51, v239
    v_accvgpr_read_b32 v232, a64
    v_accvgpr_read_b32 v233, a65
    v_accvgpr_read_b32 v234, a66
    v_accvgpr_read_b32 v235, a67
    v_accvgpr_read_b32 v236, a80
    v_accvgpr_read_b32 v237, a81
    v_accvgpr_read_b32 v238, a82
    v_accvgpr_read_b32 v239, a83
    v_ldexp_f32 v232, v232, v196
    v_ldexp_f32 v233, v233, v196
    v_ldexp_f32 v234, v234, v196
    v_ldexp_f32 v235, v235, v196
    v_ldexp_f32 v236, v236, v196
    v_ldexp_f32 v237, v237, v196
    v_ldexp_f32 v238, v238, v196
    v_ldexp_f32 v239, v239, v196
    v_accvgpr_write_b32 a64, v232
    v_accvgpr_write_b32 a65, v233
    v_accvgpr_write_b32 a66, v234
    v_accvgpr_write_b32 a67, v235
    v_accvgpr_write_b32 a80, v236
    v_accvgpr_write_b32 a81, v237
    v_accvgpr_write_b32 a82, v238
    v_accvgpr_write_b32 a83, v239
    v_accvgpr_read_b32 v232, a96
    v_accvgpr_read_b32 v233, a97
    v_accvgpr_read_b32 v234, a98
    v_accvgpr_read_b32 v235, a99
    v_accvgpr_read_b32 v236, a112
    v_accvgpr_read_b32 v237, a113
    v_accvgpr_read_b32 v238, a114
    v_accvgpr_read_b32 v239, a115
    v_ldexp_f32 v232, v232, v196
    v_ldexp_f32 v233, v233, v196
    v_ldexp_f32 v234, v234, v196
    v_ldexp_f32 v235, v235, v196
    v_ldexp_f32 v236, v236, v196
    v_ldexp_f32 v237, v237, v196
    v_ldexp_f32 v238, v238, v196
    v_ldexp_f32 v239, v239, v196
    v_accvgpr_write_b32 a96, v232
    v_accvgpr_write_b32 a97, v233
    v_accvgpr_write_b32 a98, v234
    v_accvgpr_write_b32 a99, v235
    v_accvgpr_write_b32 a112, v236
    v_accvgpr_write_b32 a113, v237
    v_accvgpr_write_b32 a114, v238
    v_accvgpr_write_b32 a115, v239
    v_sub_f32 v104, v104, v193
    v_sub_f32 v72, v72, v193
    v_sub_f32 v105, v105, v193
    v_sub_f32 v73, v73, v193
    v_sub_f32 v106, v106, v193
    v_sub_f32 v74, v74, v193
    v_sub_f32 v107, v107, v193
    v_sub_f32 v75, v75, v193
    v_sub_f32 v108, v108, v193
    v_sub_f32 v76, v76, v193
    v_sub_f32 v109, v109, v193
    v_sub_f32 v77, v77, v193
    v_sub_f32 v110, v110, v193
    v_sub_f32 v78, v78, v193
    v_sub_f32 v111, v111, v193
    v_sub_f32 v79, v79, v193
    v_sub_f32 v164, v164, v193
    v_sub_f32 v165, v165, v193
    v_sub_f32 v166, v166, v193
    v_sub_f32 v167, v167, v193
    v_sub_f32 v196, 0, v193
    v_cvt_i32_f32 v196, v196
    v_ldexp_f32 v204, v204, v196
    v_ldexp_f32 v205, v205, v196
    v_ldexp_f32 v206, v206, v196
    v_ldexp_f32 v207, v207, v196
    v_accvgpr_read_b32 v232, a4
    v_accvgpr_read_b32 v233, a5
    v_accvgpr_read_b32 v234, a6
    v_accvgpr_read_b32 v235, a7
    v_accvgpr_read_b32 v236, a20
    v_accvgpr_read_b32 v237, a21
    v_accvgpr_read_b32 v238, a22
    v_accvgpr_read_b32 v239, a23
    v_ldexp_f32 v232, v232, v196
    v_ldexp_f32 v233, v233, v196
    v_ldexp_f32 v234, v234, v196
    v_ldexp_f32 v235, v235, v196
    v_ldexp_f32 v236, v236, v196
    v_ldexp_f32 v237, v237, v196
    v_ldexp_f32 v238, v238, v196
    v_ldexp_f32 v239, v239, v196
    v_accvgpr_write_b32 a4, v232
    v_accvgpr_write_b32 a5, v233
    v_accvgpr_write_b32 a6, v234
    v_accvgpr_write_b32 a7, v235
    v_accvgpr_write_b32 a20, v236
    v_accvgpr_write_b32 a21, v237
    v_accvgpr_write_b32 a22, v238
    v_accvgpr_write_b32 a23, v239
    v_accvgpr_read_b32 v232, a36
    v_accvgpr_read_b32 v233, a37
    v_accvgpr_read_b32 v234, a38
    v_accvgpr_read_b32 v235, a39
    v_accvgpr_read_b32 v236, a52
    v_accvgpr_read_b32 v237, a53
    v_accvgpr_read_b32 v238, a54
    v_accvgpr_read_b32 v239, a55
    v_ldexp_f32 v232, v232, v196
    v_ldexp_f32 v233, v233, v196
    v_ldexp_f32 v234, v234, v196
    v_ldexp_f32 v235, v235, v196
    v_ldexp_f32 v236, v236, v196
    v_ldexp_f32 v237, v237, v196
    v_ldexp_f32 v238, v238, v196
    v_ldexp_f32 v239, v239, v196
    v_accvgpr_write_b32 a36, v232
    v_accvgpr_write_b32 a37, v233
    v_accvgpr_write_b32 a38, v234
    v_accvgpr_write_b32 a39, v235
    v_accvgpr_write_b32 a52, v236
    v_accvgpr_write_b32 a53, v237
    v_accvgpr_write_b32 a54, v238
    v_accvgpr_write_b32 a55, v239
    v_accvgpr_read_b32 v232, a68
    v_accvgpr_read_b32 v233, a69
    v_accvgpr_read_b32 v234, a70
    v_accvgpr_read_b32 v235, a71
    v_accvgpr_read_b32 v236, a84
    v_accvgpr_read_b32 v237, a85
    v_accvgpr_read_b32 v238, a86
    v_accvgpr_read_b32 v239, a87
    v_ldexp_f32 v232, v232, v196
    v_ldexp_f32 v233, v233, v196
    v_ldexp_f32 v234, v234, v196
    v_ldexp_f32 v235, v235, v196
    v_ldexp_f32 v236, v236, v196
    v_ldexp_f32 v237, v237, v196
    v_ldexp_f32 v238, v238, v196
    v_ldexp_f32 v239, v239, v196
    v_accvgpr_write_b32 a68, v232
    v_accvgpr_write_b32 a69, v233
    v_accvgpr_write_b32 a70, v234
    v_accvgpr_write_b32 a71, v235
    v_accvgpr_write_b32 a84, v236
    v_accvgpr_write_b32 a85, v237
    v_accvgpr_write_b32 a86, v238
    v_accvgpr_write_b32 a87, v239
    v_accvgpr_read_b32 v232, a100
    v_accvgpr_read_b32 v233, a101
    v_accvgpr_read_b32 v234, a102
    v_accvgpr_read_b32 v235, a103
    v_accvgpr_read_b32 v236, a116
    v_accvgpr_read_b32 v237, a117
    v_accvgpr_read_b32 v238, a118
    v_accvgpr_read_b32 v239, a119
    v_ldexp_f32 v232, v232, v196
    v_ldexp_f32 v233, v233, v196
    v_ldexp_f32 v234, v234, v196
    v_ldexp_f32 v235, v235, v196
    v_ldexp_f32 v236, v236, v196
    v_ldexp_f32 v237, v237, v196
    v_ldexp_f32 v238, v238, v196
    v_ldexp_f32 v239, v239, v196
    v_accvgpr_write_b32 a100, v232
    v_accvgpr_write_b32 a101, v233
    v_accvgpr_write_b32 a102, v234
    v_accvgpr_write_b32 a103, v235
    v_accvgpr_write_b32 a116, v236
    v_accvgpr_write_b32 a117, v237
    v_accvgpr_write_b32 a118, v238
    v_accvgpr_write_b32 a119, v239
    v_exp_f32 v232, v96
    v_exp_f32 v233, v97
    v_exp_f32 v234, v98
    v_exp_f32 v235, v99
    v_exp_f32 v236, v100
    v_exp_f32 v237, v101
    v_exp_f32 v238, v102
    v_exp_f32 v239, v103
    s_nop 0
    v_cvt_pk_bf16_f32 v144, v232, v233
    v_cvt_pk_bf16_f32 v145, v234, v235
    v_cvt_pk_bf16_f32 v146, v236, v237
    v_cvt_pk_bf16_f32 v147, v238, v239
    v_exp_f32 v232, v104
    v_exp_f32 v233, v105
    v_exp_f32 v234, v106
    v_exp_f32 v235, v107
    v_exp_f32 v236, v108
    v_exp_f32 v237, v109
    v_exp_f32 v238, v110
    v_exp_f32 v239, v111
    s_nop 0
    v_cvt_pk_bf16_f32 v148, v232, v233
    v_cvt_pk_bf16_f32 v149, v234, v235
    v_cvt_pk_bf16_f32 v150, v236, v237
    v_cvt_pk_bf16_f32 v151, v238, v239
    s_nop 1
    v_mfma_f32_16x16x32_bf16 v[216:219], v[52:55], v[144:147], v[200:203]
    v_mfma_f32_16x16x32_bf16 v[220:223], v[52:55], v[148:151], v[204:207]
    s_nop 7
    s_setpc_b64 s[40:41]
K1_rare11:
    s_nop 15
    v_max3_f32 v194, v112, v113, v114
    v_max3_f32 v194, v194, v115, v116
    v_max3_f32 v194, v194, v117, v118
    v_max_f32 v194, v194, v119
    v_mov_b32 v196, v194
    s_nop 1
    v_permlane16_swap_b32 v194, v196
    v_max_f32 v194, v194, v196
    v_mov_b32 v196, v194
    s_nop 1
    v_permlane32_swap_b32 v194, v196
    v_max_f32 v194, v194, v196
    v_add_f32 v194, s46, v194
    v_max_f32 v194, 0, v194
    v_ceil_f32 v194, v194
    v_max3_f32 v195, v120, v121, v122
    v_max3_f32 v195, v195, v123, v124
    v_max3_f32 v195, v195, v125, v126
    v_max_f32 v195, v195, v127
    v_mov_b32 v196, v195
    s_nop 1
    v_permlane16_swap_b32 v195, v196
    v_max_f32 v195, v195, v196
    v_mov_b32 v196, v195
    s_nop 1
    v_permlane32_swap_b32 v195, v196
    v_max_f32 v195, v195, v196
    v_add_f32 v195, s46, v195
    v_max_f32 v195, 0, v195
    v_ceil_f32 v195, v195
    v_sub_f32 v112, v112, v194
    v_sub_f32 v80, v80, v194
    v_sub_f32 v113, v113, v194
    v_sub_f32 v81, v81, v194
    v_sub_f32 v114, v114, v194
    v_sub_f32 v82, v82, v194
    v_sub_f32 v115, v115, v194
    v_sub_f32 v83, v83, v194
    v_sub_f32 v116, v116, v194
    v_sub_f32 v84, v84, v194
    v_sub_f32 v117, v117, v194
    v_sub_f32 v85, v85, v194
    v_sub_f32 v118, v118, v194
    v_sub_f32 v86, v86, v194
    v_sub_f32 v119, v119, v194
    v_sub_f32 v87, v87, v194
    v_sub_f32 v168, v168, v194
    v_sub_f32 v169, v169, v194
    v_sub_f32 v170, v170, v194
    v_sub_f32 v171, v171, v194
    v_sub_f32 v196, 0, v194
    v_cvt_i32_f32 v196, v196
    v_ldexp_f32 v208, v208, v196
    v_ldexp_f32 v209, v209, v196
    v_ldexp_f32 v210, v210, v196
    v_ldexp_f32 v211, v211, v196
    v_accvgpr_read_b32 v232, a8
    v_accvgpr_read_b32 v233, a9
    v_accvgpr_read_b32 v234, a10
    v_accvgpr_read_b32 v235, a11
    v_accvgpr_read_b32 v236, a24
    v_accvgpr_read_b32 v237, a25
    v_accvgpr_read_b32 v238, a26
    v_accvgpr_read_b32 v239, a27
    v_ldexp_f32 v232, v232, v196
    v_ldexp_f32 v233, v233, v196
    v_ldexp_f32 v234, v234, v196
    v_ldexp_f32 v235, v235, v196
    v_ldexp_f32 v236, v236, v196
    v_ldexp_f32 v237, v237, v196
    v_ldexp_f32 v238, v238, v196
    v_ldexp_f32 v239, v239, v196
    v_accvgpr_write_b32 a8, v232
    v_accvgpr_write_b32 a9, v233
    v_accvgpr_write_b32 a10, v234
    v_accvgpr_write_b32 a11, v235
    v_accvgpr_write_b32 a24, v236
    v_accvgpr_write_b32 a25, v237
    v_accvgpr_write_b32 a26, v238
    v_accvgpr_write_b32 a27, v239
    v_accvgpr_read_b32 v232, a40
    v_accvgpr_read_b32 v233, a41
    v_accvgpr_read_b32 v234, a42
    v_accvgpr_read_b32 v235, a43
    v_accvgpr_read_b32 v236, a56
    v_accvgpr_read_b32 v237, a57
    v_accvgpr_read_b32 v238, a58
    v_accvgpr_read_b32 v239, a59
    v_ldexp_f32 v232, v232, v196
    v_ldexp_f32 v233, v233, v196
    v_ldexp_f32 v234, v234, v196
    v_ldexp_f32 v235, v235, v196
    v_ldexp_f32 v236, v236, v196
    v_ldexp_f32 v237, v237, v196
    v_ldexp_f32 v238, v238, v196
    v_ldexp_f32 v239, v239, v196
    v_accvgpr_write_b32 a40, v232
    v_accvgpr_write_b32 a41, v233
    v_accvgpr_write_b32 a42, v234
    v_accvgpr_write_b32 a43, v235
    v_accvgpr_write_b32 a56, v236
    v_accvgpr_write_b32 a57, v237
    v_accvgpr_write_b32 a58, v238
    v_accvgpr_write_b32 a59, v239
    v_accvgpr_read_b32 v232, a72
    v_accvgpr_read_b32 v233, a73
    v_accvgpr_read_b32 v234, a74
    v_accvgpr_read_b32 v235, a75
    v_accvgpr_read_b32 v236, a88
    v_accvgpr_read_b32 v237, a89
    v_accvgpr_read_b32 v238, a90
    v_accvgpr_read_b32 v239, a91
    v_ldexp_f32 v232, v232, v196
    v_ldexp_f32 v233, v233, v196
    v_ldexp_f32 v234, v234, v196
    v_ldexp_f32 v235, v235, v196
    v_ldexp_f32 v236, v236, v196
    v_ldexp_f32 v237, v237, v196
    v_ldexp_f32 v238, v238, v196
    v_ldexp_f32 v239, v239, v196
    v_accvgpr_write_b32 a72, v232
    v_accvgpr_write_b32 a73, v233
    v_accvgpr_write_b32 a74, v234
    v_accvgpr_write_b32 a75, v235
    v_accvgpr_write_b32 a88, v236
    v_accvgpr_write_b32 a89, v237
    v_accvgpr_write_b32 a90, v238
    v_accvgpr_write_b32 a91, v239
    v_accvgpr_read_b32 v232, a104
    v_accvgpr_read_b32 v233, a105
    v_accvgpr_read_b32 v234, a106
    v_accvgpr_read_b32 v235, a107
    v_accvgpr_read_b32 v236, a120
    v_accvgpr_read_b32 v237, a121
    v_accvgpr_read_b32 v238, a122
    v_accvgpr_read_b32 v239, a123
    v_ldexp_f32 v232, v232, v196
    v_ldexp_f32 v233, v233, v196
    v_ldexp_f32 v234, v234, v196
    v_ldexp_f32 v235, v235, v196
    v_ldexp_f32 v236, v236, v196
    v_ldexp_f32 v237, v237, v196
    v_ldexp_f32 v238, v238, v196
    v_ldexp_f32 v239, v239, v196
    v_accvgpr_write_b32 a104, v232
    v_accvgpr_write_b32 a105, v233
    v_accvgpr_write_b32 a106, v234
    v_accvgpr_write_b32 a107, v235
    v_accvgpr_write_b32 a120, v236
    v_accvgpr_write_b32 a121, v237
    v_accvgpr_write_b32 a122, v238
    v_accvgpr_write_b32 a123, v239
    v_sub_f32 v120, v120, v195
    v_sub_f32 v88, v88, v195
    v_sub_f32 v121, v121, v195
    v_sub_f32 v89, v89, v195
    v_sub_f32 v122, v122, v195
    v_sub_f32 v90, v90, v195
    v_sub_f32 v123, v123, v195
    v_sub_f32 v91, v91, v195
    v_sub_f32 v124, v124, v195
    v_sub_f32 v92, v92, v195
    v_sub_f32 v125, v125, v195
    v_sub_f32 v93, v93, v195
    v_sub_f32 v126, v126, v195
    v_sub_f32 v94, v94, v195
    v_sub_f32 v127, v127, v195
    v_sub_f32 v95, v95, v195
    v_sub_f32 v172, v172, v195
    v_sub_f32 v173, v173, v195
    v_sub_f32 v174, v174, v195
    v_sub_f32 v175, v175, v195
    v_sub_f32 v196, 0, v195
    v_cvt_i32_f32 v196, v196
    v_ldexp_f32 v212, v212, v196
    v_ldexp_f32 v213, v213, v196
    v_ldexp_f32 v214, v214, v196
    v_ldexp_f32 v215, v215, v196
    v_accvgpr_read_b32 v232, a12
    v_accvgpr_read_b32 v233, a13
    v_accvgpr_read_b32 v234, a14
    v_accvgpr_read_b32 v235, a15
    v_accvgpr_read_b32 v236, a28
    v_accvgpr_read_b32 v237, a29
    v_accvgpr_read_b32 v238, a30
    v_accvgpr_read_b32 v239, a31
    v_ldexp_f32 v232, v232, v196
    v_ldexp_f32 v233, v233, v196
    v_ldexp_f32 v234, v234, v196
    v_ldexp_f32 v235, v235, v196
    v_ldexp_f32 v236, v236, v196
    v_ldexp_f32 v237, v237, v196
    v_ldexp_f32 v238, v238, v196
    v_ldexp_f32 v239, v239, v196
    v_accvgpr_write_b32 a12, v232
    v_accvgpr_write_b32 a13, v233
    v_accvgpr_write_b32 a14, v234
    v_accvgpr_write_b32 a15, v235
    v_accvgpr_write_b32 a28, v236
    v_accvgpr_write_b32 a29, v237
    v_accvgpr_write_b32 a30, v238
    v_accvgpr_write_b32 a31, v239
    v_accvgpr_read_b32 v232, a44
    v_accvgpr_read_b32 v233, a45
    v_accvgpr_read_b32 v234, a46
    v_accvgpr_read_b32 v235, a47
    v_accvgpr_read_b32 v236, a60
    v_accvgpr_read_b32 v237, a61
    v_accvgpr_read_b32 v238, a62
    v_accvgpr_read_b32 v239, a63
    v_ldexp_f32 v232, v232, v196
    v_ldexp_f32 v233, v233, v196
    v_ldexp_f32 v234, v234, v196
    v_ldexp_f32 v235, v235, v196
    v_ldexp_f32 v236, v236, v196
    v_ldexp_f32 v237, v237, v196
    v_ldexp_f32 v238, v238, v196
    v_ldexp_f32 v239, v239, v196
    v_accvgpr_write_b32 a44, v232
    v_accvgpr_write_b32 a45, v233
    v_accvgpr_write_b32 a46, v234
    v_accvgpr_write_b32 a47, v235
    v_accvgpr_write_b32 a60, v236
    v_accvgpr_write_b32 a61, v237
    v_accvgpr_write_b32 a62, v238
    v_accvgpr_write_b32 a63, v239
    v_accvgpr_read_b32 v232, a76
    v_accvgpr_read_b32 v233, a77
    v_accvgpr_read_b32 v234, a78
    v_accvgpr_read_b32 v235, a79
    v_accvgpr_read_b32 v236, a92
    v_accvgpr_read_b32 v237, a93
    v_accvgpr_read_b32 v238, a94
    v_accvgpr_read_b32 v239, a95
    v_ldexp_f32 v232, v232, v196
    v_ldexp_f32 v233, v233, v196
    v_ldexp_f32 v234, v234, v196
    v_ldexp_f32 v235, v235, v196
    v_ldexp_f32 v236, v236, v196
    v_ldexp_f32 v237, v237, v196
    v_ldexp_f32 v238, v238, v196
    v_ldexp_f32 v239, v239, v196
    v_accvgpr_write_b32 a76, v232
    v_accvgpr_write_b32 a77, v233
    v_accvgpr_write_b32 a78, v234
    v_accvgpr_write_b32 a79, v235
    v_accvgpr_write_b32 a92, v236
    v_accvgpr_write_b32 a93, v237
    v_accvgpr_write_b32 a94, v238
    v_accvgpr_write_b32 a95, v239
    v_accvgpr_read_b32 v232, a108
    v_accvgpr_read_b32 v233, a109
    v_accvgpr_read_b32 v234, a110
    v_accvgpr_read_b32 v235, a111
    v_accvgpr_read_b32 v236, a124
    v_accvgpr_read_b32 v237, a125
    v_accvgpr_read_b32 v238, a126
    v_accvgpr_read_b32 v239, a127
    v_ldexp_f32 v232, v232, v196
    v_ldexp_f32 v233, v233, v196
    v_ldexp_f32 v234, v234, v196
    v_ldexp_f32 v235, v235, v196
    v_ldexp_f32 v236, v236, v196
    v_ldexp_f32 v237, v237, v196
    v_ldexp_f32 v238, v238, v196
    v_ldexp_f32 v239, v239, v196
    v_accvgpr_write_b32 a108, v232
    v_accvgpr_write_b32 a109, v233
    v_accvgpr_write_b32 a110, v234
    v_accvgpr_write_b32 a111, v235
    v_accvgpr_write_b32 a124, v236
    v_accvgpr_write_b32 a125, v237
    v_accvgpr_write_b32 a126, v238
    v_accvgpr_write_b32 a127, v239
    v_exp_f32 v232, v112
    v_exp_f32 v233, v113
    v_exp_f32 v234, v114
    v_exp_f32 v235, v115
    v_exp_f32 v236, v116
    v_exp_f32 v237, v117
    v_exp_f32 v238, v118
    v_exp_f32 v239, v119
    s_nop 0
    v_cvt_pk_bf16_f32 v152, v232, v233
    v_cvt_pk_bf16_f32 v153, v234, v235
    v_cvt_pk_bf16_f32 v154, v236, v237
    v_cvt_pk_bf16_f32 v155, v238, v239
    v_exp_f32 v232, v120
    v_exp_f32 v233, v121
    v_exp_f32 v234, v122
    v_exp_f32 v235, v123
    v_exp_f32 v236, v124
    v_exp_f32 v237, v125
    v_exp_f32 v238, v126
    v_exp_f32 v239, v127
    s_nop 0
    v_cvt_pk_bf16_f32 v156, v232, v233
    v_cvt_pk_bf16_f32 v157, v234, v235
    v_cvt_pk_bf16_f32 v158, v236, v237
    v_cvt_pk_bf16_f32 v159, v238, v239
    s_nop 1
    v_mfma_f32_16x16x32_bf16 v[224:227], v[52:55], v[152:155], v[208:211]
    v_mfma_f32_16x16x32_bf16 v[228:231], v[52:55], v[156:159], v[212:215]
    s_nop 7
    s_setpc_b64 s[40:41]
.p2align 6
K1_loop:
    s_waitcnt lgkmcnt(0)
    v_mfma_f32_16x16x32_bf16 v[96:99], a[192:195], a[128:131], v[160:163]
    v_exp_f32 v176, v80
    v_mfma_f32_16x16x32_bf16 v[104:107], a[192:195], a[144:147], v[164:167]
    v_exp_f32 v177, v81
    v_mfma_f32_16x16x32_bf16 v[112:115], a[192:195], a[160:163], v[168:171]
    s_waitcnt vmcnt(2)
    s_barrier
    v_mfma_f32_16x16x32_bf16 v[120:123], a[192:195], a[176:179], v[172:175]
    ds_read_b64_tr_b16 a[224:225], v12 offset:0
    ds_read_b64_tr_b16 a[226:227], v12 offset:4096
    v_mfma_f32_16x16x32_bf16 v[200:203], v[52:55], v[128:131], v[216:219]
    v_exp_f32 v178, v82
    v_mfma_f32_16x16x32_bf16 v[204:207], v[52:55], v[132:135], v[220:223]
    v_exp_f32 v179, v83
    v_mfma_f32_16x16x32_bf16 v[96:99], a[196:199], a[132:135], v[96:99]
    ds_read_b64_tr_b16 a[228:229], v13 offset:0
    ds_read_b64_tr_b16 a[230:231], v13 offset:4096
    v_mfma_f32_16x16x32_bf16 v[104:107], a[196:199], a[148:151], v[104:107]
    v_cvt_pk_bf16_f32 v136, v176, v177
    s_add_u32 m0, s45, 16384
    v_mfma_f32_16x16x32_bf16 v[112:115], a[196:199], a[164:167], v[112:115]
    buffer_load_dwordx4 v20, s[12:15], s36 offen lds
    v_cvt_pk_bf16_f32 v137, v178, v179
    v_mfma_f32_16x16x32_bf16 v[120:123], a[196:199], a[180:183], v[120:123]
    v_exp_f32 v180, v84
    v_mfma_f32_16x16x32_bf16 v[96:99], a[200:203], a[136:139], v[96:99]
    ds_read_b64_tr_b16 a[232:233], v14 offset:0
    ds_read_b64_tr_b16 a[234:235], v14 offset:4096
    v_mfma_f32_16x16x32_bf16 v[104:107], a[200:203], a[152:155], v[104:107]
    v_exp_f32 v181, v85
    v_mfma_f32_16x16x32_bf16 v[112:115], a[200:203], a[168:171], v[112:115]
    ds_read_b64_tr_b16 a[236:237], v15 offset:0
    ds_read_b64_tr_b16 a[238:239], v15 offset:4096
    v_mfma_f32_16x16x32_bf16 v[120:123], a[200:203], a[184:187], v[120:123]
    v_exp_f32 v182, v86
    v_mfma_f32_16x16x32_bf16 v[96:99], a[204:207], a[140:143], v[96:99]
    buffer_load_dwordx4 v21, s[12:15], s36 offen offset:1024 lds
    s_add_u32 s36, s36, 8192
    v_mfma_f32_16x16x32_bf16 v[104:107], a[204:207], a[156:159], v[104:107]
    v_exp_f32 v183, v87
    v_mfma_f32_16x16x32_bf16 v[112:115], a[204:207], a[172:175], v[112:115]
    ds_read_b64_tr_b16 a[240:241], v16 offset:0
    ds_read_b64_tr_b16 a[242:243], v16 offset:4096
    v_mfma_f32_16x16x32_bf16 v[120:123], a[204:207], a[188:191], v[120:123]
    v_exp_f32 v176, v88
    v_mfma_f32_16x16x32_bf16 v[100:103], a[208:211], a[128:131], v[160:163]
    ds_read_b64_tr_b16 a[244:245], v17 offset:0
    ds_read_b64_tr_b16 a[246:247], v17 offset:4096
    v_mfma_f32_16x16x32_bf16 v[108:111], a[208:211], a[144:147], v[164:167]
    v_cvt_pk_bf16_f32 v138, v180, v181
    s_add_u32 m0, s45, 98304
    v_mfma_f32_16x16x32_bf16 v[116:119], a[208:211], a[160:163], v[168:171]
    buffer_load_dwordx4 v22, s[16:19], s37 offen lds
    v_cvt_pk_bf16_f32 v139, v182, v183
    v_mfma_f32_16x16x32_bf16 v[124:127], a[208:211], a[176:179], v[172:175]
    v_exp_f32 v177, v89
    v_mfma_f32_16x16x32_bf16 v[100:103], a[212:215], a[132:135], v[100:103]
    ds_read_b64_tr_b16 a[248:249], v18 offset:0
    ds_read_b64_tr_b16 a[250:251], v18 offset:4096
    v_mfma_f32_16x16x32_bf16 v[108:111], a[212:215], a[148:151], v[108:111]
    v_exp_f32 v178, v90
    v_mfma_f32_16x16x32_bf16 v[116:119], a[212:215], a[164:167], v[116:119]
    ds_read_b64_tr_b16 a[252:253], v19 offset:0
    ds_read_b64_tr_b16 a[254:255], v19 offset:4096
    v_mfma_f32_16x16x32_bf16 v[124:127], a[212:215], a[180:183], v[124:127]
    v_exp_f32 v179, v91
    v_mfma_f32_16x16x32_bf16 v[100:103], a[216:219], a[136:139], v[100:103]
    buffer_load_dwordx4 v23, s[16:19], s37 offen offset:1024 lds
    s_add_u32 s37, s37, 8192
    v_mfma_f32_16x16x32_bf16 v[108:111], a[216:219], a[152:155], v[108:111]
    v_cvt_pk_bf16_f32 v140, v176, v177
    v_add_f32 v197, v200, v204
    v_mfma_f32_16x16x32_bf16 v[116:119], a[216:219], a[168:171], v[116:119]
    v_exp_f32 v180, v92
    v_mfma_f32_16x16x32_bf16 v[124:127], a[216:219], a[184:187], v[124:127]
    v_cvt_pk_bf16_f32 v141, v178, v179
    v_cmp_nle_f32 vcc, v197, s47
    v_mfma_f32_16x16x32_bf16 v[100:103], a[220:223], a[140:143], v[100:103]
    v_exp_f32 v181, v93
    v_mfma_f32_16x16x32_bf16 v[108:111], a[220:223], a[156:159], v[108:111]
    v_exp_f32 v182, v94
    v_mfma_f32_16x16x32_bf16 v[116:119], a[220:223], a[172:175], v[116:119]
    v_exp_f32 v183, v95
    v_mfma_f32_16x16x32_bf16 v[124:127], a[220:223], a[188:191], v[124:127]
    s_cbranch_vccz K1_ok00
    s_call_b64 s[40:41], K1_rare00
K1_ok00:
    s_waitcnt lgkmcnt(8)
    v_mfma_f32_16x16x32_bf16 a[0:3], a[224:227], v[128:131], a[0:3]
    v_cvt_pk_bf16_f32 v142, v180, v181
    v_cvt_pk_bf16_f32 v143, v182, v183
    v_mfma_f32_16x16x32_bf16 a[4:7], a[224:227], v[132:135], a[4:7]
    v_mfma_f32_16x16x32_bf16 a[16:19], a[228:231], v[128:131], a[16:19]
    v_mfma_f32_16x16x32_bf16 a[20:23], a[228:231], v[132:135], a[20:23]
    v_mfma_f32_16x16x32_bf16 v[208:211], v[52:55], v[136:139], v[224:227]
    ds_read_b128 a[192:195], v8 offset:49152
    v_mfma_f32_16x16x32_bf16 v[212:215], v[52:55], v[140:143], v[228:231]
    v_exp_f32 v176, v96
    v_mfma_f32_16x16x32_bf16 a[32:35], a[232:235], v[128:131], a[32:35]
    v_exp_f32 v177, v97
    v_mfma_f32_16x16x32_bf16 a[36:39], a[232:235], v[132:135], a[36:39]
    ds_read_b128 a[196:199], v9 offset:49152
    s_add_u32 m0, s45, 24576
    v_mfma_f32_16x16x32_bf16 a[48:51], a[236:239], v[128:131], a[48:51]
    buffer_load_dwordx4 v20, s[12:15], s36 offen lds
    v_cvt_pk_bf16_f32 v144, v176, v177
    v_mfma_f32_16x16x32_bf16 a[52:55], a[236:239], v[132:135], a[52:55]
    ds_read_b128 a[200:203], v10 offset:49152
    s_waitcnt lgkmcnt(3)
    v_mfma_f32_16x16x32_bf16 a[64:67], a[240:243], v[128:131], a[64:67]
    v_exp_f32 v178, v98
    v_mfma_f32_16x16x32_bf16 a[68:71], a[240:243], v[132:135], a[68:71]
    v_exp_f32 v179, v99
    v_mfma_f32_16x16x32_bf16 a[80:83], a[244:247], v[128:131], a[80:83]
    ds_read_b128 a[204:207], v11 offset:49152
    v_add_f32 v197, v208, v212
    v_mfma_f32_16x16x32_bf16 a[84:87], a[244:247], v[132:135], a[84:87]
    v_exp_f32 v180, v100
    v_mfma_f32_16x16x32_bf16 a[96:99], a[248:251], v[128:131], a[96:99]
    buffer_load_dwordx4 v21, s[12:15], s36 offen offset:1024 lds
    s_add_u32 s36, s36, 8192
    v_cmp_nle_f32 vcc, v197, s47
    v_mfma_f32_16x16x32_bf16 a[100:103], a[248:251], v[132:135], a[100:103]
    v_exp_f32 v181, v101
    v_mfma_f32_16x16x32_bf16 a[112:115], a[252:255], v[128:131], a[112:115]
    v_exp_f32 v182, v102
    v_mfma_f32_16x16x32_bf16 a[116:119], a[252:255], v[132:135], a[116:119]
    ds_read_b128 a[208:211], v8 offset:53248
    s_cbranch_vccz K1_ok01
    s_call_b64 s[40:41], K1_rare01
K1_ok01:
    v_mfma_f32_16x16x32_bf16 a[8:11], a[224:227], v[136:139], a[8:11]
    v_exp_f32 v183, v103
    v_mfma_f32_16x16x32_bf16 a[12:15], a[224:227], v[140:143], a[12:15]
    v_exp_f32 v176, v104
    v_mfma_f32_16x16x32_bf16 a[24:27], a[228:231], v[136:139], a[24:27]
    ds_read_b128 a[212:215], v9 offset:53248
    v_cvt_pk_bf16_f32 v145, v178, v179
    v_mfma_f32_16x16x32_bf16 a[28:31], a[228:231], v[140:143], a[28:31]
    v_exp_f32 v177, v105
    v_mfma_f32_16x16x32_bf16 a[40:43], a[232:235], v[136:139], a[40:43]
    v_exp_f32 v178, v106
    v_mfma_f32_16x16x32_bf16 a[44:47], a[232:235], v[140:143], a[44:47]
    ds_read_b128 a[216:219], v10 offset:53248
    v_cvt_pk_bf16_f32 v146, v180, v181
    v_mfma_f32_16x16x32_bf16 a[56:59], a[236:239], v[136:139], a[56:59]
    v_exp_f32 v179, v107
    v_mfma_f32_16x16x32_bf16 a[60:63], a[236:239], v[140:143], a[60:63]
    v_exp_f32 v180, v108
    v_mfma_f32_16x16x32_bf16 a[72:75], a[240:243], v[136:139], a[72:75]
    ds_read_b128 a[220:223], v11 offset:53248
    v_cvt_pk_bf16_f32 v147, v182, v183
    v_mfma_f32_16x16x32_bf16 a[76:79], a[240:243], v[140:143], a[76:79]
    v_exp_f32 v181, v109
    v_mfma_f32_16x16x32_bf16 a[88:91], a[244:247], v[136:139], a[88:91]
    v_exp_f32 v182, v110
    v_mfma_f32_16x16x32_bf16 a[92:95], a[244:247], v[140:143], a[92:95]
    v_exp_f32 v183, v111
    v_mfma_f32_16x16x32_bf16 a[104:107], a[248:251], v[136:139], a[104:107]
    v_cvt_pk_bf16_f32 v148, v176, v177
    v_cvt_pk_bf16_f32 v149, v178, v179
    v_mfma_f32_16x16x32_bf16 a[108:111], a[248:251], v[140:143], a[108:111]
    v_cvt_pk_bf16_f32 v150, v180, v181
    v_cvt_pk_bf16_f32 v151, v182, v183
    v_mfma_f32_16x16x32_bf16 a[120:123], a[252:255], v[136:139], a[120:123]
    v_mfma_f32_16x16x32_bf16 a[124:127], a[252:255], v[140:143], a[124:127]
    s_waitcnt lgkmcnt(0)
    v_mfma_f32_16x16x32_bf16 v[64:67], a[192:195], a[128:131], v[160:163]
    v_exp_f32 v176, v112
    v_mfma_f32_16x16x32_bf16 v[72:75], a[192:195], a[144:147], v[164:167]
    v_exp_f32 v177, v113
    v_mfma_f32_16x16x32_bf16 v[80:83], a[192:195], a[160:163], v[168:171]
    v_exp_f32 v178, v114
    v_mfma_f32_16x16x32_bf16 v[88:91], a[192:195], a[176:179], v[172:175]
    ds_read_b64_tr_b16 a[224:225], v12 offset:8192
    ds_read_b64_tr_b16 a[226:227], v12 offset:12288
    v_mfma_f32_16x16x32_bf16 v[216:219], v[52:55], v[144:147], v[200:203]
    v_exp_f32 v179, v115
    v_mfma_f32_16x16x32_bf16 v[220:223], v[52:55], v[148:151], v[204:207]
    v_exp_f32 v180, v116
    v_mfma_f32_16x16x32_bf16 v[64:67], a[196:199], a[132:135], v[64:67]
    ds_read_b64_tr_b16 a[228:229], v13 offset:8192
    ds_read_b64_tr_b16 a[230:231], v13 offset:12288
    v_mfma_f32_16x16x32_bf16 v[72:75], a[196:199], a[148:151], v[72:75]
    v_cvt_pk_bf16_f32 v152, v176, v177
    s_add_u32 m0, s45, 106496
    v_mfma_f32_16x16x32_bf16 v[80:83], a[196:199], a[164:167], v[80:83]
    buffer_load_dwordx4 v22, s[16:19], s37 offen lds
    v_cvt_pk_bf16_f32 v153, v178, v179
    v_mfma_f32_16x16x32_bf16 v[88:91], a[196:199], a[180:183], v[88:91]
    v_exp_f32 v181, v117
    v_mfma_f32_16x16x32_bf16 v[64:67], a[200:203], a[136:139], v[64:67]
    ds_read_b64_tr_b16 a[232:233], v14 offset:8192
    ds_read_b64_tr_b16 a[234:235], v14 offset:12288
    v_mfma_f32_16x16x32_bf16 v[72:75], a[200:203], a[152:155], v[72:75]
    v_exp_f32 v182, v118
    v_mfma_f32_16x16x32_bf16 v[80:83], a[200:203], a[168:171], v[80:83]
    ds_read_b64_tr_b16 a[236:237], v15 offset:8192
    ds_read_b64_tr_b16 a[238:239], v15 offset:12288
    v_mfma_f32_16x16x32_bf16 v[88:91], a[200:203], a[184:187], v[88:91]
    v_exp_f32 v183, v119
    v_mfma_f32_16x16x32_bf16 v[64:67], a[204:207], a[140:143], v[64:67]
    buffer_load_dwordx4 v23, s[16:19], s37 offen offset:1024 lds
    s_add_u32 s37, s37, 8192
    v_mfma_f32_16x16x32_bf16 v[72:75], a[204:207], a[156:159], v[72:75]
    v_exp_f32 v176, v120
    v_mfma_f32_16x16x32_bf16 v[80:83], a[204:207], a[172:175], v[80:83]
    ds_read_b64_tr_b16 a[240:241], v16 offset:8192
    ds_read_b64_tr_b16 a[242:243], v16 offset:12288
    v_mfma_f32_16x16x32_bf16 v[88:91], a[204:207], a[188:191], v[88:91]
    v_exp_f32 v177, v121
    v_mfma_f32_16x16x32_bf16 v[68:71], a[208:211], a[128:131], v[160:163]
    ds_read_b64_tr_b16 a[244:245], v17 offset:8192
    ds_read_b64_tr_b16 a[246:247], v17 offset:12288
    v_mfma_f32_16x16x32_bf16 v[76:79], a[208:211], a[144:147], v[164:167]
    v_cvt_pk_bf16_f32 v154, v180, v181
    s_add_u32 m0, s45, 32768
    v_mfma_f32_16x16x32_bf16 v[84:87], a[208:211], a[160:163], v[168:171]
    buffer_load_dwordx4 v20, s[12:15], s36 offen lds
    v_cvt_pk_bf16_f32 v155, v182, v183
    v_mfma_f32_16x16x32_bf16 v[92:95], a[208:211], a[176:179], v[172:175]
    v_exp_f32 v178, v122
    v_mfma_f32_16x16x32_bf16 v[68:71], a[212:215], a[132:135], v[68:71]
    ds_read_b64_tr_b16 a[248:249], v18 offset:8192
    ds_read_b64_tr_b16 a[250:251], v18 offset:12288
    v_mfma_f32_16x16x32_bf16 v[76:79], a[212:215], a[148:151], v[76:79]
    v_exp_f32 v179, v123
    v_mfma_f32_16x16x32_bf16 v[84:87], a[212:215], a[164:167], v[84:87]
    ds_read_b64_tr_b16 a[252:253], v19 offset:8192
    ds_read_b64_tr_b16 a[254:255], v19 offset:12288
    v_mfma_f32_16x16x32_bf16 v[92:95], a[212:215], a[180:183], v[92:95]
    v_exp_f32 v180, v124
    v_mfma_f32_16x16x32_bf16 v[68:71], a[216:219], a[136:139], v[68:71]
    buffer_load_dwordx4 v21, s[12:15], s36 offen offset:1024 lds
    s_add_u32 s36, s36, 8192
    v_mfma_f32_16x16x32_bf16 v[76:79], a[216:219], a[152:155], v[76:79]
    v_cvt_pk_bf16_f32 v156, v176, v177
    v_add_f32 v197, v216, v220
    v_mfma_f32_16x16x32_bf16 v[84:87], a[216:219], a[168:171], v[84:87]
    v_exp_f32 v181, v125
    v_mfma_f32_16x16x32_bf16 v[92:95], a[216:219], a[184:187], v[92:95]
    v_cvt_pk_bf16_f32 v157, v178, v179
    v_cmp_nle_f32 vcc, v197, s47
    v_mfma_f32_16x16x32_bf16 v[68:71], a[220:223], a[140:143], v[68:71]
    v_exp_f32 v182, v126
    v_mfma_f32_16x16x32_bf16 v[76:79], a[220:223], a[156:159], v[76:79]
    v_exp_f32 v183, v127
    v_mfma_f32_16x16x32_bf16 v[84:87], a[220:223], a[172:175], v[84:87]
    v_cvt_pk_bf16_f32 v158, v180, v181
    v_cvt_pk_bf16_f32 v159, v182, v183
    v_mfma_f32_16x16x32_bf16 v[92:95], a[220:223], a[188:191], v[92:95]
    s_cbranch_vccz K1_ok10
    s_call_b64 s[40:41], K1_rare10
K1_ok10:
    s_waitcnt lgkmcnt(8)
    v_mfma_f32_16x16x32_bf16 a[0:3], a[224:227], v[144:147], a[0:3]
    v_mfma_f32_16x16x32_bf16 a[4:7], a[224:227], v[148:151], a[4:7]
    v_mfma_f32_16x16x32_bf16 a[16:19], a[228:231], v[144:147], a[16:19]
    v_mfma_f32_16x16x32_bf16 a[20:23], a[228:231], v[148:151], a[20:23]
    v_mfma_f32_16x16x32_bf16 v[224:227], v[52:55], v[152:155], v[208:211]
    ds_read_b128 a[192:195], v8 offset:57344
    v_mfma_f32_16x16x32_bf16 v[228:231], v[52:55], v[156:159], v[212:215]
    v_exp_f32 v176, v64
    v_mfma_f32_16x16x32_bf16 a[32:35], a[232:235], v[144:147], a[32:35]
    v_exp_f32 v177, v65
    v_mfma_f32_16x16x32_bf16 a[36:39], a[232:235], v[148:151], a[36:39]
    ds_read_b128 a[196:199], v9 offset:57344
    s_add_u32 m0, s45, 114688
    v_mfma_f32_16x16x32_bf16 a[48:51], a[236:239], v[144:147], a[48:51]
    buffer_load_dwordx4 v22, s[16:19], s37 offen lds
    v_cvt_pk_bf16_f32 v128, v176, v177
    v_mfma_f32_16x16x32_bf16 a[52:55], a[236:239], v[148:151], a[52:55]
    ds_read_b128 a[200:203], v10 offset:57344
    s_waitcnt lgkmcnt(3)
    v_mfma_f32_16x16x32_bf16 a[64:67], a[240:243], v[144:147], a[64:67]
    v_exp_f32 v178, v66
    v_mfma_f32_16x16x32_bf16 a[68:71], a[240:243], v[148:151], a[68:71]
    v_exp_f32 v179, v67
    v_mfma_f32_16x16x32_bf16 a[80:83], a[244:247], v[144:147], a[80:83]
    ds_read_b128 a[204:207], v11 offset:57344
    v_add_f32 v197, v224, v228
    v_mfma_f32_16x16x32_bf16 a[84:87], a[244:247], v[148:151], a[84:87]
    v_exp_f32 v180, v68
    v_mfma_f32_16x16x32_bf16 a[96:99], a[248:251], v[144:147], a[96:99]
    buffer_load_dwordx4 v23, s[16:19], s37 offen offset:1024 lds
    s_add_u32 s37, s37, 8192
    v_cmp_nle_f32 vcc, v197, s47
    v_mfma_f32_16x16x32_bf16 a[100:103], a[248:251], v[148:151], a[100:103]
    v_exp_f32 v181, v69
    v_mfma_f32_16x16x32_bf16 a[112:115], a[252:255], v[144:147], a[112:115]
    v_exp_f32 v182, v70
    v_mfma_f32_16x16x32_bf16 a[116:119], a[252:255], v[148:151], a[116:119]
    ds_read_b128 a[208:211], v8 offset:61440
    s_cbranch_vccz K1_ok11
    s_call_b64 s[40:41], K1_rare11
K1_ok11:
    v_mfma_f32_16x16x32_bf16 a[8:11], a[224:227], v[152:155], a[8:11]
    v_exp_f32 v183, v71
    v_mfma_f32_16x16x32_bf16 a[12:15], a[224:227], v[156:159], a[12:15]
    v_exp_f32 v176, v72
    v_mfma_f32_16x16x32_bf16 a[24:27], a[228:231], v[152:155], a[24:27]
    ds_read_b128 a[212:215], v9 offset:61440
    v_cvt_pk_bf16_f32 v129, v178, v179
    v_mfma_f32_16x16x32_bf16 a[28:31], a[228:231], v[156:159], a[28:31]
    v_exp_f32 v177, v73
    v_mfma_f32_16x16x32_bf16 a[40:43], a[232:235], v[152:155], a[40:43]
    v_exp_f32 v178, v74
    v_mfma_f32_16x16x32_bf16 a[44:47], a[232:235], v[156:159], a[44:47]
    ds_read_b128 a[216:219], v10 offset:61440
    v_cvt_pk_bf16_f32 v130, v180, v181
    v_mfma_f32_16x16x32_bf16 a[56:59], a[236:239], v[152:155], a[56:59]
    v_exp_f32 v179, v75
    v_mfma_f32_16x16x32_bf16 a[60:63], a[236:239], v[156:159], a[60:63]
    v_exp_f32 v180, v76
    v_mfma_f32_16x16x32_bf16 a[72:75], a[240:243], v[152:155], a[72:75]
    ds_read_b128 a[220:223], v11 offset:61440
    v_cvt_pk_bf16_f32 v131, v182, v183
    v_mfma_f32_16x16x32_bf16 a[76:79], a[240:243], v[156:159], a[76:79]
    v_exp_f32 v181, v77
    v_mfma_f32_16x16x32_bf16 a[88:91], a[244:247], v[152:155], a[88:91]
    v_exp_f32 v182, v78
    v_mfma_f32_16x16x32_bf16 a[92:95], a[244:247], v[156:159], a[92:95]
    v_exp_f32 v183, v79
    v_mfma_f32_16x16x32_bf16 a[104:107], a[248:251], v[152:155], a[104:107]
    v_cvt_pk_bf16_f32 v132, v176, v177
    v_cvt_pk_bf16_f32 v133, v178, v179
    v_mfma_f32_16x16x32_bf16 a[108:111], a[248:251], v[156:159], a[108:111]
    v_cvt_pk_bf16_f32 v134, v180, v181
    v_cvt_pk_bf16_f32 v135, v182, v183
    v_mfma_f32_16x16x32_bf16 a[120:123], a[252:255], v[152:155], a[120:123]
    v_mfma_f32_16x16x32_bf16 a[124:127], a[252:255], v[156:159], a[124:127]
    s_waitcnt lgkmcnt(0)
    v_mfma_f32_16x16x32_bf16 v[96:99], a[192:195], a[128:131], v[160:163]
    v_exp_f32 v176, v80
    v_mfma_f32_16x16x32_bf16 v[104:107], a[192:195], a[144:147], v[164:167]
    v_exp_f32 v177, v81
    v_mfma_f32_16x16x32_bf16 v[112:115], a[192:195], a[160:163], v[168:171]
    v_exp_f32 v178, v82
    v_mfma_f32_16x16x32_bf16 v[120:123], a[192:195], a[176:179], v[172:175]
    ds_read_b64_tr_b16 a[224:225], v12 offset:16384
    ds_read_b64_tr_b16 a[226:227], v12 offset:20480
    v_mfma_f32_16x16x32_bf16 v[200:203], v[52:55], v[128:131], v[216:219]
    v_exp_f32 v179, v83
    v_mfma_f32_16x16x32_bf16 v[204:207], v[52:55], v[132:135], v[220:223]
    v_exp_f32 v180, v84
    v_mfma_f32_16x16x32_bf16 v[96:99], a[196:199], a[132:135], v[96:99]
    ds_read_b64_tr_b16 a[228:229], v13 offset:16384
    ds_read_b64_tr_b16 a[230:231], v13 offset:20480
    v_mfma_f32_16x16x32_bf16 v[104:107], a[196:199], a[148:151], v[104:107]
    v_cvt_pk_bf16_f32 v136, v176, v177
    s_add_u32 m0, s45, 40960
    v_mfma_f32_16x16x32_bf16 v[112:115], a[196:199], a[164:167], v[112:115]
    buffer_load_dwordx4 v20, s[12:15], s36 offen lds
    v_cvt_pk_bf16_f32 v137, v178, v179
    v_mfma_f32_16x16x32_bf16 v[120:123], a[196:199], a[180:183], v[120:123]
    v_exp_f32 v181, v85
    v_mfma_f32_16x16x32_bf16 v[96:99], a[200:203], a[136:139], v[96:99]
    ds_read_b64_tr_b16 a[232:233], v14 offset:16384
    ds_read_b64_tr_b16 a[234:235], v14 offset:20480
    v_mfma_f32_16x16x32_bf16 v[104:107], a[200:203], a[152:155], v[104:107]
    v_exp_f32 v182, v86
    v_mfma_f32_16x16x32_bf16 v[112:115], a[200:203], a[168:171], v[112:115]
    ds_read_b64_tr_b16 a[236:237], v15 offset:16384
    ds_read_b64_tr_b16 a[238:239], v15 offset:20480
    v_mfma_f32_16x16x32_bf16 v[120:123], a[200:203], a[184:187], v[120:123]
    v_exp_f32 v183, v87
    v_mfma_f32_16x16x32_bf16 v[96:99], a[204:207], a[140:143], v[96:99]
    buffer_load_dwordx4 v21, s[12:15], s36 offen offset:1024 lds
    s_add_u32 s36, s36, 8192
    v_mfma_f32_16x16x32_bf16 v[104:107], a[204:207], a[156:159], v[104:107]
    v_exp_f32 v176, v88
    v_mfma_f32_16x16x32_bf16 v[112:115], a[204:207], a[172:175], v[112:115]
    ds_read_b64_tr_b16 a[240:241], v16 offset:16384
    ds_read_b64_tr_b16 a[242:243], v16 offset:20480
    v_mfma_f32_16x16x32_bf16 v[120:123], a[204:207], a[188:191], v[120:123]
    v_exp_f32 v177, v89
    v_mfma_f32_16x16x32_bf16 v[100:103], a[208:211], a[128:131], v[160:163]
    ds_read_b64_tr_b16 a[244:245], v17 offset:16384
    ds_read_b64_tr_b16 a[246:247], v17 offset:20480
    v_mfma_f32_16x16x32_bf16 v[108:111], a[208:211], a[144:147], v[164:167]
    v_cvt_pk_bf16_f32 v138, v180, v181
    s_add_u32 m0, s45, 122880
    v_mfma_f32_16x16x32_bf16 v[116:119], a[208:211], a[160:163], v[168:171]
    buffer_load_dwordx4 v22, s[16:19], s37 offen lds
    v_cvt_pk_bf16_f32 v139, v182, v183
    v_mfma_f32_16x16x32_bf16 v[124:127], a[208:211], a[176:179], v[172:175]
    v_exp_f32 v178, v90
    v_mfma_f32_16x16x32_bf16 v[100:103], a[212:215], a[132:135], v[100:103]
    ds_read_b64_tr_b16 a[248:249], v18 offset:16384
    ds_read_b64_tr_b16 a[250:251], v18 offset:20480
    v_mfma_f32_16x16x32_bf16 v[108:111], a[212:215], a[148:151], v[108:111]
    v_exp_f32 v179, v91
    v_mfma_f32_16x16x32_bf16 v[116:119], a[212:215], a[164:167], v[116:119]
    ds_read_b64_tr_b16 a[252:253], v19 offset:16384
    ds_read_b64_tr_b16 a[254:255], v19 offset:20480
    v_mfma_f32_16x16x32_bf16 v[124:127], a[212:215], a[180:183], v[124:127]
    v_exp_f32 v180, v92
    v_mfma_f32_16x16x32_bf16 v[100:103], a[216:219], a[136:139], v[100:103]
    buffer_load_dwordx4 v23, s[16:19], s37 offen offset:1024 lds
    s_add_u32 s37, s37, 8192
    v_mfma_f32_16x16x32_bf16 v[108:111], a[216:219], a[152:155], v[108:111]
    v_cvt_pk_bf16_f32 v140, v176, v177
    v_add_f32 v197, v200, v204
    v_mfma_f32_16x16x32_bf16 v[116:119], a[216:219], a[168:171], v[116:119]
    v_exp_f32 v181, v93
    v_mfma_f32_16x16x32_bf16 v[124:127], a[216:219], a[184:187], v[124:127]
    v_cvt_pk_bf16_f32 v141, v178, v179
    v_cmp_nle_f32 vcc, v197, s47
    v_mfma_f32_16x16x32_bf16 v[100:103], a[220:223], a[140:143], v[100:103]
    v_exp_f32 v182, v94
    v_mfma_f32_16x16x32_bf16 v[108:111], a[220:223], a[156:159], v[108:111]
    v_exp_f32 v183, v95
    v_mfma_f32_16x16x32_bf16 v[116:119], a[220:223], a[172:175], v[116:119]
    v_cvt_pk_bf16_f32 v142, v180, v181
    v_cvt_pk_bf16_f32 v143, v182, v183
    v_mfma_f32_16x16x32_bf16 v[124:127], a[220:223], a[188:191], v[124:127]
    s_cbranch_vccz K1_ok20
    s_call_b64 s[40:41], K1_rare00
K1_ok20:
    s_waitcnt lgkmcnt(8)
    v_mfma_f32_16x16x32_bf16 a[0:3], a[224:227], v[128:131], a[0:3]
    v_mfma_f32_16x16x32_bf16 a[4:7], a[224:227], v[132:135], a[4:7]
    v_mfma_f32_16x16x32_bf16 a[16:19], a[228:231], v[128:131], a[16:19]
    v_mfma_f32_16x16x32_bf16 a[20:23], a[228:231], v[132:135], a[20:23]
    v_mfma_f32_16x16x32_bf16 v[208:211], v[52:55], v[136:139], v[224:227]
    ds_read_b128 a[192:195], v8 offset:0
    v_mfma_f32_16x16x32_bf16 v[212:215], v[52:55], v[140:143], v[228:231]
    v_exp_f32 v176, v96
    v_mfma_f32_16x16x32_bf16 a[32:35], a[232:235], v[128:131], a[32:35]
    v_exp_f32 v177, v97
    v_mfma_f32_16x16x32_bf16 a[36:39], a[232:235], v[132:135], a[36:39]
    ds_read_b128 a[196:199], v9 offset:0
    s_mov_b32 m0, 131072
    v_mfma_f32_16x16x32_bf16 a[48:51], a[236:239], v[128:131], a[48:51]
    buffer_load_dwordx4 v3, s[72:75], s58 offen lds
    v_cvt_pk_bf16_f32 v144, v176, v177
    v_mfma_f32_16x16x32_bf16 a[52:55], a[236:239], v[132:135], a[52:55]
    ds_read_b128 a[200:203], v10 offset:0
    s_waitcnt lgkmcnt(3)
    v_mfma_f32_16x16x32_bf16 a[64:67], a[240:243], v[128:131], a[64:67]
    v_exp_f32 v178, v98
    v_mfma_f32_16x16x32_bf16 a[68:71], a[240:243], v[132:135], a[68:71]
    v_exp_f32 v179, v99
    v_mfma_f32_16x16x32_bf16 a[80:83], a[244:247], v[128:131], a[80:83]
    ds_read_b128 a[204:207], v11 offset:0
    v_add_f32 v197, v208, v212
    v_mfma_f32_16x16x32_bf16 a[84:87], a[244:247], v[132:135], a[84:87]
    v_exp_f32 v180, v100
    v_mfma_f32_16x16x32_bf16 a[96:99], a[248:251], v[128:131], a[96:99]
    buffer_load_dwordx4 v3, s[76:79], s58 offen lds
    v_cmp_nle_f32 vcc, v197, s47
    v_mfma_f32_16x16x32_bf16 a[100:103], a[248:251], v[132:135], a[100:103]
    v_exp_f32 v181, v101
    v_mfma_f32_16x16x32_bf16 a[112:115], a[252:255], v[128:131], a[112:115]
    v_exp_f32 v182, v102
    v_mfma_f32_16x16x32_bf16 a[116:119], a[252:255], v[132:135], a[116:119]
    ds_read_b128 a[208:211], v8 offset:4096
    s_cbranch_vccz K1_ok21
    s_call_b64 s[40:41], K1_rare01
K1_ok21:
    v_mfma_f32_16x16x32_bf16 a[8:11], a[224:227], v[136:139], a[8:11]
    v_exp_f32 v183, v103
    v_mfma_f32_16x16x32_bf16 a[12:15], a[224:227], v[140:143], a[12:15]
    v_exp_f32 v176, v104
    v_mfma_f32_16x16x32_bf16 a[24:27], a[228:231], v[136:139], a[24:27]
    ds_read_b128 a[212:215], v9 offset:4096
    v_cvt_pk_bf16_f32 v145, v178, v179
    v_mfma_f32_16x16x32_bf16 a[28:31], a[228:231], v[140:143], a[28:31]
    v_exp_f32 v177, v105
    v_mfma_f32_16x16x32_bf16 a[40:43], a[232:235], v[136:139], a[40:43]
    v_exp_f32 v178, v106
    v_mfma_f32_16x16x32_bf16 a[44:47], a[232:235], v[140:143], a[44:47]
    ds_read_b128 a[216:219], v10 offset:4096
    v_cvt_pk_bf16_f32 v146, v180, v181
    v_mfma_f32_16x16x32_bf16 a[56:59], a[236:239], v[136:139], a[56:59]
    v_exp_f32 v179, v107
    v_mfma_f32_16x16x32_bf16 a[60:63], a[236:239], v[140:143], a[60:63]
    v_exp_f32 v180, v108
    v_mfma_f32_16x16x32_bf16 a[72:75], a[240:243], v[136:139], a[72:75]
    ds_read_b128 a[220:223], v11 offset:4096
    v_cvt_pk_bf16_f32 v147, v182, v183
    v_mfma_f32_16x16x32_bf16 a[76:79], a[240:243], v[140:143], a[76:79]
    v_exp_f32 v181, v109
    v_mfma_f32_16x16x32_bf16 a[88:91], a[244:247], v[136:139], a[88:91]
    v_exp_f32 v182, v110
    v_mfma_f32_16x16x32_bf16 a[92:95], a[244:247], v[140:143], a[92:95]
    v_exp_f32 v183, v111
    v_mfma_f32_16x16x32_bf16 a[104:107], a[248:251], v[136:139], a[104:107]
    v_cvt_pk_bf16_f32 v148, v176, v177
    v_cvt_pk_bf16_f32 v149, v178, v179
    v_mfma_f32_16x16x32_bf16 a[108:111], a[248:251], v[140:143], a[108:111]
    v_cvt_pk_bf16_f32 v150, v180, v181
    v_cvt_pk_bf16_f32 v151, v182, v183
    v_mfma_f32_16x16x32_bf16 a[120:123], a[252:255], v[136:139], a[120:123]
    v_mfma_f32_16x16x32_bf16 a[124:127], a[252:255], v[140:143], a[124:127]
    s_waitcnt lgkmcnt(0)
    v_mfma_f32_16x16x32_bf16 v[64:67], a[192:195], a[128:131], v[160:163]
    v_exp_f32 v176, v112
    v_mfma_f32_16x16x32_bf16 v[72:75], a[192:195], a[144:147], v[164:167]
    v_exp_f32 v177, v113
    v_mfma_f32_16x16x32_bf16 v[80:83], a[192:195], a[160:163], v[168:171]
    v_exp_f32 v178, v114
    v_mfma_f32_16x16x32_bf16 v[88:91], a[192:195], a[176:179], v[172:175]
    ds_read_b64_tr_b16 a[224:225], v12 offset:24576
    ds_read_b64_tr_b16 a[226:227], v12 offset:28672
    v_mfma_f32_16x16x32_bf16 v[216:219], v[52:55], v[144:147], v[200:203]
    v_exp_f32 v179, v115
    v_mfma_f32_16x16x32_bf16 v[220:223], v[52:55], v[148:151], v[204:207]
    v_exp_f32 v180, v116
    v_mfma_f32_16x16x32_bf16 v[64:67], a[196:199], a[132:135], v[64:67]
    ds_read_b64_tr_b16 a[228:229], v13 offset:24576
    ds_read_b64_tr_b16 a[230:231], v13 offset:28672
    v_mfma_f32_16x16x32_bf16 v[72:75], a[196:199], a[148:151], v[72:75]
    v_exp_f32 v181, v117
    v_mfma_f32_16x16x32_bf16 v[80:83], a[196:199], a[164:167], v[80:83]
    v_exp_f32 v182, v118
    v_mfma_f32_16x16x32_bf16 v[88:91], a[196:199], a[180:183], v[88:91]
    v_exp_f32 v183, v119
    v_mfma_f32_16x16x32_bf16 v[64:67], a[200:203], a[136:139], v[64:67]
    ds_read_b64_tr_b16 a[232:233], v14 offset:24576
    ds_read_b64_tr_b16 a[234:235], v14 offset:28672
    v_mfma_f32_16x16x32_bf16 v[72:75], a[200:203], a[152:155], v[72:75]
    v_cvt_pk_bf16_f32 v152, v176, v177
    v_cvt_pk_bf16_f32 v153, v178, v179
    v_mfma_f32_16x16x32_bf16 v[80:83], a[200:203], a[168:171], v[80:83]
    ds_read_b64_tr_b16 a[236:237], v15 offset:24576
    ds_read_b64_tr_b16 a[238:239], v15 offset:28672
    v_mfma_f32_16x16x32_bf16 v[88:91], a[200:203], a[184:187], v[88:91]
    v_exp_f32 v176, v120
    v_mfma_f32_16x16x32_bf16 v[64:67], a[204:207], a[140:143], v[64:67]
    v_exp_f32 v177, v121
    v_mfma_f32_16x16x32_bf16 v[72:75], a[204:207], a[156:159], v[72:75]
    v_exp_f32 v178, v122
    v_mfma_f32_16x16x32_bf16 v[80:83], a[204:207], a[172:175], v[80:83]
    ds_read_b64_tr_b16 a[240:241], v16 offset:24576
    ds_read_b64_tr_b16 a[242:243], v16 offset:28672
    v_mfma_f32_16x16x32_bf16 v[88:91], a[204:207], a[188:191], v[88:91]
    v_exp_f32 v179, v123
    v_mfma_f32_16x16x32_bf16 v[68:71], a[208:211], a[128:131], v[160:163]
    ds_read_b64_tr_b16 a[244:245], v17 offset:24576
    ds_read_b64_tr_b16 a[246:247], v17 offset:28672
    v_mfma_f32_16x16x32_bf16 v[76:79], a[208:211], a[144:147], v[164:167]
    v_cvt_pk_bf16_f32 v154, v180, v181
    v_cvt_pk_bf16_f32 v155, v182, v183
    v_mfma_f32_16x16x32_bf16 v[84:87], a[208:211], a[160:163], v[168:171]
    v_exp_f32 v180, v124
    v_mfma_f32_16x16x32_bf16 v[92:95], a[208:211], a[176:179], v[172:175]
    v_exp_f32 v181, v125
    v_mfma_f32_16x16x32_bf16 v[68:71], a[212:215], a[132:135], v[68:71]
    ds_read_b64_tr_b16 a[248:249], v18 offset:24576
    ds_read_b64_tr_b16 a[250:251], v18 offset:28672
    v_mfma_f32_16x16x32_bf16 v[76:79], a[212:215], a[148:151], v[76:79]
    v_exp_f32 v182, v126
    v_mfma_f32_16x16x32_bf16 v[84:87], a[212:215], a[164:167], v[84:87]
    ds_read_b64_tr_b16 a[252:253], v19 offset:24576
    ds_read_b64_tr_b16 a[254:255], v19 offset:28672
    v_mfma_f32_16x16x32_bf16 v[92:95], a[212:215], a[180:183], v[92:95]
    v_exp_f32 v183, v127
    v_mfma_f32_16x16x32_bf16 v[68:71], a[216:219], a[136:139], v[68:71]
    v_cvt_pk_bf16_f32 v156, v176, v177
    v_cvt_pk_bf16_f32 v157, v178, v179
    v_mfma_f32_16x16x32_bf16 v[76:79], a[216:219], a[152:155], v[76:79]
    v_cvt_pk_bf16_f32 v158, v180, v181
    v_add_f32 v197, v216, v220
    v_mfma_f32_16x16x32_bf16 v[84:87], a[216:219], a[168:171], v[84:87]
    v_cvt_pk_bf16_f32 v159, v182, v183
    v_mfma_f32_16x16x32_bf16 v[92:95], a[216:219], a[184:187], v[92:95]
    v_cmp_nle_f32 vcc, v197, s47
    v_mfma_f32_16x16x32_bf16 v[68:71], a[220:223], a[140:143], v[68:71]
    v_mfma_f32_16x16x32_bf16 v[76:79], a[220:223], a[156:159], v[76:79]
    v_mfma_f32_16x16x32_bf16 v[84:87], a[220:223], a[172:175], v[84:87]
    v_mfma_f32_16x16x32_bf16 v[92:95], a[220:223], a[188:191], v[92:95]
    s_cbranch_vccz K1_ok30
    s_call_b64 s[40:41], K1_rare10
K1_ok30:
    s_waitcnt lgkmcnt(8)
    v_mfma_f32_16x16x32_bf16 a[0:3], a[224:227], v[144:147], a[0:3]
    v_mfma_f32_16x16x32_bf16 a[4:7], a[224:227], v[148:151], a[4:7]
    v_mfma_f32_16x16x32_bf16 a[16:19], a[228:231], v[144:147], a[16:19]
    v_mfma_f32_16x16x32_bf16 a[20:23], a[228:231], v[148:151], a[20:23]
    v_mfma_f32_16x16x32_bf16 v[224:227], v[52:55], v[152:155], v[208:211]
    ds_read_b128 a[192:195], v8 offset:8192
    v_mfma_f32_16x16x32_bf16 v[228:231], v[52:55], v[156:159], v[212:215]
    v_exp_f32 v176, v64
    v_mfma_f32_16x16x32_bf16 a[32:35], a[232:235], v[144:147], a[32:35]
    v_exp_f32 v177, v65
    v_mfma_f32_16x16x32_bf16 a[36:39], a[232:235], v[148:151], a[36:39]
    ds_read_b128 a[196:199], v9 offset:8192
    v_cvt_pk_bf16_f32 v128, v176, v177
    v_mfma_f32_16x16x32_bf16 a[48:51], a[236:239], v[144:147], a[48:51]
    v_exp_f32 v178, v66
    v_mfma_f32_16x16x32_bf16 a[52:55], a[236:239], v[148:151], a[52:55]
    ds_read_b128 a[200:203], v10 offset:8192
    s_waitcnt lgkmcnt(3)
    v_mfma_f32_16x16x32_bf16 a[64:67], a[240:243], v[144:147], a[64:67]
    v_exp_f32 v179, v67
    v_mfma_f32_16x16x32_bf16 a[68:71], a[240:243], v[148:151], a[68:71]
    v_exp_f32 v180, v68
    v_mfma_f32_16x16x32_bf16 a[80:83], a[244:247], v[144:147], a[80:83]
    ds_read_b128 a[204:207], v11 offset:8192
    v_add_f32 v197, v224, v228
    v_mfma_f32_16x16x32_bf16 a[84:87], a[244:247], v[148:151], a[84:87]
    v_exp_f32 v181, v69
    v_mfma_f32_16x16x32_bf16 a[96:99], a[248:251], v[144:147], a[96:99]
    v_cvt_pk_bf16_f32 v129, v178, v179
    v_cmp_nle_f32 vcc, v197, s47
    v_mfma_f32_16x16x32_bf16 a[100:103], a[248:251], v[148:151], a[100:103]
    v_exp_f32 v182, v70
    v_mfma_f32_16x16x32_bf16 a[112:115], a[252:255], v[144:147], a[112:115]
    v_exp_f32 v183, v71
    v_mfma_f32_16x16x32_bf16 a[116:119], a[252:255], v[148:151], a[116:119]
    ds_read_b128 a[208:211], v8 offset:12288
    s_cbranch_vccz K1_ok31
    s_call_b64 s[40:41], K1_rare11
K1_ok31:
    v_mfma_f32_16x16x32_bf16 a[8:11], a[224:227], v[152:155], a[8:11]
    v_exp_f32 v176, v72
    v_mfma_f32_16x16x32_bf16 a[12:15], a[224:227], v[156:159], a[12:15]
    v_exp_f32 v177, v73
    v_mfma_f32_16x16x32_bf16 a[24:27], a[228:231], v[152:155], a[24:27]
    ds_read_b128 a[212:215], v9 offset:12288
    v_cvt_pk_bf16_f32 v130, v180, v181
    v_mfma_f32_16x16x32_bf16 a[28:31], a[228:231], v[156:159], a[28:31]
    v_exp_f32 v178, v74
    v_mfma_f32_16x16x32_bf16 a[40:43], a[232:235], v[152:155], a[40:43]
    v_exp_f32 v179, v75
    v_mfma_f32_16x16x32_bf16 a[44:47], a[232:235], v[156:159], a[44:47]
    ds_read_b128 a[216:219], v10 offset:12288
    v_cvt_pk_bf16_f32 v131, v182, v183
    v_mfma_f32_16x16x32_bf16 a[56:59], a[236:239], v[152:155], a[56:59]
    v_exp_f32 v180, v76
    v_mfma_f32_16x16x32_bf16 a[60:63], a[236:239], v[156:159], a[60:63]
    v_exp_f32 v181, v77
    v_mfma_f32_16x16x32_bf16 a[72:75], a[240:243], v[152:155], a[72:75]
    ds_read_b128 a[220:223], v11 offset:12288
    v_cvt_pk_bf16_f32 v132, v176, v177
    v_mfma_f32_16x16x32_bf16 a[76:79], a[240:243], v[156:159], a[76:79]
    v_exp_f32 v182, v78
    v_mfma_f32_16x16x32_bf16 a[88:91], a[244:247], v[152:155], a[88:91]
    v_exp_f32 v183, v79
    v_mfma_f32_16x16x32_bf16 a[92:95], a[244:247], v[156:159], a[92:95]
    v_cvt_pk_bf16_f32 v133, v178, v179
    v_cvt_pk_bf16_f32 v134, v180, v181
    v_mfma_f32_16x16x32_bf16 a[104:107], a[248:251], v[152:155], a[104:107]
    v_cvt_pk_bf16_f32 v135, v182, v183
    v_mfma_f32_16x16x32_bf16 a[108:111], a[248:251], v[156:159], a[108:111]
    v_mfma_f32_16x16x32_bf16 a[120:123], a[252:255], v[152:155], a[120:123]
    v_mfma_f32_16x16x32_bf16 a[124:127], a[252:255], v[156:159], a[124:127]
    s_waitcnt lgkmcnt(0)
    v_mfma_f32_16x16x32_bf16 v[96:99], a[192:195], a[128:131], v[160:163]
    v_exp_f32 v176, v80
    v_mfma_f32_16x16x32_bf16 v[104:107], a[192:195], a[144:147], v[164:167]
    v_exp_f32 v177, v81
    v_mfma_f32_16x16x32_bf16 v[112:115], a[192:195], a[160:163], v[168:171]
    s_waitcnt vmcnt(2)
    s_barrier
    v_mfma_f32_16x16x32_bf16 v[120:123], a[192:195], a[176:179], v[172:175]
    ds_read_b64_tr_b16 a[224:225], v12 offset:32768
    ds_read_b64_tr_b16 a[226:227], v12 offset:36864
    v_mfma_f32_16x16x32_bf16 v[200:203], v[52:55], v[128:131], v[216:219]
    v_exp_f32 v178, v82
    v_mfma_f32_16x16x32_bf16 v[204:207], v[52:55], v[132:135], v[220:223]
    v_exp_f32 v179, v83
    v_mfma_f32_16x16x32_bf16 v[96:99], a[196:199], a[132:135], v[96:99]
    ds_read_b64_tr_b16 a[228:229], v13 offset:32768
    ds_read_b64_tr_b16 a[230:231], v13 offset:36864
    v_mfma_f32_16x16x32_bf16 v[104:107], a[196:199], a[148:151], v[104:107]
    v_cvt_pk_bf16_f32 v136, v176, v177
    s_add_u32 m0, s45, 49152
    v_mfma_f32_16x16x32_bf16 v[112:115], a[196:199], a[164:167], v[112:115]
    buffer_load_dwordx4 v20, s[12:15], s36 offen lds
    v_cvt_pk_bf16_f32 v137, v178, v179
    v_mfma_f32_16x16x32_bf16 v[120:123], a[196:199], a[180:183], v[120:123]
    v_exp_f32 v180, v84
    v_mfma_f32_16x16x32_bf16 v[96:99], a[200:203], a[136:139], v[96:99]
    ds_read_b64_tr_b16 a[232:233], v14 offset:32768
    ds_read_b64_tr_b16 a[234:235], v14 offset:36864
    v_mfma_f32_16x16x32_bf16 v[104:107], a[200:203], a[152:155], v[104:107]
    v_exp_f32 v181, v85
    v_mfma_f32_16x16x32_bf16 v[112:115], a[200:203], a[168:171], v[112:115]
    ds_read_b64_tr_b16 a[236:237], v15 offset:32768
    ds_read_b64_tr_b16 a[238:239], v15 offset:36864
    v_mfma_f32_16x16x32_bf16 v[120:123], a[200:203], a[184:187], v[120:123]
    v_exp_f32 v182, v86
    v_mfma_f32_16x16x32_bf16 v[96:99], a[204:207], a[140:143], v[96:99]
    buffer_load_dwordx4 v21, s[12:15], s36 offen offset:1024 lds
    s_add_u32 s36, s36, 8192
    v_mfma_f32_16x16x32_bf16 v[104:107], a[204:207], a[156:159], v[104:107]
    v_exp_f32 v183, v87
    v_mfma_f32_16x16x32_bf16 v[112:115], a[204:207], a[172:175], v[112:115]
    ds_read_b64_tr_b16 a[240:241], v16 offset:32768
    ds_read_b64_tr_b16 a[242:243], v16 offset:36864
    v_mfma_f32_16x16x32_bf16 v[120:123], a[204:207], a[188:191], v[120:123]
    v_exp_f32 v176, v88
    v_mfma_f32_16x16x32_bf16 v[100:103], a[208:211], a[128:131], v[160:163]
    ds_read_b64_tr_b16 a[244:245], v17 offset:32768
    ds_read_b64_tr_b16 a[246:247], v17 offset:36864
    v_mfma_f32_16x16x32_bf16 v[108:111], a[208:211], a[144:147], v[164:167]
    v_cvt_pk_bf16_f32 v138, v180, v181
    s_add_u32 m0, s45, 65536
    v_mfma_f32_16x16x32_bf16 v[116:119], a[208:211], a[160:163], v[168:171]
    buffer_load_dwordx4 v22, s[16:19], s37 offen lds
    v_cvt_pk_bf16_f32 v139, v182, v183
    v_mfma_f32_16x16x32_bf16 v[124:127], a[208:211], a[176:179], v[172:175]
    v_exp_f32 v177, v89
    v_mfma_f32_16x16x32_bf16 v[100:103], a[212:215], a[132:135], v[100:103]
    ds_read_b64_tr_b16 a[248:249], v18 offset:32768
    ds_read_b64_tr_b16 a[250:251], v18 offset:36864
    v_mfma_f32_16x16x32_bf16 v[108:111], a[212:215], a[148:151], v[108:111]
    v_exp_f32 v178, v90
    v_mfma_f32_16x16x32_bf16 v[116:119], a[212:215], a[164:167], v[116:119]
    ds_read_b64_tr_b16 a[252:253], v19 offset:32768
    ds_read_b64_tr_b16 a[254:255], v19 offset:36864
    v_mfma_f32_16x16x32_bf16 v[124:127], a[212:215], a[180:183], v[124:127]
    v_exp_f32 v179, v91
    v_mfma_f32_16x16x32_bf16 v[100:103], a[216:219], a[136:139], v[100:103]
    buffer_load_dwordx4 v23, s[16:19], s37 offen offset:1024 lds
    s_add_u32 s37, s37, 8192
    v_mfma_f32_16x16x32_bf16 v[108:111], a[216:219], a[152:155], v[108:111]
    v_cvt_pk_bf16_f32 v140, v176, v177
    v_add_f32 v197, v200, v204
    v_mfma_f32_16x16x32_bf16 v[116:119], a[216:219], a[168:171], v[116:119]
    v_exp_f32 v180, v92
    v_mfma_f32_16x16x32_bf16 v[124:127], a[216:219], a[184:187], v[124:127]
    v_cvt_pk_bf16_f32 v141, v178, v179
    v_cmp_nle_f32 vcc, v197, s47
    v_mfma_f32_16x16x32_bf16 v[100:103], a[220:223], a[140:143], v[100:103]
    v_exp_f32 v181, v93
    v_mfma_f32_16x16x32_bf16 v[108:111], a[220:223], a[156:159], v[108:111]
    v_exp_f32 v182, v94
    v_mfma_f32_16x16x32_bf16 v[116:119], a[220:223], a[172:175], v[116:119]
    v_exp_f32 v183, v95
    v_mfma_f32_16x16x32_bf16 v[124:127], a[220:223], a[188:191], v[124:127]
    s_cbranch_vccz K1_ok40
    s_call_b64 s[40:41], K1_rare00
K1_ok40:
    s_waitcnt lgkmcnt(8)
    v_mfma_f32_16x16x32_bf16 a[0:3], a[224:227], v[128:131], a[0:3]
    v_cvt_pk_bf16_f32 v142, v180, v181
    v_cvt_pk_bf16_f32 v143, v182, v183
    v_mfma_f32_16x16x32_bf16 a[4:7], a[224:227], v[132:135], a[4:7]
    v_mfma_f32_16x16x32_bf16 a[16:19], a[228:231], v[128:131], a[16:19]
    v_mfma_f32_16x16x32_bf16 a[20:23], a[228:231], v[132:135], a[20:23]
    v_mfma_f32_16x16x32_bf16 v[208:211], v[52:55], v[136:139], v[224:227]
    ds_read_b128 a[192:195], v8 offset:16384
    v_mfma_f32_16x16x32_bf16 v[212:215], v[52:55], v[140:143], v[228:231]
    v_exp_f32 v176, v96
    v_mfma_f32_16x16x32_bf16 a[32:35], a[232:235], v[128:131], a[32:35]
    v_exp_f32 v177, v97
    v_mfma_f32_16x16x32_bf16 a[36:39], a[232:235], v[132:135], a[36:39]
    ds_read_b128 a[196:199], v9 offset:16384
    s_add_u32 m0, s45, 57344
    v_mfma_f32_16x16x32_bf16 a[48:51], a[236:239], v[128:131], a[48:51]
    buffer_load_dwordx4 v20, s[12:15], s36 offen lds
    v_cvt_pk_bf16_f32 v144, v176, v177
    v_mfma_f32_16x16x32_bf16 a[52:55], a[236:239], v[132:135], a[52:55]
    ds_read_b128 a[200:203], v10 offset:16384
    s_waitcnt lgkmcnt(3)
    v_mfma_f32_16x16x32_bf16 a[64:67], a[240:243], v[128:131], a[64:67]
    v_exp_f32 v178, v98
    v_mfma_f32_16x16x32_bf16 a[68:71], a[240:243], v[132:135], a[68:71]
    v_exp_f32 v179, v99
    v_mfma_f32_16x16x32_bf16 a[80:83], a[244:247], v[128:131], a[80:83]
    ds_read_b128 a[204:207], v11 offset:16384
    v_add_f32 v197, v208, v212
    v_mfma_f32_16x16x32_bf16 a[84:87], a[244:247], v[132:135], a[84:87]
    v_exp_f32 v180, v100
    v_mfma_f32_16x16x32_bf16 a[96:99], a[248:251], v[128:131], a[96:99]
    buffer_load_dwordx4 v21, s[12:15], s36 offen offset:1024 lds
    s_add_u32 s36, s36, 8192
    v_cmp_nle_f32 vcc, v197, s47
    v_mfma_f32_16x16x32_bf16 a[100:103], a[248:251], v[132:135], a[100:103]
    v_exp_f32 v181, v101
    v_mfma_f32_16x16x32_bf16 a[112:115], a[252:255], v[128:131], a[112:115]
    v_exp_f32 v182, v102
    v_mfma_f32_16x16x32_bf16 a[116:119], a[252:255], v[132:135], a[116:119]
    ds_read_b128 a[208:211], v8 offset:20480
    s_cbranch_vccz K1_ok41
    s_call_b64 s[40:41], K1_rare01
K1_ok41:
    v_mfma_f32_16x16x32_bf16 a[8:11], a[224:227], v[136:139], a[8:11]
    v_exp_f32 v183, v103
    v_mfma_f32_16x16x32_bf16 a[12:15], a[224:227], v[140:143], a[12:15]
    v_exp_f32 v176, v104
    v_mfma_f32_16x16x32_bf16 a[24:27], a[228:231], v[136:139], a[24:27]
    ds_read_b128 a[212:215], v9 offset:20480
    v_cvt_pk_bf16_f32 v145, v178, v179
    v_mfma_f32_16x16x32_bf16 a[28:31], a[228:231], v[140:143], a[28:31]
    v_exp_f32 v177, v105
    v_mfma_f32_16x16x32_bf16 a[40:43], a[232:235], v[136:139], a[40:43]
    v_exp_f32 v178, v106
    v_mfma_f32_16x16x32_bf16 a[44:47], a[232:235], v[140:143], a[44:47]
    buffer_store_dwordx4 v[48:51], v45, s[88:91], s92 offen sc0 sc1
    s_add_u32 s92, s92, 1048576
    ds_read_b128 a[216:219], v10 offset:20480
    v_mfma_f32_16x16x32_bf16 a[56:59], a[236:239], v[136:139], a[56:59]
    v_exp_f32 v179, v107
    v_mfma_f32_16x16x32_bf16 a[60:63], a[236:239], v[140:143], a[60:63]
    v_cvt_pk_bf16_f32 v146, v180, v181
    v_cvt_pk_bf16_f32 v147, v182, v183
    v_mfma_f32_16x16x32_bf16 a[72:75], a[240:243], v[136:139], a[72:75]
    ds_read_b128 a[220:223], v11 offset:20480
    v_cvt_pk_bf16_f32 v148, v176, v177
    v_mfma_f32_16x16x32_bf16 a[76:79], a[240:243], v[140:143], a[76:79]
    v_exp_f32 v180, v108
    v_mfma_f32_16x16x32_bf16 a[88:91], a[244:247], v[136:139], a[88:91]
    v_exp_f32 v181, v109
    v_mfma_f32_16x16x32_bf16 a[92:95], a[244:247], v[140:143], a[92:95]
    v_exp_f32 v182, v110
    v_mfma_f32_16x16x32_bf16 a[104:107], a[248:251], v[136:139], a[104:107]
    v_exp_f32 v183, v111
    v_mfma_f32_16x16x32_bf16 a[108:111], a[248:251], v[140:143], a[108:111]
    v_cvt_pk_bf16_f32 v149, v178, v179
    v_cvt_pk_bf16_f32 v150, v180, v181
    v_mfma_f32_16x16x32_bf16 a[120:123], a[252:255], v[136:139], a[120:123]
    v_cvt_pk_bf16_f32 v151, v182, v183
    v_mfma_f32_16x16x32_bf16 a[124:127], a[252:255], v[140:143], a[124:127]
    s_waitcnt lgkmcnt(0)
    v_mfma_f32_16x16x32_bf16 v[64:67], a[192:195], a[128:131], v[160:163]
    v_exp_f32 v176, v112
    v_mfma_f32_16x16x32_bf16 v[72:75], a[192:195], a[144:147], v[164:167]
    v_exp_f32 v177, v113
    v_mfma_f32_16x16x32_bf16 v[80:83], a[192:195], a[160:163], v[168:171]
    v_exp_f32 v178, v114
    v_mfma_f32_16x16x32_bf16 v[88:91], a[192:195], a[176:179], v[172:175]
    ds_read_b64_tr_b16 a[224:225], v12 offset:40960
    ds_read_b64_tr_b16 a[226:227], v12 offset:45056
    v_mfma_f32_16x16x32_bf16 v[216:219], v[52:55], v[144:147], v[200:203]
    v_exp_f32 v179, v115
    v_mfma_f32_16x16x32_bf16 v[220:223], v[52:55], v[148:151], v[204:207]
    v_exp_f32 v180, v116
    v_mfma_f32_16x16x32_bf16 v[64:67], a[196:199], a[132:135], v[64:67]
    ds_read_b64_tr_b16 a[228:229], v13 offset:40960
    ds_read_b64_tr_b16 a[230:231], v13 offset:45056
    v_mfma_f32_16x16x32_bf16 v[72:75], a[196:199], a[148:151], v[72:75]
    v_cvt_pk_bf16_f32 v152, v176, v177
    s_add_u32 m0, s45, 73728
    v_mfma_f32_16x16x32_bf16 v[80:83], a[196:199], a[164:167], v[80:83]
    buffer_load_dwordx4 v22, s[16:19], s37 offen lds
    v_cvt_pk_bf16_f32 v153, v178, v179
    v_mfma_f32_16x16x32_bf16 v[88:91], a[196:199], a[180:183], v[88:91]
    v_exp_f32 v181, v117
    v_mfma_f32_16x16x32_bf16 v[64:67], a[200:203], a[136:139], v[64:67]
    ds_read_b64_tr_b16 a[232:233], v14 offset:40960
    ds_read_b64_tr_b16 a[234:235], v14 offset:45056
    v_mfma_f32_16x16x32_bf16 v[72:75], a[200:203], a[152:155], v[72:75]
    v_exp_f32 v182, v118
    v_mfma_f32_16x16x32_bf16 v[80:83], a[200:203], a[168:171], v[80:83]
    ds_read_b64_tr_b16 a[236:237], v15 offset:40960
    ds_read_b64_tr_b16 a[238:239], v15 offset:45056
    v_mfma_f32_16x16x32_bf16 v[88:91], a[200:203], a[184:187], v[88:91]
    v_exp_f32 v183, v119
    v_mfma_f32_16x16x32_bf16 v[64:67], a[204:207], a[140:143], v[64:67]
    buffer_load_dwordx4 v23, s[16:19], s37 offen offset:1024 lds
    s_add_u32 s37, s37, 8192
    v_mfma_f32_16x16x32_bf16 v[72:75], a[204:207], a[156:159], v[72:75]
    v_exp_f32 v176, v120
    v_mfma_f32_16x16x32_bf16 v[80:83], a[204:207], a[172:175], v[80:83]
    ds_read_b64_tr_b16 a[240:241], v16 offset:40960
    ds_read_b64_tr_b16 a[242:243], v16 offset:45056
    v_mfma_f32_16x16x32_bf16 v[88:91], a[204:207], a[188:191], v[88:91]
    v_exp_f32 v177, v121
    v_mfma_f32_16x16x32_bf16 v[68:71], a[208:211], a[128:131], v[160:163]
    ds_read_b64_tr_b16 a[244:245], v17 offset:40960
    ds_read_b64_tr_b16 a[246:247], v17 offset:45056
    v_mfma_f32_16x16x32_bf16 v[76:79], a[208:211], a[144:147], v[164:167]
    v_cvt_pk_bf16_f32 v154, v180, v181
    s_add_u32 m0, s45, 0
    v_mfma_f32_16x16x32_bf16 v[84:87], a[208:211], a[160:163], v[168:171]
    buffer_load_dwordx4 v20, s[12:15], s36 offen lds
    v_cvt_pk_bf16_f32 v155, v182, v183
    v_mfma_f32_16x16x32_bf16 v[92:95], a[208:211], a[176:179], v[172:175]
    v_exp_f32 v178, v122
    v_mfma_f32_16x16x32_bf16 v[68:71], a[212:215], a[132:135], v[68:71]
    ds_read_b64_tr_b16 a[248:249], v18 offset:40960
    ds_read_b64_tr_b16 a[250:251], v18 offset:45056
    v_mfma_f32_16x16x32_bf16 v[76:79], a[212:215], a[148:151], v[76:79]
    v_exp_f32 v179, v123
    v_mfma_f32_16x16x32_bf16 v[84:87], a[212:215], a[164:167], v[84:87]
    ds_read_b64_tr_b16 a[252:253], v19 offset:40960
    ds_read_b64_tr_b16 a[254:255], v19 offset:45056
    v_mfma_f32_16x16x32_bf16 v[92:95], a[212:215], a[180:183], v[92:95]
    v_exp_f32 v180, v124
    v_mfma_f32_16x16x32_bf16 v[68:71], a[216:219], a[136:139], v[68:71]
    buffer_load_dwordx4 v21, s[12:15], s36 offen offset:1024 lds
    s_add_u32 s36, s36, 8192
    v_mfma_f32_16x16x32_bf16 v[76:79], a[216:219], a[152:155], v[76:79]
    v_cvt_pk_bf16_f32 v156, v176, v177
    v_add_f32 v197, v216, v220
    v_mfma_f32_16x16x32_bf16 v[84:87], a[216:219], a[168:171], v[84:87]
    v_exp_f32 v181, v125
    v_mfma_f32_16x16x32_bf16 v[92:95], a[216:219], a[184:187], v[92:95]
    v_cvt_pk_bf16_f32 v157, v178, v179
    v_cmp_nle_f32 vcc, v197, s47
    v_mfma_f32_16x16x32_bf16 v[68:71], a[220:223], a[140:143], v[68:71]
    v_exp_f32 v182, v126
    v_mfma_f32_16x16x32_bf16 v[76:79], a[220:223], a[156:159], v[76:79]
    v_exp_f32 v183, v127
    v_mfma_f32_16x16x32_bf16 v[84:87], a[220:223], a[172:175], v[84:87]
    v_cvt_pk_bf16_f32 v158, v180, v181
    v_cvt_pk_bf16_f32 v159, v182, v183
    v_mfma_f32_16x16x32_bf16 v[92:95], a[220:223], a[188:191], v[92:95]
    s_cbranch_vccz K1_ok50
    s_call_b64 s[40:41], K1_rare10
K1_ok50:
    s_waitcnt lgkmcnt(8)
    v_mfma_f32_16x16x32_bf16 a[0:3], a[224:227], v[144:147], a[0:3]
    v_mfma_f32_16x16x32_bf16 a[4:7], a[224:227], v[148:151], a[4:7]
    v_mfma_f32_16x16x32_bf16 a[16:19], a[228:231], v[144:147], a[16:19]
    v_mfma_f32_16x16x32_bf16 a[20:23], a[228:231], v[148:151], a[20:23]
    v_mfma_f32_16x16x32_bf16 v[224:227], v[52:55], v[152:155], v[208:211]
    ds_read_b128 a[192:195], v8 offset:24576
    v_mfma_f32_16x16x32_bf16 v[228:231], v[52:55], v[156:159], v[212:215]
    v_exp_f32 v176, v64
    v_mfma_f32_16x16x32_bf16 a[32:35], a[232:235], v[144:147], a[32:35]
    v_exp_f32 v177, v65
    v_mfma_f32_16x16x32_bf16 a[36:39], a[232:235], v[148:151], a[36:39]
    ds_read_b128 a[196:199], v9 offset:24576
    s_add_u32 m0, s45, 81920
    v_mfma_f32_16x16x32_bf16 a[48:51], a[236:239], v[144:147], a[48:51]
    buffer_load_dwordx4 v22, s[16:19], s37 offen lds
    v_cvt_pk_bf16_f32 v128, v176, v177
    v_mfma_f32_16x16x32_bf16 a[52:55], a[236:239], v[148:151], a[52:55]
    ds_read_b128 a[200:203], v10 offset:24576
    s_waitcnt lgkmcnt(3)
    v_mfma_f32_16x16x32_bf16 a[64:67], a[240:243], v[144:147], a[64:67]
    v_exp_f32 v178, v66
    v_mfma_f32_16x16x32_bf16 a[68:71], a[240:243], v[148:151], a[68:71]
    v_exp_f32 v179, v67
    v_mfma_f32_16x16x32_bf16 a[80:83], a[244:247], v[144:147], a[80:83]
    ds_read_b128 a[204:207], v11 offset:24576
    v_add_f32 v197, v224, v228
    v_mfma_f32_16x16x32_bf16 a[84:87], a[244:247], v[148:151], a[84:87]
    v_exp_f32 v180, v68
    v_mfma_f32_16x16x32_bf16 a[96:99], a[248:251], v[144:147], a[96:99]
    buffer_load_dwordx4 v23, s[16:19], s37 offen offset:1024 lds
    s_add_u32 s37, s37, 8192
    v_cmp_nle_f32 vcc, v197, s47
    v_mfma_f32_16x16x32_bf16 a[100:103], a[248:251], v[148:151], a[100:103]
    v_exp_f32 v181, v69
    v_mfma_f32_16x16x32_bf16 a[112:115], a[252:255], v[144:147], a[112:115]
    v_exp_f32 v182, v70
    v_mfma_f32_16x16x32_bf16 a[116:119], a[252:255], v[148:151], a[116:119]
    ds_read_b128 a[208:211], v8 offset:28672
    s_cbranch_vccz K1_ok51
    s_call_b64 s[40:41], K1_rare11
K1_ok51:
    v_mfma_f32_16x16x32_bf16 a[8:11], a[224:227], v[152:155], a[8:11]
    v_exp_f32 v183, v71
    v_mfma_f32_16x16x32_bf16 a[12:15], a[224:227], v[156:159], a[12:15]
    v_exp_f32 v176, v72
    v_mfma_f32_16x16x32_bf16 a[24:27], a[228:231], v[152:155], a[24:27]
    ds_read_b128 a[212:215], v9 offset:28672
    v_cvt_pk_bf16_f32 v129, v178, v179
    v_mfma_f32_16x16x32_bf16 a[28:31], a[228:231], v[156:159], a[28:31]
    v_exp_f32 v177, v73
    v_mfma_f32_16x16x32_bf16 a[40:43], a[232:235], v[152:155], a[40:43]
    v_exp_f32 v178, v74
    v_mfma_f32_16x16x32_bf16 a[44:47], a[232:235], v[156:159], a[44:47]
    ds_read_b128 a[216:219], v10 offset:28672
    v_cvt_pk_bf16_f32 v130, v180, v181
    v_mfma_f32_16x16x32_bf16 a[56:59], a[236:239], v[152:155], a[56:59]
    v_exp_f32 v179, v75
    v_mfma_f32_16x16x32_bf16 a[60:63], a[236:239], v[156:159], a[60:63]
    v_exp_f32 v180, v76
    v_mfma_f32_16x16x32_bf16 a[72:75], a[240:243], v[152:155], a[72:75]
    ds_read_b128 a[220:223], v11 offset:28672
    v_cvt_pk_bf16_f32 v131, v182, v183
    v_mfma_f32_16x16x32_bf16 a[76:79], a[240:243], v[156:159], a[76:79]
    v_exp_f32 v181, v77
    v_mfma_f32_16x16x32_bf16 a[88:91], a[244:247], v[152:155], a[88:91]
    v_exp_f32 v182, v78
    v_mfma_f32_16x16x32_bf16 a[92:95], a[244:247], v[156:159], a[92:95]
    v_exp_f32 v183, v79
    v_mfma_f32_16x16x32_bf16 a[104:107], a[248:251], v[152:155], a[104:107]
    v_cvt_pk_bf16_f32 v132, v176, v177
    v_cvt_pk_bf16_f32 v133, v178, v179
    v_mfma_f32_16x16x32_bf16 a[108:111], a[248:251], v[156:159], a[108:111]
    v_cvt_pk_bf16_f32 v134, v180, v181
    v_cvt_pk_bf16_f32 v135, v182, v183
    v_mfma_f32_16x16x32_bf16 a[120:123], a[252:255], v[152:155], a[120:123]
    v_mfma_f32_16x16x32_bf16 a[124:127], a[252:255], v[156:159], a[124:127]
    s_waitcnt lgkmcnt(0)
    v_mfma_f32_16x16x32_bf16 v[96:99], a[192:195], a[128:131], v[160:163]
    v_exp_f32 v176, v80
    v_mfma_f32_16x16x32_bf16 v[104:107], a[192:195], a[144:147], v[164:167]
    v_exp_f32 v177, v81
    v_mfma_f32_16x16x32_bf16 v[112:115], a[192:195], a[160:163], v[168:171]
    v_exp_f32 v178, v82
    v_mfma_f32_16x16x32_bf16 v[120:123], a[192:195], a[176:179], v[172:175]
    ds_read_b64_tr_b16 a[224:225], v12 offset:49152
    ds_read_b64_tr_b16 a[226:227], v12 offset:53248
    v_mfma_f32_16x16x32_bf16 v[200:203], v[52:55], v[128:131], v[216:219]
    v_exp_f32 v179, v83
    v_mfma_f32_16x16x32_bf16 v[204:207], v[52:55], v[132:135], v[220:223]
    v_exp_f32 v180, v84
    v_mfma_f32_16x16x32_bf16 v[96:99], a[196:199], a[132:135], v[96:99]
    ds_read_b64_tr_b16 a[228:229], v13 offset:49152
    ds_read_b64_tr_b16 a[230:231], v13 offset:53248
    v_mfma_f32_16x16x32_bf16 v[104:107], a[196:199], a[148:151], v[104:107]
    v_cvt_pk_bf16_f32 v136, v176, v177
    s_add_u32 m0, s45, 8192
    v_mfma_f32_16x16x32_bf16 v[112:115], a[196:199], a[164:167], v[112:115]
    buffer_load_dwordx4 v20, s[12:15], s36 offen lds
    v_cvt_pk_bf16_f32 v137, v178, v179
    v_mfma_f32_16x16x32_bf16 v[120:123], a[196:199], a[180:183], v[120:123]
    v_exp_f32 v181, v85
    v_mfma_f32_16x16x32_bf16 v[96:99], a[200:203], a[136:139], v[96:99]
    ds_read_b64_tr_b16 a[232:233], v14 offset:49152
    ds_read_b64_tr_b16 a[234:235], v14 offset:53248
    v_mfma_f32_16x16x32_bf16 v[104:107], a[200:203], a[152:155], v[104:107]
    v_exp_f32 v182, v86
    v_mfma_f32_16x16x32_bf16 v[112:115], a[200:203], a[168:171], v[112:115]
    ds_read_b64_tr_b16 a[236:237], v15 offset:49152
    ds_read_b64_tr_b16 a[238:239], v15 offset:53248
    v_mfma_f32_16x16x32_bf16 v[120:123], a[200:203], a[184:187], v[120:123]
    v_exp_f32 v183, v87
    v_mfma_f32_16x16x32_bf16 v[96:99], a[204:207], a[140:143], v[96:99]
    buffer_load_dwordx4 v21, s[12:15], s36 offen offset:1024 lds
    s_add_u32 s36, s36, 8192
    v_mfma_f32_16x16x32_bf16 v[104:107], a[204:207], a[156:159], v[104:107]
    v_exp_f32 v176, v88
    v_mfma_f32_16x16x32_bf16 v[112:115], a[204:207], a[172:175], v[112:115]
    ds_read_b64_tr_b16 a[240:241], v16 offset:49152
    ds_read_b64_tr_b16 a[242:243], v16 offset:53248
    v_mfma_f32_16x16x32_bf16 v[120:123], a[204:207], a[188:191], v[120:123]
    v_exp_f32 v177, v89
    v_mfma_f32_16x16x32_bf16 v[100:103], a[208:211], a[128:131], v[160:163]
    ds_read_b64_tr_b16 a[244:245], v17 offset:49152
    ds_read_b64_tr_b16 a[246:247], v17 offset:53248
    v_mfma_f32_16x16x32_bf16 v[108:111], a[208:211], a[144:147], v[164:167]
    v_cvt_pk_bf16_f32 v138, v180, v181
    s_add_u32 m0, s45, 90112
    v_mfma_f32_16x16x32_bf16 v[116:119], a[208:211], a[160:163], v[168:171]
    buffer_load_dwordx4 v22, s[16:19], s37 offen lds
    v_cvt_pk_bf16_f32 v139, v182, v183
    v_mfma_f32_16x16x32_bf16 v[124:127], a[208:211], a[176:179], v[172:175]
    v_exp_f32 v178, v90
    v_mfma_f32_16x16x32_bf16 v[100:103], a[212:215], a[132:135], v[100:103]
    ds_read_b64_tr_b16 a[248:249], v18 offset:49152
    ds_read_b64_tr_b16 a[250:251], v18 offset:53248
    v_mfma_f32_16x16x32_bf16 v[108:111], a[212:215], a[148:151], v[108:111]
    v_exp_f32 v179, v91
    v_mfma_f32_16x16x32_bf16 v[116:119], a[212:215], a[164:167], v[116:119]
    ds_read_b64_tr_b16 a[252:253], v19 offset:49152
    ds_read_b64_tr_b16 a[254:255], v19 offset:53248
    v_mfma_f32_16x16x32_bf16 v[124:127], a[212:215], a[180:183], v[124:127]
    v_exp_f32 v180, v92
    v_mfma_f32_16x16x32_bf16 v[100:103], a[216:219], a[136:139], v[100:103]
    buffer_load_dwordx4 v23, s[16:19], s37 offen offset:1024 lds
    s_add_u32 s37, s37, 8192
    v_mfma_f32_16x16x32_bf16 v[108:111], a[216:219], a[152:155], v[108:111]
    v_cvt_pk_bf16_f32 v140, v176, v177
    v_add_f32 v197, v200, v204
    v_mfma_f32_16x16x32_bf16 v[116:119], a[216:219], a[168:171], v[116:119]
    v_exp_f32 v181, v93
    v_mfma_f32_16x16x32_bf16 v[124:127], a[216:219], a[184:187], v[124:127]
    v_cvt_pk_bf16_f32 v141, v178, v179
    v_cmp_nle_f32 vcc, v197, s47
    v_mfma_f32_16x16x32_bf16 v[100:103], a[220:223], a[140:143], v[100:103]
    v_exp_f32 v182, v94
    v_mfma_f32_16x16x32_bf16 v[108:111], a[220:223], a[156:159], v[108:111]
    v_exp_f32 v183, v95
    v_mfma_f32_16x16x32_bf16 v[116:119], a[220:223], a[172:175], v[116:119]
    v_cvt_pk_bf16_f32 v142, v180, v181
    v_cvt_pk_bf16_f32 v143, v182, v183
    v_mfma_f32_16x16x32_bf16 v[124:127], a[220:223], a[188:191], v[124:127]
    s_cbranch_vccz K1_ok60
    s_call_b64 s[40:41], K1_rare00
K1_ok60:
    s_waitcnt lgkmcnt(8)
    v_mfma_f32_16x16x32_bf16 a[0:3], a[224:227], v[128:131], a[0:3]
    v_mfma_f32_16x16x32_bf16 a[4:7], a[224:227], v[132:135], a[4:7]
    v_mfma_f32_16x16x32_bf16 a[16:19], a[228:231], v[128:131], a[16:19]
    v_mfma_f32_16x16x32_bf16 a[20:23], a[228:231], v[132:135], a[20:23]
    v_mfma_f32_16x16x32_bf16 v[208:211], v[52:55], v[136:139], v[224:227]
    ds_read_b128 a[192:195], v8 offset:32768
    v_mfma_f32_16x16x32_bf16 v[212:215], v[52:55], v[140:143], v[228:231]
    v_exp_f32 v176, v96
    v_mfma_f32_16x16x32_bf16 a[32:35], a[232:235], v[128:131], a[32:35]
    v_exp_f32 v177, v97
    v_mfma_f32_16x16x32_bf16 a[36:39], a[232:235], v[132:135], a[36:39]
    ds_read_b128 a[196:199], v9 offset:32768
    s_mov_b32 m0, 131072
    v_mfma_f32_16x16x32_bf16 a[48:51], a[236:239], v[128:131], a[48:51]
    buffer_load_dwordx4 v3, s[84:87], s58 offen lds
    s_add_u32 s58, s58, 0x100000
    v_mfma_f32_16x16x32_bf16 a[52:55], a[236:239], v[132:135], a[52:55]
    ds_read_b128 a[200:203], v10 offset:32768
    s_waitcnt lgkmcnt(3)
    v_mfma_f32_16x16x32_bf16 a[64:67], a[240:243], v[128:131], a[64:67]
    v_exp_f32 v178, v98
    v_mfma_f32_16x16x32_bf16 a[68:71], a[240:243], v[132:135], a[68:71]
    v_exp_f32 v179, v99
    v_mfma_f32_16x16x32_bf16 a[80:83], a[244:247], v[128:131], a[80:83]
    ds_read_b128 a[204:207], v11 offset:32768
    v_add_f32 v197, v208, v212
    v_mfma_f32_16x16x32_bf16 a[84:87], a[244:247], v[132:135], a[84:87]
    v_exp_f32 v180, v100
    v_mfma_f32_16x16x32_bf16 a[96:99], a[248:251], v[128:131], a[96:99]
    buffer_load_dwordx4 v[48:51], v44, s[80:83], s59 offen
    s_add_u32 s59, s59, 0x100000
    v_cmp_nle_f32 vcc, v197, s47
    v_mfma_f32_16x16x32_bf16 a[100:103], a[248:251], v[132:135], a[100:103]
    v_exp_f32 v181, v101
    v_mfma_f32_16x16x32_bf16 a[112:115], a[252:255], v[128:131], a[112:115]
    v_exp_f32 v182, v102
    v_mfma_f32_16x16x32_bf16 a[116:119], a[252:255], v[132:135], a[116:119]
    ds_read_b128 a[208:211], v8 offset:36864
    s_cbranch_vccz K1_ok61
    s_call_b64 s[40:41], K1_rare01
K1_ok61:
    v_mfma_f32_16x16x32_bf16 a[8:11], a[224:227], v[136:139], a[8:11]
    v_exp_f32 v183, v103
    v_mfma_f32_16x16x32_bf16 a[12:15], a[224:227], v[140:143], a[12:15]
    v_cvt_pk_bf16_f32 v144, v176, v177
    v_cvt_pk_bf16_f32 v145, v178, v179
    v_mfma_f32_16x16x32_bf16 a[24:27], a[228:231], v[136:139], a[24:27]
    ds_read_b128 a[212:215], v9 offset:36864
    v_cvt_pk_bf16_f32 v146, v180, v181
    v_mfma_f32_16x16x32_bf16 a[28:31], a[228:231], v[140:143], a[28:31]
    v_exp_f32 v176, v104
    v_mfma_f32_16x16x32_bf16 a[40:43], a[232:235], v[136:139], a[40:43]
    v_exp_f32 v177, v105
    v_mfma_f32_16x16x32_bf16 a[44:47], a[232:235], v[140:143], a[44:47]
    ds_read_b128 a[216:219], v10 offset:36864
    v_cvt_pk_bf16_f32 v147, v182, v183
    v_mfma_f32_16x16x32_bf16 a[56:59], a[236:239], v[136:139], a[56:59]
    v_exp_f32 v178, v106
    v_mfma_f32_16x16x32_bf16 a[60:63], a[236:239], v[140:143], a[60:63]
    v_exp_f32 v179, v107
    v_mfma_f32_16x16x32_bf16 a[72:75], a[240:243], v[136:139], a[72:75]
    ds_read_b128 a[220:223], v11 offset:36864
    v_cvt_pk_bf16_f32 v148, v176, v177
    v_mfma_f32_16x16x32_bf16 a[76:79], a[240:243], v[140:143], a[76:79]
    v_exp_f32 v180, v108
    v_mfma_f32_16x16x32_bf16 a[88:91], a[244:247], v[136:139], a[88:91]
    v_exp_f32 v181, v109
    v_mfma_f32_16x16x32_bf16 a[92:95], a[244:247], v[140:143], a[92:95]
    v_exp_f32 v182, v110
    v_mfma_f32_16x16x32_bf16 a[104:107], a[248:251], v[136:139], a[104:107]
    v_exp_f32 v183, v111
    v_mfma_f32_16x16x32_bf16 a[108:111], a[248:251], v[140:143], a[108:111]
    v_cvt_pk_bf16_f32 v149, v178, v179
    v_cvt_pk_bf16_f32 v150, v180, v181
    v_mfma_f32_16x16x32_bf16 a[120:123], a[252:255], v[136:139], a[120:123]
    v_cvt_pk_bf16_f32 v151, v182, v183
    v_mfma_f32_16x16x32_bf16 a[124:127], a[252:255], v[140:143], a[124:127]
    s_waitcnt lgkmcnt(0)
    v_mfma_f32_16x16x32_bf16 v[64:67], a[192:195], a[128:131], v[160:163]
    v_exp_f32 v176, v112
    v_mfma_f32_16x16x32_bf16 v[72:75], a[192:195], a[144:147], v[164:167]
    v_exp_f32 v177, v113
    v_mfma_f32_16x16x32_bf16 v[80:83], a[192:195], a[160:163], v[168:171]
    v_exp_f32 v178, v114
    v_mfma_f32_16x16x32_bf16 v[88:91], a[192:195], a[176:179], v[172:175]
    ds_read_b64_tr_b16 a[224:225], v12 offset:57344
    ds_read_b64_tr_b16 a[226:227], v12 offset:61440
    v_mfma_f32_16x16x32_bf16 v[216:219], v[52:55], v[144:147], v[200:203]
    v_exp_f32 v179, v115
    v_mfma_f32_16x16x32_bf16 v[220:223], v[52:55], v[148:151], v[204:207]
    v_exp_f32 v180, v116
    v_mfma_f32_16x16x32_bf16 v[64:67], a[196:199], a[132:135], v[64:67]
    ds_read_b64_tr_b16 a[228:229], v13 offset:57344
    ds_read_b64_tr_b16 a[230:231], v13 offset:61440
    v_mfma_f32_16x16x32_bf16 v[72:75], a[196:199], a[148:151], v[72:75]
    v_exp_f32 v181, v117
    v_mfma_f32_16x16x32_bf16 v[80:83], a[196:199], a[164:167], v[80:83]
    v_exp_f32 v182, v118
    v_mfma_f32_16x16x32_bf16 v[88:91], a[196:199], a[180:183], v[88:91]
    v_exp_f32 v183, v119
    v_mfma_f32_16x16x32_bf16 v[64:67], a[200:203], a[136:139], v[64:67]
    ds_read_b64_tr_b16 a[232:233], v14 offset:57344
    ds_read_b64_tr_b16 a[234:235], v14 offset:61440
    v_mfma_f32_16x16x32_bf16 v[72:75], a[200:203], a[152:155], v[72:75]
    v_cvt_pk_bf16_f32 v152, v176, v177
    v_cvt_pk_bf16_f32 v153, v178, v179
    v_mfma_f32_16x16x32_bf16 v[80:83], a[200:203], a[168:171], v[80:83]
    ds_read_b64_tr_b16 a[236:237], v15 offset:57344
    ds_read_b64_tr_b16 a[238:239], v15 offset:61440
    v_mfma_f32_16x16x32_bf16 v[88:91], a[200:203], a[184:187], v[88:91]
    v_exp_f32 v176, v120
    v_mfma_f32_16x16x32_bf16 v[64:67], a[204:207], a[140:143], v[64:67]
    v_exp_f32 v177, v121
    v_mfma_f32_16x16x32_bf16 v[72:75], a[204:207], a[156:159], v[72:75]
    v_exp_f32 v178, v122
    v_mfma_f32_16x16x32_bf16 v[80:83], a[204:207], a[172:175], v[80:83]
    ds_read_b64_tr_b16 a[240:241], v16 offset:57344
    ds_read_b64_tr_b16 a[242:243], v16 offset:61440
    v_mfma_f32_16x16x32_bf16 v[88:91], a[204:207], a[188:191], v[88:91]
    v_exp_f32 v179, v123
    v_mfma_f32_16x16x32_bf16 v[68:71], a[208:211], a[128:131], v[160:163]
    ds_read_b64_tr_b16 a[244:245], v17 offset:57344
    ds_read_b64_tr_b16 a[246:247], v17 offset:61440
    v_mfma_f32_16x16x32_bf16 v[76:79], a[208:211], a[144:147], v[164:167]
    v_cvt_pk_bf16_f32 v154, v180, v181
    v_cvt_pk_bf16_f32 v155, v182, v183
    v_mfma_f32_16x16x32_bf16 v[84:87], a[208:211], a[160:163], v[168:171]
    v_exp_f32 v180, v124
    v_mfma_f32_16x16x32_bf16 v[92:95], a[208:211], a[176:179], v[172:175]
    v_exp_f32 v181, v125
    v_mfma_f32_16x16x32_bf16 v[68:71], a[212:215], a[132:135], v[68:71]
    ds_read_b64_tr_b16 a[248:249], v18 offset:57344
    ds_read_b64_tr_b16 a[250:251], v18 offset:61440
    v_mfma_f32_16x16x32_bf16 v[76:79], a[212:215], a[148:151], v[76:79]
    v_exp_f32 v182, v126
    v_mfma_f32_16x16x32_bf16 v[84:87], a[212:215], a[164:167], v[84:87]
    ds_read_b64_tr_b16 a[252:253], v19 offset:57344
    ds_read_b64_tr_b16 a[254:255], v19 offset:61440
    v_mfma_f32_16x16x32_bf16 v[92:95], a[212:215], a[180:183], v[92:95]
    v_exp_f32 v183, v127
    v_mfma_f32_16x16x32_bf16 v[68:71], a[216:219], a[136:139], v[68:71]
    v_cvt_pk_bf16_f32 v156, v176, v177
    v_cvt_pk_bf16_f32 v157, v178, v179
    v_mfma_f32_16x16x32_bf16 v[76:79], a[216:219], a[152:155], v[76:79]
    v_cvt_pk_bf16_f32 v158, v180, v181
    v_add_f32 v197, v216, v220
    v_mfma_f32_16x16x32_bf16 v[84:87], a[216:219], a[168:171], v[84:87]
    v_cvt_pk_bf16_f32 v159, v182, v183
    v_mfma_f32_16x16x32_bf16 v[92:95], a[216:219], a[184:187], v[92:95]
    v_cmp_nle_f32 vcc, v197, s47
    v_mfma_f32_16x16x32_bf16 v[68:71], a[220:223], a[140:143], v[68:71]
    v_mfma_f32_16x16x32_bf16 v[76:79], a[220:223], a[156:159], v[76:79]
    v_mfma_f32_16x16x32_bf16 v[84:87], a[220:223], a[172:175], v[84:87]
    v_mfma_f32_16x16x32_bf16 v[92:95], a[220:223], a[188:191], v[92:95]
    s_cbranch_vccz K1_ok70
    s_call_b64 s[40:41], K1_rare10
K1_ok70:
    s_waitcnt lgkmcnt(8)
    v_mfma_f32_16x16x32_bf16 a[0:3], a[224:227], v[144:147], a[0:3]
    v_mfma_f32_16x16x32_bf16 a[4:7], a[224:227], v[148:151], a[4:7]
    v_mfma_f32_16x16x32_bf16 a[16:19], a[228:231], v[144:147], a[16:19]
    v_mfma_f32_16x16x32_bf16 a[20:23], a[228:231], v[148:151], a[20:23]
    v_mfma_f32_16x16x32_bf16 v[224:227], v[52:55], v[152:155], v[208:211]
    ds_read_b128 a[192:195], v8 offset:40960
    v_mfma_f32_16x16x32_bf16 v[228:231], v[52:55], v[156:159], v[212:215]
    v_exp_f32 v176, v64
    v_mfma_f32_16x16x32_bf16 a[32:35], a[232:235], v[144:147], a[32:35]
    v_exp_f32 v177, v65
    v_mfma_f32_16x16x32_bf16 a[36:39], a[232:235], v[148:151], a[36:39]
    ds_read_b128 a[196:199], v9 offset:40960
    v_cvt_pk_bf16_f32 v128, v176, v177
    v_mfma_f32_16x16x32_bf16 a[48:51], a[236:239], v[144:147], a[48:51]
    v_exp_f32 v178, v66
    v_mfma_f32_16x16x32_bf16 a[52:55], a[236:239], v[148:151], a[52:55]
    ds_read_b128 a[200:203], v10 offset:40960
    s_waitcnt lgkmcnt(3)
    v_mfma_f32_16x16x32_bf16 a[64:67], a[240:243], v[144:147], a[64:67]
    v_exp_f32 v179, v67
    v_mfma_f32_16x16x32_bf16 a[68:71], a[240:243], v[148:151], a[68:71]
    v_exp_f32 v180, v68
    v_mfma_f32_16x16x32_bf16 a[80:83], a[244:247], v[144:147], a[80:83]
    ds_read_b128 a[204:207], v11 offset:40960
    v_add_f32 v197, v224, v228
    v_mfma_f32_16x16x32_bf16 a[84:87], a[244:247], v[148:151], a[84:87]
    v_exp_f32 v181, v69
    v_mfma_f32_16x16x32_bf16 a[96:99], a[248:251], v[144:147], a[96:99]
    v_cvt_pk_bf16_f32 v129, v178, v179
    v_cmp_nle_f32 vcc, v197, s47
    v_mfma_f32_16x16x32_bf16 a[100:103], a[248:251], v[148:151], a[100:103]
    v_exp_f32 v182, v70
    v_mfma_f32_16x16x32_bf16 a[112:115], a[252:255], v[144:147], a[112:115]
    v_exp_f32 v183, v71
    v_mfma_f32_16x16x32_bf16 a[116:119], a[252:255], v[148:151], a[116:119]
    ds_read_b128 a[208:211], v8 offset:45056
    s_cbranch_vccz K1_ok71
    s_call_b64 s[40:41], K1_rare11
K1_ok71:
    v_mfma_f32_16x16x32_bf16 a[8:11], a[224:227], v[152:155], a[8:11]
    v_exp_f32 v176, v72
    v_mfma_f32_16x16x32_bf16 a[12:15], a[224:227], v[156:159], a[12:15]
    v_exp_f32 v177, v73
    v_mfma_f32_16x16x32_bf16 a[24:27], a[228:231], v[152:155], a[24:27]
    ds_read_b128 a[212:215], v9 offset:45056
    v_cvt_pk_bf16_f32 v130, v180, v181
    v_mfma_f32_16x16x32_bf16 a[28:31], a[228:231], v[156:159], a[28:31]
    v_exp_f32 v178, v74
    v_mfma_f32_16x16x32_bf16 a[40:43], a[232:235], v[152:155], a[40:43]
    v_exp_f32 v179, v75
    v_mfma_f32_16x16x32_bf16 a[44:47], a[232:235], v[156:159], a[44:47]
    ds_read_b128 a[216:219], v10 offset:45056
    v_cvt_pk_bf16_f32 v131, v182, v183
    v_mfma_f32_16x16x32_bf16 a[56:59], a[236:239], v[152:155], a[56:59]
    v_exp_f32 v180, v76
    v_mfma_f32_16x16x32_bf16 a[60:63], a[236:239], v[156:159], a[60:63]
    v_exp_f32 v181, v77
    v_mfma_f32_16x16x32_bf16 a[72:75], a[240:243], v[152:155], a[72:75]
    ds_read_b128 a[220:223], v11 offset:45056
    v_cvt_pk_bf16_f32 v132, v176, v177
    v_mfma_f32_16x16x32_bf16 a[76:79], a[240:243], v[156:159], a[76:79]
    v_exp_f32 v182, v78
    v_mfma_f32_16x16x32_bf16 a[88:91], a[244:247], v[152:155], a[88:91]
    v_exp_f32 v183, v79
    v_mfma_f32_16x16x32_bf16 a[92:95], a[244:247], v[156:159], a[92:95]
    v_cvt_pk_bf16_f32 v133, v178, v179
    v_cvt_pk_bf16_f32 v134, v180, v181
    v_mfma_f32_16x16x32_bf16 a[104:107], a[248:251], v[152:155], a[104:107]
    v_cvt_pk_bf16_f32 v135, v182, v183
    v_mfma_f32_16x16x32_bf16 a[108:111], a[248:251], v[156:159], a[108:111]
    v_mfma_f32_16x16x32_bf16 a[120:123], a[252:255], v[152:155], a[120:123]
    v_mfma_f32_16x16x32_bf16 a[124:127], a[252:255], v[156:159], a[124:127]
    s_sub_u32 s38, s38, 1
    s_cmp_lg_u32 s38, 0
    s_cbranch_scc1 K1_loop
    s_waitcnt vmcnt(0)
    buffer_store_dwordx4 v[48:51], v45, s[88:91], s92 offen sc0 sc1
    s_nop 15
    v_rcp_f32 v188, v216
    v_rcp_f32 v189, v220
    v_rcp_f32 v190, v224
    v_rcp_f32 v191, v228
    s_mul_i32 s39, s49, 131072
    s_lshl_b32 s48, s42, 13
    s_add_u32 s39, s39, s48
    s_add_u32 s48, s39, 0
    v_accvgpr_read_b32 v64, a0
    v_accvgpr_read_b32 v65, a1
    v_accvgpr_read_b32 v66, a2
    v_accvgpr_read_b32 v67, a3
    v_accvgpr_read_b32 v68, a16
    v_accvgpr_read_b32 v69, a17
    v_accvgpr_read_b32 v70, a18
    v_accvgpr_read_b32 v71, a19
    v_mul_f32 v64, v64, v188
    v_mul_f32 v65, v65, v188
    v_mul_f32 v66, v66, v188
    v_mul_f32 v67, v67, v188
    v_mul_f32 v68, v68, v188
    v_mul_f32 v69, v69, v188
    v_mul_f32 v70, v70, v188
    v_mul_f32 v71, v71, v188
    v_cvt_pk_bf16_f32 v72, v64, v65
    v_cvt_pk_bf16_f32 v73, v66, v67
    v_cvt_pk_bf16_f32 v74, v68, v69
    v_cvt_pk_bf16_f32 v75, v70, v71
    s_nop 0
    v_permlane32_swap_b32 v72, v74
    v_permlane32_swap_b32 v73, v75
    s_nop 0
    v_permlane16_swap_b32 v72, v74
    v_permlane16_swap_b32 v73, v75
    buffer_store_dwordx4 v[72:75], v3, s[32:35], s48 offen offset:0 sc0 sc1
    v_accvgpr_read_b32 v76, a32
    v_accvgpr_read_b32 v77, a33
    v_accvgpr_read_b32 v78, a34
    v_accvgpr_read_b32 v79, a35
    v_accvgpr_read_b32 v80, a48
    v_accvgpr_read_b32 v81, a49
    v_accvgpr_read_b32 v82, a50
    v_accvgpr_read_b32 v83, a51
    v_mul_f32 v76, v76, v188
    v_mul_f32 v77, v77, v188
    v_mul_f32 v78, v78, v188
    v_mul_f32 v79, v79, v188
    v_mul_f32 v80, v80, v188
    v_mul_f32 v81, v81, v188
    v_mul_f32 v82, v82, v188
    v_mul_f32 v83, v83, v188
    v_cvt_pk_bf16_f32 v84, v76, v77
    v_cvt_pk_bf16_f32 v85, v78, v79
    v_cvt_pk_bf16_f32 v86, v80, v81
    v_cvt_pk_bf16_f32 v87, v82, v83
    s_nop 0
    v_permlane32_swap_b32 v84, v86
    v_permlane32_swap_b32 v85, v87
    s_nop 0
    v_permlane16_swap_b32 v84, v86
    v_permlane16_swap_b32 v85, v87
    buffer_store_dwordx4 v[84:87], v3, s[32:35], s48 offen offset:1024 sc0 sc1
    v_accvgpr_read_b32 v88, a64
    v_accvgpr_read_b32 v89, a65
    v_accvgpr_read_b32 v90, a66
    v_accvgpr_read_b32 v91, a67
    v_accvgpr_read_b32 v92, a80
    v_accvgpr_read_b32 v93, a81
    v_accvgpr_read_b32 v94, a82
    v_accvgpr_read_b32 v95, a83
    v_mul_f32 v88, v88, v188
    v_mul_f32 v89, v89, v188
    v_mul_f32 v90, v90, v188
    v_mul_f32 v91, v91, v188
    v_mul_f32 v92, v92, v188
    v_mul_f32 v93, v93, v188
    v_mul_f32 v94, v94, v188
    v_mul_f32 v95, v95, v188
    v_cvt_pk_bf16_f32 v96, v88, v89
    v_cvt_pk_bf16_f32 v97, v90, v91
    v_cvt_pk_bf16_f32 v98, v92, v93
    v_cvt_pk_bf16_f32 v99, v94, v95
    s_nop 0
    v_permlane32_swap_b32 v96, v98
    v_permlane32_swap_b32 v97, v99
    s_nop 0
    v_permlane16_swap_b32 v96, v98
    v_permlane16_swap_b32 v97, v99
    buffer_store_dwordx4 v[96:99], v3, s[32:35], s48 offen offset:2048 sc0 sc1
    v_accvgpr_read_b32 v100, a96
    v_accvgpr_read_b32 v101, a97
    v_accvgpr_read_b32 v102, a98
    v_accvgpr_read_b32 v103, a99
    v_accvgpr_read_b32 v104, a112
    v_accvgpr_read_b32 v105, a113
    v_accvgpr_read_b32 v106, a114
    v_accvgpr_read_b32 v107, a115
    v_mul_f32 v100, v100, v188
    v_mul_f32 v101, v101, v188
    v_mul_f32 v102, v102, v188
    v_mul_f32 v103, v103, v188
    v_mul_f32 v104, v104, v188
    v_mul_f32 v105, v105, v188
    v_mul_f32 v106, v106, v188
    v_mul_f32 v107, v107, v188
    v_cvt_pk_bf16_f32 v108, v100, v101
    v_cvt_pk_bf16_f32 v109, v102, v103
    v_cvt_pk_bf16_f32 v110, v104, v105
    v_cvt_pk_bf16_f32 v111, v106, v107
    s_nop 0
    v_permlane32_swap_b32 v108, v110
    v_permlane32_swap_b32 v109, v111
    s_nop 0
    v_permlane16_swap_b32 v108, v110
    v_permlane16_swap_b32 v109, v111
    buffer_store_dwordx4 v[108:111], v3, s[32:35], s48 offen offset:3072 sc0 sc1
    s_add_u32 s48, s39, 131072
    v_accvgpr_read_b32 v112, a4
    v_accvgpr_read_b32 v113, a5
    v_accvgpr_read_b32 v114, a6
    v_accvgpr_read_b32 v115, a7
    v_accvgpr_read_b32 v116, a20
    v_accvgpr_read_b32 v117, a21
    v_accvgpr_read_b32 v118, a22
    v_accvgpr_read_b32 v119, a23
    v_mul_f32 v112, v112, v189
    v_mul_f32 v113, v113, v189
    v_mul_f32 v114, v114, v189
    v_mul_f32 v115, v115, v189
    v_mul_f32 v116, v116, v189
    v_mul_f32 v117, v117, v189
    v_mul_f32 v118, v118, v189
    v_mul_f32 v119, v119, v189
    v_cvt_pk_bf16_f32 v120, v112, v113
    v_cvt_pk_bf16_f32 v121, v114, v115
    v_cvt_pk_bf16_f32 v122, v116, v117
    v_cvt_pk_bf16_f32 v123, v118, v119
    s_nop 0
    v_permlane32_swap_b32 v120, v122
    v_permlane32_swap_b32 v121, v123
    s_nop 0
    v_permlane16_swap_b32 v120, v122
    v_permlane16_swap_b32 v121, v123
    buffer_store_dwordx4 v[120:123], v3, s[32:35], s48 offen offset:0 sc0 sc1
    v_accvgpr_read_b32 v124, a36
    v_accvgpr_read_b32 v125, a37
    v_accvgpr_read_b32 v126, a38
    v_accvgpr_read_b32 v127, a39
    v_accvgpr_read_b32 v128, a52
    v_accvgpr_read_b32 v129, a53
    v_accvgpr_read_b32 v130, a54
    v_accvgpr_read_b32 v131, a55
    v_mul_f32 v124, v124, v189
    v_mul_f32 v125, v125, v189
    v_mul_f32 v126, v126, v189
    v_mul_f32 v127, v127, v189
    v_mul_f32 v128, v128, v189
    v_mul_f32 v129, v129, v189
    v_mul_f32 v130, v130, v189
    v_mul_f32 v131, v131, v189
    v_cvt_pk_bf16_f32 v132, v124, v125
    v_cvt_pk_bf16_f32 v133, v126, v127
    v_cvt_pk_bf16_f32 v134, v128, v129
    v_cvt_pk_bf16_f32 v135, v130, v131
    s_nop 0
    v_permlane32_swap_b32 v132, v134
    v_permlane32_swap_b32 v133, v135
    s_nop 0
    v_permlane16_swap_b32 v132, v134
    v_permlane16_swap_b32 v133, v135
    buffer_store_dwordx4 v[132:135], v3, s[32:35], s48 offen offset:1024 sc0 sc1
    v_accvgpr_read_b32 v136, a68
    v_accvgpr_read_b32 v137, a69
    v_accvgpr_read_b32 v138, a70
    v_accvgpr_read_b32 v139, a71
    v_accvgpr_read_b32 v140, a84
    v_accvgpr_read_b32 v141, a85
    v_accvgpr_read_b32 v142, a86
    v_accvgpr_read_b32 v143, a87
    v_mul_f32 v136, v136, v189
    v_mul_f32 v137, v137, v189
    v_mul_f32 v138, v138, v189
    v_mul_f32 v139, v139, v189
    v_mul_f32 v140, v140, v189
    v_mul_f32 v141, v141, v189
    v_mul_f32 v142, v142, v189
    v_mul_f32 v143, v143, v189
    v_cvt_pk_bf16_f32 v144, v136, v137
    v_cvt_pk_bf16_f32 v145, v138, v139
    v_cvt_pk_bf16_f32 v146, v140, v141
    v_cvt_pk_bf16_f32 v147, v142, v143
    s_nop 0
    v_permlane32_swap_b32 v144, v146
    v_permlane32_swap_b32 v145, v147
    s_nop 0
    v_permlane16_swap_b32 v144, v146
    v_permlane16_swap_b32 v145, v147
    buffer_store_dwordx4 v[144:147], v3, s[32:35], s48 offen offset:2048 sc0 sc1
    v_accvgpr_read_b32 v148, a100
    v_accvgpr_read_b32 v149, a101
    v_accvgpr_read_b32 v150, a102
    v_accvgpr_read_b32 v151, a103
    v_accvgpr_read_b32 v152, a116
    v_accvgpr_read_b32 v153, a117
    v_accvgpr_read_b32 v154, a118
    v_accvgpr_read_b32 v155, a119
    v_mul_f32 v148, v148, v189
    v_mul_f32 v149, v149, v189
    v_mul_f32 v150, v150, v189
    v_mul_f32 v151, v151, v189
    v_mul_f32 v152, v152, v189
    v_mul_f32 v153, v153, v189
    v_mul_f32 v154, v154, v189
    v_mul_f32 v155, v155, v189
    v_cvt_pk_bf16_f32 v156, v148, v149
    v_cvt_pk_bf16_f32 v157, v150, v151
    v_cvt_pk_bf16_f32 v158, v152, v153
    v_cvt_pk_bf16_f32 v159, v154, v155
    s_nop 0
    v_permlane32_swap_b32 v156, v158
    v_permlane32_swap_b32 v157, v159
    s_nop 0
    v_permlane16_swap_b32 v156, v158
    v_permlane16_swap_b32 v157, v159
    buffer_store_dwordx4 v[156:159], v3, s[32:35], s48 offen offset:3072 sc0 sc1
    s_add_u32 s48, s39, 4096
    v_accvgpr_read_b32 v64, a8
    v_accvgpr_read_b32 v65, a9
    v_accvgpr_read_b32 v66, a10
    v_accvgpr_read_b32 v67, a11
    v_accvgpr_read_b32 v68, a24
    v_accvgpr_read_b32 v69, a25
    v_accvgpr_read_b32 v70, a26
    v_accvgpr_read_b32 v71, a27
    v_mul_f32 v64, v64, v190
    v_mul_f32 v65, v65, v190
    v_mul_f32 v66, v66, v190
    v_mul_f32 v67, v67, v190
    v_mul_f32 v68, v68, v190
    v_mul_f32 v69, v69, v190
    v_mul_f32 v70, v70, v190
    v_mul_f32 v71, v71, v190
    v_cvt_pk_bf16_f32 v72, v64, v65
    v_cvt_pk_bf16_f32 v73, v66, v67
    v_cvt_pk_bf16_f32 v74, v68, v69
    v_cvt_pk_bf16_f32 v75, v70, v71
    s_nop 0
    v_permlane32_swap_b32 v72, v74
    v_permlane32_swap_b32 v73, v75
    s_nop 0
    v_permlane16_swap_b32 v72, v74
    v_permlane16_swap_b32 v73, v75
    buffer_store_dwordx4 v[72:75], v3, s[32:35], s48 offen offset:0 sc0 sc1
    v_accvgpr_read_b32 v76, a40
    v_accvgpr_read_b32 v77, a41
    v_accvgpr_read_b32 v78, a42
    v_accvgpr_read_b32 v79, a43
    v_accvgpr_read_b32 v80, a56
    v_accvgpr_read_b32 v81, a57
    v_accvgpr_read_b32 v82, a58
    v_accvgpr_read_b32 v83, a59
    v_mul_f32 v76, v76, v190
    v_mul_f32 v77, v77, v190
    v_mul_f32 v78, v78, v190
    v_mul_f32 v79, v79, v190
    v_mul_f32 v80, v80, v190
    v_mul_f32 v81, v81, v190
    v_mul_f32 v82, v82, v190
    v_mul_f32 v83, v83, v190
    v_cvt_pk_bf16_f32 v84, v76, v77
    v_cvt_pk_bf16_f32 v85, v78, v79
    v_cvt_pk_bf16_f32 v86, v80, v81
    v_cvt_pk_bf16_f32 v87, v82, v83
    s_nop 0
    v_permlane32_swap_b32 v84, v86
    v_permlane32_swap_b32 v85, v87
    s_nop 0
    v_permlane16_swap_b32 v84, v86
    v_permlane16_swap_b32 v85, v87
    buffer_store_dwordx4 v[84:87], v3, s[32:35], s48 offen offset:1024 sc0 sc1
    v_accvgpr_read_b32 v88, a72
    v_accvgpr_read_b32 v89, a73
    v_accvgpr_read_b32 v90, a74
    v_accvgpr_read_b32 v91, a75
    v_accvgpr_read_b32 v92, a88
    v_accvgpr_read_b32 v93, a89
    v_accvgpr_read_b32 v94, a90
    v_accvgpr_read_b32 v95, a91
    v_mul_f32 v88, v88, v190
    v_mul_f32 v89, v89, v190
    v_mul_f32 v90, v90, v190
    v_mul_f32 v91, v91, v190
    v_mul_f32 v92, v92, v190
    v_mul_f32 v93, v93, v190
    v_mul_f32 v94, v94, v190
    v_mul_f32 v95, v95, v190
    v_cvt_pk_bf16_f32 v96, v88, v89
    v_cvt_pk_bf16_f32 v97, v90, v91
    v_cvt_pk_bf16_f32 v98, v92, v93
    v_cvt_pk_bf16_f32 v99, v94, v95
    s_nop 0
    v_permlane32_swap_b32 v96, v98
    v_permlane32_swap_b32 v97, v99
    s_nop 0
    v_permlane16_swap_b32 v96, v98
    v_permlane16_swap_b32 v97, v99
    buffer_store_dwordx4 v[96:99], v3, s[32:35], s48 offen offset:2048 sc0 sc1
    v_accvgpr_read_b32 v100, a104
    v_accvgpr_read_b32 v101, a105
    v_accvgpr_read_b32 v102, a106
    v_accvgpr_read_b32 v103, a107
    v_accvgpr_read_b32 v104, a120
    v_accvgpr_read_b32 v105, a121
    v_accvgpr_read_b32 v106, a122
    v_accvgpr_read_b32 v107, a123
    v_mul_f32 v100, v100, v190
    v_mul_f32 v101, v101, v190
    v_mul_f32 v102, v102, v190
    v_mul_f32 v103, v103, v190
    v_mul_f32 v104, v104, v190
    v_mul_f32 v105, v105, v190
    v_mul_f32 v106, v106, v190
    v_mul_f32 v107, v107, v190
    v_cvt_pk_bf16_f32 v108, v100, v101
    v_cvt_pk_bf16_f32 v109, v102, v103
    v_cvt_pk_bf16_f32 v110, v104, v105
    v_cvt_pk_bf16_f32 v111, v106, v107
    s_nop 0
    v_permlane32_swap_b32 v108, v110
    v_permlane32_swap_b32 v109, v111
    s_nop 0
    v_permlane16_swap_b32 v108, v110
    v_permlane16_swap_b32 v109, v111
    buffer_store_dwordx4 v[108:111], v3, s[32:35], s48 offen offset:3072 sc0 sc1
    s_add_u32 s48, s39, 135168
    v_accvgpr_read_b32 v112, a12
    v_accvgpr_read_b32 v113, a13
    v_accvgpr_read_b32 v114, a14
    v_accvgpr_read_b32 v115, a15
    v_accvgpr_read_b32 v116, a28
    v_accvgpr_read_b32 v117, a29
    v_accvgpr_read_b32 v118, a30
    v_accvgpr_read_b32 v119, a31
    v_mul_f32 v112, v112, v191
    v_mul_f32 v113, v113, v191
    v_mul_f32 v114, v114, v191
    v_mul_f32 v115, v115, v191
    v_mul_f32 v116, v116, v191
    v_mul_f32 v117, v117, v191
    v_mul_f32 v118, v118, v191
    v_mul_f32 v119, v119, v191
    v_cvt_pk_bf16_f32 v120, v112, v113
    v_cvt_pk_bf16_f32 v121, v114, v115
    v_cvt_pk_bf16_f32 v122, v116, v117
    v_cvt_pk_bf16_f32 v123, v118, v119
    s_nop 0
    v_permlane32_swap_b32 v120, v122
    v_permlane32_swap_b32 v121, v123
    s_nop 0
    v_permlane16_swap_b32 v120, v122
    v_permlane16_swap_b32 v121, v123
    buffer_store_dwordx4 v[120:123], v3, s[32:35], s48 offen offset:0 sc0 sc1
    v_accvgpr_read_b32 v124, a44
    v_accvgpr_read_b32 v125, a45
    v_accvgpr_read_b32 v126, a46
    v_accvgpr_read_b32 v127, a47
    v_accvgpr_read_b32 v128, a60
    v_accvgpr_read_b32 v129, a61
    v_accvgpr_read_b32 v130, a62
    v_accvgpr_read_b32 v131, a63
    v_mul_f32 v124, v124, v191
    v_mul_f32 v125, v125, v191
    v_mul_f32 v126, v126, v191
    v_mul_f32 v127, v127, v191
    v_mul_f32 v128, v128, v191
    v_mul_f32 v129, v129, v191
    v_mul_f32 v130, v130, v191
    v_mul_f32 v131, v131, v191
    v_cvt_pk_bf16_f32 v132, v124, v125
    v_cvt_pk_bf16_f32 v133, v126, v127
    v_cvt_pk_bf16_f32 v134, v128, v129
    v_cvt_pk_bf16_f32 v135, v130, v131
    s_nop 0
    v_permlane32_swap_b32 v132, v134
    v_permlane32_swap_b32 v133, v135
    s_nop 0
    v_permlane16_swap_b32 v132, v134
    v_permlane16_swap_b32 v133, v135
    buffer_store_dwordx4 v[132:135], v3, s[32:35], s48 offen offset:1024 sc0 sc1
    v_accvgpr_read_b32 v136, a76
    v_accvgpr_read_b32 v137, a77
    v_accvgpr_read_b32 v138, a78
    v_accvgpr_read_b32 v139, a79
    v_accvgpr_read_b32 v140, a92
    v_accvgpr_read_b32 v141, a93
    v_accvgpr_read_b32 v142, a94
    v_accvgpr_read_b32 v143, a95
    v_mul_f32 v136, v136, v191
    v_mul_f32 v137, v137, v191
    v_mul_f32 v138, v138, v191
    v_mul_f32 v139, v139, v191
    v_mul_f32 v140, v140, v191
    v_mul_f32 v141, v141, v191
    v_mul_f32 v142, v142, v191
    v_mul_f32 v143, v143, v191
    v_cvt_pk_bf16_f32 v144, v136, v137
    v_cvt_pk_bf16_f32 v145, v138, v139
    v_cvt_pk_bf16_f32 v146, v140, v141
    v_cvt_pk_bf16_f32 v147, v142, v143
    s_nop 0
    v_permlane32_swap_b32 v144, v146
    v_permlane32_swap_b32 v145, v147
    s_nop 0
    v_permlane16_swap_b32 v144, v146
    v_permlane16_swap_b32 v145, v147
    buffer_store_dwordx4 v[144:147], v3, s[32:35], s48 offen offset:2048 sc0 sc1
    v_accvgpr_read_b32 v148, a108
    v_accvgpr_read_b32 v149, a109
    v_accvgpr_read_b32 v150, a110
    v_accvgpr_read_b32 v151, a111
    v_accvgpr_read_b32 v152, a124
    v_accvgpr_read_b32 v153, a125
    v_accvgpr_read_b32 v154, a126
    v_accvgpr_read_b32 v155, a127
    v_mul_f32 v148, v148, v191
    v_mul_f32 v149, v149, v191
    v_mul_f32 v150, v150, v191
    v_mul_f32 v151, v151, v191
    v_mul_f32 v152, v152, v191
    v_mul_f32 v153, v153, v191
    v_mul_f32 v154, v154, v191
    v_mul_f32 v155, v155, v191
    v_cvt_pk_bf16_f32 v156, v148, v149
    v_cvt_pk_bf16_f32 v157, v150, v151
    v_cvt_pk_bf16_f32 v158, v152, v153
    v_cvt_pk_bf16_f32 v159, v154, v155
    s_nop 0
    v_permlane32_swap_b32 v156, v158
    v_permlane32_swap_b32 v157, v159
    s_nop 0
    v_permlane16_swap_b32 v156, v158
    v_permlane16_swap_b32 v157, v159
    buffer_store_dwordx4 v[156:159], v3, s[32:35], s48 offen offset:3072 sc0 sc1
    s_waitcnt vmcnt(0)
K1_end:
    s_endpgm
.text
.globl k2_oproj_kernel
.p2align 8
.type k2_oproj_kernel,@function
k2_oproj_kernel:
    s_sub_u32 s3, s2, 240
    s_cmp_ge_u32 s2, 240
    s_cbranch_scc1 K2_side
    s_and_b32 s28, s2, 7
    s_mul_i32 s28, s28, 30
    s_lshr_b32 s29, s2, 3
    s_add_u32 s29, s28, s29
    s_sub_u32 s3, s29, 218
    s_cmp_ge_u32 s29, 234
    s_cbranch_scc1 K2_side2
    s_mul_i32 s28, s29, 7282
    s_lshr_b32 s28, s28, 16
    s_mul_i32 s30, s28, 9
    s_sub_u32 s29, s29, s30
    s_load_dwordx2 s[4:5], s[0:1], 112
    s_load_dwordx2 s[6:7], s[0:1], 32
    s_load_dwordx2 s[8:9], s[0:1], 0
    s_load_dwordx2 s[10:11], s[0:1], 96
    v_and_b32 v1, 63, v0
    v_lshrrev_b32 v2, 6, v0
    s_nop 0
    v_readfirstlane_b32 s3, v2
    s_waitcnt lgkmcnt(0)
    s_add_u32 s12, s4, 1048576
    s_addc_u32 s13, s5, 0
    s_mov_b32 s14, 16777216
    s_mov_b32 s15, 0x00020000
    s_mov_b32 s16, s6
    s_mov_b32 s17, s7
    s_mov_b32 s18, 4718592
    s_mov_b32 s19, 0x00020000
    s_mov_b32 s20, s8
    s_mov_b32 s21, s9
    s_mov_b32 s22, 2359296
    s_mov_b32 s23, 0x00020000
    s_add_u32 s24, s4, 20971520
    s_addc_u32 s25, s5, 0
    s_mov_b32 s26, 2359296
    s_mov_b32 s27, 0x00020000
    s_add_u32 s40, s4, 0
    s_addc_u32 s41, s5, 0
    s_mov_b32 s42, 13824
    s_mov_b32 s43, 0x00020000
    s_add_u32 s84, s4, 96468992
    s_addc_u32 s85, s5, 0
    s_mov_b32 s86, 2359296
    s_mov_b32 s87, 0x00020000
    s_add_u32 s88, s4, 100663296
    s_addc_u32 s89, s5, 0
    s_mov_b32 s90, 262144
    s_mov_b32 s91, 0x00020000
    v_and_b32 v3, 3, v1
    v_bfe_u32 v4, v1, 2, 1
    v_bfe_u32 v6, v1, 4, 1
    v_xor_b32 v4, v4, v6
    v_lshl_add_u32 v3, v4, 2, v3
    v_lshlrev_b32 v3, 4, v3
    v_xor_b32 v5, 32, v3
    v_lshrrev_b32 v4, 3, v1
    s_mov_b32 s30, 1152
    v_mul_lo_u32 v4, v4, s30
    v_add_u32 v5, v5, v4
    v_add_u32 v4, v3, v4
    v_add_u32 v8, 0, v4
    v_add_u32 v9, 9216, v5
    v_add_u32 v10, 18432, v4
    v_add_u32 v11, 27648, v5
    v_add_u32 v12, 36864, v4
    v_add_u32 v13, 46080, v5
    v_add_u32 v14, 55296, v4
    v_add_u32 v15, 64512, v5
    s_mul_i32 s31, s3, 1179648
    s_lshl_b32 s32, s29, 7
    s_add_u32 s31, s31, s32
    v_lshlrev_b32 v17, 4, v1
    v_add_u32 v18, 131072, v17
    v_add_u32 v19, 262144, v17
    v_add_u32 v20, 393216, v17
    v_add_u32 v21, 524288, v17
    s_mul_i32 s33, s28, 655360
    s_mul_i32 s32, s3, 32768
    s_add_u32 s33, s33, s32
    s_mul_i32 s34, s3, 32768
    v_lshrrev_b32 v4, 4, v1
    v_bfe_u32 v3, v1, 2, 2
    v_lshlrev_b32 v3, 7, v3
    v_lshl_add_u32 v3, v4, 10, v3
    v_and_b32 v5, 3, v1
    v_lshl_add_u32 v3, v5, 3, v3
    v_add_u32 v3, s34, v3
    v_and_b32 v5, 1, v4
    v_lshlrev_b32 v5, 5, v5
    v_bfe_u32 v6, v1, 3, 1
    v_lshl_add_u32 v5, v6, 6, v5
    v_xor_b32 v6, 0, v5
    v_add_u32 v144, v3, v6
    v_xor_b32 v6, 32, v5
    v_add_u32 v145, v3, v6
    v_xor_b32 v6, 64, v5
    v_add_u32 v146, v3, v6
    v_xor_b32 v6, 96, v5
    v_add_u32 v147, v3, v6
    s_add_u32 m0, s34, 0
    s_nop 0
    buffer_load_dwordx4 v8, s[16:19], s31 offen lds
    buffer_load_dwordx4 a[0:3], v17, s[12:15], s33 offen offset:0
    buffer_load_dwordx4 a[4:7], v17, s[12:15], s33 offen offset:1024
    s_add_u32 m0, s34, 1024
    s_nop 0
    buffer_load_dwordx4 v9, s[16:19], s31 offen lds
    buffer_load_dwordx4 a[8:11], v18, s[12:15], s33 offen offset:0
    buffer_load_dwordx4 a[12:15], v18, s[12:15], s33 offen offset:1024
    s_add_u32 m0, s34, 2048
    s_nop 0
    buffer_load_dwordx4 v10, s[16:19], s31 offen lds
    buffer_load_dwordx4 a[16:19], v19, s[12:15], s33 offen offset:0
    buffer_load_dwordx4 a[20:23], v19, s[12:15], s33 offen offset:1024
    s_add_u32 m0, s34, 3072
    s_nop 0
    buffer_load_dwordx4 v11, s[16:19], s31 offen lds
    buffer_load_dwordx4 a[24:27], v20, s[12:15], s33 offen offset:0
    buffer_load_dwordx4 a[28:31], v20, s[12:15], s33 offen offset:1024
    s_add_u32 m0, s34, 4096
    s_nop 0
    buffer_load_dwordx4 v12, s[16:19], s31 offen lds
    buffer_load_dwordx4 a[32:35], v21, s[12:15], s33 offen offset:0
    buffer_load_dwordx4 a[36:39], v21, s[12:15], s33 offen offset:1024
    s_add_u32 m0, s34, 5120
    s_nop 0
    buffer_load_dwordx4 v13, s[16:19], s31 offen lds
    s_add_u32 m0, s34, 6144
    s_nop 0
    buffer_load_dwordx4 v14, s[16:19], s31 offen lds
    s_add_u32 m0, s34, 7168
    s_nop 0
    buffer_load_dwordx4 v15, s[16:19], s31 offen lds
    s_add_u32 s31, s31, 73728
    s_add_u32 s33, s33, 2048
    s_add_u32 m0, s34, 8192
    s_nop 0
    buffer_load_dwordx4 v8, s[16:19], s31 offen lds
    buffer_load_dwordx4 a[40:43], v17, s[12:15], s33 offen offset:0
    buffer_load_dwordx4 a[44:47], v17, s[12:15], s33 offen offset:1024
    s_add_u32 m0, s34, 9216
    s_nop 0
    buffer_load_dwordx4 v9, s[16:19], s31 offen lds
    buffer_load_dwordx4 a[48:51], v18, s[12:15], s33 offen offset:0
    buffer_load_dwordx4 a[52:55], v18, s[12:15], s33 offen offset:1024
    s_add_u32 m0, s34, 10240
    s_nop 0
    buffer_load_dwordx4 v10, s[16:19], s31 offen lds
    buffer_load_dwordx4 a[56:59], v19, s[12:15], s33 offen offset:0
    buffer_load_dwordx4 a[60:63], v19, s[12:15], s33 offen offset:1024
    s_add_u32 m0, s34, 11264
    s_nop 0
    buffer_load_dwordx4 v11, s[16:19], s31 offen lds
    buffer_load_dwordx4 a[64:67], v20, s[12:15], s33 offen offset:0
    buffer_load_dwordx4 a[68:71], v20, s[12:15], s33 offen offset:1024
    s_add_u32 m0, s34, 12288
    s_nop 0
    buffer_load_dwordx4 v12, s[16:19], s31 offen lds
    buffer_load_dwordx4 a[72:75], v21, s[12:15], s33 offen offset:0
    buffer_load_dwordx4 a[76:79], v21, s[12:15], s33 offen offset:1024
    s_add_u32 m0, s34, 13312
    s_nop 0
    buffer_load_dwordx4 v13, s[16:19], s31 offen lds
    s_add_u32 m0, s34, 14336
    s_nop 0
    buffer_load_dwordx4 v14, s[16:19], s31 offen lds
    s_add_u32 m0, s34, 15360
    s_nop 0
    buffer_load_dwordx4 v15, s[16:19], s31 offen lds
    s_add_u32 s31, s31, 73728
    s_add_u32 s33, s33, 2048
    s_add_u32 m0, s34, 16384
    s_nop 0
    buffer_load_dwordx4 v8, s[16:19], s31 offen lds
    buffer_load_dwordx4 a[80:83], v17, s[12:15], s33 offen offset:0
    buffer_load_dwordx4 a[84:87], v17, s[12:15], s33 offen offset:1024
    s_add_u32 m0, s34, 17408
    s_nop 0
    buffer_load_dwordx4 v9, s[16:19], s31 offen lds
    buffer_load_dwordx4 a[88:91], v18, s[12:15], s33 offen offset:0
    buffer_load_dwordx4 a[92:95], v18, s[12:15], s33 offen offset:1024
    s_add_u32 m0, s34, 18432
    s_nop 0
    buffer_load_dwordx4 v10, s[16:19], s31 offen lds
    buffer_load_dwordx4 a[96:99], v19, s[12:15], s33 offen offset:0
    buffer_load_dwordx4 a[100:103], v19, s[12:15], s33 offen offset:1024
    s_add_u32 m0, s34, 19456
    s_nop 0
    buffer_load_dwordx4 v11, s[16:19], s31 offen lds
    buffer_load_dwordx4 a[104:107], v20, s[12:15], s33 offen offset:0
    buffer_load_dwordx4 a[108:111], v20, s[12:15], s33 offen offset:1024
    s_add_u32 m0, s34, 20480
    s_nop 0
    buffer_load_dwordx4 v12, s[16:19], s31 offen lds
    buffer_load_dwordx4 a[112:115], v21, s[12:15], s33 offen offset:0
    buffer_load_dwordx4 a[116:119], v21, s[12:15], s33 offen offset:1024
    s_add_u32 m0, s34, 21504
    s_nop 0
    buffer_load_dwordx4 v13, s[16:19], s31 offen lds
    s_add_u32 m0, s34, 22528
    s_nop 0
    buffer_load_dwordx4 v14, s[16:19], s31 offen lds
    s_add_u32 m0, s34, 23552
    s_nop 0
    buffer_load_dwordx4 v15, s[16:19], s31 offen lds
    s_add_u32 s31, s31, 73728
    s_add_u32 s33, s33, 2048
    v_mov_b32 v32, 0
    v_mov_b32 v33, 0
    v_mov_b32 v34, 0
    v_mov_b32 v35, 0
    v_mov_b32 v36, 0
    v_mov_b32 v37, 0
    v_mov_b32 v38, 0
    v_mov_b32 v39, 0
    v_mov_b32 v40, 0
    v_mov_b32 v41, 0
    v_mov_b32 v42, 0
    v_mov_b32 v43, 0
    v_mov_b32 v44, 0
    v_mov_b32 v45, 0
    v_mov_b32 v46, 0
    v_mov_b32 v47, 0
    v_mov_b32 v48, 0
    v_mov_b32 v49, 0
    v_mov_b32 v50, 0
    v_mov_b32 v51, 0
    v_mov_b32 v52, 0
    v_mov_b32 v53, 0
    v_mov_b32 v54, 0
    v_mov_b32 v55, 0
    v_mov_b32 v56, 0
    v_mov_b32 v57, 0
    v_mov_b32 v58, 0
    v_mov_b32 v59, 0
    v_mov_b32 v60, 0
    v_mov_b32 v61, 0
    v_mov_b32 v62, 0
    v_mov_b32 v63, 0
    v_mov_b32 v64, 0
    v_mov_b32 v65, 0
    v_mov_b32 v66, 0
    v_mov_b32 v67, 0
    v_mov_b32 v68, 0
    v_mov_b32 v69, 0
    v_mov_b32 v70, 0
    v_mov_b32 v71, 0
    v_mov_b32 v72, 0
    v_mov_b32 v73, 0
    v_mov_b32 v74, 0
    v_mov_b32 v75, 0
    v_mov_b32 v76, 0
    v_mov_b32 v77, 0
    v_mov_b32 v78, 0
    v_mov_b32 v79, 0
    v_mov_b32 v80, 0
    v_mov_b32 v81, 0
    v_mov_b32 v82, 0
    v_mov_b32 v83, 0
    v_mov_b32 v84, 0
    v_mov_b32 v85, 0
    v_mov_b32 v86, 0
    v_mov_b32 v87, 0
    v_mov_b32 v88, 0
    v_mov_b32 v89, 0
    v_mov_b32 v90, 0
    v_mov_b32 v91, 0
    v_mov_b32 v92, 0
    v_mov_b32 v93, 0
    v_mov_b32 v94, 0
    v_mov_b32 v95, 0
    v_mov_b32 v96, 0
    v_mov_b32 v97, 0
    v_mov_b32 v98, 0
    v_mov_b32 v99, 0
    v_mov_b32 v100, 0
    v_mov_b32 v101, 0
    v_mov_b32 v102, 0
    v_mov_b32 v103, 0
    v_mov_b32 v104, 0
    v_mov_b32 v105, 0
    v_mov_b32 v106, 0
    v_mov_b32 v107, 0
    v_mov_b32 v108, 0
    v_mov_b32 v109, 0
    v_mov_b32 v110, 0
    v_mov_b32 v111, 0
    v_and_b32 v3, 15, v1
    v_lshrrev_b32 v4, 4, v1
    s_mov_b32 s30, 1152
    v_mul_lo_u32 v24, v3, s30
    v_lshl_add_u32 v24, v4, 3, v24
    s_lshl_b32 s35, s29, 2
    s_add_u32 s35, s35, s3
    s_mul_i32 s36, s28, 92160
    s_lshl_b32 s37, s35, 5
    s_add_u32 s36, s36, s37
    v_lshrrev_b32 v5, 1, v4
    v_lshlrev_b32 v5, 8, v5
    v_lshl_add_u32 v5, v3, 4, v5
    v_and_b32 v6, 1, v4
    v_lshl_add_u32 v25, v6, 3, v5
    s_mul_i32 s37, s28, 92160
    s_lshl_b32 s38, s35, 9
    s_add_u32 s37, s37, s38
    v_lshlrev_b32 v26, 4, v4
    s_lshl_b32 s38, s35, 6
    s_add_u32 s38, s38, 4608
    s_waitcnt vmcnt(36)
    ds_read_b64_tr_b16 v[112:113], v144 offset:0
    ds_read_b64_tr_b16 v[114:115], v144 offset:512
    ds_read_b64_tr_b16 v[116:117], v145 offset:0
    ds_read_b64_tr_b16 v[118:119], v145 offset:512
    ds_read_b64_tr_b16 v[120:121], v146 offset:0
    ds_read_b64_tr_b16 v[122:123], v146 offset:512
    ds_read_b64_tr_b16 v[124:125], v147 offset:0
    ds_read_b64_tr_b16 v[126:127], v147 offset:512
    ds_read_b64_tr_b16 v[128:129], v144 offset:4096
    ds_read_b64_tr_b16 v[130:131], v144 offset:4608
    ds_read_b64_tr_b16 v[132:133], v145 offset:4096
    ds_read_b64_tr_b16 v[134:135], v145 offset:4608
    ds_read_b64_tr_b16 v[136:137], v146 offset:4096
    ds_read_b64_tr_b16 v[138:139], v146 offset:4608
    ds_read_b64_tr_b16 v[140:141], v147 offset:4096
    ds_read_b64_tr_b16 v[142:143], v147 offset:4608
    s_waitcnt lgkmcnt(14)
    v_mfma_f32_16x16x32_bf16 v[32:35], v[112:115], a[0:3], v[32:35]
    v_mfma_f32_16x16x32_bf16 v[36:39], v[112:115], a[8:11], v[36:39]
    s_add_u32 m0, s34, 24576
    s_nop 0
    buffer_load_dwordx4 v8, s[16:19], s31 offen lds
    v_mfma_f32_16x16x32_bf16 v[40:43], v[112:115], a[16:19], v[40:43]
    v_mfma_f32_16x16x32_bf16 v[44:47], v[112:115], a[24:27], v[44:47]
    buffer_load_dwordx4 a[120:123], v17, s[12:15], s33 offen offset:0
    v_mfma_f32_16x16x32_bf16 v[48:51], v[112:115], a[32:35], v[48:51]
    s_waitcnt lgkmcnt(12)
    v_mfma_f32_16x16x32_bf16 v[52:55], v[116:119], a[0:3], v[52:55]
    buffer_load_dwordx4 a[124:127], v17, s[12:15], s33 offen offset:1024
    v_mfma_f32_16x16x32_bf16 v[56:59], v[116:119], a[8:11], v[56:59]
    v_mfma_f32_16x16x32_bf16 v[60:63], v[116:119], a[16:19], v[60:63]
    s_add_u32 m0, s34, 25600
    s_nop 0
    buffer_load_dwordx4 v9, s[16:19], s31 offen lds
    v_mfma_f32_16x16x32_bf16 v[64:67], v[116:119], a[24:27], v[64:67]
    v_mfma_f32_16x16x32_bf16 v[68:71], v[116:119], a[32:35], v[68:71]
    buffer_load_dwordx4 a[128:131], v18, s[12:15], s33 offen offset:0
    s_waitcnt lgkmcnt(10)
    v_mfma_f32_16x16x32_bf16 v[72:75], v[120:123], a[0:3], v[72:75]
    v_mfma_f32_16x16x32_bf16 v[76:79], v[120:123], a[8:11], v[76:79]
    buffer_load_dwordx4 a[132:135], v18, s[12:15], s33 offen offset:1024
    v_mfma_f32_16x16x32_bf16 v[80:83], v[120:123], a[16:19], v[80:83]
    v_mfma_f32_16x16x32_bf16 v[84:87], v[120:123], a[24:27], v[84:87]
    s_add_u32 m0, s34, 26624
    s_nop 0
    buffer_load_dwordx4 v10, s[16:19], s31 offen lds
    v_mfma_f32_16x16x32_bf16 v[88:91], v[120:123], a[32:35], v[88:91]
    s_waitcnt lgkmcnt(8)
    v_mfma_f32_16x16x32_bf16 v[92:95], v[124:127], a[0:3], v[92:95]
    buffer_load_dwordx4 a[136:139], v19, s[12:15], s33 offen offset:0
    v_mfma_f32_16x16x32_bf16 v[96:99], v[124:127], a[8:11], v[96:99]
    v_mfma_f32_16x16x32_bf16 v[100:103], v[124:127], a[16:19], v[100:103]
    buffer_load_dwordx4 a[140:143], v19, s[12:15], s33 offen offset:1024
    v_mfma_f32_16x16x32_bf16 v[104:107], v[124:127], a[24:27], v[104:107]
    v_mfma_f32_16x16x32_bf16 v[108:111], v[124:127], a[32:35], v[108:111]
    s_add_u32 m0, s34, 27648
    s_nop 0
    buffer_load_dwordx4 v11, s[16:19], s31 offen lds
    s_waitcnt lgkmcnt(6)
    v_mfma_f32_16x16x32_bf16 v[32:35], v[128:131], a[4:7], v[32:35]
    v_mfma_f32_16x16x32_bf16 v[36:39], v[128:131], a[12:15], v[36:39]
    buffer_load_dwordx4 a[144:147], v20, s[12:15], s33 offen offset:0
    v_mfma_f32_16x16x32_bf16 v[40:43], v[128:131], a[20:23], v[40:43]
    v_mfma_f32_16x16x32_bf16 v[44:47], v[128:131], a[28:31], v[44:47]
    buffer_load_dwordx4 a[148:151], v20, s[12:15], s33 offen offset:1024
    v_mfma_f32_16x16x32_bf16 v[48:51], v[128:131], a[36:39], v[48:51]
    s_waitcnt lgkmcnt(4)
    v_mfma_f32_16x16x32_bf16 v[52:55], v[132:135], a[4:7], v[52:55]
    s_add_u32 m0, s34, 28672
    s_nop 0
    buffer_load_dwordx4 v12, s[16:19], s31 offen lds
    v_mfma_f32_16x16x32_bf16 v[56:59], v[132:135], a[12:15], v[56:59]
    v_mfma_f32_16x16x32_bf16 v[60:63], v[132:135], a[20:23], v[60:63]
    buffer_load_dwordx4 a[152:155], v21, s[12:15], s33 offen offset:0
    v_mfma_f32_16x16x32_bf16 v[64:67], v[132:135], a[28:31], v[64:67]
    v_mfma_f32_16x16x32_bf16 v[68:71], v[132:135], a[36:39], v[68:71]
    buffer_load_dwordx4 a[156:159], v21, s[12:15], s33 offen offset:1024
    s_waitcnt lgkmcnt(2)
    v_mfma_f32_16x16x32_bf16 v[72:75], v[136:139], a[4:7], v[72:75]
    v_mfma_f32_16x16x32_bf16 v[76:79], v[136:139], a[12:15], v[76:79]
    s_add_u32 m0, s34, 29696
    s_nop 0
    buffer_load_dwordx4 v13, s[16:19], s31 offen lds
    v_mfma_f32_16x16x32_bf16 v[80:83], v[136:139], a[20:23], v[80:83]
    v_mfma_f32_16x16x32_bf16 v[84:87], v[136:139], a[28:31], v[84:87]
    s_add_u32 m0, s34, 30720
    s_nop 0
    buffer_load_dwordx4 v14, s[16:19], s31 offen lds
    v_mfma_f32_16x16x32_bf16 v[88:91], v[136:139], a[36:39], v[88:91]
    s_waitcnt lgkmcnt(0)
    v_mfma_f32_16x16x32_bf16 v[92:95], v[140:143], a[4:7], v[92:95]
    s_add_u32 m0, s34, 31744
    s_nop 0
    buffer_load_dwordx4 v15, s[16:19], s31 offen lds
    s_add_u32 s31, s31, 73728
    s_add_u32 s33, s33, 2048
    v_mfma_f32_16x16x32_bf16 v[96:99], v[140:143], a[12:15], v[96:99]
    v_mfma_f32_16x16x32_bf16 v[100:103], v[140:143], a[20:23], v[100:103]
    v_mfma_f32_16x16x32_bf16 v[104:107], v[140:143], a[28:31], v[104:107]
    v_mfma_f32_16x16x32_bf16 v[108:111], v[140:143], a[36:39], v[108:111]
    s_waitcnt vmcnt(36)
    ds_read_b64_tr_b16 v[112:113], v144 offset:8192
    ds_read_b64_tr_b16 v[114:115], v144 offset:8704
    ds_read_b64_tr_b16 v[116:117], v145 offset:8192
    ds_read_b64_tr_b16 v[118:119], v145 offset:8704
    ds_read_b64_tr_b16 v[120:121], v146 offset:8192
    ds_read_b64_tr_b16 v[122:123], v146 offset:8704
    ds_read_b64_tr_b16 v[124:125], v147 offset:8192
    ds_read_b64_tr_b16 v[126:127], v147 offset:8704
    ds_read_b64_tr_b16 v[128:129], v144 offset:12288
    ds_read_b64_tr_b16 v[130:131], v144 offset:12800
    ds_read_b64_tr_b16 v[132:133], v145 offset:12288
    ds_read_b64_tr_b16 v[134:135], v145 offset:12800
    ds_read_b64_tr_b16 v[136:137], v146 offset:12288
    ds_read_b64_tr_b16 v[138:139], v146 offset:12800
    ds_read_b64_tr_b16 v[140:141], v147 offset:12288
    ds_read_b64_tr_b16 v[142:143], v147 offset:12800
    s_waitcnt lgkmcnt(14)
    v_mfma_f32_16x16x32_bf16 v[32:35], v[112:115], a[40:43], v[32:35]
    v_mfma_f32_16x16x32_bf16 v[36:39], v[112:115], a[48:51], v[36:39]
    s_add_u32 m0, s34, 0
    s_nop 0
    buffer_load_dwordx4 v8, s[16:19], s31 offen lds
    v_mfma_f32_16x16x32_bf16 v[40:43], v[112:115], a[56:59], v[40:43]
    v_mfma_f32_16x16x32_bf16 v[44:47], v[112:115], a[64:67], v[44:47]
    buffer_load_dwordx4 a[0:3], v17, s[12:15], s33 offen offset:0
    v_mfma_f32_16x16x32_bf16 v[48:51], v[112:115], a[72:75], v[48:51]
    s_waitcnt lgkmcnt(12)
    v_mfma_f32_16x16x32_bf16 v[52:55], v[116:119], a[40:43], v[52:55]
    buffer_load_dwordx4 a[4:7], v17, s[12:15], s33 offen offset:1024
    v_mfma_f32_16x16x32_bf16 v[56:59], v[116:119], a[48:51], v[56:59]
    v_mfma_f32_16x16x32_bf16 v[60:63], v[116:119], a[56:59], v[60:63]
    s_add_u32 m0, s34, 1024
    s_nop 0
    buffer_load_dwordx4 v9, s[16:19], s31 offen lds
    v_mfma_f32_16x16x32_bf16 v[64:67], v[116:119], a[64:67], v[64:67]
    v_mfma_f32_16x16x32_bf16 v[68:71], v[116:119], a[72:75], v[68:71]
    buffer_load_dwordx4 a[8:11], v18, s[12:15], s33 offen offset:0
    s_waitcnt lgkmcnt(10)
    v_mfma_f32_16x16x32_bf16 v[72:75], v[120:123], a[40:43], v[72:75]
    v_mfma_f32_16x16x32_bf16 v[76:79], v[120:123], a[48:51], v[76:79]
    buffer_load_dwordx4 a[12:15], v18, s[12:15], s33 offen offset:1024
    v_mfma_f32_16x16x32_bf16 v[80:83], v[120:123], a[56:59], v[80:83]
    v_mfma_f32_16x16x32_bf16 v[84:87], v[120:123], a[64:67], v[84:87]
    s_add_u32 m0, s34, 2048
    s_nop 0
    buffer_load_dwordx4 v10, s[16:19], s31 offen lds
    v_mfma_f32_16x16x32_bf16 v[88:91], v[120:123], a[72:75], v[88:91]
    s_waitcnt lgkmcnt(8)
    v_mfma_f32_16x16x32_bf16 v[92:95], v[124:127], a[40:43], v[92:95]
    buffer_load_dwordx4 a[16:19], v19, s[12:15], s33 offen offset:0
    v_mfma_f32_16x16x32_bf16 v[96:99], v[124:127], a[48:51], v[96:99]
    v_mfma_f32_16x16x32_bf16 v[100:103], v[124:127], a[56:59], v[100:103]
    buffer_load_dwordx4 a[20:23], v19, s[12:15], s33 offen offset:1024
    v_mfma_f32_16x16x32_bf16 v[104:107], v[124:127], a[64:67], v[104:107]
    v_mfma_f32_16x16x32_bf16 v[108:111], v[124:127], a[72:75], v[108:111]
    s_add_u32 m0, s34, 3072
    s_nop 0
    buffer_load_dwordx4 v11, s[16:19], s31 offen lds
    s_waitcnt lgkmcnt(6)
    v_mfma_f32_16x16x32_bf16 v[32:35], v[128:131], a[44:47], v[32:35]
    v_mfma_f32_16x16x32_bf16 v[36:39], v[128:131], a[52:55], v[36:39]
    buffer_load_dwordx4 a[24:27], v20, s[12:15], s33 offen offset:0
    v_mfma_f32_16x16x32_bf16 v[40:43], v[128:131], a[60:63], v[40:43]
    v_mfma_f32_16x16x32_bf16 v[44:47], v[128:131], a[68:71], v[44:47]
    buffer_load_dwordx4 a[28:31], v20, s[12:15], s33 offen offset:1024
    v_mfma_f32_16x16x32_bf16 v[48:51], v[128:131], a[76:79], v[48:51]
    s_waitcnt lgkmcnt(4)
    v_mfma_f32_16x16x32_bf16 v[52:55], v[132:135], a[44:47], v[52:55]
    s_add_u32 m0, s34, 4096
    s_nop 0
    buffer_load_dwordx4 v12, s[16:19], s31 offen lds
    v_mfma_f32_16x16x32_bf16 v[56:59], v[132:135], a[52:55], v[56:59]
    v_mfma_f32_16x16x32_bf16 v[60:63], v[132:135], a[60:63], v[60:63]
    buffer_load_dwordx4 a[32:35], v21, s[12:15], s33 offen offset:0
    v_mfma_f32_16x16x32_bf16 v[64:67], v[132:135], a[68:71], v[64:67]
    v_mfma_f32_16x16x32_bf16 v[68:71], v[132:135], a[76:79], v[68:71]
    buffer_load_dwordx4 a[36:39], v21, s[12:15], s33 offen offset:1024
    s_waitcnt lgkmcnt(2)
    v_mfma_f32_16x16x32_bf16 v[72:75], v[136:139], a[44:47], v[72:75]
    v_mfma_f32_16x16x32_bf16 v[76:79], v[136:139], a[52:55], v[76:79]
    s_add_u32 m0, s34, 5120
    s_nop 0
    buffer_load_dwordx4 v13, s[16:19], s31 offen lds
    v_mfma_f32_16x16x32_bf16 v[80:83], v[136:139], a[60:63], v[80:83]
    v_mfma_f32_16x16x32_bf16 v[84:87], v[136:139], a[68:71], v[84:87]
    s_add_u32 m0, s34, 6144
    s_nop 0
    buffer_load_dwordx4 v14, s[16:19], s31 offen lds
    v_mfma_f32_16x16x32_bf16 v[88:91], v[136:139], a[76:79], v[88:91]
    s_waitcnt lgkmcnt(0)
    v_mfma_f32_16x16x32_bf16 v[92:95], v[140:143], a[44:47], v[92:95]
    s_add_u32 m0, s34, 7168
    s_nop 0
    buffer_load_dwordx4 v15, s[16:19], s31 offen lds
    s_add_u32 s31, s31, 73728
    s_add_u32 s33, s33, 2048
    v_mfma_f32_16x16x32_bf16 v[96:99], v[140:143], a[52:55], v[96:99]
    v_mfma_f32_16x16x32_bf16 v[100:103], v[140:143], a[60:63], v[100:103]
    v_mfma_f32_16x16x32_bf16 v[104:107], v[140:143], a[68:71], v[104:107]
    v_mfma_f32_16x16x32_bf16 v[108:111], v[140:143], a[76:79], v[108:111]
    s_waitcnt vmcnt(36)
    ds_read_b64_tr_b16 v[112:113], v144 offset:16384
    ds_read_b64_tr_b16 v[114:115], v144 offset:16896
    ds_read_b64_tr_b16 v[116:117], v145 offset:16384
    ds_read_b64_tr_b16 v[118:119], v145 offset:16896
    ds_read_b64_tr_b16 v[120:121], v146 offset:16384
    ds_read_b64_tr_b16 v[122:123], v146 offset:16896
    ds_read_b64_tr_b16 v[124:125], v147 offset:16384
    ds_read_b64_tr_b16 v[126:127], v147 offset:16896
    ds_read_b64_tr_b16 v[128:129], v144 offset:20480
    ds_read_b64_tr_b16 v[130:131], v144 offset:20992
    ds_read_b64_tr_b16 v[132:133], v145 offset:20480
    ds_read_b64_tr_b16 v[134:135], v145 offset:20992
    ds_read_b64_tr_b16 v[136:137], v146 offset:20480
    ds_read_b64_tr_b16 v[138:139], v146 offset:20992
    ds_read_b64_tr_b16 v[140:141], v147 offset:20480
    ds_read_b64_tr_b16 v[142:143], v147 offset:20992
    s_waitcnt lgkmcnt(14)
    v_mfma_f32_16x16x32_bf16 v[32:35], v[112:115], a[80:83], v[32:35]
    v_mfma_f32_16x16x32_bf16 v[36:39], v[112:115], a[88:91], v[36:39]
    s_add_u32 m0, s34, 8192
    s_nop 0
    buffer_load_dwordx4 v8, s[16:19], s31 offen lds
    v_mfma_f32_16x16x32_bf16 v[40:43], v[112:115], a[96:99], v[40:43]
    v_mfma_f32_16x16x32_bf16 v[44:47], v[112:115], a[104:107], v[44:47]
    buffer_load_dwordx4 a[40:43], v17, s[12:15], s33 offen offset:0
    v_mfma_f32_16x16x32_bf16 v[48:51], v[112:115], a[112:115], v[48:51]
    s_waitcnt lgkmcnt(12)
    v_mfma_f32_16x16x32_bf16 v[52:55], v[116:119], a[80:83], v[52:55]
    buffer_load_dwordx4 a[44:47], v17, s[12:15], s33 offen offset:1024
    v_mfma_f32_16x16x32_bf16 v[56:59], v[116:119], a[88:91], v[56:59]
    v_mfma_f32_16x16x32_bf16 v[60:63], v[116:119], a[96:99], v[60:63]
    s_add_u32 m0, s34, 9216
    s_nop 0
    buffer_load_dwordx4 v9, s[16:19], s31 offen lds
    v_mfma_f32_16x16x32_bf16 v[64:67], v[116:119], a[104:107], v[64:67]
    v_mfma_f32_16x16x32_bf16 v[68:71], v[116:119], a[112:115], v[68:71]
    buffer_load_dwordx4 a[48:51], v18, s[12:15], s33 offen offset:0
    s_waitcnt lgkmcnt(10)
    v_mfma_f32_16x16x32_bf16 v[72:75], v[120:123], a[80:83], v[72:75]
    v_mfma_f32_16x16x32_bf16 v[76:79], v[120:123], a[88:91], v[76:79]
    buffer_load_dwordx4 a[52:55], v18, s[12:15], s33 offen offset:1024
    v_mfma_f32_16x16x32_bf16 v[80:83], v[120:123], a[96:99], v[80:83]
    v_mfma_f32_16x16x32_bf16 v[84:87], v[120:123], a[104:107], v[84:87]
    s_add_u32 m0, s34, 10240
    s_nop 0
    buffer_load_dwordx4 v10, s[16:19], s31 offen lds
    v_mfma_f32_16x16x32_bf16 v[88:91], v[120:123], a[112:115], v[88:91]
    s_waitcnt lgkmcnt(8)
    v_mfma_f32_16x16x32_bf16 v[92:95], v[124:127], a[80:83], v[92:95]
    buffer_load_dwordx4 a[56:59], v19, s[12:15], s33 offen offset:0
    v_mfma_f32_16x16x32_bf16 v[96:99], v[124:127], a[88:91], v[96:99]
    v_mfma_f32_16x16x32_bf16 v[100:103], v[124:127], a[96:99], v[100:103]
    buffer_load_dwordx4 a[60:63], v19, s[12:15], s33 offen offset:1024
    v_mfma_f32_16x16x32_bf16 v[104:107], v[124:127], a[104:107], v[104:107]
    v_mfma_f32_16x16x32_bf16 v[108:111], v[124:127], a[112:115], v[108:111]
    s_add_u32 m0, s34, 11264
    s_nop 0
    buffer_load_dwordx4 v11, s[16:19], s31 offen lds
    s_waitcnt lgkmcnt(6)
    v_mfma_f32_16x16x32_bf16 v[32:35], v[128:131], a[84:87], v[32:35]
    v_mfma_f32_16x16x32_bf16 v[36:39], v[128:131], a[92:95], v[36:39]
    buffer_load_dwordx4 a[64:67], v20, s[12:15], s33 offen offset:0
    v_mfma_f32_16x16x32_bf16 v[40:43], v[128:131], a[100:103], v[40:43]
    v_mfma_f32_16x16x32_bf16 v[44:47], v[128:131], a[108:111], v[44:47]
    buffer_load_dwordx4 a[68:71], v20, s[12:15], s33 offen offset:1024
    v_mfma_f32_16x16x32_bf16 v[48:51], v[128:131], a[116:119], v[48:51]
    s_waitcnt lgkmcnt(4)
    v_mfma_f32_16x16x32_bf16 v[52:55], v[132:135], a[84:87], v[52:55]
    s_add_u32 m0, s34, 12288
    s_nop 0
    buffer_load_dwordx4 v12, s[16:19], s31 offen lds
    v_mfma_f32_16x16x32_bf16 v[56:59], v[132:135], a[92:95], v[56:59]
    v_mfma_f32_16x16x32_bf16 v[60:63], v[132:135], a[100:103], v[60:63]
    buffer_load_dwordx4 a[72:75], v21, s[12:15], s33 offen offset:0
    v_mfma_f32_16x16x32_bf16 v[64:67], v[132:135], a[108:111], v[64:67]
    v_mfma_f32_16x16x32_bf16 v[68:71], v[132:135], a[116:119], v[68:71]
    buffer_load_dwordx4 a[76:79], v21, s[12:15], s33 offen offset:1024
    s_waitcnt lgkmcnt(2)
    v_mfma_f32_16x16x32_bf16 v[72:75], v[136:139], a[84:87], v[72:75]
    v_mfma_f32_16x16x32_bf16 v[76:79], v[136:139], a[92:95], v[76:79]
    s_add_u32 m0, s34, 13312
    s_nop 0
    buffer_load_dwordx4 v13, s[16:19], s31 offen lds
    v_mfma_f32_16x16x32_bf16 v[80:83], v[136:139], a[100:103], v[80:83]
    v_mfma_f32_16x16x32_bf16 v[84:87], v[136:139], a[108:111], v[84:87]
    s_add_u32 m0, s34, 14336
    s_nop 0
    buffer_load_dwordx4 v14, s[16:19], s31 offen lds
    v_mfma_f32_16x16x32_bf16 v[88:91], v[136:139], a[116:119], v[88:91]
    s_waitcnt lgkmcnt(0)
    v_mfma_f32_16x16x32_bf16 v[92:95], v[140:143], a[84:87], v[92:95]
    s_add_u32 m0, s34, 15360
    s_nop 0
    buffer_load_dwordx4 v15, s[16:19], s31 offen lds
    s_add_u32 s31, s31, 73728
    s_add_u32 s33, s33, 2048
    v_mfma_f32_16x16x32_bf16 v[96:99], v[140:143], a[92:95], v[96:99]
    v_mfma_f32_16x16x32_bf16 v[100:103], v[140:143], a[100:103], v[100:103]
    v_mfma_f32_16x16x32_bf16 v[104:107], v[140:143], a[108:111], v[104:107]
    v_mfma_f32_16x16x32_bf16 v[108:111], v[140:143], a[116:119], v[108:111]
    s_waitcnt vmcnt(36)
    ds_read_b64_tr_b16 v[112:113], v144 offset:24576
    ds_read_b64_tr_b16 v[114:115], v144 offset:25088
    ds_read_b64_tr_b16 v[116:117], v145 offset:24576
    ds_read_b64_tr_b16 v[118:119], v145 offset:25088
    ds_read_b64_tr_b16 v[120:121], v146 offset:24576
    ds_read_b64_tr_b16 v[122:123], v146 offset:25088
    ds_read_b64_tr_b16 v[124:125], v147 offset:24576
    ds_read_b64_tr_b16 v[126:127], v147 offset:25088
    ds_read_b64_tr_b16 v[128:129], v144 offset:28672
    ds_read_b64_tr_b16 v[130:131], v144 offset:29184
    ds_read_b64_tr_b16 v[132:133], v145 offset:28672
    ds_read_b64_tr_b16 v[134:135], v145 offset:29184
    ds_read_b64_tr_b16 v[136:137], v146 offset:28672
    ds_read_b64_tr_b16 v[138:139], v146 offset:29184
    ds_read_b64_tr_b16 v[140:141], v147 offset:28672
    ds_read_b64_tr_b16 v[142:143], v147 offset:29184
    s_waitcnt lgkmcnt(14)
    v_mfma_f32_16x16x32_bf16 v[32:35], v[112:115], a[120:123], v[32:35]
    v_mfma_f32_16x16x32_bf16 v[36:39], v[112:115], a[128:131], v[36:39]
    s_add_u32 m0, s34, 16384
    s_nop 0
    buffer_load_dwordx4 v8, s[16:19], s31 offen lds
    v_mfma_f32_16x16x32_bf16 v[40:43], v[112:115], a[136:139], v[40:43]
    v_mfma_f32_16x16x32_bf16 v[44:47], v[112:115], a[144:147], v[44:47]
    buffer_load_dwordx4 a[80:83], v17, s[12:15], s33 offen offset:0
    v_mfma_f32_16x16x32_bf16 v[48:51], v[112:115], a[152:155], v[48:51]
    s_waitcnt lgkmcnt(12)
    v_mfma_f32_16x16x32_bf16 v[52:55], v[116:119], a[120:123], v[52:55]
    buffer_load_dwordx4 a[84:87], v17, s[12:15], s33 offen offset:1024
    v_mfma_f32_16x16x32_bf16 v[56:59], v[116:119], a[128:131], v[56:59]
    v_mfma_f32_16x16x32_bf16 v[60:63], v[116:119], a[136:139], v[60:63]
    s_add_u32 m0, s34, 17408
    s_nop 0
    buffer_load_dwordx4 v9, s[16:19], s31 offen lds
    v_mfma_f32_16x16x32_bf16 v[64:67], v[116:119], a[144:147], v[64:67]
    v_mfma_f32_16x16x32_bf16 v[68:71], v[116:119], a[152:155], v[68:71]
    buffer_load_dwordx4 a[88:91], v18, s[12:15], s33 offen offset:0
    s_waitcnt lgkmcnt(10)
    v_mfma_f32_16x16x32_bf16 v[72:75], v[120:123], a[120:123], v[72:75]
    v_mfma_f32_16x16x32_bf16 v[76:79], v[120:123], a[128:131], v[76:79]
    buffer_load_dwordx4 a[92:95], v18, s[12:15], s33 offen offset:1024
    v_mfma_f32_16x16x32_bf16 v[80:83], v[120:123], a[136:139], v[80:83]
    v_mfma_f32_16x16x32_bf16 v[84:87], v[120:123], a[144:147], v[84:87]
    s_add_u32 m0, s34, 18432
    s_nop 0
    buffer_load_dwordx4 v10, s[16:19], s31 offen lds
    v_mfma_f32_16x16x32_bf16 v[88:91], v[120:123], a[152:155], v[88:91]
    s_waitcnt lgkmcnt(8)
    v_mfma_f32_16x16x32_bf16 v[92:95], v[124:127], a[120:123], v[92:95]
    buffer_load_dwordx4 a[96:99], v19, s[12:15], s33 offen offset:0
    v_mfma_f32_16x16x32_bf16 v[96:99], v[124:127], a[128:131], v[96:99]
    v_mfma_f32_16x16x32_bf16 v[100:103], v[124:127], a[136:139], v[100:103]
    buffer_load_dwordx4 a[100:103], v19, s[12:15], s33 offen offset:1024
    v_mfma_f32_16x16x32_bf16 v[104:107], v[124:127], a[144:147], v[104:107]
    v_mfma_f32_16x16x32_bf16 v[108:111], v[124:127], a[152:155], v[108:111]
    s_add_u32 m0, s34, 19456
    s_nop 0
    buffer_load_dwordx4 v11, s[16:19], s31 offen lds
    s_waitcnt lgkmcnt(6)
    v_mfma_f32_16x16x32_bf16 v[32:35], v[128:131], a[124:127], v[32:35]
    v_mfma_f32_16x16x32_bf16 v[36:39], v[128:131], a[132:135], v[36:39]
    buffer_load_dwordx4 a[104:107], v20, s[12:15], s33 offen offset:0
    v_mfma_f32_16x16x32_bf16 v[40:43], v[128:131], a[140:143], v[40:43]
    v_mfma_f32_16x16x32_bf16 v[44:47], v[128:131], a[148:151], v[44:47]
    buffer_load_dwordx4 a[108:111], v20, s[12:15], s33 offen offset:1024
    v_mfma_f32_16x16x32_bf16 v[48:51], v[128:131], a[156:159], v[48:51]
    s_waitcnt lgkmcnt(4)
    v_mfma_f32_16x16x32_bf16 v[52:55], v[132:135], a[124:127], v[52:55]
    s_add_u32 m0, s34, 20480
    s_nop 0
    buffer_load_dwordx4 v12, s[16:19], s31 offen lds
    v_mfma_f32_16x16x32_bf16 v[56:59], v[132:135], a[132:135], v[56:59]
    v_mfma_f32_16x16x32_bf16 v[60:63], v[132:135], a[140:143], v[60:63]
    buffer_load_dwordx4 a[112:115], v21, s[12:15], s33 offen offset:0
    v_mfma_f32_16x16x32_bf16 v[64:67], v[132:135], a[148:151], v[64:67]
    v_mfma_f32_16x16x32_bf16 v[68:71], v[132:135], a[156:159], v[68:71]
    buffer_load_dwordx4 a[116:119], v21, s[12:15], s33 offen offset:1024
    s_waitcnt lgkmcnt(2)
    v_mfma_f32_16x16x32_bf16 v[72:75], v[136:139], a[124:127], v[72:75]
    v_mfma_f32_16x16x32_bf16 v[76:79], v[136:139], a[132:135], v[76:79]
    s_add_u32 m0, s34, 21504
    s_nop 0
    buffer_load_dwordx4 v13, s[16:19], s31 offen lds
    v_mfma_f32_16x16x32_bf16 v[80:83], v[136:139], a[140:143], v[80:83]
    v_mfma_f32_16x16x32_bf16 v[84:87], v[136:139], a[148:151], v[84:87]
    s_add_u32 m0, s34, 22528
    s_nop 0
    buffer_load_dwordx4 v14, s[16:19], s31 offen lds
    v_mfma_f32_16x16x32_bf16 v[88:91], v[136:139], a[156:159], v[88:91]
    s_waitcnt lgkmcnt(0)
    v_mfma_f32_16x16x32_bf16 v[92:95], v[140:143], a[124:127], v[92:95]
    s_add_u32 m0, s34, 23552
    s_nop 0
    buffer_load_dwordx4 v15, s[16:19], s31 offen lds
    s_add_u32 s31, s31, 73728
    s_add_u32 s33, s33, 2048
    v_mfma_f32_16x16x32_bf16 v[96:99], v[140:143], a[132:135], v[96:99]
    v_mfma_f32_16x16x32_bf16 v[100:103], v[140:143], a[140:143], v[100:103]
    v_mfma_f32_16x16x32_bf16 v[104:107], v[140:143], a[148:151], v[104:107]
    v_mfma_f32_16x16x32_bf16 v[108:111], v[140:143], a[156:159], v[108:111]
    s_waitcnt vmcnt(36)
    ds_read_b64_tr_b16 v[112:113], v144 offset:0
    ds_read_b64_tr_b16 v[114:115], v144 offset:512
    ds_read_b64_tr_b16 v[116:117], v145 offset:0
    ds_read_b64_tr_b16 v[118:119], v145 offset:512
    ds_read_b64_tr_b16 v[120:121], v146 offset:0
    ds_read_b64_tr_b16 v[122:123], v146 offset:512
    ds_read_b64_tr_b16 v[124:125], v147 offset:0
    ds_read_b64_tr_b16 v[126:127], v147 offset:512
    ds_read_b64_tr_b16 v[128:129], v144 offset:4096
    ds_read_b64_tr_b16 v[130:131], v144 offset:4608
    ds_read_b64_tr_b16 v[132:133], v145 offset:4096
    ds_read_b64_tr_b16 v[134:135], v145 offset:4608
    ds_read_b64_tr_b16 v[136:137], v146 offset:4096
    ds_read_b64_tr_b16 v[138:139], v146 offset:4608
    ds_read_b64_tr_b16 v[140:141], v147 offset:4096
    ds_read_b64_tr_b16 v[142:143], v147 offset:4608
    s_waitcnt lgkmcnt(14)
    v_mfma_f32_16x16x32_bf16 v[32:35], v[112:115], a[0:3], v[32:35]
    v_mfma_f32_16x16x32_bf16 v[36:39], v[112:115], a[8:11], v[36:39]
    s_add_u32 m0, s34, 24576
    s_nop 0
    buffer_load_dwordx4 v8, s[16:19], s31 offen lds
    v_mfma_f32_16x16x32_bf16 v[40:43], v[112:115], a[16:19], v[40:43]
    v_mfma_f32_16x16x32_bf16 v[44:47], v[112:115], a[24:27], v[44:47]
    buffer_load_dwordx4 a[120:123], v17, s[12:15], s33 offen offset:0
    v_mfma_f32_16x16x32_bf16 v[48:51], v[112:115], a[32:35], v[48:51]
    s_waitcnt lgkmcnt(12)
    v_mfma_f32_16x16x32_bf16 v[52:55], v[116:119], a[0:3], v[52:55]
    buffer_load_dwordx4 a[124:127], v17, s[12:15], s33 offen offset:1024
    v_mfma_f32_16x16x32_bf16 v[56:59], v[116:119], a[8:11], v[56:59]
    v_mfma_f32_16x16x32_bf16 v[60:63], v[116:119], a[16:19], v[60:63]
    s_add_u32 m0, s34, 25600
    s_nop 0
    buffer_load_dwordx4 v9, s[16:19], s31 offen lds
    v_mfma_f32_16x16x32_bf16 v[64:67], v[116:119], a[24:27], v[64:67]
    v_mfma_f32_16x16x32_bf16 v[68:71], v[116:119], a[32:35], v[68:71]
    buffer_load_dwordx4 a[128:131], v18, s[12:15], s33 offen offset:0
    s_waitcnt lgkmcnt(10)
    v_mfma_f32_16x16x32_bf16 v[72:75], v[120:123], a[0:3], v[72:75]
    v_mfma_f32_16x16x32_bf16 v[76:79], v[120:123], a[8:11], v[76:79]
    buffer_load_dwordx4 a[132:135], v18, s[12:15], s33 offen offset:1024
    v_mfma_f32_16x16x32_bf16 v[80:83], v[120:123], a[16:19], v[80:83]
    v_mfma_f32_16x16x32_bf16 v[84:87], v[120:123], a[24:27], v[84:87]
    s_add_u32 m0, s34, 26624
    s_nop 0
    buffer_load_dwordx4 v10, s[16:19], s31 offen lds
    v_mfma_f32_16x16x32_bf16 v[88:91], v[120:123], a[32:35], v[88:91]
    s_waitcnt lgkmcnt(8)
    v_mfma_f32_16x16x32_bf16 v[92:95], v[124:127], a[0:3], v[92:95]
    buffer_load_dwordx4 a[136:139], v19, s[12:15], s33 offen offset:0
    v_mfma_f32_16x16x32_bf16 v[96:99], v[124:127], a[8:11], v[96:99]
    v_mfma_f32_16x16x32_bf16 v[100:103], v[124:127], a[16:19], v[100:103]
    buffer_load_dwordx4 a[140:143], v19, s[12:15], s33 offen offset:1024
    v_mfma_f32_16x16x32_bf16 v[104:107], v[124:127], a[24:27], v[104:107]
    v_mfma_f32_16x16x32_bf16 v[108:111], v[124:127], a[32:35], v[108:111]
    s_add_u32 m0, s34, 27648
    s_nop 0
    buffer_load_dwordx4 v11, s[16:19], s31 offen lds
    s_waitcnt lgkmcnt(6)
    v_mfma_f32_16x16x32_bf16 v[32:35], v[128:131], a[4:7], v[32:35]
    v_mfma_f32_16x16x32_bf16 v[36:39], v[128:131], a[12:15], v[36:39]
    buffer_load_dwordx4 a[144:147], v20, s[12:15], s33 offen offset:0
    v_mfma_f32_16x16x32_bf16 v[40:43], v[128:131], a[20:23], v[40:43]
    v_mfma_f32_16x16x32_bf16 v[44:47], v[128:131], a[28:31], v[44:47]
    buffer_load_dwordx4 a[148:151], v20, s[12:15], s33 offen offset:1024
    v_mfma_f32_16x16x32_bf16 v[48:51], v[128:131], a[36:39], v[48:51]
    s_waitcnt lgkmcnt(4)
    v_mfma_f32_16x16x32_bf16 v[52:55], v[132:135], a[4:7], v[52:55]
    s_add_u32 m0, s34, 28672
    s_nop 0
    buffer_load_dwordx4 v12, s[16:19], s31 offen lds
    v_mfma_f32_16x16x32_bf16 v[56:59], v[132:135], a[12:15], v[56:59]
    v_mfma_f32_16x16x32_bf16 v[60:63], v[132:135], a[20:23], v[60:63]
    buffer_load_dwordx4 a[152:155], v21, s[12:15], s33 offen offset:0
    v_mfma_f32_16x16x32_bf16 v[64:67], v[132:135], a[28:31], v[64:67]
    v_mfma_f32_16x16x32_bf16 v[68:71], v[132:135], a[36:39], v[68:71]
    buffer_load_dwordx4 a[156:159], v21, s[12:15], s33 offen offset:1024
    s_waitcnt lgkmcnt(2)
    v_mfma_f32_16x16x32_bf16 v[72:75], v[136:139], a[4:7], v[72:75]
    v_mfma_f32_16x16x32_bf16 v[76:79], v[136:139], a[12:15], v[76:79]
    s_add_u32 m0, s34, 29696
    s_nop 0
    buffer_load_dwordx4 v13, s[16:19], s31 offen lds
    v_mfma_f32_16x16x32_bf16 v[80:83], v[136:139], a[20:23], v[80:83]
    v_mfma_f32_16x16x32_bf16 v[84:87], v[136:139], a[28:31], v[84:87]
    s_add_u32 m0, s34, 30720
    s_nop 0
    buffer_load_dwordx4 v14, s[16:19], s31 offen lds
    v_mfma_f32_16x16x32_bf16 v[88:91], v[136:139], a[36:39], v[88:91]
    s_waitcnt lgkmcnt(0)
    v_mfma_f32_16x16x32_bf16 v[92:95], v[140:143], a[4:7], v[92:95]
    s_add_u32 m0, s34, 31744
    s_nop 0
    buffer_load_dwordx4 v15, s[16:19], s31 offen lds
    s_add_u32 s31, s31, 73728
    s_add_u32 s33, s33, 2048
    v_mfma_f32_16x16x32_bf16 v[96:99], v[140:143], a[12:15], v[96:99]
    v_mfma_f32_16x16x32_bf16 v[100:103], v[140:143], a[20:23], v[100:103]
    v_mfma_f32_16x16x32_bf16 v[104:107], v[140:143], a[28:31], v[104:107]
    v_mfma_f32_16x16x32_bf16 v[108:111], v[140:143], a[36:39], v[108:111]
    s_waitcnt vmcnt(36)
    ds_read_b64_tr_b16 v[112:113], v144 offset:8192
    ds_read_b64_tr_b16 v[114:115], v144 offset:8704
    ds_read_b64_tr_b16 v[116:117], v145 offset:8192
    ds_read_b64_tr_b16 v[118:119], v145 offset:8704
    ds_read_b64_tr_b16 v[120:121], v146 offset:8192
    ds_read_b64_tr_b16 v[122:123], v146 offset:8704
    ds_read_b64_tr_b16 v[124:125], v147 offset:8192
    ds_read_b64_tr_b16 v[126:127], v147 offset:8704
    ds_read_b64_tr_b16 v[128:129], v144 offset:12288
    ds_read_b64_tr_b16 v[130:131], v144 offset:12800
    ds_read_b64_tr_b16 v[132:133], v145 offset:12288
    ds_read_b64_tr_b16 v[134:135], v145 offset:12800
    ds_read_b64_tr_b16 v[136:137], v146 offset:12288
    ds_read_b64_tr_b16 v[138:139], v146 offset:12800
    ds_read_b64_tr_b16 v[140:141], v147 offset:12288
    ds_read_b64_tr_b16 v[142:143], v147 offset:12800
    s_waitcnt lgkmcnt(14)
    v_mfma_f32_16x16x32_bf16 v[32:35], v[112:115], a[40:43], v[32:35]
    v_mfma_f32_16x16x32_bf16 v[36:39], v[112:115], a[48:51], v[36:39]
    s_add_u32 m0, s34, 0
    s_nop 0
    buffer_load_dwordx4 v8, s[16:19], s31 offen lds
    v_mfma_f32_16x16x32_bf16 v[40:43], v[112:115], a[56:59], v[40:43]
    v_mfma_f32_16x16x32_bf16 v[44:47], v[112:115], a[64:67], v[44:47]
    buffer_load_dwordx4 a[0:3], v17, s[12:15], s33 offen offset:0
    v_mfma_f32_16x16x32_bf16 v[48:51], v[112:115], a[72:75], v[48:51]
    s_waitcnt lgkmcnt(12)
    v_mfma_f32_16x16x32_bf16 v[52:55], v[116:119], a[40:43], v[52:55]
    buffer_load_dwordx4 a[4:7], v17, s[12:15], s33 offen offset:1024
    v_mfma_f32_16x16x32_bf16 v[56:59], v[116:119], a[48:51], v[56:59]
    v_mfma_f32_16x16x32_bf16 v[60:63], v[116:119], a[56:59], v[60:63]
    s_add_u32 m0, s34, 1024
    s_nop 0
    buffer_load_dwordx4 v9, s[16:19], s31 offen lds
    v_mfma_f32_16x16x32_bf16 v[64:67], v[116:119], a[64:67], v[64:67]
    v_mfma_f32_16x16x32_bf16 v[68:71], v[116:119], a[72:75], v[68:71]
    buffer_load_dwordx4 a[8:11], v18, s[12:15], s33 offen offset:0
    s_waitcnt lgkmcnt(10)
    v_mfma_f32_16x16x32_bf16 v[72:75], v[120:123], a[40:43], v[72:75]
    v_mfma_f32_16x16x32_bf16 v[76:79], v[120:123], a[48:51], v[76:79]
    buffer_load_dwordx4 a[12:15], v18, s[12:15], s33 offen offset:1024
    v_mfma_f32_16x16x32_bf16 v[80:83], v[120:123], a[56:59], v[80:83]
    v_mfma_f32_16x16x32_bf16 v[84:87], v[120:123], a[64:67], v[84:87]
    s_add_u32 m0, s34, 2048
    s_nop 0
    buffer_load_dwordx4 v10, s[16:19], s31 offen lds
    v_mfma_f32_16x16x32_bf16 v[88:91], v[120:123], a[72:75], v[88:91]
    s_waitcnt lgkmcnt(8)
    v_mfma_f32_16x16x32_bf16 v[92:95], v[124:127], a[40:43], v[92:95]
    buffer_load_dwordx4 a[16:19], v19, s[12:15], s33 offen offset:0
    v_mfma_f32_16x16x32_bf16 v[96:99], v[124:127], a[48:51], v[96:99]
    v_mfma_f32_16x16x32_bf16 v[100:103], v[124:127], a[56:59], v[100:103]
    buffer_load_dwordx4 a[20:23], v19, s[12:15], s33 offen offset:1024
    v_mfma_f32_16x16x32_bf16 v[104:107], v[124:127], a[64:67], v[104:107]
    v_mfma_f32_16x16x32_bf16 v[108:111], v[124:127], a[72:75], v[108:111]
    s_add_u32 m0, s34, 3072
    s_nop 0
    buffer_load_dwordx4 v11, s[16:19], s31 offen lds
    s_waitcnt lgkmcnt(6)
    v_mfma_f32_16x16x32_bf16 v[32:35], v[128:131], a[44:47], v[32:35]
    v_mfma_f32_16x16x32_bf16 v[36:39], v[128:131], a[52:55], v[36:39]
    buffer_load_dwordx4 a[24:27], v20, s[12:15], s33 offen offset:0
    v_mfma_f32_16x16x32_bf16 v[40:43], v[128:131], a[60:63], v[40:43]
    v_mfma_f32_16x16x32_bf16 v[44:47], v[128:131], a[68:71], v[44:47]
    buffer_load_dwordx4 a[28:31], v20, s[12:15], s33 offen offset:1024
    v_mfma_f32_16x16x32_bf16 v[48:51], v[128:131], a[76:79], v[48:51]
    s_waitcnt lgkmcnt(4)
    v_mfma_f32_16x16x32_bf16 v[52:55], v[132:135], a[44:47], v[52:55]
    s_add_u32 m0, s34, 4096
    s_nop 0
    buffer_load_dwordx4 v12, s[16:19], s31 offen lds
    v_mfma_f32_16x16x32_bf16 v[56:59], v[132:135], a[52:55], v[56:59]
    v_mfma_f32_16x16x32_bf16 v[60:63], v[132:135], a[60:63], v[60:63]
    buffer_load_dwordx4 a[32:35], v21, s[12:15], s33 offen offset:0
    v_mfma_f32_16x16x32_bf16 v[64:67], v[132:135], a[68:71], v[64:67]
    v_mfma_f32_16x16x32_bf16 v[68:71], v[132:135], a[76:79], v[68:71]
    buffer_load_dwordx4 a[36:39], v21, s[12:15], s33 offen offset:1024
    s_waitcnt lgkmcnt(2)
    v_mfma_f32_16x16x32_bf16 v[72:75], v[136:139], a[44:47], v[72:75]
    v_mfma_f32_16x16x32_bf16 v[76:79], v[136:139], a[52:55], v[76:79]
    s_add_u32 m0, s34, 5120
    s_nop 0
    buffer_load_dwordx4 v13, s[16:19], s31 offen lds
    v_mfma_f32_16x16x32_bf16 v[80:83], v[136:139], a[60:63], v[80:83]
    v_mfma_f32_16x16x32_bf16 v[84:87], v[136:139], a[68:71], v[84:87]
    s_add_u32 m0, s34, 6144
    s_nop 0
    buffer_load_dwordx4 v14, s[16:19], s31 offen lds
    v_mfma_f32_16x16x32_bf16 v[88:91], v[136:139], a[76:79], v[88:91]
    s_waitcnt lgkmcnt(0)
    v_mfma_f32_16x16x32_bf16 v[92:95], v[140:143], a[44:47], v[92:95]
    s_add_u32 m0, s34, 7168
    s_nop 0
    buffer_load_dwordx4 v15, s[16:19], s31 offen lds
    s_add_u32 s31, s31, 73728
    s_add_u32 s33, s33, 2048
    v_mfma_f32_16x16x32_bf16 v[96:99], v[140:143], a[52:55], v[96:99]
    v_mfma_f32_16x16x32_bf16 v[100:103], v[140:143], a[60:63], v[100:103]
    v_mfma_f32_16x16x32_bf16 v[104:107], v[140:143], a[68:71], v[104:107]
    v_mfma_f32_16x16x32_bf16 v[108:111], v[140:143], a[76:79], v[108:111]
    s_waitcnt vmcnt(36)
    ds_read_b64_tr_b16 v[112:113], v144 offset:16384
    ds_read_b64_tr_b16 v[114:115], v144 offset:16896
    ds_read_b64_tr_b16 v[116:117], v145 offset:16384
    ds_read_b64_tr_b16 v[118:119], v145 offset:16896
    ds_read_b64_tr_b16 v[120:121], v146 offset:16384
    ds_read_b64_tr_b16 v[122:123], v146 offset:16896
    ds_read_b64_tr_b16 v[124:125], v147 offset:16384
    ds_read_b64_tr_b16 v[126:127], v147 offset:16896
    ds_read_b64_tr_b16 v[128:129], v144 offset:20480
    ds_read_b64_tr_b16 v[130:131], v144 offset:20992
    ds_read_b64_tr_b16 v[132:133], v145 offset:20480
    ds_read_b64_tr_b16 v[134:135], v145 offset:20992
    ds_read_b64_tr_b16 v[136:137], v146 offset:20480
    ds_read_b64_tr_b16 v[138:139], v146 offset:20992
    ds_read_b64_tr_b16 v[140:141], v147 offset:20480
    ds_read_b64_tr_b16 v[142:143], v147 offset:20992
    s_waitcnt lgkmcnt(14)
    v_mfma_f32_16x16x32_bf16 v[32:35], v[112:115], a[80:83], v[32:35]
    v_mfma_f32_16x16x32_bf16 v[36:39], v[112:115], a[88:91], v[36:39]
    s_add_u32 m0, s34, 8192
    s_nop 0
    buffer_load_dwordx4 v8, s[16:19], s31 offen lds
    v_mfma_f32_16x16x32_bf16 v[40:43], v[112:115], a[96:99], v[40:43]
    v_mfma_f32_16x16x32_bf16 v[44:47], v[112:115], a[104:107], v[44:47]
    buffer_load_dwordx4 a[40:43], v17, s[12:15], s33 offen offset:0
    v_mfma_f32_16x16x32_bf16 v[48:51], v[112:115], a[112:115], v[48:51]
    s_waitcnt lgkmcnt(12)
    v_mfma_f32_16x16x32_bf16 v[52:55], v[116:119], a[80:83], v[52:55]
    buffer_load_dwordx4 a[44:47], v17, s[12:15], s33 offen offset:1024
    v_mfma_f32_16x16x32_bf16 v[56:59], v[116:119], a[88:91], v[56:59]
    v_mfma_f32_16x16x32_bf16 v[60:63], v[116:119], a[96:99], v[60:63]
    s_add_u32 m0, s34, 9216
    s_nop 0
    buffer_load_dwordx4 v9, s[16:19], s31 offen lds
    v_mfma_f32_16x16x32_bf16 v[64:67], v[116:119], a[104:107], v[64:67]
    v_mfma_f32_16x16x32_bf16 v[68:71], v[116:119], a[112:115], v[68:71]
    buffer_load_dwordx4 a[48:51], v18, s[12:15], s33 offen offset:0
    s_waitcnt lgkmcnt(10)
    v_mfma_f32_16x16x32_bf16 v[72:75], v[120:123], a[80:83], v[72:75]
    v_mfma_f32_16x16x32_bf16 v[76:79], v[120:123], a[88:91], v[76:79]
    buffer_load_dwordx4 a[52:55], v18, s[12:15], s33 offen offset:1024
    v_mfma_f32_16x16x32_bf16 v[80:83], v[120:123], a[96:99], v[80:83]
    v_mfma_f32_16x16x32_bf16 v[84:87], v[120:123], a[104:107], v[84:87]
    s_add_u32 m0, s34, 10240
    s_nop 0
    buffer_load_dwordx4 v10, s[16:19], s31 offen lds
    v_mfma_f32_16x16x32_bf16 v[88:91], v[120:123], a[112:115], v[88:91]
    s_waitcnt lgkmcnt(8)
    v_mfma_f32_16x16x32_bf16 v[92:95], v[124:127], a[80:83], v[92:95]
    buffer_load_dwordx4 a[56:59], v19, s[12:15], s33 offen offset:0
    v_mfma_f32_16x16x32_bf16 v[96:99], v[124:127], a[88:91], v[96:99]
    v_mfma_f32_16x16x32_bf16 v[100:103], v[124:127], a[96:99], v[100:103]
    buffer_load_dwordx4 a[60:63], v19, s[12:15], s33 offen offset:1024
    v_mfma_f32_16x16x32_bf16 v[104:107], v[124:127], a[104:107], v[104:107]
    v_mfma_f32_16x16x32_bf16 v[108:111], v[124:127], a[112:115], v[108:111]
    s_add_u32 m0, s34, 11264
    s_nop 0
    buffer_load_dwordx4 v11, s[16:19], s31 offen lds
    s_waitcnt lgkmcnt(6)
    v_mfma_f32_16x16x32_bf16 v[32:35], v[128:131], a[84:87], v[32:35]
    v_mfma_f32_16x16x32_bf16 v[36:39], v[128:131], a[92:95], v[36:39]
    buffer_load_dwordx4 a[64:67], v20, s[12:15], s33 offen offset:0
    v_mfma_f32_16x16x32_bf16 v[40:43], v[128:131], a[100:103], v[40:43]
    v_mfma_f32_16x16x32_bf16 v[44:47], v[128:131], a[108:111], v[44:47]
    buffer_load_dwordx4 a[68:71], v20, s[12:15], s33 offen offset:1024
    v_mfma_f32_16x16x32_bf16 v[48:51], v[128:131], a[116:119], v[48:51]
    s_waitcnt lgkmcnt(4)
    v_mfma_f32_16x16x32_bf16 v[52:55], v[132:135], a[84:87], v[52:55]
    s_add_u32 m0, s34, 12288
    s_nop 0
    buffer_load_dwordx4 v12, s[16:19], s31 offen lds
    v_mfma_f32_16x16x32_bf16 v[56:59], v[132:135], a[92:95], v[56:59]
    v_mfma_f32_16x16x32_bf16 v[60:63], v[132:135], a[100:103], v[60:63]
    buffer_load_dwordx4 a[72:75], v21, s[12:15], s33 offen offset:0
    v_mfma_f32_16x16x32_bf16 v[64:67], v[132:135], a[108:111], v[64:67]
    v_mfma_f32_16x16x32_bf16 v[68:71], v[132:135], a[116:119], v[68:71]
    buffer_load_dwordx4 a[76:79], v21, s[12:15], s33 offen offset:1024
    s_waitcnt lgkmcnt(2)
    v_mfma_f32_16x16x32_bf16 v[72:75], v[136:139], a[84:87], v[72:75]
    v_mfma_f32_16x16x32_bf16 v[76:79], v[136:139], a[92:95], v[76:79]
    s_add_u32 m0, s34, 13312
    s_nop 0
    buffer_load_dwordx4 v13, s[16:19], s31 offen lds
    v_mfma_f32_16x16x32_bf16 v[80:83], v[136:139], a[100:103], v[80:83]
    v_mfma_f32_16x16x32_bf16 v[84:87], v[136:139], a[108:111], v[84:87]
    s_add_u32 m0, s34, 14336
    s_nop 0
    buffer_load_dwordx4 v14, s[16:19], s31 offen lds
    v_mfma_f32_16x16x32_bf16 v[88:91], v[136:139], a[116:119], v[88:91]
    s_waitcnt lgkmcnt(0)
    v_mfma_f32_16x16x32_bf16 v[92:95], v[140:143], a[84:87], v[92:95]
    s_add_u32 m0, s34, 15360
    s_nop 0
    buffer_load_dwordx4 v15, s[16:19], s31 offen lds
    s_add_u32 s31, s31, 73728
    s_add_u32 s33, s33, 2048
    v_mfma_f32_16x16x32_bf16 v[96:99], v[140:143], a[92:95], v[96:99]
    v_mfma_f32_16x16x32_bf16 v[100:103], v[140:143], a[100:103], v[100:103]
    v_mfma_f32_16x16x32_bf16 v[104:107], v[140:143], a[108:111], v[104:107]
    v_mfma_f32_16x16x32_bf16 v[108:111], v[140:143], a[116:119], v[108:111]
    s_waitcnt vmcnt(36)
    ds_read_b64_tr_b16 v[112:113], v144 offset:24576
    ds_read_b64_tr_b16 v[114:115], v144 offset:25088
    ds_read_b64_tr_b16 v[116:117], v145 offset:24576
    ds_read_b64_tr_b16 v[118:119], v145 offset:25088
    ds_read_b64_tr_b16 v[120:121], v146 offset:24576
    ds_read_b64_tr_b16 v[122:123], v146 offset:25088
    ds_read_b64_tr_b16 v[124:125], v147 offset:24576
    ds_read_b64_tr_b16 v[126:127], v147 offset:25088
    ds_read_b64_tr_b16 v[128:129], v144 offset:28672
    ds_read_b64_tr_b16 v[130:131], v144 offset:29184
    ds_read_b64_tr_b16 v[132:133], v145 offset:28672
    ds_read_b64_tr_b16 v[134:135], v145 offset:29184
    ds_read_b64_tr_b16 v[136:137], v146 offset:28672
    ds_read_b64_tr_b16 v[138:139], v146 offset:29184
    ds_read_b64_tr_b16 v[140:141], v147 offset:28672
    ds_read_b64_tr_b16 v[142:143], v147 offset:29184
    s_waitcnt lgkmcnt(14)
    v_mfma_f32_16x16x32_bf16 v[32:35], v[112:115], a[120:123], v[32:35]
    v_mfma_f32_16x16x32_bf16 v[36:39], v[112:115], a[128:131], v[36:39]
    s_add_u32 m0, s34, 16384
    s_nop 0
    buffer_load_dwordx4 v8, s[16:19], s31 offen lds
    v_mfma_f32_16x16x32_bf16 v[40:43], v[112:115], a[136:139], v[40:43]
    v_mfma_f32_16x16x32_bf16 v[44:47], v[112:115], a[144:147], v[44:47]
    buffer_load_dwordx4 a[80:83], v17, s[12:15], s33 offen offset:0
    v_mfma_f32_16x16x32_bf16 v[48:51], v[112:115], a[152:155], v[48:51]
    s_waitcnt lgkmcnt(12)
    v_mfma_f32_16x16x32_bf16 v[52:55], v[116:119], a[120:123], v[52:55]
    buffer_load_dwordx4 a[84:87], v17, s[12:15], s33 offen offset:1024
    v_mfma_f32_16x16x32_bf16 v[56:59], v[116:119], a[128:131], v[56:59]
    v_mfma_f32_16x16x32_bf16 v[60:63], v[116:119], a[136:139], v[60:63]
    s_add_u32 m0, s34, 17408
    s_nop 0
    buffer_load_dwordx4 v9, s[16:19], s31 offen lds
    v_mfma_f32_16x16x32_bf16 v[64:67], v[116:119], a[144:147], v[64:67]
    v_mfma_f32_16x16x32_bf16 v[68:71], v[116:119], a[152:155], v[68:71]
    buffer_load_dwordx4 a[88:91], v18, s[12:15], s33 offen offset:0
    s_waitcnt lgkmcnt(10)
    v_mfma_f32_16x16x32_bf16 v[72:75], v[120:123], a[120:123], v[72:75]
    v_mfma_f32_16x16x32_bf16 v[76:79], v[120:123], a[128:131], v[76:79]
    buffer_load_dwordx4 a[92:95], v18, s[12:15], s33 offen offset:1024
    v_mfma_f32_16x16x32_bf16 v[80:83], v[120:123], a[136:139], v[80:83]
    v_mfma_f32_16x16x32_bf16 v[84:87], v[120:123], a[144:147], v[84:87]
    s_add_u32 m0, s34, 18432
    s_nop 0
    buffer_load_dwordx4 v10, s[16:19], s31 offen lds
    v_mfma_f32_16x16x32_bf16 v[88:91], v[120:123], a[152:155], v[88:91]
    s_waitcnt lgkmcnt(8)
    v_mfma_f32_16x16x32_bf16 v[92:95], v[124:127], a[120:123], v[92:95]
    buffer_load_dwordx4 a[96:99], v19, s[12:15], s33 offen offset:0
    v_mfma_f32_16x16x32_bf16 v[96:99], v[124:127], a[128:131], v[96:99]
    v_mfma_f32_16x16x32_bf16 v[100:103], v[124:127], a[136:139], v[100:103]
    buffer_load_dwordx4 a[100:103], v19, s[12:15], s33 offen offset:1024
    v_mfma_f32_16x16x32_bf16 v[104:107], v[124:127], a[144:147], v[104:107]
    v_mfma_f32_16x16x32_bf16 v[108:111], v[124:127], a[152:155], v[108:111]
    s_add_u32 m0, s34, 19456
    s_nop 0
    buffer_load_dwordx4 v11, s[16:19], s31 offen lds
    s_waitcnt lgkmcnt(6)
    v_mfma_f32_16x16x32_bf16 v[32:35], v[128:131], a[124:127], v[32:35]
    v_mfma_f32_16x16x32_bf16 v[36:39], v[128:131], a[132:135], v[36:39]
    buffer_load_dwordx4 a[104:107], v20, s[12:15], s33 offen offset:0
    v_mfma_f32_16x16x32_bf16 v[40:43], v[128:131], a[140:143], v[40:43]
    v_mfma_f32_16x16x32_bf16 v[44:47], v[128:131], a[148:151], v[44:47]
    buffer_load_dwordx4 a[108:111], v20, s[12:15], s33 offen offset:1024
    v_mfma_f32_16x16x32_bf16 v[48:51], v[128:131], a[156:159], v[48:51]
    s_waitcnt lgkmcnt(4)
    v_mfma_f32_16x16x32_bf16 v[52:55], v[132:135], a[124:127], v[52:55]
    s_add_u32 m0, s34, 20480
    s_nop 0
    buffer_load_dwordx4 v12, s[16:19], s31 offen lds
    v_mfma_f32_16x16x32_bf16 v[56:59], v[132:135], a[132:135], v[56:59]
    v_mfma_f32_16x16x32_bf16 v[60:63], v[132:135], a[140:143], v[60:63]
    buffer_load_dwordx4 a[112:115], v21, s[12:15], s33 offen offset:0
    v_mfma_f32_16x16x32_bf16 v[64:67], v[132:135], a[148:151], v[64:67]
    v_mfma_f32_16x16x32_bf16 v[68:71], v[132:135], a[156:159], v[68:71]
    buffer_load_dwordx4 a[116:119], v21, s[12:15], s33 offen offset:1024
    s_waitcnt lgkmcnt(2)
    v_mfma_f32_16x16x32_bf16 v[72:75], v[136:139], a[124:127], v[72:75]
    v_mfma_f32_16x16x32_bf16 v[76:79], v[136:139], a[132:135], v[76:79]
    s_add_u32 m0, s34, 21504
    s_nop 0
    buffer_load_dwordx4 v13, s[16:19], s31 offen lds
    v_mfma_f32_16x16x32_bf16 v[80:83], v[136:139], a[140:143], v[80:83]
    v_mfma_f32_16x16x32_bf16 v[84:87], v[136:139], a[148:151], v[84:87]
    s_add_u32 m0, s34, 22528
    s_nop 0
    buffer_load_dwordx4 v14, s[16:19], s31 offen lds
    v_mfma_f32_16x16x32_bf16 v[88:91], v[136:139], a[156:159], v[88:91]
    s_waitcnt lgkmcnt(0)
    v_mfma_f32_16x16x32_bf16 v[92:95], v[140:143], a[124:127], v[92:95]
    s_add_u32 m0, s34, 23552
    s_nop 0
    buffer_load_dwordx4 v15, s[16:19], s31 offen lds
    s_add_u32 s31, s31, 73728
    s_add_u32 s33, s33, 2048
    v_mfma_f32_16x16x32_bf16 v[96:99], v[140:143], a[132:135], v[96:99]
    v_mfma_f32_16x16x32_bf16 v[100:103], v[140:143], a[140:143], v[100:103]
    v_mfma_f32_16x16x32_bf16 v[104:107], v[140:143], a[148:151], v[104:107]
    v_mfma_f32_16x16x32_bf16 v[108:111], v[140:143], a[156:159], v[108:111]
    s_waitcnt vmcnt(36)
    ds_read_b64_tr_b16 v[112:113], v144 offset:0
    ds_read_b64_tr_b16 v[114:115], v144 offset:512
    ds_read_b64_tr_b16 v[116:117], v145 offset:0
    ds_read_b64_tr_b16 v[118:119], v145 offset:512
    ds_read_b64_tr_b16 v[120:121], v146 offset:0
    ds_read_b64_tr_b16 v[122:123], v146 offset:512
    ds_read_b64_tr_b16 v[124:125], v147 offset:0
    ds_read_b64_tr_b16 v[126:127], v147 offset:512
    ds_read_b64_tr_b16 v[128:129], v144 offset:4096
    ds_read_b64_tr_b16 v[130:131], v144 offset:4608
    ds_read_b64_tr_b16 v[132:133], v145 offset:4096
    ds_read_b64_tr_b16 v[134:135], v145 offset:4608
    ds_read_b64_tr_b16 v[136:137], v146 offset:4096
    ds_read_b64_tr_b16 v[138:139], v146 offset:4608
    ds_read_b64_tr_b16 v[140:141], v147 offset:4096
    ds_read_b64_tr_b16 v[142:143], v147 offset:4608
    s_waitcnt lgkmcnt(14)
    v_mfma_f32_16x16x32_bf16 v[32:35], v[112:115], a[0:3], v[32:35]
    v_mfma_f32_16x16x32_bf16 v[36:39], v[112:115], a[8:11], v[36:39]
    s_add_u32 m0, s34, 24576
    s_nop 0
    buffer_load_dwordx4 v8, s[16:19], s31 offen lds
    v_mfma_f32_16x16x32_bf16 v[40:43], v[112:115], a[16:19], v[40:43]
    v_mfma_f32_16x16x32_bf16 v[44:47], v[112:115], a[24:27], v[44:47]
    buffer_load_dwordx4 a[120:123], v17, s[12:15], s33 offen offset:0
    v_mfma_f32_16x16x32_bf16 v[48:51], v[112:115], a[32:35], v[48:51]
    s_waitcnt lgkmcnt(12)
    v_mfma_f32_16x16x32_bf16 v[52:55], v[116:119], a[0:3], v[52:55]
    buffer_load_dwordx4 a[124:127], v17, s[12:15], s33 offen offset:1024
    v_mfma_f32_16x16x32_bf16 v[56:59], v[116:119], a[8:11], v[56:59]
    v_mfma_f32_16x16x32_bf16 v[60:63], v[116:119], a[16:19], v[60:63]
    s_add_u32 m0, s34, 25600
    s_nop 0
    buffer_load_dwordx4 v9, s[16:19], s31 offen lds
    v_mfma_f32_16x16x32_bf16 v[64:67], v[116:119], a[24:27], v[64:67]
    v_mfma_f32_16x16x32_bf16 v[68:71], v[116:119], a[32:35], v[68:71]
    buffer_load_dwordx4 a[128:131], v18, s[12:15], s33 offen offset:0
    s_waitcnt lgkmcnt(10)
    v_mfma_f32_16x16x32_bf16 v[72:75], v[120:123], a[0:3], v[72:75]
    v_mfma_f32_16x16x32_bf16 v[76:79], v[120:123], a[8:11], v[76:79]
    buffer_load_dwordx4 a[132:135], v18, s[12:15], s33 offen offset:1024
    v_mfma_f32_16x16x32_bf16 v[80:83], v[120:123], a[16:19], v[80:83]
    v_mfma_f32_16x16x32_bf16 v[84:87], v[120:123], a[24:27], v[84:87]
    s_add_u32 m0, s34, 26624
    s_nop 0
    buffer_load_dwordx4 v10, s[16:19], s31 offen lds
    v_mfma_f32_16x16x32_bf16 v[88:91], v[120:123], a[32:35], v[88:91]
    s_waitcnt lgkmcnt(8)
    v_mfma_f32_16x16x32_bf16 v[92:95], v[124:127], a[0:3], v[92:95]
    buffer_load_dwordx4 a[136:139], v19, s[12:15], s33 offen offset:0
    v_mfma_f32_16x16x32_bf16 v[96:99], v[124:127], a[8:11], v[96:99]
    v_mfma_f32_16x16x32_bf16 v[100:103], v[124:127], a[16:19], v[100:103]
    buffer_load_dwordx4 a[140:143], v19, s[12:15], s33 offen offset:1024
    v_mfma_f32_16x16x32_bf16 v[104:107], v[124:127], a[24:27], v[104:107]
    v_mfma_f32_16x16x32_bf16 v[108:111], v[124:127], a[32:35], v[108:111]
    s_add_u32 m0, s34, 27648
    s_nop 0
    buffer_load_dwordx4 v11, s[16:19], s31 offen lds
    s_waitcnt lgkmcnt(6)
    v_mfma_f32_16x16x32_bf16 v[32:35], v[128:131], a[4:7], v[32:35]
    v_mfma_f32_16x16x32_bf16 v[36:39], v[128:131], a[12:15], v[36:39]
    buffer_load_dwordx4 a[144:147], v20, s[12:15], s33 offen offset:0
    v_mfma_f32_16x16x32_bf16 v[40:43], v[128:131], a[20:23], v[40:43]
    v_mfma_f32_16x16x32_bf16 v[44:47], v[128:131], a[28:31], v[44:47]
    buffer_load_dwordx4 a[148:151], v20, s[12:15], s33 offen offset:1024
    v_mfma_f32_16x16x32_bf16 v[48:51], v[128:131], a[36:39], v[48:51]
    s_waitcnt lgkmcnt(4)
    v_mfma_f32_16x16x32_bf16 v[52:55], v[132:135], a[4:7], v[52:55]
    s_add_u32 m0, s34, 28672
    s_nop 0
    buffer_load_dwordx4 v12, s[16:19], s31 offen lds
    v_mfma_f32_16x16x32_bf16 v[56:59], v[132:135], a[12:15], v[56:59]
    v_mfma_f32_16x16x32_bf16 v[60:63], v[132:135], a[20:23], v[60:63]
    buffer_load_dwordx4 a[152:155], v21, s[12:15], s33 offen offset:0
    v_mfma_f32_16x16x32_bf16 v[64:67], v[132:135], a[28:31], v[64:67]
    v_mfma_f32_16x16x32_bf16 v[68:71], v[132:135], a[36:39], v[68:71]
    buffer_load_dwordx4 a[156:159], v21, s[12:15], s33 offen offset:1024
    s_waitcnt lgkmcnt(2)
    v_mfma_f32_16x16x32_bf16 v[72:75], v[136:139], a[4:7], v[72:75]
    v_mfma_f32_16x16x32_bf16 v[76:79], v[136:139], a[12:15], v[76:79]
    s_add_u32 m0, s34, 29696
    s_nop 0
    buffer_load_dwordx4 v13, s[16:19], s31 offen lds
    v_mfma_f32_16x16x32_bf16 v[80:83], v[136:139], a[20:23], v[80:83]
    v_mfma_f32_16x16x32_bf16 v[84:87], v[136:139], a[28:31], v[84:87]
    s_add_u32 m0, s34, 30720
    s_nop 0
    buffer_load_dwordx4 v14, s[16:19], s31 offen lds
    v_mfma_f32_16x16x32_bf16 v[88:91], v[136:139], a[36:39], v[88:91]
    s_waitcnt lgkmcnt(0)
    v_mfma_f32_16x16x32_bf16 v[92:95], v[140:143], a[4:7], v[92:95]
    s_add_u32 m0, s34, 31744
    s_nop 0
    buffer_load_dwordx4 v15, s[16:19], s31 offen lds
    s_add_u32 s31, s31, 73728
    s_add_u32 s33, s33, 2048
    v_mfma_f32_16x16x32_bf16 v[96:99], v[140:143], a[12:15], v[96:99]
    v_mfma_f32_16x16x32_bf16 v[100:103], v[140:143], a[20:23], v[100:103]
    v_mfma_f32_16x16x32_bf16 v[104:107], v[140:143], a[28:31], v[104:107]
    v_mfma_f32_16x16x32_bf16 v[108:111], v[140:143], a[36:39], v[108:111]
    s_waitcnt vmcnt(36)
    ds_read_b64_tr_b16 v[112:113], v144 offset:8192
    ds_read_b64_tr_b16 v[114:115], v144 offset:8704
    ds_read_b64_tr_b16 v[116:117], v145 offset:8192
    ds_read_b64_tr_b16 v[118:119], v145 offset:8704
    ds_read_b64_tr_b16 v[120:121], v146 offset:8192
    ds_read_b64_tr_b16 v[122:123], v146 offset:8704
    ds_read_b64_tr_b16 v[124:125], v147 offset:8192
    ds_read_b64_tr_b16 v[126:127], v147 offset:8704
    ds_read_b64_tr_b16 v[128:129], v144 offset:12288
    ds_read_b64_tr_b16 v[130:131], v144 offset:12800
    ds_read_b64_tr_b16 v[132:133], v145 offset:12288
    ds_read_b64_tr_b16 v[134:135], v145 offset:12800
    ds_read_b64_tr_b16 v[136:137], v146 offset:12288
    ds_read_b64_tr_b16 v[138:139], v146 offset:12800
    ds_read_b64_tr_b16 v[140:141], v147 offset:12288
    ds_read_b64_tr_b16 v[142:143], v147 offset:12800
    s_waitcnt lgkmcnt(14)
    v_mfma_f32_16x16x32_bf16 v[32:35], v[112:115], a[40:43], v[32:35]
    v_mfma_f32_16x16x32_bf16 v[36:39], v[112:115], a[48:51], v[36:39]
    s_add_u32 m0, s34, 0
    s_nop 0
    buffer_load_dwordx4 v8, s[16:19], s31 offen lds
    v_mfma_f32_16x16x32_bf16 v[40:43], v[112:115], a[56:59], v[40:43]
    v_mfma_f32_16x16x32_bf16 v[44:47], v[112:115], a[64:67], v[44:47]
    buffer_load_dwordx4 a[0:3], v17, s[12:15], s33 offen offset:0
    v_mfma_f32_16x16x32_bf16 v[48:51], v[112:115], a[72:75], v[48:51]
    s_waitcnt lgkmcnt(12)
    v_mfma_f32_16x16x32_bf16 v[52:55], v[116:119], a[40:43], v[52:55]
    buffer_load_dwordx4 a[4:7], v17, s[12:15], s33 offen offset:1024
    v_mfma_f32_16x16x32_bf16 v[56:59], v[116:119], a[48:51], v[56:59]
    v_mfma_f32_16x16x32_bf16 v[60:63], v[116:119], a[56:59], v[60:63]
    s_add_u32 m0, s34, 1024
    s_nop 0
    buffer_load_dwordx4 v9, s[16:19], s31 offen lds
    v_mfma_f32_16x16x32_bf16 v[64:67], v[116:119], a[64:67], v[64:67]
    v_mfma_f32_16x16x32_bf16 v[68:71], v[116:119], a[72:75], v[68:71]
    buffer_load_dwordx4 a[8:11], v18, s[12:15], s33 offen offset:0
    s_waitcnt lgkmcnt(10)
    v_mfma_f32_16x16x32_bf16 v[72:75], v[120:123], a[40:43], v[72:75]
    v_mfma_f32_16x16x32_bf16 v[76:79], v[120:123], a[48:51], v[76:79]
    buffer_load_dwordx4 a[12:15], v18, s[12:15], s33 offen offset:1024
    v_mfma_f32_16x16x32_bf16 v[80:83], v[120:123], a[56:59], v[80:83]
    v_mfma_f32_16x16x32_bf16 v[84:87], v[120:123], a[64:67], v[84:87]
    s_add_u32 m0, s34, 2048
    s_nop 0
    buffer_load_dwordx4 v10, s[16:19], s31 offen lds
    v_mfma_f32_16x16x32_bf16 v[88:91], v[120:123], a[72:75], v[88:91]
    s_waitcnt lgkmcnt(8)
    v_mfma_f32_16x16x32_bf16 v[92:95], v[124:127], a[40:43], v[92:95]
    buffer_load_dwordx4 a[16:19], v19, s[12:15], s33 offen offset:0
    v_mfma_f32_16x16x32_bf16 v[96:99], v[124:127], a[48:51], v[96:99]
    v_mfma_f32_16x16x32_bf16 v[100:103], v[124:127], a[56:59], v[100:103]
    buffer_load_dwordx4 a[20:23], v19, s[12:15], s33 offen offset:1024
    v_mfma_f32_16x16x32_bf16 v[104:107], v[124:127], a[64:67], v[104:107]
    v_mfma_f32_16x16x32_bf16 v[108:111], v[124:127], a[72:75], v[108:111]
    s_add_u32 m0, s34, 3072
    s_nop 0
    buffer_load_dwordx4 v11, s[16:19], s31 offen lds
    s_waitcnt lgkmcnt(6)
    v_mfma_f32_16x16x32_bf16 v[32:35], v[128:131], a[44:47], v[32:35]
    v_mfma_f32_16x16x32_bf16 v[36:39], v[128:131], a[52:55], v[36:39]
    buffer_load_dwordx4 a[24:27], v20, s[12:15], s33 offen offset:0
    v_mfma_f32_16x16x32_bf16 v[40:43], v[128:131], a[60:63], v[40:43]
    v_mfma_f32_16x16x32_bf16 v[44:47], v[128:131], a[68:71], v[44:47]
    buffer_load_dwordx4 a[28:31], v20, s[12:15], s33 offen offset:1024
    v_mfma_f32_16x16x32_bf16 v[48:51], v[128:131], a[76:79], v[48:51]
    s_waitcnt lgkmcnt(4)
    v_mfma_f32_16x16x32_bf16 v[52:55], v[132:135], a[44:47], v[52:55]
    s_add_u32 m0, s34, 4096
    s_nop 0
    buffer_load_dwordx4 v12, s[16:19], s31 offen lds
    v_mfma_f32_16x16x32_bf16 v[56:59], v[132:135], a[52:55], v[56:59]
    v_mfma_f32_16x16x32_bf16 v[60:63], v[132:135], a[60:63], v[60:63]
    buffer_load_dwordx4 a[32:35], v21, s[12:15], s33 offen offset:0
    v_mfma_f32_16x16x32_bf16 v[64:67], v[132:135], a[68:71], v[64:67]
    v_mfma_f32_16x16x32_bf16 v[68:71], v[132:135], a[76:79], v[68:71]
    buffer_load_dwordx4 a[36:39], v21, s[12:15], s33 offen offset:1024
    s_waitcnt lgkmcnt(2)
    v_mfma_f32_16x16x32_bf16 v[72:75], v[136:139], a[44:47], v[72:75]
    v_mfma_f32_16x16x32_bf16 v[76:79], v[136:139], a[52:55], v[76:79]
    s_add_u32 m0, s34, 5120
    s_nop 0
    buffer_load_dwordx4 v13, s[16:19], s31 offen lds
    v_mfma_f32_16x16x32_bf16 v[80:83], v[136:139], a[60:63], v[80:83]
    v_mfma_f32_16x16x32_bf16 v[84:87], v[136:139], a[68:71], v[84:87]
    s_add_u32 m0, s34, 6144
    s_nop 0
    buffer_load_dwordx4 v14, s[16:19], s31 offen lds
    v_mfma_f32_16x16x32_bf16 v[88:91], v[136:139], a[76:79], v[88:91]
    s_waitcnt lgkmcnt(0)
    v_mfma_f32_16x16x32_bf16 v[92:95], v[140:143], a[44:47], v[92:95]
    s_add_u32 m0, s34, 7168
    s_nop 0
    buffer_load_dwordx4 v15, s[16:19], s31 offen lds
    s_add_u32 s31, s31, 73728
    s_add_u32 s33, s33, 2048
    v_mfma_f32_16x16x32_bf16 v[96:99], v[140:143], a[52:55], v[96:99]
    v_mfma_f32_16x16x32_bf16 v[100:103], v[140:143], a[60:63], v[100:103]
    v_mfma_f32_16x16x32_bf16 v[104:107], v[140:143], a[68:71], v[104:107]
    v_mfma_f32_16x16x32_bf16 v[108:111], v[140:143], a[76:79], v[108:111]
    s_waitcnt vmcnt(36)
    ds_read_b64_tr_b16 v[112:113], v144 offset:16384
    ds_read_b64_tr_b16 v[114:115], v144 offset:16896
    ds_read_b64_tr_b16 v[116:117], v145 offset:16384
    ds_read_b64_tr_b16 v[118:119], v145 offset:16896
    ds_read_b64_tr_b16 v[120:121], v146 offset:16384
    ds_read_b64_tr_b16 v[122:123], v146 offset:16896
    ds_read_b64_tr_b16 v[124:125], v147 offset:16384
    ds_read_b64_tr_b16 v[126:127], v147 offset:16896
    ds_read_b64_tr_b16 v[128:129], v144 offset:20480
    ds_read_b64_tr_b16 v[130:131], v144 offset:20992
    ds_read_b64_tr_b16 v[132:133], v145 offset:20480
    ds_read_b64_tr_b16 v[134:135], v145 offset:20992
    ds_read_b64_tr_b16 v[136:137], v146 offset:20480
    ds_read_b64_tr_b16 v[138:139], v146 offset:20992
    ds_read_b64_tr_b16 v[140:141], v147 offset:20480
    ds_read_b64_tr_b16 v[142:143], v147 offset:20992
    s_waitcnt lgkmcnt(14)
    v_mfma_f32_16x16x32_bf16 v[32:35], v[112:115], a[80:83], v[32:35]
    v_mfma_f32_16x16x32_bf16 v[36:39], v[112:115], a[88:91], v[36:39]
    s_add_u32 m0, s34, 8192
    s_nop 0
    buffer_load_dwordx4 v8, s[16:19], s31 offen lds
    v_mfma_f32_16x16x32_bf16 v[40:43], v[112:115], a[96:99], v[40:43]
    v_mfma_f32_16x16x32_bf16 v[44:47], v[112:115], a[104:107], v[44:47]
    buffer_load_dwordx4 a[40:43], v17, s[12:15], s33 offen offset:0
    v_mfma_f32_16x16x32_bf16 v[48:51], v[112:115], a[112:115], v[48:51]
    s_waitcnt lgkmcnt(12)
    v_mfma_f32_16x16x32_bf16 v[52:55], v[116:119], a[80:83], v[52:55]
    buffer_load_dwordx4 a[44:47], v17, s[12:15], s33 offen offset:1024
    v_mfma_f32_16x16x32_bf16 v[56:59], v[116:119], a[88:91], v[56:59]
    v_mfma_f32_16x16x32_bf16 v[60:63], v[116:119], a[96:99], v[60:63]
    s_add_u32 m0, s34, 9216
    s_nop 0
    buffer_load_dwordx4 v9, s[16:19], s31 offen lds
    v_mfma_f32_16x16x32_bf16 v[64:67], v[116:119], a[104:107], v[64:67]
    v_mfma_f32_16x16x32_bf16 v[68:71], v[116:119], a[112:115], v[68:71]
    buffer_load_dwordx4 a[48:51], v18, s[12:15], s33 offen offset:0
    s_waitcnt lgkmcnt(10)
    v_mfma_f32_16x16x32_bf16 v[72:75], v[120:123], a[80:83], v[72:75]
    v_mfma_f32_16x16x32_bf16 v[76:79], v[120:123], a[88:91], v[76:79]
    buffer_load_dwordx4 a[52:55], v18, s[12:15], s33 offen offset:1024
    v_mfma_f32_16x16x32_bf16 v[80:83], v[120:123], a[96:99], v[80:83]
    v_mfma_f32_16x16x32_bf16 v[84:87], v[120:123], a[104:107], v[84:87]
    s_add_u32 m0, s34, 10240
    s_nop 0
    buffer_load_dwordx4 v10, s[16:19], s31 offen lds
    v_mfma_f32_16x16x32_bf16 v[88:91], v[120:123], a[112:115], v[88:91]
    s_waitcnt lgkmcnt(8)
    v_mfma_f32_16x16x32_bf16 v[92:95], v[124:127], a[80:83], v[92:95]
    buffer_load_dwordx4 a[56:59], v19, s[12:15], s33 offen offset:0
    v_mfma_f32_16x16x32_bf16 v[96:99], v[124:127], a[88:91], v[96:99]
    v_mfma_f32_16x16x32_bf16 v[100:103], v[124:127], a[96:99], v[100:103]
    buffer_load_dwordx4 a[60:63], v19, s[12:15], s33 offen offset:1024
    v_mfma_f32_16x16x32_bf16 v[104:107], v[124:127], a[104:107], v[104:107]
    v_mfma_f32_16x16x32_bf16 v[108:111], v[124:127], a[112:115], v[108:111]
    s_add_u32 m0, s34, 11264
    s_nop 0
    buffer_load_dwordx4 v11, s[16:19], s31 offen lds
    s_waitcnt lgkmcnt(6)
    v_mfma_f32_16x16x32_bf16 v[32:35], v[128:131], a[84:87], v[32:35]
    v_mfma_f32_16x16x32_bf16 v[36:39], v[128:131], a[92:95], v[36:39]
    buffer_load_dwordx4 a[64:67], v20, s[12:15], s33 offen offset:0
    v_mfma_f32_16x16x32_bf16 v[40:43], v[128:131], a[100:103], v[40:43]
    v_mfma_f32_16x16x32_bf16 v[44:47], v[128:131], a[108:111], v[44:47]
    buffer_load_dwordx4 a[68:71], v20, s[12:15], s33 offen offset:1024
    v_mfma_f32_16x16x32_bf16 v[48:51], v[128:131], a[116:119], v[48:51]
    s_waitcnt lgkmcnt(4)
    v_mfma_f32_16x16x32_bf16 v[52:55], v[132:135], a[84:87], v[52:55]
    s_add_u32 m0, s34, 12288
    s_nop 0
    buffer_load_dwordx4 v12, s[16:19], s31 offen lds
    v_mfma_f32_16x16x32_bf16 v[56:59], v[132:135], a[92:95], v[56:59]
    v_mfma_f32_16x16x32_bf16 v[60:63], v[132:135], a[100:103], v[60:63]
    buffer_load_dwordx4 a[72:75], v21, s[12:15], s33 offen offset:0
    v_mfma_f32_16x16x32_bf16 v[64:67], v[132:135], a[108:111], v[64:67]
    v_mfma_f32_16x16x32_bf16 v[68:71], v[132:135], a[116:119], v[68:71]
    buffer_load_dwordx4 a[76:79], v21, s[12:15], s33 offen offset:1024
    s_waitcnt lgkmcnt(2)
    v_mfma_f32_16x16x32_bf16 v[72:75], v[136:139], a[84:87], v[72:75]
    v_mfma_f32_16x16x32_bf16 v[76:79], v[136:139], a[92:95], v[76:79]
    s_add_u32 m0, s34, 13312
    s_nop 0
    buffer_load_dwordx4 v13, s[16:19], s31 offen lds
    v_mfma_f32_16x16x32_bf16 v[80:83], v[136:139], a[100:103], v[80:83]
    v_mfma_f32_16x16x32_bf16 v[84:87], v[136:139], a[108:111], v[84:87]
    s_add_u32 m0, s34, 14336
    s_nop 0
    buffer_load_dwordx4 v14, s[16:19], s31 offen lds
    v_mfma_f32_16x16x32_bf16 v[88:91], v[136:139], a[116:119], v[88:91]
    s_waitcnt lgkmcnt(0)
    v_mfma_f32_16x16x32_bf16 v[92:95], v[140:143], a[84:87], v[92:95]
    s_add_u32 m0, s34, 15360
    s_nop 0
    buffer_load_dwordx4 v15, s[16:19], s31 offen lds
    s_add_u32 s31, s31, 73728
    s_add_u32 s33, s33, 2048
    v_mfma_f32_16x16x32_bf16 v[96:99], v[140:143], a[92:95], v[96:99]
    v_mfma_f32_16x16x32_bf16 v[100:103], v[140:143], a[100:103], v[100:103]
    v_mfma_f32_16x16x32_bf16 v[104:107], v[140:143], a[108:111], v[104:107]
    v_mfma_f32_16x16x32_bf16 v[108:111], v[140:143], a[116:119], v[108:111]
    s_waitcnt vmcnt(36)
    ds_read_b64_tr_b16 v[112:113], v144 offset:24576
    ds_read_b64_tr_b16 v[114:115], v144 offset:25088
    ds_read_b64_tr_b16 v[116:117], v145 offset:24576
    ds_read_b64_tr_b16 v[118:119], v145 offset:25088
    ds_read_b64_tr_b16 v[120:121], v146 offset:24576
    ds_read_b64_tr_b16 v[122:123], v146 offset:25088
    ds_read_b64_tr_b16 v[124:125], v147 offset:24576
    ds_read_b64_tr_b16 v[126:127], v147 offset:25088
    ds_read_b64_tr_b16 v[128:129], v144 offset:28672
    ds_read_b64_tr_b16 v[130:131], v144 offset:29184
    ds_read_b64_tr_b16 v[132:133], v145 offset:28672
    ds_read_b64_tr_b16 v[134:135], v145 offset:29184
    ds_read_b64_tr_b16 v[136:137], v146 offset:28672
    ds_read_b64_tr_b16 v[138:139], v146 offset:29184
    ds_read_b64_tr_b16 v[140:141], v147 offset:28672
    ds_read_b64_tr_b16 v[142:143], v147 offset:29184
    s_waitcnt lgkmcnt(14)
    v_mfma_f32_16x16x32_bf16 v[32:35], v[112:115], a[120:123], v[32:35]
    v_mfma_f32_16x16x32_bf16 v[36:39], v[112:115], a[128:131], v[36:39]
    s_add_u32 m0, s34, 16384
    s_nop 0
    buffer_load_dwordx4 v8, s[16:19], s31 offen lds
    v_mfma_f32_16x16x32_bf16 v[40:43], v[112:115], a[136:139], v[40:43]
    v_mfma_f32_16x16x32_bf16 v[44:47], v[112:115], a[144:147], v[44:47]
    buffer_load_dwordx4 a[80:83], v17, s[12:15], s33 offen offset:0
    v_mfma_f32_16x16x32_bf16 v[48:51], v[112:115], a[152:155], v[48:51]
    s_waitcnt lgkmcnt(12)
    v_mfma_f32_16x16x32_bf16 v[52:55], v[116:119], a[120:123], v[52:55]
    buffer_load_dwordx4 a[84:87], v17, s[12:15], s33 offen offset:1024
    v_mfma_f32_16x16x32_bf16 v[56:59], v[116:119], a[128:131], v[56:59]
    v_mfma_f32_16x16x32_bf16 v[60:63], v[116:119], a[136:139], v[60:63]
    s_add_u32 m0, s34, 17408
    s_nop 0
    buffer_load_dwordx4 v9, s[16:19], s31 offen lds
    v_mfma_f32_16x16x32_bf16 v[64:67], v[116:119], a[144:147], v[64:67]
    v_mfma_f32_16x16x32_bf16 v[68:71], v[116:119], a[152:155], v[68:71]
    buffer_load_dwordx4 a[88:91], v18, s[12:15], s33 offen offset:0
    s_waitcnt lgkmcnt(10)
    v_mfma_f32_16x16x32_bf16 v[72:75], v[120:123], a[120:123], v[72:75]
    v_mfma_f32_16x16x32_bf16 v[76:79], v[120:123], a[128:131], v[76:79]
    buffer_load_dwordx4 a[92:95], v18, s[12:15], s33 offen offset:1024
    v_mfma_f32_16x16x32_bf16 v[80:83], v[120:123], a[136:139], v[80:83]
    v_mfma_f32_16x16x32_bf16 v[84:87], v[120:123], a[144:147], v[84:87]
    s_add_u32 m0, s34, 18432
    s_nop 0
    buffer_load_dwordx4 v10, s[16:19], s31 offen lds
    v_mfma_f32_16x16x32_bf16 v[88:91], v[120:123], a[152:155], v[88:91]
    s_waitcnt lgkmcnt(8)
    v_mfma_f32_16x16x32_bf16 v[92:95], v[124:127], a[120:123], v[92:95]
    buffer_load_dwordx4 a[96:99], v19, s[12:15], s33 offen offset:0
    v_mfma_f32_16x16x32_bf16 v[96:99], v[124:127], a[128:131], v[96:99]
    v_mfma_f32_16x16x32_bf16 v[100:103], v[124:127], a[136:139], v[100:103]
    buffer_load_dwordx4 a[100:103], v19, s[12:15], s33 offen offset:1024
    v_mfma_f32_16x16x32_bf16 v[104:107], v[124:127], a[144:147], v[104:107]
    v_mfma_f32_16x16x32_bf16 v[108:111], v[124:127], a[152:155], v[108:111]
    s_add_u32 m0, s34, 19456
    s_nop 0
    buffer_load_dwordx4 v11, s[16:19], s31 offen lds
    s_waitcnt lgkmcnt(6)
    v_mfma_f32_16x16x32_bf16 v[32:35], v[128:131], a[124:127], v[32:35]
    v_mfma_f32_16x16x32_bf16 v[36:39], v[128:131], a[132:135], v[36:39]
    buffer_load_dwordx4 a[104:107], v20, s[12:15], s33 offen offset:0
    v_mfma_f32_16x16x32_bf16 v[40:43], v[128:131], a[140:143], v[40:43]
    v_mfma_f32_16x16x32_bf16 v[44:47], v[128:131], a[148:151], v[44:47]
    buffer_load_dwordx4 a[108:111], v20, s[12:15], s33 offen offset:1024
    v_mfma_f32_16x16x32_bf16 v[48:51], v[128:131], a[156:159], v[48:51]
    s_waitcnt lgkmcnt(4)
    v_mfma_f32_16x16x32_bf16 v[52:55], v[132:135], a[124:127], v[52:55]
    s_add_u32 m0, s34, 20480
    s_nop 0
    buffer_load_dwordx4 v12, s[16:19], s31 offen lds
    v_mfma_f32_16x16x32_bf16 v[56:59], v[132:135], a[132:135], v[56:59]
    v_mfma_f32_16x16x32_bf16 v[60:63], v[132:135], a[140:143], v[60:63]
    buffer_load_dwordx4 a[112:115], v21, s[12:15], s33 offen offset:0
    v_mfma_f32_16x16x32_bf16 v[64:67], v[132:135], a[148:151], v[64:67]
    v_mfma_f32_16x16x32_bf16 v[68:71], v[132:135], a[156:159], v[68:71]
    buffer_load_dwordx4 a[116:119], v21, s[12:15], s33 offen offset:1024
    s_waitcnt lgkmcnt(2)
    v_mfma_f32_16x16x32_bf16 v[72:75], v[136:139], a[124:127], v[72:75]
    v_mfma_f32_16x16x32_bf16 v[76:79], v[136:139], a[132:135], v[76:79]
    s_add_u32 m0, s34, 21504
    s_nop 0
    buffer_load_dwordx4 v13, s[16:19], s31 offen lds
    v_mfma_f32_16x16x32_bf16 v[80:83], v[136:139], a[140:143], v[80:83]
    v_mfma_f32_16x16x32_bf16 v[84:87], v[136:139], a[148:151], v[84:87]
    s_add_u32 m0, s34, 22528
    s_nop 0
    buffer_load_dwordx4 v14, s[16:19], s31 offen lds
    v_mfma_f32_16x16x32_bf16 v[88:91], v[136:139], a[156:159], v[88:91]
    s_waitcnt lgkmcnt(0)
    v_mfma_f32_16x16x32_bf16 v[92:95], v[140:143], a[124:127], v[92:95]
    s_add_u32 m0, s34, 23552
    s_nop 0
    buffer_load_dwordx4 v15, s[16:19], s31 offen lds
    s_add_u32 s31, s31, 73728
    s_add_u32 s33, s33, 2048
    v_mfma_f32_16x16x32_bf16 v[96:99], v[140:143], a[132:135], v[96:99]
    v_mfma_f32_16x16x32_bf16 v[100:103], v[140:143], a[140:143], v[100:103]
    v_mfma_f32_16x16x32_bf16 v[104:107], v[140:143], a[148:151], v[104:107]
    v_mfma_f32_16x16x32_bf16 v[108:111], v[140:143], a[156:159], v[108:111]
    s_waitcnt vmcnt(36)
    ds_read_b64_tr_b16 v[112:113], v144 offset:0
    ds_read_b64_tr_b16 v[114:115], v144 offset:512
    ds_read_b64_tr_b16 v[116:117], v145 offset:0
    ds_read_b64_tr_b16 v[118:119], v145 offset:512
    ds_read_b64_tr_b16 v[120:121], v146 offset:0
    ds_read_b64_tr_b16 v[122:123], v146 offset:512
    ds_read_b64_tr_b16 v[124:125], v147 offset:0
    ds_read_b64_tr_b16 v[126:127], v147 offset:512
    ds_read_b64_tr_b16 v[128:129], v144 offset:4096
    ds_read_b64_tr_b16 v[130:131], v144 offset:4608
    ds_read_b64_tr_b16 v[132:133], v145 offset:4096
    ds_read_b64_tr_b16 v[134:135], v145 offset:4608
    ds_read_b64_tr_b16 v[136:137], v146 offset:4096
    ds_read_b64_tr_b16 v[138:139], v146 offset:4608
    ds_read_b64_tr_b16 v[140:141], v147 offset:4096
    ds_read_b64_tr_b16 v[142:143], v147 offset:4608
    s_waitcnt lgkmcnt(14)
    v_mfma_f32_16x16x32_bf16 v[32:35], v[112:115], a[0:3], v[32:35]
    v_mfma_f32_16x16x32_bf16 v[36:39], v[112:115], a[8:11], v[36:39]
    s_add_u32 m0, s34, 24576
    s_nop 0
    buffer_load_dwordx4 v8, s[16:19], s31 offen lds
    v_mfma_f32_16x16x32_bf16 v[40:43], v[112:115], a[16:19], v[40:43]
    v_mfma_f32_16x16x32_bf16 v[44:47], v[112:115], a[24:27], v[44:47]
    buffer_load_dwordx4 a[120:123], v17, s[12:15], s33 offen offset:0
    v_mfma_f32_16x16x32_bf16 v[48:51], v[112:115], a[32:35], v[48:51]
    s_waitcnt lgkmcnt(12)
    v_mfma_f32_16x16x32_bf16 v[52:55], v[116:119], a[0:3], v[52:55]
    buffer_load_dwordx4 a[124:127], v17, s[12:15], s33 offen offset:1024
    v_mfma_f32_16x16x32_bf16 v[56:59], v[116:119], a[8:11], v[56:59]
    v_mfma_f32_16x16x32_bf16 v[60:63], v[116:119], a[16:19], v[60:63]
    s_add_u32 m0, s34, 25600
    s_nop 0
    buffer_load_dwordx4 v9, s[16:19], s31 offen lds
    v_mfma_f32_16x16x32_bf16 v[64:67], v[116:119], a[24:27], v[64:67]
    v_mfma_f32_16x16x32_bf16 v[68:71], v[116:119], a[32:35], v[68:71]
    buffer_load_dwordx4 a[128:131], v18, s[12:15], s33 offen offset:0
    s_waitcnt lgkmcnt(10)
    v_mfma_f32_16x16x32_bf16 v[72:75], v[120:123], a[0:3], v[72:75]
    v_mfma_f32_16x16x32_bf16 v[76:79], v[120:123], a[8:11], v[76:79]
    buffer_load_dwordx4 a[132:135], v18, s[12:15], s33 offen offset:1024
    v_mfma_f32_16x16x32_bf16 v[80:83], v[120:123], a[16:19], v[80:83]
    v_mfma_f32_16x16x32_bf16 v[84:87], v[120:123], a[24:27], v[84:87]
    s_add_u32 m0, s34, 26624
    s_nop 0
    buffer_load_dwordx4 v10, s[16:19], s31 offen lds
    v_mfma_f32_16x16x32_bf16 v[88:91], v[120:123], a[32:35], v[88:91]
    s_waitcnt lgkmcnt(8)
    v_mfma_f32_16x16x32_bf16 v[92:95], v[124:127], a[0:3], v[92:95]
    buffer_load_dwordx4 a[136:139], v19, s[12:15], s33 offen offset:0
    v_mfma_f32_16x16x32_bf16 v[96:99], v[124:127], a[8:11], v[96:99]
    v_mfma_f32_16x16x32_bf16 v[100:103], v[124:127], a[16:19], v[100:103]
    buffer_load_dwordx4 a[140:143], v19, s[12:15], s33 offen offset:1024
    v_mfma_f32_16x16x32_bf16 v[104:107], v[124:127], a[24:27], v[104:107]
    v_mfma_f32_16x16x32_bf16 v[108:111], v[124:127], a[32:35], v[108:111]
    s_add_u32 m0, s34, 27648
    s_nop 0
    buffer_load_dwordx4 v11, s[16:19], s31 offen lds
    s_waitcnt lgkmcnt(6)
    v_mfma_f32_16x16x32_bf16 v[32:35], v[128:131], a[4:7], v[32:35]
    v_mfma_f32_16x16x32_bf16 v[36:39], v[128:131], a[12:15], v[36:39]
    buffer_load_dwordx4 a[144:147], v20, s[12:15], s33 offen offset:0
    v_mfma_f32_16x16x32_bf16 v[40:43], v[128:131], a[20:23], v[40:43]
    v_mfma_f32_16x16x32_bf16 v[44:47], v[128:131], a[28:31], v[44:47]
    buffer_load_dwordx4 a[148:151], v20, s[12:15], s33 offen offset:1024
    v_mfma_f32_16x16x32_bf16 v[48:51], v[128:131], a[36:39], v[48:51]
    s_waitcnt lgkmcnt(4)
    v_mfma_f32_16x16x32_bf16 v[52:55], v[132:135], a[4:7], v[52:55]
    s_add_u32 m0, s34, 28672
    s_nop 0
    buffer_load_dwordx4 v12, s[16:19], s31 offen lds
    v_mfma_f32_16x16x32_bf16 v[56:59], v[132:135], a[12:15], v[56:59]
    v_mfma_f32_16x16x32_bf16 v[60:63], v[132:135], a[20:23], v[60:63]
    buffer_load_dwordx4 a[152:155], v21, s[12:15], s33 offen offset:0
    v_mfma_f32_16x16x32_bf16 v[64:67], v[132:135], a[28:31], v[64:67]
    v_mfma_f32_16x16x32_bf16 v[68:71], v[132:135], a[36:39], v[68:71]
    buffer_load_dwordx4 a[156:159], v21, s[12:15], s33 offen offset:1024
    s_waitcnt lgkmcnt(2)
    v_mfma_f32_16x16x32_bf16 v[72:75], v[136:139], a[4:7], v[72:75]
    v_mfma_f32_16x16x32_bf16 v[76:79], v[136:139], a[12:15], v[76:79]
    s_add_u32 m0, s34, 29696
    s_nop 0
    buffer_load_dwordx4 v13, s[16:19], s31 offen lds
    v_mfma_f32_16x16x32_bf16 v[80:83], v[136:139], a[20:23], v[80:83]
    v_mfma_f32_16x16x32_bf16 v[84:87], v[136:139], a[28:31], v[84:87]
    s_add_u32 m0, s34, 30720
    s_nop 0
    buffer_load_dwordx4 v14, s[16:19], s31 offen lds
    v_mfma_f32_16x16x32_bf16 v[88:91], v[136:139], a[36:39], v[88:91]
    s_waitcnt lgkmcnt(0)
    v_mfma_f32_16x16x32_bf16 v[92:95], v[140:143], a[4:7], v[92:95]
    s_add_u32 m0, s34, 31744
    s_nop 0
    buffer_load_dwordx4 v15, s[16:19], s31 offen lds
    s_add_u32 s31, s31, 73728
    s_add_u32 s33, s33, 2048
    v_mfma_f32_16x16x32_bf16 v[96:99], v[140:143], a[12:15], v[96:99]
    v_mfma_f32_16x16x32_bf16 v[100:103], v[140:143], a[20:23], v[100:103]
    v_mfma_f32_16x16x32_bf16 v[104:107], v[140:143], a[28:31], v[104:107]
    v_mfma_f32_16x16x32_bf16 v[108:111], v[140:143], a[36:39], v[108:111]
    s_waitcnt vmcnt(36)
    ds_read_b64_tr_b16 v[112:113], v144 offset:8192
    ds_read_b64_tr_b16 v[114:115], v144 offset:8704
    ds_read_b64_tr_b16 v[116:117], v145 offset:8192
    ds_read_b64_tr_b16 v[118:119], v145 offset:8704
    ds_read_b64_tr_b16 v[120:121], v146 offset:8192
    ds_read_b64_tr_b16 v[122:123], v146 offset:8704
    ds_read_b64_tr_b16 v[124:125], v147 offset:8192
    ds_read_b64_tr_b16 v[126:127], v147 offset:8704
    ds_read_b64_tr_b16 v[128:129], v144 offset:12288
    ds_read_b64_tr_b16 v[130:131], v144 offset:12800
    ds_read_b64_tr_b16 v[132:133], v145 offset:12288
    ds_read_b64_tr_b16 v[134:135], v145 offset:12800
    ds_read_b64_tr_b16 v[136:137], v146 offset:12288
    ds_read_b64_tr_b16 v[138:139], v146 offset:12800
    ds_read_b64_tr_b16 v[140:141], v147 offset:12288
    ds_read_b64_tr_b16 v[142:143], v147 offset:12800
    s_waitcnt lgkmcnt(14)
    v_mfma_f32_16x16x32_bf16 v[32:35], v[112:115], a[40:43], v[32:35]
    v_mfma_f32_16x16x32_bf16 v[36:39], v[112:115], a[48:51], v[36:39]
    buffer_load_dwordx4 v[172:175], v26, s[40:43], s38 offen
    v_mfma_f32_16x16x32_bf16 v[40:43], v[112:115], a[56:59], v[40:43]
    v_mfma_f32_16x16x32_bf16 v[44:47], v[112:115], a[64:67], v[44:47]
    s_add_u32 s39, s38, 4608
    buffer_load_dwordx4 v[176:179], v26, s[40:43], s39 offen
    v_mfma_f32_16x16x32_bf16 v[48:51], v[112:115], a[72:75], v[48:51]
    s_waitcnt lgkmcnt(12)
    v_mfma_f32_16x16x32_bf16 v[52:55], v[116:119], a[40:43], v[52:55]
    s_add_u32 s39, s36, 0
    buffer_load_dwordx2 v[160:161], v24, s[20:23], s39 offen
    v_mfma_f32_16x16x32_bf16 v[56:59], v[116:119], a[48:51], v[56:59]
    v_mfma_f32_16x16x32_bf16 v[60:63], v[116:119], a[56:59], v[60:63]
    s_add_u32 s39, s36, 18432
    buffer_load_dwordx2 v[162:163], v24, s[20:23], s39 offen
    v_mfma_f32_16x16x32_bf16 v[64:67], v[116:119], a[64:67], v[64:67]
    v_mfma_f32_16x16x32_bf16 v[68:71], v[116:119], a[72:75], v[68:71]
    s_add_u32 s39, s36, 36864
    buffer_load_dwordx2 v[164:165], v24, s[20:23], s39 offen
    s_waitcnt lgkmcnt(10)
    v_mfma_f32_16x16x32_bf16 v[72:75], v[120:123], a[40:43], v[72:75]
    v_mfma_f32_16x16x32_bf16 v[76:79], v[120:123], a[48:51], v[76:79]
    s_add_u32 s39, s36, 55296
    buffer_load_dwordx2 v[166:167], v24, s[20:23], s39 offen
    v_mfma_f32_16x16x32_bf16 v[80:83], v[120:123], a[56:59], v[80:83]
    v_mfma_f32_16x16x32_bf16 v[84:87], v[120:123], a[64:67], v[84:87]
    s_add_u32 s39, s36, 73728
    buffer_load_dwordx2 v[168:169], v24, s[20:23], s39 offen
    v_mfma_f32_16x16x32_bf16 v[88:91], v[120:123], a[72:75], v[88:91]
    s_waitcnt lgkmcnt(8)
    v_mfma_f32_16x16x32_bf16 v[92:95], v[124:127], a[40:43], v[92:95]
    v_mfma_f32_16x16x32_bf16 v[96:99], v[124:127], a[48:51], v[96:99]
    v_mfma_f32_16x16x32_bf16 v[100:103], v[124:127], a[56:59], v[100:103]
    v_mfma_f32_16x16x32_bf16 v[104:107], v[124:127], a[64:67], v[104:107]
    v_mfma_f32_16x16x32_bf16 v[108:111], v[124:127], a[72:75], v[108:111]
    s_waitcnt lgkmcnt(6)
    v_mfma_f32_16x16x32_bf16 v[32:35], v[128:131], a[44:47], v[32:35]
    v_mfma_f32_16x16x32_bf16 v[36:39], v[128:131], a[52:55], v[36:39]
    v_mfma_f32_16x16x32_bf16 v[40:43], v[128:131], a[60:63], v[40:43]
    v_mfma_f32_16x16x32_bf16 v[44:47], v[128:131], a[68:71], v[44:47]
    v_mfma_f32_16x16x32_bf16 v[48:51], v[128:131], a[76:79], v[48:51]
    s_waitcnt lgkmcnt(4)
    v_mfma_f32_16x16x32_bf16 v[52:55], v[132:135], a[44:47], v[52:55]
    v_mfma_f32_16x16x32_bf16 v[56:59], v[132:135], a[52:55], v[56:59]
    v_mfma_f32_16x16x32_bf16 v[60:63], v[132:135], a[60:63], v[60:63]
    v_mfma_f32_16x16x32_bf16 v[64:67], v[132:135], a[68:71], v[64:67]
    v_mfma_f32_16x16x32_bf16 v[68:71], v[132:135], a[76:79], v[68:71]
    s_waitcnt lgkmcnt(2)
    v_mfma_f32_16x16x32_bf16 v[72:75], v[136:139], a[44:47], v[72:75]
    v_mfma_f32_16x16x32_bf16 v[76:79], v[136:139], a[52:55], v[76:79]
    v_mfma_f32_16x16x32_bf16 v[80:83], v[136:139], a[60:63], v[80:83]
    v_mfma_f32_16x16x32_bf16 v[84:87], v[136:139], a[68:71], v[84:87]
    v_mfma_f32_16x16x32_bf16 v[88:91], v[136:139], a[76:79], v[88:91]
    s_waitcnt lgkmcnt(0)
    v_mfma_f32_16x16x32_bf16 v[92:95], v[140:143], a[44:47], v[92:95]
    v_mfma_f32_16x16x32_bf16 v[96:99], v[140:143], a[52:55], v[96:99]
    v_mfma_f32_16x16x32_bf16 v[100:103], v[140:143], a[60:63], v[100:103]
    v_mfma_f32_16x16x32_bf16 v[104:107], v[140:143], a[68:71], v[104:107]
    v_mfma_f32_16x16x32_bf16 v[108:111], v[140:143], a[76:79], v[108:111]
    s_waitcnt vmcnt(25)
    ds_read_b64_tr_b16 v[112:113], v144 offset:16384
    ds_read_b64_tr_b16 v[114:115], v144 offset:16896
    ds_read_b64_tr_b16 v[116:117], v145 offset:16384
    ds_read_b64_tr_b16 v[118:119], v145 offset:16896
    ds_read_b64_tr_b16 v[120:121], v146 offset:16384
    ds_read_b64_tr_b16 v[122:123], v146 offset:16896
    ds_read_b64_tr_b16 v[124:125], v147 offset:16384
    ds_read_b64_tr_b16 v[126:127], v147 offset:16896
    ds_read_b64_tr_b16 v[128:129], v144 offset:20480
    ds_read_b64_tr_b16 v[130:131], v144 offset:20992
    ds_read_b64_tr_b16 v[132:133], v145 offset:20480
    ds_read_b64_tr_b16 v[134:135], v145 offset:20992
    ds_read_b64_tr_b16 v[136:137], v146 offset:20480
    ds_read_b64_tr_b16 v[138:139], v146 offset:20992
    ds_read_b64_tr_b16 v[140:141], v147 offset:20480
    ds_read_b64_tr_b16 v[142:143], v147 offset:20992
    s_waitcnt lgkmcnt(14)
    v_mfma_f32_16x16x32_bf16 v[32:35], v[112:115], a[80:83], v[32:35]
    v_mfma_f32_16x16x32_bf16 v[36:39], v[112:115], a[88:91], v[36:39]
    v_mfma_f32_16x16x32_bf16 v[40:43], v[112:115], a[96:99], v[40:43]
    v_mfma_f32_16x16x32_bf16 v[44:47], v[112:115], a[104:107], v[44:47]
    v_mfma_f32_16x16x32_bf16 v[48:51], v[112:115], a[112:115], v[48:51]
    s_waitcnt lgkmcnt(12)
    v_mfma_f32_16x16x32_bf16 v[52:55], v[116:119], a[80:83], v[52:55]
    v_mfma_f32_16x16x32_bf16 v[56:59], v[116:119], a[88:91], v[56:59]
    v_mfma_f32_16x16x32_bf16 v[60:63], v[116:119], a[96:99], v[60:63]
    v_mfma_f32_16x16x32_bf16 v[64:67], v[116:119], a[104:107], v[64:67]
    v_mfma_f32_16x16x32_bf16 v[68:71], v[116:119], a[112:115], v[68:71]
    s_waitcnt lgkmcnt(10)
    v_mfma_f32_16x16x32_bf16 v[72:75], v[120:123], a[80:83], v[72:75]
    v_mfma_f32_16x16x32_bf16 v[76:79], v[120:123], a[88:91], v[76:79]
    v_mfma_f32_16x16x32_bf16 v[80:83], v[120:123], a[96:99], v[80:83]
    v_mfma_f32_16x16x32_bf16 v[84:87], v[120:123], a[104:107], v[84:87]
    v_mfma_f32_16x16x32_bf16 v[88:91], v[120:123], a[112:115], v[88:91]
    s_waitcnt lgkmcnt(8)
    v_mfma_f32_16x16x32_bf16 v[92:95], v[124:127], a[80:83], v[92:95]
    v_mfma_f32_16x16x32_bf16 v[96:99], v[124:127], a[88:91], v[96:99]
    v_mfma_f32_16x16x32_bf16 v[100:103], v[124:127], a[96:99], v[100:103]
    v_mfma_f32_16x16x32_bf16 v[104:107], v[124:127], a[104:107], v[104:107]
    v_mfma_f32_16x16x32_bf16 v[108:111], v[124:127], a[112:115], v[108:111]
    s_waitcnt lgkmcnt(6)
    v_mfma_f32_16x16x32_bf16 v[32:35], v[128:131], a[84:87], v[32:35]
    v_mfma_f32_16x16x32_bf16 v[36:39], v[128:131], a[92:95], v[36:39]
    v_mfma_f32_16x16x32_bf16 v[40:43], v[128:131], a[100:103], v[40:43]
    v_mfma_f32_16x16x32_bf16 v[44:47], v[128:131], a[108:111], v[44:47]
    v_mfma_f32_16x16x32_bf16 v[48:51], v[128:131], a[116:119], v[48:51]
    s_waitcnt lgkmcnt(4)
    v_mfma_f32_16x16x32_bf16 v[52:55], v[132:135], a[84:87], v[52:55]
    v_mfma_f32_16x16x32_bf16 v[56:59], v[132:135], a[92:95], v[56:59]
    v_mfma_f32_16x16x32_bf16 v[60:63], v[132:135], a[100:103], v[60:63]
    v_mfma_f32_16x16x32_bf16 v[64:67], v[132:135], a[108:111], v[64:67]
    v_mfma_f32_16x16x32_bf16 v[68:71], v[132:135], a[116:119], v[68:71]
    s_waitcnt lgkmcnt(2)
    v_mfma_f32_16x16x32_bf16 v[72:75], v[136:139], a[84:87], v[72:75]
    v_mfma_f32_16x16x32_bf16 v[76:79], v[136:139], a[92:95], v[76:79]
    v_mfma_f32_16x16x32_bf16 v[80:83], v[136:139], a[100:103], v[80:83]
    v_mfma_f32_16x16x32_bf16 v[84:87], v[136:139], a[108:111], v[84:87]
    v_mfma_f32_16x16x32_bf16 v[88:91], v[136:139], a[116:119], v[88:91]
    s_waitcnt lgkmcnt(0)
    v_mfma_f32_16x16x32_bf16 v[92:95], v[140:143], a[84:87], v[92:95]
    v_mfma_f32_16x16x32_bf16 v[96:99], v[140:143], a[92:95], v[96:99]
    v_mfma_f32_16x16x32_bf16 v[100:103], v[140:143], a[100:103], v[100:103]
    v_mfma_f32_16x16x32_bf16 v[104:107], v[140:143], a[108:111], v[104:107]
    v_mfma_f32_16x16x32_bf16 v[108:111], v[140:143], a[116:119], v[108:111]
    s_waitcnt vmcnt(7)
    ds_read_b64_tr_b16 v[112:113], v144 offset:24576
    ds_read_b64_tr_b16 v[114:115], v144 offset:25088
    ds_read_b64_tr_b16 v[116:117], v145 offset:24576
    ds_read_b64_tr_b16 v[118:119], v145 offset:25088
    ds_read_b64_tr_b16 v[120:121], v146 offset:24576
    ds_read_b64_tr_b16 v[122:123], v146 offset:25088
    ds_read_b64_tr_b16 v[124:125], v147 offset:24576
    ds_read_b64_tr_b16 v[126:127], v147 offset:25088
    ds_read_b64_tr_b16 v[128:129], v144 offset:28672
    ds_read_b64_tr_b16 v[130:131], v144 offset:29184
    ds_read_b64_tr_b16 v[132:133], v145 offset:28672
    ds_read_b64_tr_b16 v[134:135], v145 offset:29184
    ds_read_b64_tr_b16 v[136:137], v146 offset:28672
    ds_read_b64_tr_b16 v[138:139], v146 offset:29184
    ds_read_b64_tr_b16 v[140:141], v147 offset:28672
    ds_read_b64_tr_b16 v[142:143], v147 offset:29184
    s_waitcnt lgkmcnt(14)
    v_mfma_f32_16x16x32_bf16 v[32:35], v[112:115], a[120:123], v[32:35]
    v_mfma_f32_16x16x32_bf16 v[36:39], v[112:115], a[128:131], v[36:39]
    v_mfma_f32_16x16x32_bf16 v[40:43], v[112:115], a[136:139], v[40:43]
    v_mfma_f32_16x16x32_bf16 v[44:47], v[112:115], a[144:147], v[44:47]
    v_mfma_f32_16x16x32_bf16 v[48:51], v[112:115], a[152:155], v[48:51]
    s_waitcnt lgkmcnt(12)
    v_mfma_f32_16x16x32_bf16 v[52:55], v[116:119], a[120:123], v[52:55]
    v_mfma_f32_16x16x32_bf16 v[56:59], v[116:119], a[128:131], v[56:59]
    v_mfma_f32_16x16x32_bf16 v[60:63], v[116:119], a[136:139], v[60:63]
    v_mfma_f32_16x16x32_bf16 v[64:67], v[116:119], a[144:147], v[64:67]
    v_mfma_f32_16x16x32_bf16 v[68:71], v[116:119], a[152:155], v[68:71]
    s_waitcnt lgkmcnt(10)
    v_mfma_f32_16x16x32_bf16 v[72:75], v[120:123], a[120:123], v[72:75]
    v_mfma_f32_16x16x32_bf16 v[76:79], v[120:123], a[128:131], v[76:79]
    v_mfma_f32_16x16x32_bf16 v[80:83], v[120:123], a[136:139], v[80:83]
    v_mfma_f32_16x16x32_bf16 v[84:87], v[120:123], a[144:147], v[84:87]
    v_mfma_f32_16x16x32_bf16 v[88:91], v[120:123], a[152:155], v[88:91]
    s_waitcnt lgkmcnt(8)
    v_mfma_f32_16x16x32_bf16 v[92:95], v[124:127], a[120:123], v[92:95]
    v_mfma_f32_16x16x32_bf16 v[96:99], v[124:127], a[128:131], v[96:99]
    v_mfma_f32_16x16x32_bf16 v[100:103], v[124:127], a[136:139], v[100:103]
    v_mfma_f32_16x16x32_bf16 v[104:107], v[124:127], a[144:147], v[104:107]
    v_mfma_f32_16x16x32_bf16 v[108:111], v[124:127], a[152:155], v[108:111]
    s_waitcnt lgkmcnt(6)
    v_mfma_f32_16x16x32_bf16 v[32:35], v[128:131], a[124:127], v[32:35]
    v_mfma_f32_16x16x32_bf16 v[36:39], v[128:131], a[132:135], v[36:39]
    v_mfma_f32_16x16x32_bf16 v[40:43], v[128:131], a[140:143], v[40:43]
    v_mfma_f32_16x16x32_bf16 v[44:47], v[128:131], a[148:151], v[44:47]
    v_mfma_f32_16x16x32_bf16 v[48:51], v[128:131], a[156:159], v[48:51]
    s_waitcnt lgkmcnt(4)
    v_mfma_f32_16x16x32_bf16 v[52:55], v[132:135], a[124:127], v[52:55]
    v_mfma_f32_16x16x32_bf16 v[56:59], v[132:135], a[132:135], v[56:59]
    v_mfma_f32_16x16x32_bf16 v[60:63], v[132:135], a[140:143], v[60:63]
    v_mfma_f32_16x16x32_bf16 v[64:67], v[132:135], a[148:151], v[64:67]
    v_mfma_f32_16x16x32_bf16 v[68:71], v[132:135], a[156:159], v[68:71]
    s_waitcnt lgkmcnt(2)
    v_mfma_f32_16x16x32_bf16 v[72:75], v[136:139], a[124:127], v[72:75]
    v_mfma_f32_16x16x32_bf16 v[76:79], v[136:139], a[132:135], v[76:79]
    v_mfma_f32_16x16x32_bf16 v[80:83], v[136:139], a[140:143], v[80:83]
    v_mfma_f32_16x16x32_bf16 v[84:87], v[136:139], a[148:151], v[84:87]
    v_mfma_f32_16x16x32_bf16 v[88:91], v[136:139], a[156:159], v[88:91]
    s_waitcnt lgkmcnt(0)
    v_mfma_f32_16x16x32_bf16 v[92:95], v[140:143], a[124:127], v[92:95]
    v_mfma_f32_16x16x32_bf16 v[96:99], v[140:143], a[132:135], v[96:99]
    v_mfma_f32_16x16x32_bf16 v[100:103], v[140:143], a[140:143], v[100:103]
    v_mfma_f32_16x16x32_bf16 v[104:107], v[140:143], a[148:151], v[104:107]
    v_mfma_f32_16x16x32_bf16 v[108:111], v[140:143], a[156:159], v[108:111]
    v_lshlrev_b32 v3, 4, v1
    v_add_u32 v4, s34, v3
    s_nop 7
    ds_write_b128 v4, v[32:35] offset:0
    ds_write_b128 v4, v[36:39] offset:1024
    ds_write_b128 v4, v[40:43] offset:2048
    ds_write_b128 v4, v[44:47] offset:3072
    ds_write_b128 v4, v[48:51] offset:4096
    ds_write_b128 v4, v[52:55] offset:5120
    ds_write_b128 v4, v[56:59] offset:6144
    ds_write_b128 v4, v[60:63] offset:7168
    ds_write_b128 v4, v[64:67] offset:8192
    ds_write_b128 v4, v[68:71] offset:9216
    ds_write_b128 v4, v[72:75] offset:10240
    ds_write_b128 v4, v[76:79] offset:11264
    ds_write_b128 v4, v[80:83] offset:12288
    ds_write_b128 v4, v[84:87] offset:13312
    ds_write_b128 v4, v[88:91] offset:14336
    ds_write_b128 v4, v[92:95] offset:15360
    ds_write_b128 v4, v[96:99] offset:16384
    ds_write_b128 v4, v[100:103] offset:17408
    ds_write_b128 v4, v[104:107] offset:18432
    ds_write_b128 v4, v[108:111] offset:19456
    s_mul_i32 s39, s3, 5120
    v_add_u32 v4, s39, v3
    v_add_u32 v5, 65536, v4
    s_waitcnt lgkmcnt(0)
    s_barrier
    ds_read_b128 v[32:35], v4 offset:0
    ds_read_b128 v[36:39], v4 offset:32768
    ds_read_b128 v[40:43], v5 offset:0
    ds_read_b128 v[44:47], v5 offset:32768
    ds_read_b128 v[48:51], v4 offset:1024
    ds_read_b128 v[52:55], v4 offset:33792
    ds_read_b128 v[56:59], v5 offset:1024
    ds_read_b128 v[60:63], v5 offset:33792
    ds_read_b128 v[64:67], v4 offset:2048
    ds_read_b128 v[68:71], v4 offset:34816
    ds_read_b128 v[72:75], v5 offset:2048
    ds_read_b128 v[76:79], v5 offset:34816
    ds_read_b128 v[80:83], v4 offset:3072
    ds_read_b128 v[84:87], v4 offset:35840
    ds_read_b128 v[88:91], v5 offset:3072
    ds_read_b128 v[92:95], v5 offset:35840
    ds_read_b128 v[96:99], v4 offset:4096
    ds_read_b128 v[100:103], v4 offset:36864
    ds_read_b128 v[104:107], v5 offset:4096
    ds_read_b128 v[108:111], v5 offset:36864
    s_waitcnt lgkmcnt(0) vmcnt(0)
    v_and_b32 v27, 15, v1
    v_lshlrev_b32 v27, 3, v27
    s_mul_i32 s39, s3, 640
    s_add_u32 s39, s39, 24576
    v_add_u32 v27, s39, v27
    v_add_f32 v32, v32, v36
    v_add_f32 v40, v40, v44
    v_add_f32 v33, v33, v37
    v_add_f32 v41, v41, v45
    v_add_f32 v34, v34, v38
    v_add_f32 v42, v42, v46
    v_add_f32 v35, v35, v39
    v_add_f32 v43, v43, v47
    v_add_f32 v32, v32, v40
    v_add_f32 v33, v33, v41
    v_add_f32 v34, v34, v42
    v_add_f32 v35, v35, v43
    v_cvt_pk_bf16_f32 v36, v32, v33
    v_cvt_pk_bf16_f32 v37, v34, v35
    v_lshlrev_b32 v32, 16, v36
    v_and_b32 v33, 0xffff0000, v36
    v_lshlrev_b32 v34, 16, v37
    v_and_b32 v35, 0xffff0000, v37
    v_mul_f32 v32, v32, v172
    v_mul_f32 v33, v33, v173
    v_mul_f32 v34, v34, v174
    v_mul_f32 v35, v35, v175
    v_cvt_pk_bf16_f32 v36, v32, v33
    v_cvt_pk_bf16_f32 v37, v34, v35
    v_lshlrev_b32 v32, 16, v36
    v_and_b32 v33, 0xffff0000, v36
    v_lshlrev_b32 v34, 16, v37
    v_and_b32 v35, 0xffff0000, v37
    v_lshlrev_b32 v40, 16, v160
    v_and_b32 v41, 0xffff0000, v160
    v_lshlrev_b32 v42, 16, v161
    v_and_b32 v43, 0xffff0000, v161
    v_add_f32 v32, v32, v40
    v_add_f32 v33, v33, v41
    v_add_f32 v34, v34, v42
    v_add_f32 v35, v35, v43
    v_cvt_pk_bf16_f32 v36, v32, v33
    v_cvt_pk_bf16_f32 v37, v34, v35
    s_add_u32 s39, s37, 0
    buffer_store_dwordx2 v[36:37], v25, s[24:27], s39 offen sc0 sc1
    v_lshlrev_b32 v32, 16, v36
    v_and_b32 v33, 0xffff0000, v36
    v_lshlrev_b32 v34, 16, v37
    v_and_b32 v35, 0xffff0000, v37
    v_mul_f32 v40, v32, v176
    v_mul_f32 v41, v33, v177
    v_mul_f32 v42, v34, v178
    v_mul_f32 v43, v35, v179
    v_cvt_pk_bf16_f32 v38, v40, v41
    v_cvt_pk_bf16_f32 v39, v42, v43
    buffer_store_dwordx2 v[38:39], v25, s[84:87], s39 offen sc0 sc1
    v_add_f32 v44, v32, v33
    v_add_f32 v45, v34, v35
    v_add_f32 v44, v44, v45
    v_mul_f32 v45, v32, v32
    v_fmac_f32 v45, v33, v33
    v_fmac_f32 v45, v34, v34
    v_fmac_f32 v45, v35, v35
    v_mov_b32 v46, v44
    v_mov_b32 v47, v45
    s_nop 1
    v_permlane16_swap_b32 v44, v46
    v_permlane16_swap_b32 v45, v47
    v_add_f32 v44, v44, v46
    v_add_f32 v45, v45, v47
    v_mov_b32 v46, v44
    v_mov_b32 v47, v45
    s_nop 1
    v_permlane32_swap_b32 v44, v46
    v_permlane32_swap_b32 v45, v47
    v_add_f32 v44, v44, v46
    v_add_f32 v45, v45, v47
    ds_write_b64 v27, v[44:45] offset:0
    v_add_f32 v48, v48, v52
    v_add_f32 v56, v56, v60
    v_add_f32 v49, v49, v53
    v_add_f32 v57, v57, v61
    v_add_f32 v50, v50, v54
    v_add_f32 v58, v58, v62
    v_add_f32 v51, v51, v55
    v_add_f32 v59, v59, v63
    v_add_f32 v48, v48, v56
    v_add_f32 v49, v49, v57
    v_add_f32 v50, v50, v58
    v_add_f32 v51, v51, v59
    v_cvt_pk_bf16_f32 v52, v48, v49
    v_cvt_pk_bf16_f32 v53, v50, v51
    v_lshlrev_b32 v48, 16, v52
    v_and_b32 v49, 0xffff0000, v52
    v_lshlrev_b32 v50, 16, v53
    v_and_b32 v51, 0xffff0000, v53
    v_mul_f32 v48, v48, v172
    v_mul_f32 v49, v49, v173
    v_mul_f32 v50, v50, v174
    v_mul_f32 v51, v51, v175
    v_cvt_pk_bf16_f32 v52, v48, v49
    v_cvt_pk_bf16_f32 v53, v50, v51
    v_lshlrev_b32 v48, 16, v52
    v_and_b32 v49, 0xffff0000, v52
    v_lshlrev_b32 v50, 16, v53
    v_and_b32 v51, 0xffff0000, v53
    v_lshlrev_b32 v56, 16, v162
    v_and_b32 v57, 0xffff0000, v162
    v_lshlrev_b32 v58, 16, v163
    v_and_b32 v59, 0xffff0000, v163
    v_add_f32 v48, v48, v56
    v_add_f32 v49, v49, v57
    v_add_f32 v50, v50, v58
    v_add_f32 v51, v51, v59
    v_cvt_pk_bf16_f32 v52, v48, v49
    v_cvt_pk_bf16_f32 v53, v50, v51
    s_add_u32 s39, s37, 18432
    buffer_store_dwordx2 v[52:53], v25, s[24:27], s39 offen sc0 sc1
    v_lshlrev_b32 v48, 16, v52
    v_and_b32 v49, 0xffff0000, v52
    v_lshlrev_b32 v50, 16, v53
    v_and_b32 v51, 0xffff0000, v53
    v_mul_f32 v56, v48, v176
    v_mul_f32 v57, v49, v177
    v_mul_f32 v58, v50, v178
    v_mul_f32 v59, v51, v179
    v_cvt_pk_bf16_f32 v54, v56, v57
    v_cvt_pk_bf16_f32 v55, v58, v59
    buffer_store_dwordx2 v[54:55], v25, s[84:87], s39 offen sc0 sc1
    v_add_f32 v60, v48, v49
    v_add_f32 v61, v50, v51
    v_add_f32 v60, v60, v61
    v_mul_f32 v61, v48, v48
    v_fmac_f32 v61, v49, v49
    v_fmac_f32 v61, v50, v50
    v_fmac_f32 v61, v51, v51
    v_mov_b32 v62, v60
    v_mov_b32 v63, v61
    s_nop 1
    v_permlane16_swap_b32 v60, v62
    v_permlane16_swap_b32 v61, v63
    v_add_f32 v60, v60, v62
    v_add_f32 v61, v61, v63
    v_mov_b32 v62, v60
    v_mov_b32 v63, v61
    s_nop 1
    v_permlane32_swap_b32 v60, v62
    v_permlane32_swap_b32 v61, v63
    v_add_f32 v60, v60, v62
    v_add_f32 v61, v61, v63
    ds_write_b64 v27, v[60:61] offset:128
    v_add_f32 v64, v64, v68
    v_add_f32 v72, v72, v76
    v_add_f32 v65, v65, v69
    v_add_f32 v73, v73, v77
    v_add_f32 v66, v66, v70
    v_add_f32 v74, v74, v78
    v_add_f32 v67, v67, v71
    v_add_f32 v75, v75, v79
    v_add_f32 v64, v64, v72
    v_add_f32 v65, v65, v73
    v_add_f32 v66, v66, v74
    v_add_f32 v67, v67, v75
    v_cvt_pk_bf16_f32 v68, v64, v65
    v_cvt_pk_bf16_f32 v69, v66, v67
    v_lshlrev_b32 v64, 16, v68
    v_and_b32 v65, 0xffff0000, v68
    v_lshlrev_b32 v66, 16, v69
    v_and_b32 v67, 0xffff0000, v69
    v_mul_f32 v64, v64, v172
    v_mul_f32 v65, v65, v173
    v_mul_f32 v66, v66, v174
    v_mul_f32 v67, v67, v175
    v_cvt_pk_bf16_f32 v68, v64, v65
    v_cvt_pk_bf16_f32 v69, v66, v67
    v_lshlrev_b32 v64, 16, v68
    v_and_b32 v65, 0xffff0000, v68
    v_lshlrev_b32 v66, 16, v69
    v_and_b32 v67, 0xffff0000, v69
    v_lshlrev_b32 v72, 16, v164
    v_and_b32 v73, 0xffff0000, v164
    v_lshlrev_b32 v74, 16, v165
    v_and_b32 v75, 0xffff0000, v165
    v_add_f32 v64, v64, v72
    v_add_f32 v65, v65, v73
    v_add_f32 v66, v66, v74
    v_add_f32 v67, v67, v75
    v_cvt_pk_bf16_f32 v68, v64, v65
    v_cvt_pk_bf16_f32 v69, v66, v67
    s_add_u32 s39, s37, 36864
    buffer_store_dwordx2 v[68:69], v25, s[24:27], s39 offen sc0 sc1
    v_lshlrev_b32 v64, 16, v68
    v_and_b32 v65, 0xffff0000, v68
    v_lshlrev_b32 v66, 16, v69
    v_and_b32 v67, 0xffff0000, v69
    v_mul_f32 v72, v64, v176
    v_mul_f32 v73, v65, v177
    v_mul_f32 v74, v66, v178
    v_mul_f32 v75, v67, v179
    v_cvt_pk_bf16_f32 v70, v72, v73
    v_cvt_pk_bf16_f32 v71, v74, v75
    buffer_store_dwordx2 v[70:71], v25, s[84:87], s39 offen sc0 sc1
    v_add_f32 v76, v64, v65
    v_add_f32 v77, v66, v67
    v_add_f32 v76, v76, v77
    v_mul_f32 v77, v64, v64
    v_fmac_f32 v77, v65, v65
    v_fmac_f32 v77, v66, v66
    v_fmac_f32 v77, v67, v67
    v_mov_b32 v78, v76
    v_mov_b32 v79, v77
    s_nop 1
    v_permlane16_swap_b32 v76, v78
    v_permlane16_swap_b32 v77, v79
    v_add_f32 v76, v76, v78
    v_add_f32 v77, v77, v79
    v_mov_b32 v78, v76
    v_mov_b32 v79, v77
    s_nop 1
    v_permlane32_swap_b32 v76, v78
    v_permlane32_swap_b32 v77, v79
    v_add_f32 v76, v76, v78
    v_add_f32 v77, v77, v79
    ds_write_b64 v27, v[76:77] offset:256
    v_add_f32 v80, v80, v84
    v_add_f32 v88, v88, v92
    v_add_f32 v81, v81, v85
    v_add_f32 v89, v89, v93
    v_add_f32 v82, v82, v86
    v_add_f32 v90, v90, v94
    v_add_f32 v83, v83, v87
    v_add_f32 v91, v91, v95
    v_add_f32 v80, v80, v88
    v_add_f32 v81, v81, v89
    v_add_f32 v82, v82, v90
    v_add_f32 v83, v83, v91
    v_cvt_pk_bf16_f32 v84, v80, v81
    v_cvt_pk_bf16_f32 v85, v82, v83
    v_lshlrev_b32 v80, 16, v84
    v_and_b32 v81, 0xffff0000, v84
    v_lshlrev_b32 v82, 16, v85
    v_and_b32 v83, 0xffff0000, v85
    v_mul_f32 v80, v80, v172
    v_mul_f32 v81, v81, v173
    v_mul_f32 v82, v82, v174
    v_mul_f32 v83, v83, v175
    v_cvt_pk_bf16_f32 v84, v80, v81
    v_cvt_pk_bf16_f32 v85, v82, v83
    v_lshlrev_b32 v80, 16, v84
    v_and_b32 v81, 0xffff0000, v84
    v_lshlrev_b32 v82, 16, v85
    v_and_b32 v83, 0xffff0000, v85
    v_lshlrev_b32 v88, 16, v166
    v_and_b32 v89, 0xffff0000, v166
    v_lshlrev_b32 v90, 16, v167
    v_and_b32 v91, 0xffff0000, v167
    v_add_f32 v80, v80, v88
    v_add_f32 v81, v81, v89
    v_add_f32 v82, v82, v90
    v_add_f32 v83, v83, v91
    v_cvt_pk_bf16_f32 v84, v80, v81
    v_cvt_pk_bf16_f32 v85, v82, v83
    s_add_u32 s39, s37, 55296
    buffer_store_dwordx2 v[84:85], v25, s[24:27], s39 offen sc0 sc1
    v_lshlrev_b32 v80, 16, v84
    v_and_b32 v81, 0xffff0000, v84
    v_lshlrev_b32 v82, 16, v85
    v_and_b32 v83, 0xffff0000, v85
    v_mul_f32 v88, v80, v176
    v_mul_f32 v89, v81, v177
    v_mul_f32 v90, v82, v178
    v_mul_f32 v91, v83, v179
    v_cvt_pk_bf16_f32 v86, v88, v89
    v_cvt_pk_bf16_f32 v87, v90, v91
    buffer_store_dwordx2 v[86:87], v25, s[84:87], s39 offen sc0 sc1
    v_add_f32 v92, v80, v81
    v_add_f32 v93, v82, v83
    v_add_f32 v92, v92, v93
    v_mul_f32 v93, v80, v80
    v_fmac_f32 v93, v81, v81
    v_fmac_f32 v93, v82, v82
    v_fmac_f32 v93, v83, v83
    v_mov_b32 v94, v92
    v_mov_b32 v95, v93
    s_nop 1
    v_permlane16_swap_b32 v92, v94
    v_permlane16_swap_b32 v93, v95
    v_add_f32 v92, v92, v94
    v_add_f32 v93, v93, v95
    v_mov_b32 v94, v92
    v_mov_b32 v95, v93
    s_nop 1
    v_permlane32_swap_b32 v92, v94
    v_permlane32_swap_b32 v93, v95
    v_add_f32 v92, v92, v94
    v_add_f32 v93, v93, v95
    ds_write_b64 v27, v[92:93] offset:384
    v_add_f32 v96, v96, v100
    v_add_f32 v104, v104, v108
    v_add_f32 v97, v97, v101
    v_add_f32 v105, v105, v109
    v_add_f32 v98, v98, v102
    v_add_f32 v106, v106, v110
    v_add_f32 v99, v99, v103
    v_add_f32 v107, v107, v111
    v_add_f32 v96, v96, v104
    v_add_f32 v97, v97, v105
    v_add_f32 v98, v98, v106
    v_add_f32 v99, v99, v107
    v_cvt_pk_bf16_f32 v100, v96, v97
    v_cvt_pk_bf16_f32 v101, v98, v99
    v_lshlrev_b32 v96, 16, v100
    v_and_b32 v97, 0xffff0000, v100
    v_lshlrev_b32 v98, 16, v101
    v_and_b32 v99, 0xffff0000, v101
    v_mul_f32 v96, v96, v172
    v_mul_f32 v97, v97, v173
    v_mul_f32 v98, v98, v174
    v_mul_f32 v99, v99, v175
    v_cvt_pk_bf16_f32 v100, v96, v97
    v_cvt_pk_bf16_f32 v101, v98, v99
    v_lshlrev_b32 v96, 16, v100
    v_and_b32 v97, 0xffff0000, v100
    v_lshlrev_b32 v98, 16, v101
    v_and_b32 v99, 0xffff0000, v101
    v_lshlrev_b32 v104, 16, v168
    v_and_b32 v105, 0xffff0000, v168
    v_lshlrev_b32 v106, 16, v169
    v_and_b32 v107, 0xffff0000, v169
    v_add_f32 v96, v96, v104
    v_add_f32 v97, v97, v105
    v_add_f32 v98, v98, v106
    v_add_f32 v99, v99, v107
    v_cvt_pk_bf16_f32 v100, v96, v97
    v_cvt_pk_bf16_f32 v101, v98, v99
    s_add_u32 s39, s37, 73728
    buffer_store_dwordx2 v[100:101], v25, s[24:27], s39 offen sc0 sc1
    v_lshlrev_b32 v96, 16, v100
    v_and_b32 v97, 0xffff0000, v100
    v_lshlrev_b32 v98, 16, v101
    v_and_b32 v99, 0xffff0000, v101
    v_mul_f32 v104, v96, v176
    v_mul_f32 v105, v97, v177
    v_mul_f32 v106, v98, v178
    v_mul_f32 v107, v99, v179
    v_cvt_pk_bf16_f32 v102, v104, v105
    v_cvt_pk_bf16_f32 v103, v106, v107
    buffer_store_dwordx2 v[102:103], v25, s[84:87], s39 offen sc0 sc1
    v_add_f32 v108, v96, v97
    v_add_f32 v109, v98, v99
    v_add_f32 v108, v108, v109
    v_mul_f32 v109, v96, v96
    v_fmac_f32 v109, v97, v97
    v_fmac_f32 v109, v98, v98
    v_fmac_f32 v109, v99, v99
    v_mov_b32 v110, v108
    v_mov_b32 v111, v109
    s_nop 1
    v_permlane16_swap_b32 v108, v110
    v_permlane16_swap_b32 v109, v111
    v_add_f32 v108, v108, v110
    v_add_f32 v109, v109, v111
    v_mov_b32 v110, v108
    v_mov_b32 v111, v109
    s_nop 1
    v_permlane32_swap_b32 v108, v110
    v_permlane32_swap_b32 v109, v111
    v_add_f32 v108, v108, v110
    v_add_f32 v109, v109, v111
    ds_write_b64 v27, v[108:109] offset:512
    s_waitcnt lgkmcnt(0)
    s_barrier
    v_cmp_gt_u32 vcc, 80, v0
    s_and_saveexec_b64 s[92:93], vcc
    s_cbranch_execz K2_skipst
    v_lshlrev_b32 v3, 3, v0
    v_add_u32 v4, 24576, v3
    ds_read_b64 v[8:9], v4 offset:0
    ds_read_b64 v[10:11], v4 offset:640
    ds_read_b64 v[12:13], v4 offset:1280
    ds_read_b64 v[14:15], v4 offset:1920
    v_lshlrev_b32 v5, 7, v0
    s_mul_i32 s39, s28, 10240
    s_lshl_b32 s94, s29, 3
    s_add_u32 s39, s39, s94
    s_waitcnt lgkmcnt(0)
    v_add_f32 v8, v8, v10
    v_add_f32 v9, v9, v11
    v_add_f32 v12, v12, v14
    v_add_f32 v13, v13, v15
    v_add_f32 v8, v8, v12
    v_add_f32 v9, v9, v13
    buffer_store_dwordx2 v[8:9], v5, s[88:91], s39 offen
K2_skipst:
    s_or_b64 exec, exec, s[92:93]
    s_waitcnt vmcnt(0)
K2_end:
    s_endpgm
K2_side:
    s_cmp_ge_u32 s2, 256
    s_cbranch_scc1 K2_end2
K2_side2:
    s_cmp_ge_u32 s3, 18
    s_cbranch_scc1 K2_end2
    s_load_dwordx2 s[4:5], s[0:1], 112
    s_load_dwordx2 s[6:7], s[0:1], 48
    v_and_b32 v1, 31, v0
    v_lshrrev_b32 v2, 5, v0
    s_waitcnt lgkmcnt(0)
    s_mov_b32 s12, s6
    s_mov_b32 s13, s7
    s_mov_b32 s14, 5308416
    s_mov_b32 s15, 0x00020000
    s_add_u32 s16, s4, 0
    s_addc_u32 s17, s5, 0
    s_mov_b32 s18, 13824
    s_mov_b32 s19, 0x00020000
    s_add_u32 s20, s4, 101711872
    s_addc_u32 s21, s5, 0
    s_mov_b32 s22, 36864
    s_mov_b32 s23, 0x00020000
    s_add_u32 s28, s4, 62914560
    s_addc_u32 s29, s5, 0
    s_mov_b32 s30, 524288
    s_mov_b32 s31, 0x00020000
    v_lshlrev_b32 v5, 4, v0
    v_mov_b32 v8, -1
    v_mov_b32 v9, -1
    v_mov_b32 v10, -1
    v_mov_b32 v11, -1
    s_lshl_b32 s32, s3, 15
    buffer_store_dwordx4 v[8:11], v5, s[28:31], s32 offen
    s_add_u32 s32, s32, 4096
    buffer_store_dwordx4 v[8:11], v5, s[28:31], s32 offen
    s_add_u32 s32, s32, 4096
    buffer_store_dwordx4 v[8:11], v5, s[28:31], s32 offen
    s_add_u32 s32, s32, 4096
    buffer_store_dwordx4 v[8:11], v5, s[28:31], s32 offen
    s_add_u32 s32, s32, 4096
    buffer_store_dwordx4 v[8:11], v5, s[28:31], s32 offen
    s_add_u32 s32, s32, 4096
    buffer_store_dwordx4 v[8:11], v5, s[28:31], s32 offen
    s_add_u32 s32, s32, 4096
    buffer_store_dwordx4 v[8:11], v5, s[28:31], s32 offen
    s_add_u32 s32, s32, 4096
    buffer_store_dwordx4 v[8:11], v5, s[28:31], s32 offen
    s_nop 1
    s_mov_b32 s24, 9216
    v_mul_lo_u32 v3, v2, s24
    v_lshl_add_u32 v3, v1, 4, v3
    s_lshl_b32 s25, s3, 9
    v_lshlrev_b32 v4, 2, v2
    v_mov_b32 v8, 0
    v_mov_b32 v9, 0
    v_mov_b32 v10, 0
    v_mov_b32 v11, 0
    v_mov_b32 v12, 0
    v_mov_b32 v13, 0
    v_mov_b32 v14, 0
    v_mov_b32 v15, 0
    v_mov_b32 v16, 0
    v_mov_b32 v17, 0
    v_mov_b32 v18, 0
    v_mov_b32 v19, 0
    v_mov_b32 v20, 0
    v_mov_b32 v21, 0
    v_mov_b32 v22, 0
    v_mov_b32 v23, 0
    s_mov_b32 s26, 3
    s_mov_b32 s27, 6912
K2_sloop:
    buffer_load_dword v128, v4, s[16:19], s27 offen offset:0
    buffer_load_dword v152, v4, s[16:19], s27 offen offset:2304
    buffer_load_dword v129, v4, s[16:19], s27 offen offset:32
    buffer_load_dword v153, v4, s[16:19], s27 offen offset:2336
    buffer_load_dword v130, v4, s[16:19], s27 offen offset:64
    buffer_load_dword v154, v4, s[16:19], s27 offen offset:2368
    buffer_load_dword v131, v4, s[16:19], s27 offen offset:96
    buffer_load_dword v155, v4, s[16:19], s27 offen offset:2400
    buffer_load_dword v132, v4, s[16:19], s27 offen offset:128
    buffer_load_dword v156, v4, s[16:19], s27 offen offset:2432
    buffer_load_dword v133, v4, s[16:19], s27 offen offset:160
    buffer_load_dword v157, v4, s[16:19], s27 offen offset:2464
    buffer_load_dword v134, v4, s[16:19], s27 offen offset:192
    buffer_load_dword v158, v4, s[16:19], s27 offen offset:2496
    buffer_load_dword v135, v4, s[16:19], s27 offen offset:224
    buffer_load_dword v159, v4, s[16:19], s27 offen offset:2528
    buffer_load_dword v136, v4, s[16:19], s27 offen offset:256
    buffer_load_dword v160, v4, s[16:19], s27 offen offset:2560
    buffer_load_dword v137, v4, s[16:19], s27 offen offset:288
    buffer_load_dword v161, v4, s[16:19], s27 offen offset:2592
    buffer_load_dword v138, v4, s[16:19], s27 offen offset:320
    buffer_load_dword v162, v4, s[16:19], s27 offen offset:2624
    buffer_load_dword v139, v4, s[16:19], s27 offen offset:352
    buffer_load_dword v163, v4, s[16:19], s27 offen offset:2656
    buffer_load_dword v140, v4, s[16:19], s27 offen offset:384
    buffer_load_dword v164, v4, s[16:19], s27 offen offset:2688
    buffer_load_dword v141, v4, s[16:19], s27 offen offset:416
    buffer_load_dword v165, v4, s[16:19], s27 offen offset:2720
    buffer_load_dword v142, v4, s[16:19], s27 offen offset:448
    buffer_load_dword v166, v4, s[16:19], s27 offen offset:2752
    buffer_load_dword v143, v4, s[16:19], s27 offen offset:480
    buffer_load_dword v167, v4, s[16:19], s27 offen offset:2784
    buffer_load_dword v144, v4, s[16:19], s27 offen offset:512
    buffer_load_dword v168, v4, s[16:19], s27 offen offset:2816
    buffer_load_dword v145, v4, s[16:19], s27 offen offset:544
    buffer_load_dword v169, v4, s[16:19], s27 offen offset:2848
    buffer_load_dword v146, v4, s[16:19], s27 offen offset:576
    buffer_load_dword v170, v4, s[16:19], s27 offen offset:2880
    buffer_load_dword v147, v4, s[16:19], s27 offen offset:608
    buffer_load_dword v171, v4, s[16:19], s27 offen offset:2912
    buffer_load_dword v148, v4, s[16:19], s27 offen offset:640
    buffer_load_dword v172, v4, s[16:19], s27 offen offset:2944
    buffer_load_dword v149, v4, s[16:19], s27 offen offset:672
    buffer_load_dword v173, v4, s[16:19], s27 offen offset:2976
    buffer_load_dword v150, v4, s[16:19], s27 offen offset:704
    buffer_load_dword v174, v4, s[16:19], s27 offen offset:3008
    buffer_load_dword v151, v4, s[16:19], s27 offen offset:736
    buffer_load_dword v175, v4, s[16:19], s27 offen offset:3040
    buffer_load_dwordx4 v[32:35], v3, s[12:15], s25 offen
    s_add_u32 s25, s25, 73728
    buffer_load_dwordx4 v[36:39], v3, s[12:15], s25 offen
    s_add_u32 s25, s25, 73728
    buffer_load_dwordx4 v[40:43], v3, s[12:15], s25 offen
    s_add_u32 s25, s25, 73728
    buffer_load_dwordx4 v[44:47], v3, s[12:15], s25 offen
    s_add_u32 s25, s25, 73728
    buffer_load_dwordx4 v[48:51], v3, s[12:15], s25 offen
    s_add_u32 s25, s25, 73728
    buffer_load_dwordx4 v[52:55], v3, s[12:15], s25 offen
    s_add_u32 s25, s25, 73728
    buffer_load_dwordx4 v[56:59], v3, s[12:15], s25 offen
    s_add_u32 s25, s25, 73728
    buffer_load_dwordx4 v[60:63], v3, s[12:15], s25 offen
    s_add_u32 s25, s25, 73728
    buffer_load_dwordx4 v[64:67], v3, s[12:15], s25 offen
    s_add_u32 s25, s25, 73728
    buffer_load_dwordx4 v[68:71], v3, s[12:15], s25 offen
    s_add_u32 s25, s25, 73728
    buffer_load_dwordx4 v[72:75], v3, s[12:15], s25 offen
    s_add_u32 s25, s25, 73728
    buffer_load_dwordx4 v[76:79], v3, s[12:15], s25 offen
    s_add_u32 s25, s25, 73728
    buffer_load_dwordx4 v[80:83], v3, s[12:15], s25 offen
    s_add_u32 s25, s25, 73728
    buffer_load_dwordx4 v[84:87], v3, s[12:15], s25 offen
    s_add_u32 s25, s25, 73728
    buffer_load_dwordx4 v[88:91], v3, s[12:15], s25 offen
    s_add_u32 s25, s25, 73728
    buffer_load_dwordx4 v[92:95], v3, s[12:15], s25 offen
    s_add_u32 s25, s25, 73728
    buffer_load_dwordx4 v[96:99], v3, s[12:15], s25 offen
    s_add_u32 s25, s25, 73728
    buffer_load_dwordx4 v[100:103], v3, s[12:15], s25 offen
    s_add_u32 s25, s25, 73728
    buffer_load_dwordx4 v[104:107], v3, s[12:15], s25 offen
    s_add_u32 s25, s25, 73728
    buffer_load_dwordx4 v[108:111], v3, s[12:15], s25 offen
    s_add_u32 s25, s25, 73728
    buffer_load_dwordx4 v[112:115], v3, s[12:15], s25 offen
    s_add_u32 s25, s25, 73728
    buffer_load_dwordx4 v[116:119], v3, s[12:15], s25 offen
    s_add_u32 s25, s25, 73728
    buffer_load_dwordx4 v[120:123], v3, s[12:15], s25 offen
    s_add_u32 s25, s25, 73728
    buffer_load_dwordx4 v[124:127], v3, s[12:15], s25 offen
    s_add_u32 s25, s25, 73728
    s_add_u32 s27, s27, 768
    s_waitcnt vmcnt(23)
    v_lshlrev_b32 v24, 16, v32
    v_and_b32 v25, 0xffff0000, v32
    v_fmac_f32 v8, v152, v24
    v_fmac_f32 v9, v152, v25
    v_fmac_f32 v16, v128, v24
    v_fmac_f32 v17, v128, v25
    v_lshlrev_b32 v24, 16, v33
    v_and_b32 v25, 0xffff0000, v33
    v_fmac_f32 v10, v152, v24
    v_fmac_f32 v11, v152, v25
    v_fmac_f32 v18, v128, v24
    v_fmac_f32 v19, v128, v25
    v_lshlrev_b32 v24, 16, v34
    v_and_b32 v25, 0xffff0000, v34
    v_fmac_f32 v12, v152, v24
    v_fmac_f32 v13, v152, v25
    v_fmac_f32 v20, v128, v24
    v_fmac_f32 v21, v128, v25
    v_lshlrev_b32 v24, 16, v35
    v_and_b32 v25, 0xffff0000, v35
    v_fmac_f32 v14, v152, v24
    v_fmac_f32 v15, v152, v25
    v_fmac_f32 v22, v128, v24
    v_fmac_f32 v23, v128, v25
    s_waitcnt vmcnt(22)
    v_lshlrev_b32 v24, 16, v36
    v_and_b32 v25, 0xffff0000, v36
    v_fmac_f32 v8, v153, v24
    v_fmac_f32 v9, v153, v25
    v_fmac_f32 v16, v129, v24
    v_fmac_f32 v17, v129, v25
    v_lshlrev_b32 v24, 16, v37
    v_and_b32 v25, 0xffff0000, v37
    v_fmac_f32 v10, v153, v24
    v_fmac_f32 v11, v153, v25
    v_fmac_f32 v18, v129, v24
    v_fmac_f32 v19, v129, v25
    v_lshlrev_b32 v24, 16, v38
    v_and_b32 v25, 0xffff0000, v38
    v_fmac_f32 v12, v153, v24
    v_fmac_f32 v13, v153, v25
    v_fmac_f32 v20, v129, v24
    v_fmac_f32 v21, v129, v25
    v_lshlrev_b32 v24, 16, v39
    v_and_b32 v25, 0xffff0000, v39
    v_fmac_f32 v14, v153, v24
    v_fmac_f32 v15, v153, v25
    v_fmac_f32 v22, v129, v24
    v_fmac_f32 v23, v129, v25
    s_waitcnt vmcnt(21)
    v_lshlrev_b32 v24, 16, v40
    v_and_b32 v25, 0xffff0000, v40
    v_fmac_f32 v8, v154, v24
    v_fmac_f32 v9, v154, v25
    v_fmac_f32 v16, v130, v24
    v_fmac_f32 v17, v130, v25
    v_lshlrev_b32 v24, 16, v41
    v_and_b32 v25, 0xffff0000, v41
    v_fmac_f32 v10, v154, v24
    v_fmac_f32 v11, v154, v25
    v_fmac_f32 v18, v130, v24
    v_fmac_f32 v19, v130, v25
    v_lshlrev_b32 v24, 16, v42
    v_and_b32 v25, 0xffff0000, v42
    v_fmac_f32 v12, v154, v24
    v_fmac_f32 v13, v154, v25
    v_fmac_f32 v20, v130, v24
    v_fmac_f32 v21, v130, v25
    v_lshlrev_b32 v24, 16, v43
    v_and_b32 v25, 0xffff0000, v43
    v_fmac_f32 v14, v154, v24
    v_fmac_f32 v15, v154, v25
    v_fmac_f32 v22, v130, v24
    v_fmac_f32 v23, v130, v25
    s_waitcnt vmcnt(20)
    v_lshlrev_b32 v24, 16, v44
    v_and_b32 v25, 0xffff0000, v44
    v_fmac_f32 v8, v155, v24
    v_fmac_f32 v9, v155, v25
    v_fmac_f32 v16, v131, v24
    v_fmac_f32 v17, v131, v25
    v_lshlrev_b32 v24, 16, v45
    v_and_b32 v25, 0xffff0000, v45
    v_fmac_f32 v10, v155, v24
    v_fmac_f32 v11, v155, v25
    v_fmac_f32 v18, v131, v24
    v_fmac_f32 v19, v131, v25
    v_lshlrev_b32 v24, 16, v46
    v_and_b32 v25, 0xffff0000, v46
    v_fmac_f32 v12, v155, v24
    v_fmac_f32 v13, v155, v25
    v_fmac_f32 v20, v131, v24
    v_fmac_f32 v21, v131, v25
    v_lshlrev_b32 v24, 16, v47
    v_and_b32 v25, 0xffff0000, v47
    v_fmac_f32 v14, v155, v24
    v_fmac_f32 v15, v155, v25
    v_fmac_f32 v22, v131, v24
    v_fmac_f32 v23, v131, v25
    s_waitcnt vmcnt(19)
    v_lshlrev_b32 v24, 16, v48
    v_and_b32 v25, 0xffff0000, v48
    v_fmac_f32 v8, v156, v24
    v_fmac_f32 v9, v156, v25
    v_fmac_f32 v16, v132, v24
    v_fmac_f32 v17, v132, v25
    v_lshlrev_b32 v24, 16, v49
    v_and_b32 v25, 0xffff0000, v49
    v_fmac_f32 v10, v156, v24
    v_fmac_f32 v11, v156, v25
    v_fmac_f32 v18, v132, v24
    v_fmac_f32 v19, v132, v25
    v_lshlrev_b32 v24, 16, v50
    v_and_b32 v25, 0xffff0000, v50
    v_fmac_f32 v12, v156, v24
    v_fmac_f32 v13, v156, v25
    v_fmac_f32 v20, v132, v24
    v_fmac_f32 v21, v132, v25
    v_lshlrev_b32 v24, 16, v51
    v_and_b32 v25, 0xffff0000, v51
    v_fmac_f32 v14, v156, v24
    v_fmac_f32 v15, v156, v25
    v_fmac_f32 v22, v132, v24
    v_fmac_f32 v23, v132, v25
    s_waitcnt vmcnt(18)
    v_lshlrev_b32 v24, 16, v52
    v_and_b32 v25, 0xffff0000, v52
    v_fmac_f32 v8, v157, v24
    v_fmac_f32 v9, v157, v25
    v_fmac_f32 v16, v133, v24
    v_fmac_f32 v17, v133, v25
    v_lshlrev_b32 v24, 16, v53
    v_and_b32 v25, 0xffff0000, v53
    v_fmac_f32 v10, v157, v24
    v_fmac_f32 v11, v157, v25
    v_fmac_f32 v18, v133, v24
    v_fmac_f32 v19, v133, v25
    v_lshlrev_b32 v24, 16, v54
    v_and_b32 v25, 0xffff0000, v54
    v_fmac_f32 v12, v157, v24
    v_fmac_f32 v13, v157, v25
    v_fmac_f32 v20, v133, v24
    v_fmac_f32 v21, v133, v25
    v_lshlrev_b32 v24, 16, v55
    v_and_b32 v25, 0xffff0000, v55
    v_fmac_f32 v14, v157, v24
    v_fmac_f32 v15, v157, v25
    v_fmac_f32 v22, v133, v24
    v_fmac_f32 v23, v133, v25
    s_waitcnt vmcnt(17)
    v_lshlrev_b32 v24, 16, v56
    v_and_b32 v25, 0xffff0000, v56
    v_fmac_f32 v8, v158, v24
    v_fmac_f32 v9, v158, v25
    v_fmac_f32 v16, v134, v24
    v_fmac_f32 v17, v134, v25
    v_lshlrev_b32 v24, 16, v57
    v_and_b32 v25, 0xffff0000, v57
    v_fmac_f32 v10, v158, v24
    v_fmac_f32 v11, v158, v25
    v_fmac_f32 v18, v134, v24
    v_fmac_f32 v19, v134, v25
    v_lshlrev_b32 v24, 16, v58
    v_and_b32 v25, 0xffff0000, v58
    v_fmac_f32 v12, v158, v24
    v_fmac_f32 v13, v158, v25
    v_fmac_f32 v20, v134, v24
    v_fmac_f32 v21, v134, v25
    v_lshlrev_b32 v24, 16, v59
    v_and_b32 v25, 0xffff0000, v59
    v_fmac_f32 v14, v158, v24
    v_fmac_f32 v15, v158, v25
    v_fmac_f32 v22, v134, v24
    v_fmac_f32 v23, v134, v25
    s_waitcnt vmcnt(16)
    v_lshlrev_b32 v24, 16, v60
    v_and_b32 v25, 0xffff0000, v60
    v_fmac_f32 v8, v159, v24
    v_fmac_f32 v9, v159, v25
    v_fmac_f32 v16, v135, v24
    v_fmac_f32 v17, v135, v25
    v_lshlrev_b32 v24, 16, v61
    v_and_b32 v25, 0xffff0000, v61
    v_fmac_f32 v10, v159, v24
    v_fmac_f32 v11, v159, v25
    v_fmac_f32 v18, v135, v24
    v_fmac_f32 v19, v135, v25
    v_lshlrev_b32 v24, 16, v62
    v_and_b32 v25, 0xffff0000, v62
    v_fmac_f32 v12, v159, v24
    v_fmac_f32 v13, v159, v25
    v_fmac_f32 v20, v135, v24
    v_fmac_f32 v21, v135, v25
    v_lshlrev_b32 v24, 16, v63
    v_and_b32 v25, 0xffff0000, v63
    v_fmac_f32 v14, v159, v24
    v_fmac_f32 v15, v159, v25
    v_fmac_f32 v22, v135, v24
    v_fmac_f32 v23, v135, v25
    s_waitcnt vmcnt(15)
    v_lshlrev_b32 v24, 16, v64
    v_and_b32 v25, 0xffff0000, v64
    v_fmac_f32 v8, v160, v24
    v_fmac_f32 v9, v160, v25
    v_fmac_f32 v16, v136, v24
    v_fmac_f32 v17, v136, v25
    v_lshlrev_b32 v24, 16, v65
    v_and_b32 v25, 0xffff0000, v65
    v_fmac_f32 v10, v160, v24
    v_fmac_f32 v11, v160, v25
    v_fmac_f32 v18, v136, v24
    v_fmac_f32 v19, v136, v25
    v_lshlrev_b32 v24, 16, v66
    v_and_b32 v25, 0xffff0000, v66
    v_fmac_f32 v12, v160, v24
    v_fmac_f32 v13, v160, v25
    v_fmac_f32 v20, v136, v24
    v_fmac_f32 v21, v136, v25
    v_lshlrev_b32 v24, 16, v67
    v_and_b32 v25, 0xffff0000, v67
    v_fmac_f32 v14, v160, v24
    v_fmac_f32 v15, v160, v25
    v_fmac_f32 v22, v136, v24
    v_fmac_f32 v23, v136, v25
    s_waitcnt vmcnt(14)
    v_lshlrev_b32 v24, 16, v68
    v_and_b32 v25, 0xffff0000, v68
    v_fmac_f32 v8, v161, v24
    v_fmac_f32 v9, v161, v25
    v_fmac_f32 v16, v137, v24
    v_fmac_f32 v17, v137, v25
    v_lshlrev_b32 v24, 16, v69
    v_and_b32 v25, 0xffff0000, v69
    v_fmac_f32 v10, v161, v24
    v_fmac_f32 v11, v161, v25
    v_fmac_f32 v18, v137, v24
    v_fmac_f32 v19, v137, v25
    v_lshlrev_b32 v24, 16, v70
    v_and_b32 v25, 0xffff0000, v70
    v_fmac_f32 v12, v161, v24
    v_fmac_f32 v13, v161, v25
    v_fmac_f32 v20, v137, v24
    v_fmac_f32 v21, v137, v25
    v_lshlrev_b32 v24, 16, v71
    v_and_b32 v25, 0xffff0000, v71
    v_fmac_f32 v14, v161, v24
    v_fmac_f32 v15, v161, v25
    v_fmac_f32 v22, v137, v24
    v_fmac_f32 v23, v137, v25
    s_waitcnt vmcnt(13)
    v_lshlrev_b32 v24, 16, v72
    v_and_b32 v25, 0xffff0000, v72
    v_fmac_f32 v8, v162, v24
    v_fmac_f32 v9, v162, v25
    v_fmac_f32 v16, v138, v24
    v_fmac_f32 v17, v138, v25
    v_lshlrev_b32 v24, 16, v73
    v_and_b32 v25, 0xffff0000, v73
    v_fmac_f32 v10, v162, v24
    v_fmac_f32 v11, v162, v25
    v_fmac_f32 v18, v138, v24
    v_fmac_f32 v19, v138, v25
    v_lshlrev_b32 v24, 16, v74
    v_and_b32 v25, 0xffff0000, v74
    v_fmac_f32 v12, v162, v24
    v_fmac_f32 v13, v162, v25
    v_fmac_f32 v20, v138, v24
    v_fmac_f32 v21, v138, v25
    v_lshlrev_b32 v24, 16, v75
    v_and_b32 v25, 0xffff0000, v75
    v_fmac_f32 v14, v162, v24
    v_fmac_f32 v15, v162, v25
    v_fmac_f32 v22, v138, v24
    v_fmac_f32 v23, v138, v25
    s_waitcnt vmcnt(12)
    v_lshlrev_b32 v24, 16, v76
    v_and_b32 v25, 0xffff0000, v76
    v_fmac_f32 v8, v163, v24
    v_fmac_f32 v9, v163, v25
    v_fmac_f32 v16, v139, v24
    v_fmac_f32 v17, v139, v25
    v_lshlrev_b32 v24, 16, v77
    v_and_b32 v25, 0xffff0000, v77
    v_fmac_f32 v10, v163, v24
    v_fmac_f32 v11, v163, v25
    v_fmac_f32 v18, v139, v24
    v_fmac_f32 v19, v139, v25
    v_lshlrev_b32 v24, 16, v78
    v_and_b32 v25, 0xffff0000, v78
    v_fmac_f32 v12, v163, v24
    v_fmac_f32 v13, v163, v25
    v_fmac_f32 v20, v139, v24
    v_fmac_f32 v21, v139, v25
    v_lshlrev_b32 v24, 16, v79
    v_and_b32 v25, 0xffff0000, v79
    v_fmac_f32 v14, v163, v24
    v_fmac_f32 v15, v163, v25
    v_fmac_f32 v22, v139, v24
    v_fmac_f32 v23, v139, v25
    s_waitcnt vmcnt(11)
    v_lshlrev_b32 v24, 16, v80
    v_and_b32 v25, 0xffff0000, v80
    v_fmac_f32 v8, v164, v24
    v_fmac_f32 v9, v164, v25
    v_fmac_f32 v16, v140, v24
    v_fmac_f32 v17, v140, v25
    v_lshlrev_b32 v24, 16, v81
    v_and_b32 v25, 0xffff0000, v81
    v_fmac_f32 v10, v164, v24
    v_fmac_f32 v11, v164, v25
    v_fmac_f32 v18, v140, v24
    v_fmac_f32 v19, v140, v25
    v_lshlrev_b32 v24, 16, v82
    v_and_b32 v25, 0xffff0000, v82
    v_fmac_f32 v12, v164, v24
    v_fmac_f32 v13, v164, v25
    v_fmac_f32 v20, v140, v24
    v_fmac_f32 v21, v140, v25
    v_lshlrev_b32 v24, 16, v83
    v_and_b32 v25, 0xffff0000, v83
    v_fmac_f32 v14, v164, v24
    v_fmac_f32 v15, v164, v25
    v_fmac_f32 v22, v140, v24
    v_fmac_f32 v23, v140, v25
    s_waitcnt vmcnt(10)
    v_lshlrev_b32 v24, 16, v84
    v_and_b32 v25, 0xffff0000, v84
    v_fmac_f32 v8, v165, v24
    v_fmac_f32 v9, v165, v25
    v_fmac_f32 v16, v141, v24
    v_fmac_f32 v17, v141, v25
    v_lshlrev_b32 v24, 16, v85
    v_and_b32 v25, 0xffff0000, v85
    v_fmac_f32 v10, v165, v24
    v_fmac_f32 v11, v165, v25
    v_fmac_f32 v18, v141, v24
    v_fmac_f32 v19, v141, v25
    v_lshlrev_b32 v24, 16, v86
    v_and_b32 v25, 0xffff0000, v86
    v_fmac_f32 v12, v165, v24
    v_fmac_f32 v13, v165, v25
    v_fmac_f32 v20, v141, v24
    v_fmac_f32 v21, v141, v25
    v_lshlrev_b32 v24, 16, v87
    v_and_b32 v25, 0xffff0000, v87
    v_fmac_f32 v14, v165, v24
    v_fmac_f32 v15, v165, v25
    v_fmac_f32 v22, v141, v24
    v_fmac_f32 v23, v141, v25
    s_waitcnt vmcnt(9)
    v_lshlrev_b32 v24, 16, v88
    v_and_b32 v25, 0xffff0000, v88
    v_fmac_f32 v8, v166, v24
    v_fmac_f32 v9, v166, v25
    v_fmac_f32 v16, v142, v24
    v_fmac_f32 v17, v142, v25
    v_lshlrev_b32 v24, 16, v89
    v_and_b32 v25, 0xffff0000, v89
    v_fmac_f32 v10, v166, v24
    v_fmac_f32 v11, v166, v25
    v_fmac_f32 v18, v142, v24
    v_fmac_f32 v19, v142, v25
    v_lshlrev_b32 v24, 16, v90
    v_and_b32 v25, 0xffff0000, v90
    v_fmac_f32 v12, v166, v24
    v_fmac_f32 v13, v166, v25
    v_fmac_f32 v20, v142, v24
    v_fmac_f32 v21, v142, v25
    v_lshlrev_b32 v24, 16, v91
    v_and_b32 v25, 0xffff0000, v91
    v_fmac_f32 v14, v166, v24
    v_fmac_f32 v15, v166, v25
    v_fmac_f32 v22, v142, v24
    v_fmac_f32 v23, v142, v25
    s_waitcnt vmcnt(8)
    v_lshlrev_b32 v24, 16, v92
    v_and_b32 v25, 0xffff0000, v92
    v_fmac_f32 v8, v167, v24
    v_fmac_f32 v9, v167, v25
    v_fmac_f32 v16, v143, v24
    v_fmac_f32 v17, v143, v25
    v_lshlrev_b32 v24, 16, v93
    v_and_b32 v25, 0xffff0000, v93
    v_fmac_f32 v10, v167, v24
    v_fmac_f32 v11, v167, v25
    v_fmac_f32 v18, v143, v24
    v_fmac_f32 v19, v143, v25
    v_lshlrev_b32 v24, 16, v94
    v_and_b32 v25, 0xffff0000, v94
    v_fmac_f32 v12, v167, v24
    v_fmac_f32 v13, v167, v25
    v_fmac_f32 v20, v143, v24
    v_fmac_f32 v21, v143, v25
    v_lshlrev_b32 v24, 16, v95
    v_and_b32 v25, 0xffff0000, v95
    v_fmac_f32 v14, v167, v24
    v_fmac_f32 v15, v167, v25
    v_fmac_f32 v22, v143, v24
    v_fmac_f32 v23, v143, v25
    s_waitcnt vmcnt(7)
    v_lshlrev_b32 v24, 16, v96
    v_and_b32 v25, 0xffff0000, v96
    v_fmac_f32 v8, v168, v24
    v_fmac_f32 v9, v168, v25
    v_fmac_f32 v16, v144, v24
    v_fmac_f32 v17, v144, v25
    v_lshlrev_b32 v24, 16, v97
    v_and_b32 v25, 0xffff0000, v97
    v_fmac_f32 v10, v168, v24
    v_fmac_f32 v11, v168, v25
    v_fmac_f32 v18, v144, v24
    v_fmac_f32 v19, v144, v25
    v_lshlrev_b32 v24, 16, v98
    v_and_b32 v25, 0xffff0000, v98
    v_fmac_f32 v12, v168, v24
    v_fmac_f32 v13, v168, v25
    v_fmac_f32 v20, v144, v24
    v_fmac_f32 v21, v144, v25
    v_lshlrev_b32 v24, 16, v99
    v_and_b32 v25, 0xffff0000, v99
    v_fmac_f32 v14, v168, v24
    v_fmac_f32 v15, v168, v25
    v_fmac_f32 v22, v144, v24
    v_fmac_f32 v23, v144, v25
    s_waitcnt vmcnt(6)
    v_lshlrev_b32 v24, 16, v100
    v_and_b32 v25, 0xffff0000, v100
    v_fmac_f32 v8, v169, v24
    v_fmac_f32 v9, v169, v25
    v_fmac_f32 v16, v145, v24
    v_fmac_f32 v17, v145, v25
    v_lshlrev_b32 v24, 16, v101
    v_and_b32 v25, 0xffff0000, v101
    v_fmac_f32 v10, v169, v24
    v_fmac_f32 v11, v169, v25
    v_fmac_f32 v18, v145, v24
    v_fmac_f32 v19, v145, v25
    v_lshlrev_b32 v24, 16, v102
    v_and_b32 v25, 0xffff0000, v102
    v_fmac_f32 v12, v169, v24
    v_fmac_f32 v13, v169, v25
    v_fmac_f32 v20, v145, v24
    v_fmac_f32 v21, v145, v25
    v_lshlrev_b32 v24, 16, v103
    v_and_b32 v25, 0xffff0000, v103
    v_fmac_f32 v14, v169, v24
    v_fmac_f32 v15, v169, v25
    v_fmac_f32 v22, v145, v24
    v_fmac_f32 v23, v145, v25
    s_waitcnt vmcnt(5)
    v_lshlrev_b32 v24, 16, v104
    v_and_b32 v25, 0xffff0000, v104
    v_fmac_f32 v8, v170, v24
    v_fmac_f32 v9, v170, v25
    v_fmac_f32 v16, v146, v24
    v_fmac_f32 v17, v146, v25
    v_lshlrev_b32 v24, 16, v105
    v_and_b32 v25, 0xffff0000, v105
    v_fmac_f32 v10, v170, v24
    v_fmac_f32 v11, v170, v25
    v_fmac_f32 v18, v146, v24
    v_fmac_f32 v19, v146, v25
    v_lshlrev_b32 v24, 16, v106
    v_and_b32 v25, 0xffff0000, v106
    v_fmac_f32 v12, v170, v24
    v_fmac_f32 v13, v170, v25
    v_fmac_f32 v20, v146, v24
    v_fmac_f32 v21, v146, v25
    v_lshlrev_b32 v24, 16, v107
    v_and_b32 v25, 0xffff0000, v107
    v_fmac_f32 v14, v170, v24
    v_fmac_f32 v15, v170, v25
    v_fmac_f32 v22, v146, v24
    v_fmac_f32 v23, v146, v25
    s_waitcnt vmcnt(4)
    v_lshlrev_b32 v24, 16, v108
    v_and_b32 v25, 0xffff0000, v108
    v_fmac_f32 v8, v171, v24
    v_fmac_f32 v9, v171, v25
    v_fmac_f32 v16, v147, v24
    v_fmac_f32 v17, v147, v25
    v_lshlrev_b32 v24, 16, v109
    v_and_b32 v25, 0xffff0000, v109
    v_fmac_f32 v10, v171, v24
    v_fmac_f32 v11, v171, v25
    v_fmac_f32 v18, v147, v24
    v_fmac_f32 v19, v147, v25
    v_lshlrev_b32 v24, 16, v110
    v_and_b32 v25, 0xffff0000, v110
    v_fmac_f32 v12, v171, v24
    v_fmac_f32 v13, v171, v25
    v_fmac_f32 v20, v147, v24
    v_fmac_f32 v21, v147, v25
    v_lshlrev_b32 v24, 16, v111
    v_and_b32 v25, 0xffff0000, v111
    v_fmac_f32 v14, v171, v24
    v_fmac_f32 v15, v171, v25
    v_fmac_f32 v22, v147, v24
    v_fmac_f32 v23, v147, v25
    s_waitcnt vmcnt(3)
    v_lshlrev_b32 v24, 16, v112
    v_and_b32 v25, 0xffff0000, v112
    v_fmac_f32 v8, v172, v24
    v_fmac_f32 v9, v172, v25
    v_fmac_f32 v16, v148, v24
    v_fmac_f32 v17, v148, v25
    v_lshlrev_b32 v24, 16, v113
    v_and_b32 v25, 0xffff0000, v113
    v_fmac_f32 v10, v172, v24
    v_fmac_f32 v11, v172, v25
    v_fmac_f32 v18, v148, v24
    v_fmac_f32 v19, v148, v25
    v_lshlrev_b32 v24, 16, v114
    v_and_b32 v25, 0xffff0000, v114
    v_fmac_f32 v12, v172, v24
    v_fmac_f32 v13, v172, v25
    v_fmac_f32 v20, v148, v24
    v_fmac_f32 v21, v148, v25
    v_lshlrev_b32 v24, 16, v115
    v_and_b32 v25, 0xffff0000, v115
    v_fmac_f32 v14, v172, v24
    v_fmac_f32 v15, v172, v25
    v_fmac_f32 v22, v148, v24
    v_fmac_f32 v23, v148, v25
    s_waitcnt vmcnt(2)
    v_lshlrev_b32 v24, 16, v116
    v_and_b32 v25, 0xffff0000, v116
    v_fmac_f32 v8, v173, v24
    v_fmac_f32 v9, v173, v25
    v_fmac_f32 v16, v149, v24
    v_fmac_f32 v17, v149, v25
    v_lshlrev_b32 v24, 16, v117
    v_and_b32 v25, 0xffff0000, v117
    v_fmac_f32 v10, v173, v24
    v_fmac_f32 v11, v173, v25
    v_fmac_f32 v18, v149, v24
    v_fmac_f32 v19, v149, v25
    v_lshlrev_b32 v24, 16, v118
    v_and_b32 v25, 0xffff0000, v118
    v_fmac_f32 v12, v173, v24
    v_fmac_f32 v13, v173, v25
    v_fmac_f32 v20, v149, v24
    v_fmac_f32 v21, v149, v25
    v_lshlrev_b32 v24, 16, v119
    v_and_b32 v25, 0xffff0000, v119
    v_fmac_f32 v14, v173, v24
    v_fmac_f32 v15, v173, v25
    v_fmac_f32 v22, v149, v24
    v_fmac_f32 v23, v149, v25
    s_waitcnt vmcnt(1)
    v_lshlrev_b32 v24, 16, v120
    v_and_b32 v25, 0xffff0000, v120
    v_fmac_f32 v8, v174, v24
    v_fmac_f32 v9, v174, v25
    v_fmac_f32 v16, v150, v24
    v_fmac_f32 v17, v150, v25
    v_lshlrev_b32 v24, 16, v121
    v_and_b32 v25, 0xffff0000, v121
    v_fmac_f32 v10, v174, v24
    v_fmac_f32 v11, v174, v25
    v_fmac_f32 v18, v150, v24
    v_fmac_f32 v19, v150, v25
    v_lshlrev_b32 v24, 16, v122
    v_and_b32 v25, 0xffff0000, v122
    v_fmac_f32 v12, v174, v24
    v_fmac_f32 v13, v174, v25
    v_fmac_f32 v20, v150, v24
    v_fmac_f32 v21, v150, v25
    v_lshlrev_b32 v24, 16, v123
    v_and_b32 v25, 0xffff0000, v123
    v_fmac_f32 v14, v174, v24
    v_fmac_f32 v15, v174, v25
    v_fmac_f32 v22, v150, v24
    v_fmac_f32 v23, v150, v25
    s_waitcnt vmcnt(0)
    v_lshlrev_b32 v24, 16, v124
    v_and_b32 v25, 0xffff0000, v124
    v_fmac_f32 v8, v175, v24
    v_fmac_f32 v9, v175, v25
    v_fmac_f32 v16, v151, v24
    v_fmac_f32 v17, v151, v25
    v_lshlrev_b32 v24, 16, v125
    v_and_b32 v25, 0xffff0000, v125
    v_fmac_f32 v10, v175, v24
    v_fmac_f32 v11, v175, v25
    v_fmac_f32 v18, v151, v24
    v_fmac_f32 v19, v151, v25
    v_lshlrev_b32 v24, 16, v126
    v_and_b32 v25, 0xffff0000, v126
    v_fmac_f32 v12, v175, v24
    v_fmac_f32 v13, v175, v25
    v_fmac_f32 v20, v151, v24
    v_fmac_f32 v21, v151, v25
    v_lshlrev_b32 v24, 16, v127
    v_and_b32 v25, 0xffff0000, v127
    v_fmac_f32 v14, v175, v24
    v_fmac_f32 v15, v175, v25
    v_fmac_f32 v22, v151, v24
    v_fmac_f32 v23, v151, v25
    s_sub_u32 s26, s26, 1
    s_cmp_lg_u32 s26, 0
    s_cbranch_scc1 K2_sloop
    v_lshlrev_b32 v5, 11, v2
    v_lshl_add_u32 v5, v1, 5, v5
    ds_write_b128 v5, v[8:11]
    ds_write_b128 v5, v[12:15] offset:16
    ds_write_b128 v5, v[16:19] offset:1024
    ds_write_b128 v5, v[20:23] offset:1040
    s_waitcnt lgkmcnt(0)
    s_barrier
    v_lshlrev_b32 v5, 2, v0
    ds_read_b32 v8, v5 offset:0
    ds_read_b32 v16, v5 offset:1024
    ds_read_b32 v9, v5 offset:2048
    ds_read_b32 v17, v5 offset:3072
    ds_read_b32 v10, v5 offset:4096
    ds_read_b32 v18, v5 offset:5120
    ds_read_b32 v11, v5 offset:6144
    ds_read_b32 v19, v5 offset:7168
    ds_read_b32 v12, v5 offset:8192
    ds_read_b32 v20, v5 offset:9216
    ds_read_b32 v13, v5 offset:10240
    ds_read_b32 v21, v5 offset:11264
    ds_read_b32 v14, v5 offset:12288
    ds_read_b32 v22, v5 offset:13312
    ds_read_b32 v15, v5 offset:14336
    ds_read_b32 v23, v5 offset:15360
    s_waitcnt lgkmcnt(0)
    v_add_f32 v8, v8, v12
    v_add_f32 v16, v16, v20
    v_add_f32 v9, v9, v13
    v_add_f32 v17, v17, v21
    v_add_f32 v10, v10, v14
    v_add_f32 v18, v18, v22
    v_add_f32 v11, v11, v15
    v_add_f32 v19, v19, v23
    v_add_f32 v8, v8, v10
    v_add_f32 v16, v16, v18
    v_add_f32 v9, v9, v11
    v_add_f32 v17, v17, v19
    v_add_f32 v8, v8, v9
    v_add_f32 v16, v16, v17
    s_lshl_b32 s25, s3, 10
    buffer_store_dword v8, v5, s[20:23], s25 offen
    s_add_u32 s25, s25, 18432
    buffer_store_dword v16, v5, s[20:23], s25 offen
    s_waitcnt vmcnt(0)
K2_end2:
    s_endpgm
.text
.globl k3_win_kernel
.p2align 8
.type k3_win_kernel,@function
k3_win_kernel:
    s_cmp_ge_u32 s2, 256
    s_cbranch_scc1 K3_end
    s_load_dwordx2 s[4:5], s[0:1], 112
    s_load_dwordx2 s[6:7], s[0:1], 48
    v_and_b32 v1, 63, v0
    v_lshrrev_b32 v2, 6, v0
    v_lshlrev_b32 v18, 4, v1
    v_readfirstlane_b32 s3, v2
    s_and_b32 s28, s2, 7
    s_lshl_b32 s28, s28, 2
    s_bfe_u32 s29, s2, 0x20003
    s_add_u32 s28, s28, s29
    s_lshr_b32 s29, s2, 5
    s_and_b32 s31, s28, 1
    s_lshr_b32 s32, s28, 1
    s_mul_i32 s32, s32, 9
    s_mul_i32 s33, s31, 5
    s_add_u32 s52, s32, s33
    s_lshl_b32 s33, s31, 2
    s_add_u32 s53, s32, s33
    s_lshr_b32 s54, s52, 1
    s_lshl_b32 s54, s54, 6
    s_add_u32 s54, s54, 4608
    s_lshr_b32 s55, s53, 1
    s_lshl_b32 s55, s55, 6
    v_lshrrev_b32 v3, 2, v1
    v_and_b32 v4, 3, v1
    v_lshrrev_b32 v5, 5, v1
    v_lshlrev_b32 v5, 1, v5
    v_xor_b32 v4, v4, v5
    s_mov_b32 s30, 9216
    v_mul_lo_u32 v3, v3, s30
    v_lshl_add_u32 v17, v4, 4, v3
    s_add_u32 s34, s3, 0
    s_mul_i32 s35, s34, 43
    s_lshr_b32 s35, s35, 8
    s_mul_i32 s36, s35, 6
    s_sub_u32 s36, s34, s36
    s_mul_i32 s35, s35, 147456
    s_cmp_ge_u32 s36, 3
    s_cselect_b32 s39, s55, s54
    s_cselect_b32 s33, 3, 0
    s_sub_u32 s36, s36, s33
    s_lshl_b32 s36, s36, 6
    s_add_u32 s35, s35, s36
    s_add_u32 s40, s35, s39
    s_lshl_b32 s44, s34, 10
    s_add_u32 s34, s3, 8
    s_mul_i32 s35, s34, 43
    s_lshr_b32 s35, s35, 8
    s_mul_i32 s36, s35, 6
    s_sub_u32 s36, s34, s36
    s_mul_i32 s35, s35, 147456
    s_cmp_ge_u32 s36, 3
    s_cselect_b32 s39, s55, s54
    s_cselect_b32 s33, 3, 0
    s_sub_u32 s36, s36, s33
    s_lshl_b32 s36, s36, 6
    s_add_u32 s35, s35, s36
    s_add_u32 s41, s35, s39
    s_lshl_b32 s45, s34, 10
    s_add_u32 s34, s3, 16
    s_mul_i32 s35, s34, 43
    s_lshr_b32 s35, s35, 8
    s_mul_i32 s36, s35, 6
    s_sub_u32 s36, s34, s36
    s_mul_i32 s35, s35, 147456
    s_cmp_ge_u32 s36, 3
    s_cselect_b32 s39, s55, s54
    s_cselect_b32 s33, 3, 0
    s_sub_u32 s36, s36, s33
    s_lshl_b32 s36, s36, 6
    s_add_u32 s35, s35, s36
    s_add_u32 s42, s35, s39
    s_lshl_b32 s46, s34, 10
    v_add_u32 v19, 18432, v18
    s_lshl_b32 s37, s29, 4
    s_lshl_b32 s38, s3, 1
    s_add_u32 s37, s37, s38
    s_mul_i32 s38, s37, 18432
    v_and_b32 v3, 31, v1
    v_lshlrev_b32 v3, 7, v3
    s_lshl_b32 s30, s37, 11
    s_waitcnt lgkmcnt(0)
    s_add_u32 s12, s4, 96468992
    s_addc_u32 s13, s5, 0
    s_mov_b32 s14, 2359296
    s_mov_b32 s15, 0x00020000
    s_mov_b32 s16, s6
    s_mov_b32 s17, s7
    s_mov_b32 s18, 5308416
    s_mov_b32 s19, 0x00020000
    s_add_u32 s20, s4, 100663296
    s_addc_u32 s21, s5, 0
    s_mov_b32 s22, 262144
    s_mov_b32 s23, 0x00020000
    s_add_u32 s24, s4, 101711872
    s_addc_u32 s25, s5, 0
    s_mov_b32 s26, 36864
    s_mov_b32 s27, 0x00020000
    s_add_u32 m0, s44, 0
    s_nop 0
    buffer_load_dwordx4 v17, s[16:19], s40 offen lds
    s_add_u32 s40, s40, 589824
    buffer_load_dwordx4 a[72:75], v18, s[12:15], s38 offen offset:0
    buffer_load_dwordx4 a[76:79], v18, s[12:15], s38 offen offset:1024
    s_add_u32 m0, s45, 0
    s_nop 0
    buffer_load_dwordx4 v17, s[16:19], s41 offen lds
    s_add_u32 s41, s41, 589824
    buffer_load_dwordx4 a[80:83], v19, s[12:15], s38 offen offset:0
    buffer_load_dwordx4 a[84:87], v19, s[12:15], s38 offen offset:1024
    s_add_u32 s38, s38, 2048
    s_add_u32 m0, s46, 0
    s_nop 0
    buffer_load_dwordx4 v17, s[16:19], s42 offen lds
    s_add_u32 s42, s42, 589824
    buffer_load_dwordx4 v[32:35], v3, s[20:23], s30 offen offset:0
    buffer_load_dwordx4 v[36:39], v3, s[20:23], s30 offen offset:16
    buffer_load_dwordx4 v[40:43], v3, s[20:23], s30 offen offset:32
    buffer_load_dwordx4 v[44:47], v3, s[20:23], s30 offen offset:48
    buffer_load_dwordx2 v[48:49], v3, s[20:23], s30 offen offset:64
    s_and_b32 s33, s3, 3
    s_lshl_b32 s49, s52, 6
    s_add_u32 s49, s49, 9216
    s_lshl_b32 s50, s53, 6
    s_cmp_ge_u32 s33, 2
    s_cselect_b32 s49, s50, s49
    s_and_b32 s50, s33, 1
    s_mul_i32 s50, s50, 18432
    s_add_u32 s49, s49, s50
    s_lshl_b32 s33, s33, 10
    s_add_u32 m0, s33, 100352
    s_nop 0
    buffer_load_dwordx4 v18, s[24:27], s49 offen lds
    s_add_u32 m0, s44, 24576
    s_nop 0
    buffer_load_dwordx4 v17, s[16:19], s40 offen lds
    s_add_u32 s40, s40, 589824
    buffer_load_dwordx4 a[88:91], v18, s[12:15], s38 offen offset:0
    buffer_load_dwordx4 a[92:95], v18, s[12:15], s38 offen offset:1024
    s_add_u32 m0, s45, 24576
    s_nop 0
    buffer_load_dwordx4 v17, s[16:19], s41 offen lds
    s_add_u32 s41, s41, 589824
    buffer_load_dwordx4 a[96:99], v19, s[12:15], s38 offen offset:0
    buffer_load_dwordx4 a[100:103], v19, s[12:15], s38 offen offset:1024
    s_add_u32 s38, s38, 2048
    s_add_u32 m0, s46, 24576
    s_nop 0
    buffer_load_dwordx4 v17, s[16:19], s42 offen lds
    s_add_u32 s42, s42, 589824
    v_lshrrev_b32 v4, 4, v1
    v_lshrrev_b32 v5, 1, v4
    s_movk_i32 s30, 6144
    v_mul_lo_u32 v5, v5, s30
    v_and_b32 v6, 1, v4
    v_lshl_add_u32 v5, v6, 9, v5
    v_bfe_u32 v7, v1, 2, 2
    v_lshl_add_u32 v5, v7, 6, v5
    v_and_b32 v7, 3, v1
    v_lshl_add_u32 v5, v7, 3, v5
    v_lshlrev_b32 v6, 5, v6
    s_and_b32 s56, s52, 1
    s_and_b32 s57, s53, 1
    s_add_u32 s57, s57, 6
    s_sub_u32 s58, 5, s31
    s_add_u32 s30, s56, 0
    s_add_u32 s33, s57, 0
    s_sub_u32 s33, s33, s58
    s_cmp_gt_u32 s58, 0
    s_cselect_b32 s30, s30, s33
    s_lshr_b32 s33, s30, 1
    s_lshl_b32 s33, s33, 10
    s_and_b32 s30, s30, 1
    s_lshl_b32 s30, s30, 5
    v_xor_b32 v7, s30, v6
    v_add3_u32 v8, v7, v5, s33
    v_add_u32 v23, 49152, v8
    s_add_u32 s30, s56, 1
    s_add_u32 s33, s57, 1
    s_sub_u32 s33, s33, s58
    s_cmp_gt_u32 s58, 1
    s_cselect_b32 s30, s30, s33
    s_lshr_b32 s33, s30, 1
    s_lshl_b32 s33, s33, 10
    s_and_b32 s30, s30, 1
    s_lshl_b32 s30, s30, 5
    v_xor_b32 v7, s30, v6
    v_add3_u32 v9, v7, v5, s33
    v_add_u32 v24, 49152, v9
    s_add_u32 s30, s56, 2
    s_add_u32 s33, s57, 2
    s_sub_u32 s33, s33, s58
    s_cmp_gt_u32 s58, 2
    s_cselect_b32 s30, s30, s33
    s_lshr_b32 s33, s30, 1
    s_lshl_b32 s33, s33, 10
    s_and_b32 s30, s30, 1
    s_lshl_b32 s30, s30, 5
    v_xor_b32 v7, s30, v6
    v_add3_u32 v10, v7, v5, s33
    v_add_u32 v25, 49152, v10
    s_add_u32 s30, s56, 3
    s_add_u32 s33, s57, 3
    s_sub_u32 s33, s33, s58
    s_cmp_gt_u32 s58, 3
    s_cselect_b32 s30, s30, s33
    s_lshr_b32 s33, s30, 1
    s_lshl_b32 s33, s33, 10
    s_and_b32 s30, s30, 1
    s_lshl_b32 s30, s30, 5
    v_xor_b32 v7, s30, v6
    v_add3_u32 v11, v7, v5, s33
    v_add_u32 v26, 49152, v11
    s_add_u32 s30, s56, 4
    s_add_u32 s33, s57, 4
    s_sub_u32 s33, s33, s58
    s_cmp_gt_u32 s58, 4
    s_cselect_b32 s30, s30, s33
    s_lshr_b32 s33, s30, 1
    s_lshl_b32 s33, s33, 10
    s_and_b32 s30, s30, 1
    s_lshl_b32 s30, s30, 5
    v_xor_b32 v7, s30, v6
    v_add3_u32 v12, v7, v5, s33
    v_add_u32 v27, 49152, v12
    s_add_u32 s30, s56, 5
    s_add_u32 s33, s57, 5
    s_sub_u32 s33, s33, s58
    s_cmp_gt_u32 s58, 5
    s_cselect_b32 s30, s30, s33
    s_lshr_b32 s33, s30, 1
    s_lshl_b32 s33, s33, 10
    s_and_b32 s30, s30, 1
    s_lshl_b32 s30, s30, 5
    v_xor_b32 v7, s30, v6
    v_add3_u32 v13, v7, v5, s33
    v_add_u32 v28, 49152, v13
    s_add_u32 s30, s56, 6
    s_add_u32 s33, s57, 6
    s_sub_u32 s33, s33, s58
    s_cmp_gt_u32 s58, 6
    s_cselect_b32 s30, s30, s33
    s_lshr_b32 s33, s30, 1
    s_lshl_b32 s33, s33, 10
    s_and_b32 s30, s30, 1
    s_lshl_b32 s30, s30, 5
    v_xor_b32 v7, s30, v6
    v_add3_u32 v14, v7, v5, s33
    v_add_u32 v29, 49152, v14
    s_add_u32 s30, s56, 7
    s_add_u32 s33, s57, 7
    s_sub_u32 s33, s33, s58
    s_cmp_gt_u32 s58, 7
    s_cselect_b32 s30, s30, s33
    s_lshr_b32 s33, s30, 1
    s_lshl_b32 s33, s33, 10
    s_and_b32 s30, s30, 1
    s_lshl_b32 s30, s30, 5
    v_xor_b32 v7, s30, v6
    v_add3_u32 v15, v7, v5, s33
    v_add_u32 v30, 49152, v15
    s_add_u32 s30, s56, 8
    s_add_u32 s33, s57, 8
    s_sub_u32 s33, s33, s58
    s_cmp_gt_u32 s58, 8
    s_cselect_b32 s30, s30, s33
    s_lshr_b32 s33, s30, 1
    s_lshl_b32 s33, s33, 10
    s_and_b32 s30, s30, 1
    s_lshl_b32 s30, s30, 5
    v_xor_b32 v7, s30, v6
    v_add3_u32 v16, v7, v5, s33
    v_add_u32 v31, 49152, v16
    v_mov_b32 v50, 0
    v_mov_b32 v51, 0
    v_mov_b32 v52, 0
    v_mov_b32 v53, 0
    v_mov_b32 v54, 0
    v_mov_b32 v55, 0
    v_mov_b32 v56, 0
    v_mov_b32 v57, 0
    v_mov_b32 v58, 0
    v_mov_b32 v59, 0
    v_mov_b32 v60, 0
    v_mov_b32 v61, 0
    v_mov_b32 v62, 0
    v_mov_b32 v63, 0
    v_mov_b32 v64, 0
    v_mov_b32 v65, 0
    v_mov_b32 v66, 0
    v_mov_b32 v67, 0
    v_mov_b32 v68, 0
    v_mov_b32 v69, 0
    v_mov_b32 v70, 0
    v_mov_b32 v71, 0
    v_mov_b32 v72, 0
    v_mov_b32 v73, 0
    v_mov_b32 v74, 0
    v_mov_b32 v75, 0
    v_mov_b32 v76, 0
    v_mov_b32 v77, 0
    v_mov_b32 v78, 0
    v_mov_b32 v79, 0
    v_mov_b32 v80, 0
    v_mov_b32 v81, 0
    v_mov_b32 v82, 0
    v_mov_b32 v83, 0
    v_mov_b32 v84, 0
    v_mov_b32 v85, 0
    v_mov_b32 v86, 0
    v_mov_b32 v87, 0
    v_mov_b32 v88, 0
    v_mov_b32 v89, 0
    v_mov_b32 v90, 0
    v_mov_b32 v91, 0
    v_mov_b32 v92, 0
    v_mov_b32 v93, 0
    v_mov_b32 v94, 0
    v_mov_b32 v95, 0
    v_mov_b32 v96, 0
    v_mov_b32 v97, 0
    v_mov_b32 v98, 0
    v_mov_b32 v99, 0
    v_mov_b32 v100, 0
    v_mov_b32 v101, 0
    v_mov_b32 v102, 0
    v_mov_b32 v103, 0
    v_lshrrev_b32 v5, 1, v4
    v_lshlrev_b32 v5, 8, v5
    v_and_b32 v6, 15, v1
    v_lshl_add_u32 v5, v6, 4, v5
    v_and_b32 v7, 1, v4
    v_lshl_add_u32 v21, v7, 3, v5
    s_mov_b32 s47, 3222493025
    s_mov_b32 s48, 3184710632
    v_mov_b32 v20, s47
    s_lshl_b32 s30, s3, 8
    s_add_u32 s30, s30, 98304
    s_waitcnt vmcnt(7)
    s_barrier
    ds_read_b64_tr_b16 a[0:1], v8 offset:0
    ds_read_b64_tr_b16 a[2:3], v8 offset:256
    ds_read_b64_tr_b16 a[4:5], v9 offset:0
    ds_read_b64_tr_b16 a[6:7], v9 offset:256
    ds_read_b64_tr_b16 a[8:9], v10 offset:0
    ds_read_b64_tr_b16 a[10:11], v10 offset:256
    ds_read_b64_tr_b16 a[12:13], v11 offset:0
    ds_read_b64_tr_b16 a[14:15], v11 offset:256
    ds_read_b64_tr_b16 a[16:17], v12 offset:0
    ds_read_b64_tr_b16 a[18:19], v12 offset:256
    ds_read_b64_tr_b16 a[20:21], v13 offset:0
    ds_read_b64_tr_b16 a[22:23], v13 offset:256
    ds_read_b64_tr_b16 a[24:25], v14 offset:0
    ds_read_b64_tr_b16 a[26:27], v14 offset:256
    ds_read_b64_tr_b16 a[28:29], v15 offset:0
    ds_read_b64_tr_b16 a[30:31], v15 offset:256
    ds_read_b64_tr_b16 a[32:33], v16 offset:0
    ds_read_b64_tr_b16 a[34:35], v16 offset:256
    v_add_f32 v32, v32, v34
    v_add_f32 v33, v33, v35
    v_add_f32 v32, v32, v36
    v_add_f32 v33, v33, v37
    v_add_f32 v32, v32, v38
    v_add_f32 v33, v33, v39
    v_add_f32 v32, v32, v40
    v_add_f32 v33, v33, v41
    v_add_f32 v32, v32, v42
    v_add_f32 v33, v33, v43
    v_add_f32 v32, v32, v44
    v_add_f32 v33, v33, v45
    v_add_f32 v32, v32, v46
    v_add_f32 v33, v33, v47
    v_add_f32 v32, v32, v48
    v_add_f32 v33, v33, v49
    s_mov_b32 s33, 987991609
    v_mul_f32 v32, s33, v32
    v_mul_f32 v33, s33, v33
    v_fma_f32 v33, -v32, v32, v33
    v_max_f32 v33, 0, v33
    v_add_f32 v33, 925353388, v33
    v_rsq_f32 v33, v33
    v_and_b32 v3, 31, v1
    v_mul_f32 v32, v32, v33
    v_sub_f32 v32, 0, v32
    v_lshl_add_u32 v3, v3, 2, s30
    s_waitcnt lgkmcnt(0)
    ds_write_b32 v3, v33
    ds_write_b32 v3, v32 offset:128
    s_waitcnt lgkmcnt(0)
    v_mov_b32 v32, 0
    v_mov_b32 v33, 0
    v_mov_b32 v34, 0
    v_mov_b32 v35, 0
    v_mov_b32 v36, 0
    v_mov_b32 v37, 0
    v_mov_b32 v38, 0
    v_mov_b32 v39, 0
    v_mov_b32 v40, 0
    v_mov_b32 v41, 0
    v_mov_b32 v42, 0
    v_mov_b32 v43, 0
    v_mov_b32 v44, 0
    v_mov_b32 v45, 0
    v_mov_b32 v46, 0
    v_mov_b32 v47, 0
    v_mov_b32 v48, 0
    v_mov_b32 v49, 0
    s_add_u32 s8, s4, 25165824
    s_addc_u32 s9, s5, 0
    s_mov_b32 s10, 9437184
    s_mov_b32 s11, 0x00020000
    s_add_u32 s20, s4, 37748736
    s_addc_u32 s21, s5, 0
    s_mov_b32 s22, 9437184
    s_mov_b32 s23, 0x00020000
    s_add_u32 s24, s4, 62914560
    s_addc_u32 s25, s5, 0
    s_mov_b32 s26, 524288
    s_mov_b32 s27, 0x00020000
    s_cmp_eq_u32 s31, 1
    s_cbranch_scc1 K3_odd
    s_waitcnt lgkmcnt(14)
    v_mfma_f32_16x16x32_bf16 v[32:35], a[72:75], a[0:3], v[32:35]
    ds_read_b64_tr_b16 a[36:37], v8 offset:12288
    v_mfma_f32_16x16x32_bf16 v[36:39], a[80:83], a[0:3], v[36:39]
    ds_read_b64_tr_b16 a[38:39], v8 offset:12544
    s_add_u32 m0, s44, 49152
    s_nop 0
    buffer_load_dwordx4 v17, s[16:19], s40 offen lds
    s_add_u32 s40, s40, 589824
    v_mfma_f32_16x16x32_bf16 v[40:43], a[72:75], a[4:7], v[40:43]
    ds_read_b64_tr_b16 a[40:41], v9 offset:12288
    v_mfma_f32_16x16x32_bf16 v[44:47], a[80:83], a[4:7], v[44:47]
    ds_read_b64_tr_b16 a[42:43], v9 offset:12544
    buffer_load_dwordx4 a[104:107], v18, s[12:15], s38 offen offset:0
    s_waitcnt lgkmcnt(14)
    v_mfma_f32_16x16x32_bf16 v[48:51], a[72:75], a[8:11], v[48:51]
    ds_read_b64_tr_b16 a[44:45], v10 offset:12288
    v_mfma_f32_16x16x32_bf16 v[52:55], a[80:83], a[8:11], v[52:55]
    ds_read_b64_tr_b16 a[46:47], v10 offset:12544
    buffer_load_dwordx4 a[108:111], v18, s[12:15], s38 offen offset:1024
    v_mfma_f32_16x16x32_bf16 v[56:59], a[72:75], a[12:15], v[56:59]
    ds_read_b64_tr_b16 a[48:49], v11 offset:12288
    v_mfma_f32_16x16x32_bf16 v[60:63], a[80:83], a[12:15], v[60:63]
    ds_read_b64_tr_b16 a[50:51], v11 offset:12544
    s_add_u32 m0, s45, 49152
    s_nop 0
    buffer_load_dwordx4 v17, s[16:19], s41 offen lds
    s_add_u32 s41, s41, 589824
    s_waitcnt lgkmcnt(14)
    v_mfma_f32_16x16x32_bf16 v[64:67], a[72:75], a[16:19], v[64:67]
    ds_read_b64_tr_b16 a[52:53], v12 offset:12288
    v_mfma_f32_16x16x32_bf16 v[68:71], a[80:83], a[16:19], v[68:71]
    ds_read_b64_tr_b16 a[54:55], v12 offset:12544
    buffer_load_dwordx4 a[112:115], v19, s[12:15], s38 offen offset:0
    v_mfma_f32_16x16x32_bf16 v[72:75], a[20:23], a[72:75], v[72:75]
    ds_read_b64_tr_b16 a[56:57], v13 offset:12288
    v_mfma_f32_16x16x32_bf16 v[76:79], a[20:23], a[80:83], v[76:79]
    ds_read_b64_tr_b16 a[58:59], v13 offset:12544
    buffer_load_dwordx4 a[116:119], v19, s[12:15], s38 offen offset:1024
    s_add_u32 s38, s38, 2048
    s_waitcnt lgkmcnt(14)
    v_mfma_f32_16x16x32_bf16 v[80:83], a[24:27], a[72:75], v[80:83]
    ds_read_b64_tr_b16 a[60:61], v14 offset:12288
    v_mfma_f32_16x16x32_bf16 v[84:87], a[24:27], a[80:83], v[84:87]
    ds_read_b64_tr_b16 a[62:63], v14 offset:12544
    s_add_u32 m0, s46, 49152
    s_nop 0
    buffer_load_dwordx4 v17, s[16:19], s42 offen lds
    s_add_u32 s42, s42, 589824
    v_mfma_f32_16x16x32_bf16 v[88:91], a[28:31], a[72:75], v[88:91]
    ds_read_b64_tr_b16 a[64:65], v15 offset:12288
    v_mfma_f32_16x16x32_bf16 v[92:95], a[28:31], a[80:83], v[92:95]
    ds_read_b64_tr_b16 a[66:67], v15 offset:12544
    s_waitcnt lgkmcnt(15)
    v_mfma_f32_16x16x32_bf16 v[96:99], a[32:35], a[72:75], v[96:99]
    ds_read_b64_tr_b16 a[68:69], v16 offset:12288
    v_mfma_f32_16x16x32_bf16 v[100:103], a[32:35], a[80:83], v[100:103]
    ds_read_b64_tr_b16 a[70:71], v16 offset:12544
    s_waitcnt vmcnt(7)
    s_barrier
    s_waitcnt lgkmcnt(14)
    v_mfma_f32_16x16x32_bf16 v[32:35], a[76:79], a[36:39], v[32:35]
    ds_read_b64_tr_b16 a[0:1], v8 offset:24576
    v_mfma_f32_16x16x32_bf16 v[36:39], a[84:87], a[36:39], v[36:39]
    ds_read_b64_tr_b16 a[2:3], v8 offset:24832
    s_add_u32 m0, s44, 73728
    s_nop 0
    buffer_load_dwordx4 v17, s[16:19], s40 offen lds
    s_add_u32 s40, s40, 589824
    v_mfma_f32_16x16x32_bf16 v[40:43], a[76:79], a[40:43], v[40:43]
    ds_read_b64_tr_b16 a[4:5], v9 offset:24576
    v_mfma_f32_16x16x32_bf16 v[44:47], a[84:87], a[40:43], v[44:47]
    ds_read_b64_tr_b16 a[6:7], v9 offset:24832
    buffer_load_dwordx4 a[120:123], v18, s[12:15], s38 offen offset:0
    s_waitcnt lgkmcnt(14)
    v_mfma_f32_16x16x32_bf16 v[48:51], a[76:79], a[44:47], v[48:51]
    ds_read_b64_tr_b16 a[8:9], v10 offset:24576
    v_mfma_f32_16x16x32_bf16 v[52:55], a[84:87], a[44:47], v[52:55]
    ds_read_b64_tr_b16 a[10:11], v10 offset:24832
    buffer_load_dwordx4 a[124:127], v18, s[12:15], s38 offen offset:1024
    v_mfma_f32_16x16x32_bf16 v[56:59], a[76:79], a[48:51], v[56:59]
    ds_read_b64_tr_b16 a[12:13], v11 offset:24576
    v_mfma_f32_16x16x32_bf16 v[60:63], a[84:87], a[48:51], v[60:63]
    ds_read_b64_tr_b16 a[14:15], v11 offset:24832
    s_add_u32 m0, s45, 73728
    s_nop 0
    buffer_load_dwordx4 v17, s[16:19], s41 offen lds
    s_add_u32 s41, s41, 589824
    s_waitcnt lgkmcnt(14)
    v_mfma_f32_16x16x32_bf16 v[64:67], a[76:79], a[52:55], v[64:67]
    ds_read_b64_tr_b16 a[16:17], v12 offset:24576
    v_mfma_f32_16x16x32_bf16 v[68:71], a[84:87], a[52:55], v[68:71]
    ds_read_b64_tr_b16 a[18:19], v12 offset:24832
    buffer_load_dwordx4 a[128:131], v19, s[12:15], s38 offen offset:0
    v_mfma_f32_16x16x32_bf16 v[72:75], a[56:59], a[76:79], v[72:75]
    ds_read_b64_tr_b16 a[20:21], v13 offset:24576
    v_mfma_f32_16x16x32_bf16 v[76:79], a[56:59], a[84:87], v[76:79]
    ds_read_b64_tr_b16 a[22:23], v13 offset:24832
    buffer_load_dwordx4 a[132:135], v19, s[12:15], s38 offen offset:1024
    s_add_u32 s38, s38, 2048
    s_waitcnt lgkmcnt(14)
    v_mfma_f32_16x16x32_bf16 v[80:83], a[60:63], a[76:79], v[80:83]
    ds_read_b64_tr_b16 a[24:25], v14 offset:24576
    v_mfma_f32_16x16x32_bf16 v[84:87], a[60:63], a[84:87], v[84:87]
    ds_read_b64_tr_b16 a[26:27], v14 offset:24832
    s_add_u32 m0, s46, 73728
    s_nop 0
    buffer_load_dwordx4 v17, s[16:19], s42 offen lds
    s_add_u32 s42, s42, 589824
    v_mfma_f32_16x16x32_bf16 v[88:91], a[64:67], a[76:79], v[88:91]
    ds_read_b64_tr_b16 a[28:29], v15 offset:24576
    v_mfma_f32_16x16x32_bf16 v[92:95], a[64:67], a[84:87], v[92:95]
    ds_read_b64_tr_b16 a[30:31], v15 offset:24832
    s_waitcnt lgkmcnt(15)
    v_mfma_f32_16x16x32_bf16 v[96:99], a[68:71], a[76:79], v[96:99]
    ds_read_b64_tr_b16 a[32:33], v16 offset:24576
    v_mfma_f32_16x16x32_bf16 v[100:103], a[68:71], a[84:87], v[100:103]
    ds_read_b64_tr_b16 a[34:35], v16 offset:24832
    s_waitcnt vmcnt(7)
    s_barrier
    s_waitcnt lgkmcnt(14)
    v_mfma_f32_16x16x32_bf16 v[32:35], a[88:91], a[0:3], v[32:35]
    ds_read_b64_tr_b16 a[36:37], v8 offset:36864
    v_mfma_f32_16x16x32_bf16 v[36:39], a[96:99], a[0:3], v[36:39]
    ds_read_b64_tr_b16 a[38:39], v8 offset:37120
    v_mfma_f32_16x16x32_bf16 v[40:43], a[88:91], a[4:7], v[40:43]
    ds_read_b64_tr_b16 a[40:41], v9 offset:36864
    v_mfma_f32_16x16x32_bf16 v[44:47], a[96:99], a[4:7], v[44:47]
    ds_read_b64_tr_b16 a[42:43], v9 offset:37120
    s_add_u32 m0, s44, 0
    s_nop 0
    buffer_load_dwordx4 v17, s[16:19], s40 offen lds
    s_add_u32 s40, s40, 589824
    s_waitcnt lgkmcnt(14)
    v_mfma_f32_16x16x32_bf16 v[48:51], a[88:91], a[8:11], v[48:51]
    ds_read_b64_tr_b16 a[44:45], v10 offset:36864
    v_mfma_f32_16x16x32_bf16 v[52:55], a[96:99], a[8:11], v[52:55]
    ds_read_b64_tr_b16 a[46:47], v10 offset:37120
    v_mfma_f32_16x16x32_bf16 v[56:59], a[88:91], a[12:15], v[56:59]
    ds_read_b64_tr_b16 a[48:49], v11 offset:36864
    v_mfma_f32_16x16x32_bf16 v[60:63], a[96:99], a[12:15], v[60:63]
    ds_read_b64_tr_b16 a[50:51], v11 offset:37120
    buffer_load_dwordx4 a[72:75], v18, s[12:15], s38 offen offset:0
    s_waitcnt lgkmcnt(14)
    v_mfma_f32_16x16x32_bf16 v[64:67], a[88:91], a[16:19], v[64:67]
    ds_read_b64_tr_b16 a[52:53], v12 offset:36864
    v_mfma_f32_16x16x32_bf16 v[68:71], a[96:99], a[16:19], v[68:71]
    ds_read_b64_tr_b16 a[54:55], v12 offset:37120
    v_mfma_f32_16x16x32_bf16 v[72:75], a[20:23], a[88:91], v[72:75]
    ds_read_b64_tr_b16 a[56:57], v13 offset:36864
    v_mfma_f32_16x16x32_bf16 v[76:79], a[20:23], a[96:99], v[76:79]
    ds_read_b64_tr_b16 a[58:59], v13 offset:37120
    buffer_load_dwordx4 a[76:79], v18, s[12:15], s38 offen offset:1024
    s_waitcnt lgkmcnt(14)
    v_mfma_f32_16x16x32_bf16 v[80:83], a[24:27], a[88:91], v[80:83]
    ds_read_b64_tr_b16 a[60:61], v14 offset:36864
    v_mfma_f32_16x16x32_bf16 v[84:87], a[24:27], a[96:99], v[84:87]
    ds_read_b64_tr_b16 a[62:63], v14 offset:37120
    v_mfma_f32_16x16x32_bf16 v[88:91], a[28:31], a[88:91], v[88:91]
    ds_read_b64_tr_b16 a[64:65], v15 offset:36864
    v_mfma_f32_16x16x32_bf16 v[92:95], a[28:31], a[96:99], v[92:95]
    ds_read_b64_tr_b16 a[66:67], v15 offset:37120
    s_add_u32 m0, s45, 0
    s_nop 0
    buffer_load_dwordx4 v17, s[16:19], s41 offen lds
    s_add_u32 s41, s41, 589824
    s_waitcnt lgkmcnt(15)
    v_mfma_f32_16x16x32_bf16 v[96:99], a[32:35], a[88:91], v[96:99]
    ds_read_b64_tr_b16 a[68:69], v16 offset:36864
    v_mfma_f32_16x16x32_bf16 v[100:103], a[32:35], a[96:99], v[100:103]
    ds_read_b64_tr_b16 a[70:71], v16 offset:37120
    s_waitcnt lgkmcnt(14)
    v_mfma_f32_16x16x32_bf16 v[32:35], a[92:95], a[36:39], v[32:35]
    ds_read_b64_tr_b16 a[0:1], v23 offset:0
    v_mfma_f32_16x16x32_bf16 v[36:39], a[100:103], a[36:39], v[36:39]
    ds_read_b64_tr_b16 a[2:3], v23 offset:256
    v_mfma_f32_16x16x32_bf16 v[40:43], a[92:95], a[40:43], v[40:43]
    ds_read_b64_tr_b16 a[4:5], v24 offset:0
    v_mfma_f32_16x16x32_bf16 v[44:47], a[100:103], a[40:43], v[44:47]
    ds_read_b64_tr_b16 a[6:7], v24 offset:256
    buffer_load_dwordx4 a[80:83], v19, s[12:15], s38 offen offset:0
    s_waitcnt lgkmcnt(14)
    v_mfma_f32_16x16x32_bf16 v[48:51], a[92:95], a[44:47], v[48:51]
    ds_read_b64_tr_b16 a[8:9], v25 offset:0
    v_mfma_f32_16x16x32_bf16 v[52:55], a[100:103], a[44:47], v[52:55]
    ds_read_b64_tr_b16 a[10:11], v25 offset:256
    v_mfma_f32_16x16x32_bf16 v[56:59], a[92:95], a[48:51], v[56:59]
    ds_read_b64_tr_b16 a[12:13], v26 offset:0
    v_mfma_f32_16x16x32_bf16 v[60:63], a[100:103], a[48:51], v[60:63]
    ds_read_b64_tr_b16 a[14:15], v26 offset:256
    buffer_load_dwordx4 a[84:87], v19, s[12:15], s38 offen offset:1024
    s_add_u32 s38, s38, 2048
    s_waitcnt lgkmcnt(14)
    v_mfma_f32_16x16x32_bf16 v[64:67], a[92:95], a[52:55], v[64:67]
    ds_read_b64_tr_b16 a[16:17], v27 offset:0
    v_mfma_f32_16x16x32_bf16 v[68:71], a[100:103], a[52:55], v[68:71]
    ds_read_b64_tr_b16 a[18:19], v27 offset:256
    v_mfma_f32_16x16x32_bf16 v[72:75], a[56:59], a[92:95], v[72:75]
    ds_read_b64_tr_b16 a[20:21], v28 offset:0
    v_mfma_f32_16x16x32_bf16 v[76:79], a[56:59], a[100:103], v[76:79]
    ds_read_b64_tr_b16 a[22:23], v28 offset:256
    s_add_u32 m0, s46, 0
    s_nop 0
    buffer_load_dwordx4 v17, s[16:19], s42 offen lds
    s_add_u32 s42, s42, 589824
    s_waitcnt lgkmcnt(14)
    v_mfma_f32_16x16x32_bf16 v[80:83], a[60:63], a[92:95], v[80:83]
    ds_read_b64_tr_b16 a[24:25], v29 offset:0
    v_mfma_f32_16x16x32_bf16 v[84:87], a[60:63], a[100:103], v[84:87]
    ds_read_b64_tr_b16 a[26:27], v29 offset:256
    v_mfma_f32_16x16x32_bf16 v[88:91], a[64:67], a[92:95], v[88:91]
    ds_read_b64_tr_b16 a[28:29], v30 offset:0
    v_mfma_f32_16x16x32_bf16 v[92:95], a[64:67], a[100:103], v[92:95]
    ds_read_b64_tr_b16 a[30:31], v30 offset:256
    s_waitcnt lgkmcnt(15)
    v_mfma_f32_16x16x32_bf16 v[96:99], a[68:71], a[92:95], v[96:99]
    ds_read_b64_tr_b16 a[32:33], v31 offset:0
    v_mfma_f32_16x16x32_bf16 v[100:103], a[68:71], a[100:103], v[100:103]
    ds_read_b64_tr_b16 a[34:35], v31 offset:256
    s_waitcnt vmcnt(7)
    s_barrier
    s_waitcnt lgkmcnt(14)
    v_mfma_f32_16x16x32_bf16 v[32:35], a[104:107], a[0:3], v[32:35]
    ds_read_b64_tr_b16 a[36:37], v23 offset:12288
    v_mfma_f32_16x16x32_bf16 v[36:39], a[112:115], a[0:3], v[36:39]
    ds_read_b64_tr_b16 a[38:39], v23 offset:12544
    v_mfma_f32_16x16x32_bf16 v[40:43], a[104:107], a[4:7], v[40:43]
    ds_read_b64_tr_b16 a[40:41], v24 offset:12288
    v_mfma_f32_16x16x32_bf16 v[44:47], a[112:115], a[4:7], v[44:47]
    ds_read_b64_tr_b16 a[42:43], v24 offset:12544
    s_add_u32 m0, s44, 24576
    s_nop 0
    buffer_load_dwordx4 v17, s[16:19], s40 offen lds
    s_add_u32 s40, s40, 589824
    s_waitcnt lgkmcnt(14)
    v_mfma_f32_16x16x32_bf16 v[48:51], a[104:107], a[8:11], v[48:51]
    ds_read_b64_tr_b16 a[44:45], v25 offset:12288
    v_mfma_f32_16x16x32_bf16 v[52:55], a[112:115], a[8:11], v[52:55]
    ds_read_b64_tr_b16 a[46:47], v25 offset:12544
    v_mfma_f32_16x16x32_bf16 v[56:59], a[104:107], a[12:15], v[56:59]
    ds_read_b64_tr_b16 a[48:49], v26 offset:12288
    v_mfma_f32_16x16x32_bf16 v[60:63], a[112:115], a[12:15], v[60:63]
    ds_read_b64_tr_b16 a[50:51], v26 offset:12544
    buffer_load_dwordx4 a[88:91], v18, s[12:15], s38 offen offset:0
    s_waitcnt lgkmcnt(14)
    v_mfma_f32_16x16x32_bf16 v[64:67], a[104:107], a[16:19], v[64:67]
    ds_read_b64_tr_b16 a[52:53], v27 offset:12288
    v_mfma_f32_16x16x32_bf16 v[68:71], a[112:115], a[16:19], v[68:71]
    ds_read_b64_tr_b16 a[54:55], v27 offset:12544
    v_mfma_f32_16x16x32_bf16 v[72:75], a[20:23], a[104:107], v[72:75]
    ds_read_b64_tr_b16 a[56:57], v28 offset:12288
    v_mfma_f32_16x16x32_bf16 v[76:79], a[20:23], a[112:115], v[76:79]
    ds_read_b64_tr_b16 a[58:59], v28 offset:12544
    buffer_load_dwordx4 a[92:95], v18, s[12:15], s38 offen offset:1024
    s_waitcnt lgkmcnt(14)
    v_mfma_f32_16x16x32_bf16 v[80:83], a[24:27], a[104:107], v[80:83]
    ds_read_b64_tr_b16 a[60:61], v29 offset:12288
    v_mfma_f32_16x16x32_bf16 v[84:87], a[24:27], a[112:115], v[84:87]
    ds_read_b64_tr_b16 a[62:63], v29 offset:12544
    v_mfma_f32_16x16x32_bf16 v[88:91], a[28:31], a[104:107], v[88:91]
    ds_read_b64_tr_b16 a[64:65], v30 offset:12288
    v_mfma_f32_16x16x32_bf16 v[92:95], a[28:31], a[112:115], v[92:95]
    ds_read_b64_tr_b16 a[66:67], v30 offset:12544
    s_add_u32 m0, s45, 24576
    s_nop 0
    buffer_load_dwordx4 v17, s[16:19], s41 offen lds
    s_add_u32 s41, s41, 589824
    s_waitcnt lgkmcnt(15)
    v_mfma_f32_16x16x32_bf16 v[96:99], a[32:35], a[104:107], v[96:99]
    ds_read_b64_tr_b16 a[68:69], v31 offset:12288
    v_mfma_f32_16x16x32_bf16 v[100:103], a[32:35], a[112:115], v[100:103]
    ds_read_b64_tr_b16 a[70:71], v31 offset:12544
    s_waitcnt lgkmcnt(14)
    v_mfma_f32_16x16x32_bf16 v[32:35], a[108:111], a[36:39], v[32:35]
    ds_read_b64_tr_b16 a[0:1], v23 offset:24576
    v_mfma_f32_16x16x32_bf16 v[36:39], a[116:119], a[36:39], v[36:39]
    ds_read_b64_tr_b16 a[2:3], v23 offset:24832
    v_mfma_f32_16x16x32_bf16 v[40:43], a[108:111], a[40:43], v[40:43]
    ds_read_b64_tr_b16 a[4:5], v24 offset:24576
    v_mfma_f32_16x16x32_bf16 v[44:47], a[116:119], a[40:43], v[44:47]
    ds_read_b64_tr_b16 a[6:7], v24 offset:24832
    buffer_load_dwordx4 a[96:99], v19, s[12:15], s38 offen offset:0
    s_waitcnt lgkmcnt(14)
    v_mfma_f32_16x16x32_bf16 v[48:51], a[108:111], a[44:47], v[48:51]
    ds_read_b64_tr_b16 a[8:9], v25 offset:24576
    v_mfma_f32_16x16x32_bf16 v[52:55], a[116:119], a[44:47], v[52:55]
    ds_read_b64_tr_b16 a[10:11], v25 offset:24832
    v_mfma_f32_16x16x32_bf16 v[56:59], a[108:111], a[48:51], v[56:59]
    ds_read_b64_tr_b16 a[12:13], v26 offset:24576
    v_mfma_f32_16x16x32_bf16 v[60:63], a[116:119], a[48:51], v[60:63]
    ds_read_b64_tr_b16 a[14:15], v26 offset:24832
    buffer_load_dwordx4 a[100:103], v19, s[12:15], s38 offen offset:1024
    s_add_u32 s38, s38, 2048
    s_waitcnt lgkmcnt(14)
    v_mfma_f32_16x16x32_bf16 v[64:67], a[108:111], a[52:55], v[64:67]
    ds_read_b64_tr_b16 a[16:17], v27 offset:24576
    v_mfma_f32_16x16x32_bf16 v[68:71], a[116:119], a[52:55], v[68:71]
    ds_read_b64_tr_b16 a[18:19], v27 offset:24832
    v_mfma_f32_16x16x32_bf16 v[72:75], a[56:59], a[108:111], v[72:75]
    ds_read_b64_tr_b16 a[20:21], v28 offset:24576
    v_mfma_f32_16x16x32_bf16 v[76:79], a[56:59], a[116:119], v[76:79]
    ds_read_b64_tr_b16 a[22:23], v28 offset:24832
    s_add_u32 m0, s46, 24576
    s_nop 0
    buffer_load_dwordx4 v17, s[16:19], s42 offen lds
    s_add_u32 s42, s42, 589824
    s_waitcnt lgkmcnt(14)
    v_mfma_f32_16x16x32_bf16 v[80:83], a[60:63], a[108:111], v[80:83]
    ds_read_b64_tr_b16 a[24:25], v29 offset:24576
    v_mfma_f32_16x16x32_bf16 v[84:87], a[60:63], a[116:119], v[84:87]
    ds_read_b64_tr_b16 a[26:27], v29 offset:24832
    v_mfma_f32_16x16x32_bf16 v[88:91], a[64:67], a[108:111], v[88:91]
    ds_read_b64_tr_b16 a[28:29], v30 offset:24576
    v_mfma_f32_16x16x32_bf16 v[92:95], a[64:67], a[116:119], v[92:95]
    ds_read_b64_tr_b16 a[30:31], v30 offset:24832
    s_waitcnt lgkmcnt(15)
    v_mfma_f32_16x16x32_bf16 v[96:99], a[68:71], a[108:111], v[96:99]
    ds_read_b64_tr_b16 a[32:33], v31 offset:24576
    v_mfma_f32_16x16x32_bf16 v[100:103], a[68:71], a[116:119], v[100:103]
    ds_read_b64_tr_b16 a[34:35], v31 offset:24832
    s_waitcnt vmcnt(7)
    s_barrier
    s_waitcnt lgkmcnt(14)
    v_mfma_f32_16x16x32_bf16 v[32:35], a[120:123], a[0:3], v[32:35]
    ds_read_b64_tr_b16 a[36:37], v23 offset:36864
    v_mfma_f32_16x16x32_bf16 v[36:39], a[128:131], a[0:3], v[36:39]
    ds_read_b64_tr_b16 a[38:39], v23 offset:37120
    v_mfma_f32_16x16x32_bf16 v[40:43], a[120:123], a[4:7], v[40:43]
    ds_read_b64_tr_b16 a[40:41], v24 offset:36864
    v_mfma_f32_16x16x32_bf16 v[44:47], a[128:131], a[4:7], v[44:47]
    ds_read_b64_tr_b16 a[42:43], v24 offset:37120
    s_add_u32 m0, s44, 49152
    s_nop 0
    buffer_load_dwordx4 v17, s[16:19], s40 offen lds
    s_add_u32 s40, s40, 589824
    s_waitcnt lgkmcnt(14)
    v_mfma_f32_16x16x32_bf16 v[48:51], a[120:123], a[8:11], v[48:51]
    ds_read_b64_tr_b16 a[44:45], v25 offset:36864
    v_mfma_f32_16x16x32_bf16 v[52:55], a[128:131], a[8:11], v[52:55]
    ds_read_b64_tr_b16 a[46:47], v25 offset:37120
    v_mfma_f32_16x16x32_bf16 v[56:59], a[120:123], a[12:15], v[56:59]
    ds_read_b64_tr_b16 a[48:49], v26 offset:36864
    v_mfma_f32_16x16x32_bf16 v[60:63], a[128:131], a[12:15], v[60:63]
    ds_read_b64_tr_b16 a[50:51], v26 offset:37120
    buffer_load_dwordx4 a[104:107], v18, s[12:15], s38 offen offset:0
    s_waitcnt lgkmcnt(14)
    v_mfma_f32_16x16x32_bf16 v[64:67], a[120:123], a[16:19], v[64:67]
    ds_read_b64_tr_b16 a[52:53], v27 offset:36864
    v_mfma_f32_16x16x32_bf16 v[68:71], a[128:131], a[16:19], v[68:71]
    ds_read_b64_tr_b16 a[54:55], v27 offset:37120
    v_mfma_f32_16x16x32_bf16 v[72:75], a[20:23], a[120:123], v[72:75]
    ds_read_b64_tr_b16 a[56:57], v28 offset:36864
    v_mfma_f32_16x16x32_bf16 v[76:79], a[20:23], a[128:131], v[76:79]
    ds_read_b64_tr_b16 a[58:59], v28 offset:37120
    buffer_load_dwordx4 a[108:111], v18, s[12:15], s38 offen offset:1024
    s_waitcnt lgkmcnt(14)
    v_mfma_f32_16x16x32_bf16 v[80:83], a[24:27], a[120:123], v[80:83]
    ds_read_b64_tr_b16 a[60:61], v29 offset:36864
    v_mfma_f32_16x16x32_bf16 v[84:87], a[24:27], a[128:131], v[84:87]
    ds_read_b64_tr_b16 a[62:63], v29 offset:37120
    v_mfma_f32_16x16x32_bf16 v[88:91], a[28:31], a[120:123], v[88:91]
    ds_read_b64_tr_b16 a[64:65], v30 offset:36864
    v_mfma_f32_16x16x32_bf16 v[92:95], a[28:31], a[128:131], v[92:95]
    ds_read_b64_tr_b16 a[66:67], v30 offset:37120
    s_add_u32 m0, s45, 49152
    s_nop 0
    buffer_load_dwordx4 v17, s[16:19], s41 offen lds
    s_add_u32 s41, s41, 589824
    s_waitcnt lgkmcnt(15)
    v_mfma_f32_16x16x32_bf16 v[96:99], a[32:35], a[120:123], v[96:99]
    ds_read_b64_tr_b16 a[68:69], v31 offset:36864
    v_mfma_f32_16x16x32_bf16 v[100:103], a[32:35], a[128:131], v[100:103]
    ds_read_b64_tr_b16 a[70:71], v31 offset:37120
    s_waitcnt lgkmcnt(14)
    v_mfma_f32_16x16x32_bf16 v[32:35], a[124:127], a[36:39], v[32:35]
    ds_read_b64_tr_b16 a[0:1], v8 offset:0
    v_mfma_f32_16x16x32_bf16 v[36:39], a[132:135], a[36:39], v[36:39]
    ds_read_b64_tr_b16 a[2:3], v8 offset:256
    v_mfma_f32_16x16x32_bf16 v[40:43], a[124:127], a[40:43], v[40:43]
    ds_read_b64_tr_b16 a[4:5], v9 offset:0
    v_mfma_f32_16x16x32_bf16 v[44:47], a[132:135], a[40:43], v[44:47]
    ds_read_b64_tr_b16 a[6:7], v9 offset:256
    buffer_load_dwordx4 a[112:115], v19, s[12:15], s38 offen offset:0
    s_waitcnt lgkmcnt(14)
    v_mfma_f32_16x16x32_bf16 v[48:51], a[124:127], a[44:47], v[48:51]
    ds_read_b64_tr_b16 a[8:9], v10 offset:0
    v_mfma_f32_16x16x32_bf16 v[52:55], a[132:135], a[44:47], v[52:55]
    ds_read_b64_tr_b16 a[10:11], v10 offset:256
    v_mfma_f32_16x16x32_bf16 v[56:59], a[124:127], a[48:51], v[56:59]
    ds_read_b64_tr_b16 a[12:13], v11 offset:0
    v_mfma_f32_16x16x32_bf16 v[60:63], a[132:135], a[48:51], v[60:63]
    ds_read_b64_tr_b16 a[14:15], v11 offset:256
    buffer_load_dwordx4 a[116:119], v19, s[12:15], s38 offen offset:1024
    s_add_u32 s38, s38, 2048
    s_waitcnt lgkmcnt(14)
    v_mfma_f32_16x16x32_bf16 v[64:67], a[124:127], a[52:55], v[64:67]
    ds_read_b64_tr_b16 a[16:17], v12 offset:0
    v_mfma_f32_16x16x32_bf16 v[68:71], a[132:135], a[52:55], v[68:71]
    ds_read_b64_tr_b16 a[18:19], v12 offset:256
    v_mfma_f32_16x16x32_bf16 v[72:75], a[56:59], a[124:127], v[72:75]
    ds_read_b64_tr_b16 a[20:21], v13 offset:0
    v_mfma_f32_16x16x32_bf16 v[76:79], a[56:59], a[132:135], v[76:79]
    ds_read_b64_tr_b16 a[22:23], v13 offset:256
    s_add_u32 m0, s46, 49152
    s_nop 0
    buffer_load_dwordx4 v17, s[16:19], s42 offen lds
    s_add_u32 s42, s42, 589824
    s_waitcnt lgkmcnt(14)
    v_mfma_f32_16x16x32_bf16 v[80:83], a[60:63], a[124:127], v[80:83]
    ds_read_b64_tr_b16 a[24:25], v14 offset:0
    v_mfma_f32_16x16x32_bf16 v[84:87], a[60:63], a[132:135], v[84:87]
    ds_read_b64_tr_b16 a[26:27], v14 offset:256
    v_mfma_f32_16x16x32_bf16 v[88:91], a[64:67], a[124:127], v[88:91]
    ds_read_b64_tr_b16 a[28:29], v15 offset:0
    v_mfma_f32_16x16x32_bf16 v[92:95], a[64:67], a[132:135], v[92:95]
    ds_read_b64_tr_b16 a[30:31], v15 offset:256
    s_waitcnt lgkmcnt(15)
    v_mfma_f32_16x16x32_bf16 v[96:99], a[68:71], a[124:127], v[96:99]
    ds_read_b64_tr_b16 a[32:33], v16 offset:0
    v_mfma_f32_16x16x32_bf16 v[100:103], a[68:71], a[132:135], v[100:103]
    ds_read_b64_tr_b16 a[34:35], v16 offset:256
    s_waitcnt vmcnt(7)
    s_barrier
    s_waitcnt lgkmcnt(14)
    v_mfma_f32_16x16x32_bf16 v[32:35], a[72:75], a[0:3], v[32:35]
    ds_read_b64_tr_b16 a[36:37], v8 offset:12288
    v_mfma_f32_16x16x32_bf16 v[36:39], a[80:83], a[0:3], v[36:39]
    ds_read_b64_tr_b16 a[38:39], v8 offset:12544
    v_mfma_f32_16x16x32_bf16 v[40:43], a[72:75], a[4:7], v[40:43]
    ds_read_b64_tr_b16 a[40:41], v9 offset:12288
    v_mfma_f32_16x16x32_bf16 v[44:47], a[80:83], a[4:7], v[44:47]
    ds_read_b64_tr_b16 a[42:43], v9 offset:12544
    s_add_u32 m0, s44, 73728
    s_nop 0
    buffer_load_dwordx4 v17, s[16:19], s40 offen lds
    s_add_u32 s40, s40, 589824
    s_waitcnt lgkmcnt(14)
    v_mfma_f32_16x16x32_bf16 v[48:51], a[72:75], a[8:11], v[48:51]
    ds_read_b64_tr_b16 a[44:45], v10 offset:12288
    v_mfma_f32_16x16x32_bf16 v[52:55], a[80:83], a[8:11], v[52:55]
    ds_read_b64_tr_b16 a[46:47], v10 offset:12544
    v_mfma_f32_16x16x32_bf16 v[56:59], a[72:75], a[12:15], v[56:59]
    ds_read_b64_tr_b16 a[48:49], v11 offset:12288
    v_mfma_f32_16x16x32_bf16 v[60:63], a[80:83], a[12:15], v[60:63]
    ds_read_b64_tr_b16 a[50:51], v11 offset:12544
    buffer_load_dwordx4 a[120:123], v18, s[12:15], s38 offen offset:0
    s_waitcnt lgkmcnt(14)
    v_mfma_f32_16x16x32_bf16 v[64:67], a[72:75], a[16:19], v[64:67]
    ds_read_b64_tr_b16 a[52:53], v12 offset:12288
    v_mfma_f32_16x16x32_bf16 v[68:71], a[80:83], a[16:19], v[68:71]
    ds_read_b64_tr_b16 a[54:55], v12 offset:12544
    v_mfma_f32_16x16x32_bf16 v[72:75], a[20:23], a[72:75], v[72:75]
    ds_read_b64_tr_b16 a[56:57], v13 offset:12288
    v_mfma_f32_16x16x32_bf16 v[76:79], a[20:23], a[80:83], v[76:79]
    ds_read_b64_tr_b16 a[58:59], v13 offset:12544
    buffer_load_dwordx4 a[124:127], v18, s[12:15], s38 offen offset:1024
    s_waitcnt lgkmcnt(14)
    v_mfma_f32_16x16x32_bf16 v[80:83], a[24:27], a[72:75], v[80:83]
    ds_read_b64_tr_b16 a[60:61], v14 offset:12288
    v_mfma_f32_16x16x32_bf16 v[84:87], a[24:27], a[80:83], v[84:87]
    ds_read_b64_tr_b16 a[62:63], v14 offset:12544
    v_mfma_f32_16x16x32_bf16 v[88:91], a[28:31], a[72:75], v[88:91]
    ds_read_b64_tr_b16 a[64:65], v15 offset:12288
    v_mfma_f32_16x16x32_bf16 v[92:95], a[28:31], a[80:83], v[92:95]
    ds_read_b64_tr_b16 a[66:67], v15 offset:12544
    s_add_u32 m0, s45, 73728
    s_nop 0
    buffer_load_dwordx4 v17, s[16:19], s41 offen lds
    s_add_u32 s41, s41, 589824
    s_waitcnt lgkmcnt(15)
    v_mfma_f32_16x16x32_bf16 v[96:99], a[32:35], a[72:75], v[96:99]
    ds_read_b64_tr_b16 a[68:69], v16 offset:12288
    v_mfma_f32_16x16x32_bf16 v[100:103], a[32:35], a[80:83], v[100:103]
    ds_read_b64_tr_b16 a[70:71], v16 offset:12544
    s_waitcnt lgkmcnt(14)
    v_mfma_f32_16x16x32_bf16 v[32:35], a[76:79], a[36:39], v[32:35]
    ds_read_b64_tr_b16 a[0:1], v8 offset:24576
    v_mfma_f32_16x16x32_bf16 v[36:39], a[84:87], a[36:39], v[36:39]
    ds_read_b64_tr_b16 a[2:3], v8 offset:24832
    v_mfma_f32_16x16x32_bf16 v[40:43], a[76:79], a[40:43], v[40:43]
    ds_read_b64_tr_b16 a[4:5], v9 offset:24576
    v_mfma_f32_16x16x32_bf16 v[44:47], a[84:87], a[40:43], v[44:47]
    ds_read_b64_tr_b16 a[6:7], v9 offset:24832
    buffer_load_dwordx4 a[128:131], v19, s[12:15], s38 offen offset:0
    s_waitcnt lgkmcnt(14)
    v_mfma_f32_16x16x32_bf16 v[48:51], a[76:79], a[44:47], v[48:51]
    ds_read_b64_tr_b16 a[8:9], v10 offset:24576
    v_mfma_f32_16x16x32_bf16 v[52:55], a[84:87], a[44:47], v[52:55]
    ds_read_b64_tr_b16 a[10:11], v10 offset:24832
    v_mfma_f32_16x16x32_bf16 v[56:59], a[76:79], a[48:51], v[56:59]
    ds_read_b64_tr_b16 a[12:13], v11 offset:24576
    v_mfma_f32_16x16x32_bf16 v[60:63], a[84:87], a[48:51], v[60:63]
    ds_read_b64_tr_b16 a[14:15], v11 offset:24832
    buffer_load_dwordx4 a[132:135], v19, s[12:15], s38 offen offset:1024
    s_add_u32 s38, s38, 2048
    s_waitcnt lgkmcnt(14)
    v_mfma_f32_16x16x32_bf16 v[64:67], a[76:79], a[52:55], v[64:67]
    ds_read_b64_tr_b16 a[16:17], v12 offset:24576
    v_mfma_f32_16x16x32_bf16 v[68:71], a[84:87], a[52:55], v[68:71]
    ds_read_b64_tr_b16 a[18:19], v12 offset:24832
    v_mfma_f32_16x16x32_bf16 v[72:75], a[56:59], a[76:79], v[72:75]
    ds_read_b64_tr_b16 a[20:21], v13 offset:24576
    v_mfma_f32_16x16x32_bf16 v[76:79], a[56:59], a[84:87], v[76:79]
    ds_read_b64_tr_b16 a[22:23], v13 offset:24832
    s_add_u32 m0, s46, 73728
    s_nop 0
    buffer_load_dwordx4 v17, s[16:19], s42 offen lds
    s_add_u32 s42, s42, 589824
    s_waitcnt lgkmcnt(14)
    v_mfma_f32_16x16x32_bf16 v[80:83], a[60:63], a[76:79], v[80:83]
    ds_read_b64_tr_b16 a[24:25], v14 offset:24576
    v_mfma_f32_16x16x32_bf16 v[84:87], a[60:63], a[84:87], v[84:87]
    ds_read_b64_tr_b16 a[26:27], v14 offset:24832
    v_mfma_f32_16x16x32_bf16 v[88:91], a[64:67], a[76:79], v[88:91]
    ds_read_b64_tr_b16 a[28:29], v15 offset:24576
    v_mfma_f32_16x16x32_bf16 v[92:95], a[64:67], a[84:87], v[92:95]
    ds_read_b64_tr_b16 a[30:31], v15 offset:24832
    s_waitcnt lgkmcnt(15)
    v_mfma_f32_16x16x32_bf16 v[96:99], a[68:71], a[76:79], v[96:99]
    ds_read_b64_tr_b16 a[32:33], v16 offset:24576
    v_mfma_f32_16x16x32_bf16 v[100:103], a[68:71], a[84:87], v[100:103]
    ds_read_b64_tr_b16 a[34:35], v16 offset:24832
    s_waitcnt vmcnt(7)
    s_barrier
    s_waitcnt lgkmcnt(14)
    v_mfma_f32_16x16x32_bf16 v[32:35], a[88:91], a[0:3], v[32:35]
    ds_read_b64_tr_b16 a[36:37], v8 offset:36864
    v_mfma_f32_16x16x32_bf16 v[36:39], a[96:99], a[0:3], v[36:39]
    ds_read_b64_tr_b16 a[38:39], v8 offset:37120
    v_mfma_f32_16x16x32_bf16 v[40:43], a[88:91], a[4:7], v[40:43]
    ds_read_b64_tr_b16 a[40:41], v9 offset:36864
    v_mfma_f32_16x16x32_bf16 v[44:47], a[96:99], a[4:7], v[44:47]
    ds_read_b64_tr_b16 a[42:43], v9 offset:37120
    s_add_u32 m0, s44, 0
    s_nop 0
    buffer_load_dwordx4 v17, s[16:19], s40 offen lds
    s_add_u32 s40, s40, 589824
    s_waitcnt lgkmcnt(14)
    v_mfma_f32_16x16x32_bf16 v[48:51], a[88:91], a[8:11], v[48:51]
    ds_read_b64_tr_b16 a[44:45], v10 offset:36864
    v_mfma_f32_16x16x32_bf16 v[52:55], a[96:99], a[8:11], v[52:55]
    ds_read_b64_tr_b16 a[46:47], v10 offset:37120
    v_mfma_f32_16x16x32_bf16 v[56:59], a[88:91], a[12:15], v[56:59]
    ds_read_b64_tr_b16 a[48:49], v11 offset:36864
    v_mfma_f32_16x16x32_bf16 v[60:63], a[96:99], a[12:15], v[60:63]
    ds_read_b64_tr_b16 a[50:51], v11 offset:37120
    buffer_load_dwordx4 a[72:75], v18, s[12:15], s38 offen offset:0
    s_waitcnt lgkmcnt(14)
    v_mfma_f32_16x16x32_bf16 v[64:67], a[88:91], a[16:19], v[64:67]
    ds_read_b64_tr_b16 a[52:53], v12 offset:36864
    v_mfma_f32_16x16x32_bf16 v[68:71], a[96:99], a[16:19], v[68:71]
    ds_read_b64_tr_b16 a[54:55], v12 offset:37120
    v_mfma_f32_16x16x32_bf16 v[72:75], a[20:23], a[88:91], v[72:75]
    ds_read_b64_tr_b16 a[56:57], v13 offset:36864
    v_mfma_f32_16x16x32_bf16 v[76:79], a[20:23], a[96:99], v[76:79]
    ds_read_b64_tr_b16 a[58:59], v13 offset:37120
    buffer_load_dwordx4 a[76:79], v18, s[12:15], s38 offen offset:1024
    s_waitcnt lgkmcnt(14)
    v_mfma_f32_16x16x32_bf16 v[80:83], a[24:27], a[88:91], v[80:83]
    ds_read_b64_tr_b16 a[60:61], v14 offset:36864
    v_mfma_f32_16x16x32_bf16 v[84:87], a[24:27], a[96:99], v[84:87]
    ds_read_b64_tr_b16 a[62:63], v14 offset:37120
    v_mfma_f32_16x16x32_bf16 v[88:91], a[28:31], a[88:91], v[88:91]
    ds_read_b64_tr_b16 a[64:65], v15 offset:36864
    v_mfma_f32_16x16x32_bf16 v[92:95], a[28:31], a[96:99], v[92:95]
    ds_read_b64_tr_b16 a[66:67], v15 offset:37120
    s_add_u32 m0, s45, 0
    s_nop 0
    buffer_load_dwordx4 v17, s[16:19], s41 offen lds
    s_add_u32 s41, s41, 589824
    s_waitcnt lgkmcnt(15)
    v_mfma_f32_16x16x32_bf16 v[96:99], a[32:35], a[88:91], v[96:99]
    ds_read_b64_tr_b16 a[68:69], v16 offset:36864
    v_mfma_f32_16x16x32_bf16 v[100:103], a[32:35], a[96:99], v[100:103]
    ds_read_b64_tr_b16 a[70:71], v16 offset:37120
    s_waitcnt lgkmcnt(14)
    v_mfma_f32_16x16x32_bf16 v[32:35], a[92:95], a[36:39], v[32:35]
    ds_read_b64_tr_b16 a[0:1], v23 offset:0
    v_mfma_f32_16x16x32_bf16 v[36:39], a[100:103], a[36:39], v[36:39]
    ds_read_b64_tr_b16 a[2:3], v23 offset:256
    v_mfma_f32_16x16x32_bf16 v[40:43], a[92:95], a[40:43], v[40:43]
    ds_read_b64_tr_b16 a[4:5], v24 offset:0
    v_mfma_f32_16x16x32_bf16 v[44:47], a[100:103], a[40:43], v[44:47]
    ds_read_b64_tr_b16 a[6:7], v24 offset:256
    buffer_load_dwordx4 a[80:83], v19, s[12:15], s38 offen offset:0
    s_waitcnt lgkmcnt(14)
    v_mfma_f32_16x16x32_bf16 v[48:51], a[92:95], a[44:47], v[48:51]
    ds_read_b64_tr_b16 a[8:9], v25 offset:0
    v_mfma_f32_16x16x32_bf16 v[52:55], a[100:103], a[44:47], v[52:55]
    ds_read_b64_tr_b16 a[10:11], v25 offset:256
    v_mfma_f32_16x16x32_bf16 v[56:59], a[92:95], a[48:51], v[56:59]
    ds_read_b64_tr_b16 a[12:13], v26 offset:0
    v_mfma_f32_16x16x32_bf16 v[60:63], a[100:103], a[48:51], v[60:63]
    ds_read_b64_tr_b16 a[14:15], v26 offset:256
    buffer_load_dwordx4 a[84:87], v19, s[12:15], s38 offen offset:1024
    s_add_u32 s38, s38, 2048
    s_waitcnt lgkmcnt(14)
    v_mfma_f32_16x16x32_bf16 v[64:67], a[92:95], a[52:55], v[64:67]
    ds_read_b64_tr_b16 a[16:17], v27 offset:0
    v_mfma_f32_16x16x32_bf16 v[68:71], a[100:103], a[52:55], v[68:71]
    ds_read_b64_tr_b16 a[18:19], v27 offset:256
    v_mfma_f32_16x16x32_bf16 v[72:75], a[56:59], a[92:95], v[72:75]
    ds_read_b64_tr_b16 a[20:21], v28 offset:0
    v_mfma_f32_16x16x32_bf16 v[76:79], a[56:59], a[100:103], v[76:79]
    ds_read_b64_tr_b16 a[22:23], v28 offset:256
    s_add_u32 m0, s46, 0
    s_nop 0
    buffer_load_dwordx4 v17, s[16:19], s42 offen lds
    s_add_u32 s42, s42, 589824
    s_waitcnt lgkmcnt(14)
    v_mfma_f32_16x16x32_bf16 v[80:83], a[60:63], a[92:95], v[80:83]
    ds_read_b64_tr_b16 a[24:25], v29 offset:0
    v_mfma_f32_16x16x32_bf16 v[84:87], a[60:63], a[100:103], v[84:87]
    ds_read_b64_tr_b16 a[26:27], v29 offset:256
    v_mfma_f32_16x16x32_bf16 v[88:91], a[64:67], a[92:95], v[88:91]
    ds_read_b64_tr_b16 a[28:29], v30 offset:0
    v_mfma_f32_16x16x32_bf16 v[92:95], a[64:67], a[100:103], v[92:95]
    ds_read_b64_tr_b16 a[30:31], v30 offset:256
    s_waitcnt lgkmcnt(15)
    v_mfma_f32_16x16x32_bf16 v[96:99], a[68:71], a[92:95], v[96:99]
    ds_read_b64_tr_b16 a[32:33], v31 offset:0
    v_mfma_f32_16x16x32_bf16 v[100:103], a[68:71], a[100:103], v[100:103]
    ds_read_b64_tr_b16 a[34:35], v31 offset:256
    s_waitcnt vmcnt(7)
    s_barrier
    s_waitcnt lgkmcnt(14)
    v_mfma_f32_16x16x32_bf16 v[32:35], a[104:107], a[0:3], v[32:35]
    ds_read_b64_tr_b16 a[36:37], v23 offset:12288
    v_mfma_f32_16x16x32_bf16 v[36:39], a[112:115], a[0:3], v[36:39]
    ds_read_b64_tr_b16 a[38:39], v23 offset:12544
    v_mfma_f32_16x16x32_bf16 v[40:43], a[104:107], a[4:7], v[40:43]
    ds_read_b64_tr_b16 a[40:41], v24 offset:12288
    v_mfma_f32_16x16x32_bf16 v[44:47], a[112:115], a[4:7], v[44:47]
    ds_read_b64_tr_b16 a[42:43], v24 offset:12544
    s_waitcnt lgkmcnt(14)
    v_mfma_f32_16x16x32_bf16 v[48:51], a[104:107], a[8:11], v[48:51]
    ds_read_b64_tr_b16 a[44:45], v25 offset:12288
    v_mfma_f32_16x16x32_bf16 v[52:55], a[112:115], a[8:11], v[52:55]
    ds_read_b64_tr_b16 a[46:47], v25 offset:12544
    v_mfma_f32_16x16x32_bf16 v[56:59], a[104:107], a[12:15], v[56:59]
    ds_read_b64_tr_b16 a[48:49], v26 offset:12288
    v_mfma_f32_16x16x32_bf16 v[60:63], a[112:115], a[12:15], v[60:63]
    ds_read_b64_tr_b16 a[50:51], v26 offset:12544
    s_waitcnt lgkmcnt(14)
    v_mfma_f32_16x16x32_bf16 v[64:67], a[104:107], a[16:19], v[64:67]
    ds_read_b64_tr_b16 a[52:53], v27 offset:12288
    v_mfma_f32_16x16x32_bf16 v[68:71], a[112:115], a[16:19], v[68:71]
    ds_read_b64_tr_b16 a[54:55], v27 offset:12544
    v_mfma_f32_16x16x32_bf16 v[72:75], a[20:23], a[104:107], v[72:75]
    ds_read_b64_tr_b16 a[56:57], v28 offset:12288
    v_mfma_f32_16x16x32_bf16 v[76:79], a[20:23], a[112:115], v[76:79]
    ds_read_b64_tr_b16 a[58:59], v28 offset:12544
    s_waitcnt lgkmcnt(14)
    v_mfma_f32_16x16x32_bf16 v[80:83], a[24:27], a[104:107], v[80:83]
    ds_read_b64_tr_b16 a[60:61], v29 offset:12288
    v_mfma_f32_16x16x32_bf16 v[84:87], a[24:27], a[112:115], v[84:87]
    ds_read_b64_tr_b16 a[62:63], v29 offset:12544
    v_mfma_f32_16x16x32_bf16 v[88:91], a[28:31], a[104:107], v[88:91]
    ds_read_b64_tr_b16 a[64:65], v30 offset:12288
    v_mfma_f32_16x16x32_bf16 v[92:95], a[28:31], a[112:115], v[92:95]
    ds_read_b64_tr_b16 a[66:67], v30 offset:12544
    s_waitcnt lgkmcnt(15)
    v_mfma_f32_16x16x32_bf16 v[96:99], a[32:35], a[104:107], v[96:99]
    ds_read_b64_tr_b16 a[68:69], v31 offset:12288
    v_mfma_f32_16x16x32_bf16 v[100:103], a[32:35], a[112:115], v[100:103]
    ds_read_b64_tr_b16 a[70:71], v31 offset:12544
    s_waitcnt lgkmcnt(14)
    v_mfma_f32_16x16x32_bf16 v[32:35], a[108:111], a[36:39], v[32:35]
    ds_read_b64_tr_b16 a[0:1], v23 offset:24576
    v_mfma_f32_16x16x32_bf16 v[36:39], a[116:119], a[36:39], v[36:39]
    ds_read_b64_tr_b16 a[2:3], v23 offset:24832
    v_mfma_f32_16x16x32_bf16 v[40:43], a[108:111], a[40:43], v[40:43]
    ds_read_b64_tr_b16 a[4:5], v24 offset:24576
    v_mfma_f32_16x16x32_bf16 v[44:47], a[116:119], a[40:43], v[44:47]
    ds_read_b64_tr_b16 a[6:7], v24 offset:24832
    s_waitcnt lgkmcnt(14)
    v_mfma_f32_16x16x32_bf16 v[48:51], a[108:111], a[44:47], v[48:51]
    ds_read_b64_tr_b16 a[8:9], v25 offset:24576
    v_mfma_f32_16x16x32_bf16 v[52:55], a[116:119], a[44:47], v[52:55]
    ds_read_b64_tr_b16 a[10:11], v25 offset:24832
    v_mfma_f32_16x16x32_bf16 v[56:59], a[108:111], a[48:51], v[56:59]
    ds_read_b64_tr_b16 a[12:13], v26 offset:24576
    v_mfma_f32_16x16x32_bf16 v[60:63], a[116:119], a[48:51], v[60:63]
    ds_read_b64_tr_b16 a[14:15], v26 offset:24832
    s_waitcnt lgkmcnt(14)
    v_mfma_f32_16x16x32_bf16 v[64:67], a[108:111], a[52:55], v[64:67]
    ds_read_b64_tr_b16 a[16:17], v27 offset:24576
    v_mfma_f32_16x16x32_bf16 v[68:71], a[116:119], a[52:55], v[68:71]
    ds_read_b64_tr_b16 a[18:19], v27 offset:24832
    v_mfma_f32_16x16x32_bf16 v[72:75], a[56:59], a[108:111], v[72:75]
    ds_read_b64_tr_b16 a[20:21], v28 offset:24576
    v_mfma_f32_16x16x32_bf16 v[76:79], a[56:59], a[116:119], v[76:79]
    ds_read_b64_tr_b16 a[22:23], v28 offset:24832
    s_waitcnt lgkmcnt(14)
    v_mfma_f32_16x16x32_bf16 v[80:83], a[60:63], a[108:111], v[80:83]
    ds_read_b64_tr_b16 a[24:25], v29 offset:24576
    v_mfma_f32_16x16x32_bf16 v[84:87], a[60:63], a[116:119], v[84:87]
    ds_read_b64_tr_b16 a[26:27], v29 offset:24832
    v_mfma_f32_16x16x32_bf16 v[88:91], a[64:67], a[108:111], v[88:91]
    ds_read_b64_tr_b16 a[28:29], v30 offset:24576
    v_mfma_f32_16x16x32_bf16 v[92:95], a[64:67], a[116:119], v[92:95]
    ds_read_b64_tr_b16 a[30:31], v30 offset:24832
    s_waitcnt lgkmcnt(15)
    v_mfma_f32_16x16x32_bf16 v[96:99], a[68:71], a[108:111], v[96:99]
    ds_read_b64_tr_b16 a[32:33], v31 offset:24576
    v_mfma_f32_16x16x32_bf16 v[100:103], a[68:71], a[116:119], v[100:103]
    ds_read_b64_tr_b16 a[34:35], v31 offset:24832
    s_waitcnt vmcnt(0)
    s_barrier
    s_waitcnt lgkmcnt(14)
    v_mfma_f32_16x16x32_bf16 v[32:35], a[120:123], a[0:3], v[32:35]
    ds_read_b64_tr_b16 a[36:37], v23 offset:36864
    v_mfma_f32_16x16x32_bf16 v[36:39], a[128:131], a[0:3], v[36:39]
    ds_read_b64_tr_b16 a[38:39], v23 offset:37120
    v_mfma_f32_16x16x32_bf16 v[40:43], a[120:123], a[4:7], v[40:43]
    ds_read_b64_tr_b16 a[40:41], v24 offset:36864
    v_mfma_f32_16x16x32_bf16 v[44:47], a[128:131], a[4:7], v[44:47]
    ds_read_b64_tr_b16 a[42:43], v24 offset:37120
    s_waitcnt lgkmcnt(14)
    v_mfma_f32_16x16x32_bf16 v[48:51], a[120:123], a[8:11], v[48:51]
    ds_read_b64_tr_b16 a[44:45], v25 offset:36864
    v_mfma_f32_16x16x32_bf16 v[52:55], a[128:131], a[8:11], v[52:55]
    ds_read_b64_tr_b16 a[46:47], v25 offset:37120
    v_mfma_f32_16x16x32_bf16 v[56:59], a[120:123], a[12:15], v[56:59]
    ds_read_b64_tr_b16 a[48:49], v26 offset:36864
    v_mfma_f32_16x16x32_bf16 v[60:63], a[128:131], a[12:15], v[60:63]
    ds_read_b64_tr_b16 a[50:51], v26 offset:37120
    s_waitcnt lgkmcnt(14)
    v_mfma_f32_16x16x32_bf16 v[64:67], a[120:123], a[16:19], v[64:67]
    ds_read_b64_tr_b16 a[52:53], v27 offset:36864
    v_mfma_f32_16x16x32_bf16 v[68:71], a[128:131], a[16:19], v[68:71]
    ds_read_b64_tr_b16 a[54:55], v27 offset:37120
    v_mfma_f32_16x16x32_bf16 v[72:75], a[20:23], a[120:123], v[72:75]
    ds_read_b64_tr_b16 a[56:57], v28 offset:36864
    v_mfma_f32_16x16x32_bf16 v[76:79], a[20:23], a[128:131], v[76:79]
    ds_read_b64_tr_b16 a[58:59], v28 offset:37120
    s_waitcnt lgkmcnt(14)
    v_mfma_f32_16x16x32_bf16 v[80:83], a[24:27], a[120:123], v[80:83]
    ds_read_b64_tr_b16 a[60:61], v29 offset:36864
    v_mfma_f32_16x16x32_bf16 v[84:87], a[24:27], a[128:131], v[84:87]
    ds_read_b64_tr_b16 a[62:63], v29 offset:37120
    v_mfma_f32_16x16x32_bf16 v[88:91], a[28:31], a[120:123], v[88:91]
    ds_read_b64_tr_b16 a[64:65], v30 offset:36864
    v_mfma_f32_16x16x32_bf16 v[92:95], a[28:31], a[128:131], v[92:95]
    ds_read_b64_tr_b16 a[66:67], v30 offset:37120
    s_waitcnt lgkmcnt(15)
    v_mfma_f32_16x16x32_bf16 v[96:99], a[32:35], a[120:123], v[96:99]
    ds_read_b64_tr_b16 a[68:69], v31 offset:36864
    v_mfma_f32_16x16x32_bf16 v[100:103], a[32:35], a[128:131], v[100:103]
    ds_read_b64_tr_b16 a[70:71], v31 offset:37120
    s_waitcnt lgkmcnt(14)
    v_mfma_f32_16x16x32_bf16 v[32:35], a[124:127], a[36:39], v[32:35]
    ds_read_b64_tr_b16 a[0:1], v8 offset:0
    v_mfma_f32_16x16x32_bf16 v[36:39], a[132:135], a[36:39], v[36:39]
    ds_read_b64_tr_b16 a[2:3], v8 offset:256
    v_mfma_f32_16x16x32_bf16 v[40:43], a[124:127], a[40:43], v[40:43]
    ds_read_b64_tr_b16 a[4:5], v9 offset:0
    v_mfma_f32_16x16x32_bf16 v[44:47], a[132:135], a[40:43], v[44:47]
    ds_read_b64_tr_b16 a[6:7], v9 offset:256
    s_waitcnt lgkmcnt(14)
    v_mfma_f32_16x16x32_bf16 v[48:51], a[124:127], a[44:47], v[48:51]
    ds_read_b64_tr_b16 a[8:9], v10 offset:0
    v_mfma_f32_16x16x32_bf16 v[52:55], a[132:135], a[44:47], v[52:55]
    ds_read_b64_tr_b16 a[10:11], v10 offset:256
    v_mfma_f32_16x16x32_bf16 v[56:59], a[124:127], a[48:51], v[56:59]
    ds_read_b64_tr_b16 a[12:13], v11 offset:0
    v_mfma_f32_16x16x32_bf16 v[60:63], a[132:135], a[48:51], v[60:63]
    ds_read_b64_tr_b16 a[14:15], v11 offset:256
    s_waitcnt lgkmcnt(14)
    v_mfma_f32_16x16x32_bf16 v[64:67], a[124:127], a[52:55], v[64:67]
    ds_read_b64_tr_b16 a[16:17], v12 offset:0
    v_mfma_f32_16x16x32_bf16 v[68:71], a[132:135], a[52:55], v[68:71]
    ds_read_b64_tr_b16 a[18:19], v12 offset:256
    v_mfma_f32_16x16x32_bf16 v[72:75], a[56:59], a[124:127], v[72:75]
    ds_read_b64_tr_b16 a[20:21], v13 offset:0
    v_mfma_f32_16x16x32_bf16 v[76:79], a[56:59], a[132:135], v[76:79]
    ds_read_b64_tr_b16 a[22:23], v13 offset:256
    s_waitcnt lgkmcnt(14)
    v_mfma_f32_16x16x32_bf16 v[80:83], a[60:63], a[124:127], v[80:83]
    ds_read_b64_tr_b16 a[24:25], v14 offset:0
    v_mfma_f32_16x16x32_bf16 v[84:87], a[60:63], a[132:135], v[84:87]
    ds_read_b64_tr_b16 a[26:27], v14 offset:256
    v_mfma_f32_16x16x32_bf16 v[88:91], a[64:67], a[124:127], v[88:91]
    ds_read_b64_tr_b16 a[28:29], v15 offset:0
    v_mfma_f32_16x16x32_bf16 v[92:95], a[64:67], a[132:135], v[92:95]
    ds_read_b64_tr_b16 a[30:31], v15 offset:256
    s_waitcnt lgkmcnt(15)
    v_mfma_f32_16x16x32_bf16 v[96:99], a[68:71], a[124:127], v[96:99]
    ds_read_b64_tr_b16 a[32:33], v16 offset:0
    v_mfma_f32_16x16x32_bf16 v[100:103], a[68:71], a[132:135], v[100:103]
    ds_read_b64_tr_b16 a[34:35], v16 offset:256
    s_waitcnt lgkmcnt(14)
    v_mfma_f32_16x16x32_bf16 v[32:35], a[72:75], a[0:3], v[32:35]
    ds_read_b64_tr_b16 a[36:37], v8 offset:12288
    v_mfma_f32_16x16x32_bf16 v[36:39], a[80:83], a[0:3], v[36:39]
    ds_read_b64_tr_b16 a[38:39], v8 offset:12544
    v_mfma_f32_16x16x32_bf16 v[40:43], a[72:75], a[4:7], v[40:43]
    ds_read_b64_tr_b16 a[40:41], v9 offset:12288
    v_mfma_f32_16x16x32_bf16 v[44:47], a[80:83], a[4:7], v[44:47]
    ds_read_b64_tr_b16 a[42:43], v9 offset:12544
    s_waitcnt lgkmcnt(14)
    v_mfma_f32_16x16x32_bf16 v[48:51], a[72:75], a[8:11], v[48:51]
    ds_read_b64_tr_b16 a[44:45], v10 offset:12288
    v_mfma_f32_16x16x32_bf16 v[52:55], a[80:83], a[8:11], v[52:55]
    ds_read_b64_tr_b16 a[46:47], v10 offset:12544
    v_mfma_f32_16x16x32_bf16 v[56:59], a[72:75], a[12:15], v[56:59]
    ds_read_b64_tr_b16 a[48:49], v11 offset:12288
    v_mfma_f32_16x16x32_bf16 v[60:63], a[80:83], a[12:15], v[60:63]
    ds_read_b64_tr_b16 a[50:51], v11 offset:12544
    s_waitcnt lgkmcnt(14)
    v_mfma_f32_16x16x32_bf16 v[64:67], a[72:75], a[16:19], v[64:67]
    ds_read_b64_tr_b16 a[52:53], v12 offset:12288
    v_mfma_f32_16x16x32_bf16 v[68:71], a[80:83], a[16:19], v[68:71]
    ds_read_b64_tr_b16 a[54:55], v12 offset:12544
    v_mfma_f32_16x16x32_bf16 v[72:75], a[20:23], a[72:75], v[72:75]
    ds_read_b64_tr_b16 a[56:57], v13 offset:12288
    v_mfma_f32_16x16x32_bf16 v[76:79], a[20:23], a[80:83], v[76:79]
    ds_read_b64_tr_b16 a[58:59], v13 offset:12544
    s_waitcnt lgkmcnt(14)
    v_mfma_f32_16x16x32_bf16 v[80:83], a[24:27], a[72:75], v[80:83]
    ds_read_b64_tr_b16 a[60:61], v14 offset:12288
    v_mfma_f32_16x16x32_bf16 v[84:87], a[24:27], a[80:83], v[84:87]
    ds_read_b64_tr_b16 a[62:63], v14 offset:12544
    v_mfma_f32_16x16x32_bf16 v[88:91], a[28:31], a[72:75], v[88:91]
    ds_read_b64_tr_b16 a[64:65], v15 offset:12288
    v_mfma_f32_16x16x32_bf16 v[92:95], a[28:31], a[80:83], v[92:95]
    ds_read_b64_tr_b16 a[66:67], v15 offset:12544
    s_waitcnt lgkmcnt(15)
    v_mfma_f32_16x16x32_bf16 v[96:99], a[32:35], a[72:75], v[96:99]
    ds_read_b64_tr_b16 a[68:69], v16 offset:12288
    v_mfma_f32_16x16x32_bf16 v[100:103], a[32:35], a[80:83], v[100:103]
    ds_read_b64_tr_b16 a[70:71], v16 offset:12544
    s_waitcnt lgkmcnt(14)
    v_mfma_f32_16x16x32_bf16 v[32:35], a[76:79], a[36:39], v[32:35]
    v_mfma_f32_16x16x32_bf16 v[36:39], a[84:87], a[36:39], v[36:39]
    v_mfma_f32_16x16x32_bf16 v[40:43], a[76:79], a[40:43], v[40:43]
    v_mfma_f32_16x16x32_bf16 v[44:47], a[84:87], a[40:43], v[44:47]
    s_waitcnt lgkmcnt(10)
    v_mfma_f32_16x16x32_bf16 v[48:51], a[76:79], a[44:47], v[48:51]
    v_mfma_f32_16x16x32_bf16 v[52:55], a[84:87], a[44:47], v[52:55]
    v_mfma_f32_16x16x32_bf16 v[56:59], a[76:79], a[48:51], v[56:59]
    v_mfma_f32_16x16x32_bf16 v[60:63], a[84:87], a[48:51], v[60:63]
    s_waitcnt lgkmcnt(6)
    v_mfma_f32_16x16x32_bf16 v[64:67], a[76:79], a[52:55], v[64:67]
    v_mfma_f32_16x16x32_bf16 v[68:71], a[84:87], a[52:55], v[68:71]
    v_mfma_f32_16x16x32_bf16 v[72:75], a[56:59], a[76:79], v[72:75]
    v_mfma_f32_16x16x32_bf16 v[76:79], a[56:59], a[84:87], v[76:79]
    s_waitcnt lgkmcnt(2)
    v_mfma_f32_16x16x32_bf16 v[80:83], a[60:63], a[76:79], v[80:83]
    v_mfma_f32_16x16x32_bf16 v[84:87], a[60:63], a[84:87], v[84:87]
    v_mfma_f32_16x16x32_bf16 v[88:91], a[64:67], a[76:79], v[88:91]
    v_mfma_f32_16x16x32_bf16 v[92:95], a[64:67], a[84:87], v[92:95]
    s_waitcnt lgkmcnt(0)
    v_mfma_f32_16x16x32_bf16 v[96:99], a[68:71], a[76:79], v[96:99]
    v_mfma_f32_16x16x32_bf16 v[100:103], a[68:71], a[84:87], v[100:103]
    v_lshl_add_u32 v3, v4, 4, s30
    ds_read_b128 v[104:107], v3
    ds_read_b128 v[108:111], v3 offset:64
    ds_read_b128 v[112:115], v3 offset:128
    ds_read_b128 v[116:119], v3 offset:192
    v_lshlrev_b32 v22, 2, v6
    v_add_u32 v22, 100352, v22
    ds_read_b32 a0, v22 offset:0
    ds_read_b32 a1, v22 offset:1024
    ds_read_b32 a2, v22 offset:64
    ds_read_b32 a3, v22 offset:1088
    ds_read_b32 a4, v22 offset:128
    ds_read_b32 a5, v22 offset:1152
    ds_read_b32 a6, v22 offset:192
    ds_read_b32 a7, v22 offset:1216
    ds_read_b32 a8, v22 offset:256
    ds_read_b32 a9, v22 offset:1280
    v_mov_b32 v8, 0
    v_mov_b32 v9, 0
    v_mov_b32 v10, 0
    v_mov_b32 v11, 0
    v_mov_b32 v12, 0
    v_mov_b32 v13, 0
    v_mov_b32 v14, 0
    v_mov_b32 v15, 0
    v_mov_b32 v16, 0
    v_mov_b32 v17, 0
    v_mov_b32 v18, 0
    v_mov_b32 v19, 0
    v_mov_b32 v24, 0
    v_mov_b32 v25, 0
    v_mov_b32 v26, 0
    v_mov_b32 v27, 0
    s_waitcnt lgkmcnt(0)
    v_accvgpr_read_b32 v7, a0
    v_accvgpr_read_b32 v0, a1
    v_fma_f32 v28, v112, v7, v0
    v_fma_f32 v29, v113, v7, v0
    v_fma_f32 v30, v114, v7, v0
    v_fma_f32 v31, v115, v7, v0
    v_fma_f32 v32, v104, v32, v28
    v_fma_f32 v33, v105, v33, v29
    v_fma_f32 v34, v106, v34, v30
    v_fma_f32 v35, v107, v35, v31
    v_mul_f32 v22, v32, v32
    v_mul_f32 v23, v33, v33
    v_mul_f32 v2, v34, v34
    v_mul_f32 v5, v35, v35
    v_fma_f32 v22, v22, s48, v20
    v_fma_f32 v23, v23, s48, v20
    v_fma_f32 v2, v2, s48, v20
    v_fma_f32 v5, v5, s48, v20
    v_mul_f32 v22, v22, v32
    v_mul_f32 v23, v23, v33
    v_mul_f32 v2, v2, v34
    v_mul_f32 v5, v5, v35
    v_exp_f32 v22, v22
    v_exp_f32 v23, v23
    v_exp_f32 v2, v2
    v_exp_f32 v5, v5
    v_add_f32 v22, 1.0, v22
    v_add_f32 v23, 1.0, v23
    v_add_f32 v2, 1.0, v2
    v_add_f32 v5, 1.0, v5
    v_rcp_f32 v22, v22
    v_rcp_f32 v23, v23
    v_rcp_f32 v2, v2
    v_rcp_f32 v5, v5
    v_mul_f32 v32, v32, v22
    v_mul_f32 v33, v33, v23
    v_mul_f32 v34, v34, v2
    v_mul_f32 v35, v35, v5
    v_add_f32 v8, v8, v32
    v_fmac_f32 v9, v32, v32
    v_add_f32 v10, v10, v33
    v_fmac_f32 v11, v33, v33
    v_add_f32 v12, v12, v34
    v_fmac_f32 v13, v34, v34
    v_add_f32 v14, v14, v35
    v_fmac_f32 v15, v35, v35
    v_fma_f32 v28, v116, v7, v0
    v_fma_f32 v29, v117, v7, v0
    v_fma_f32 v30, v118, v7, v0
    v_fma_f32 v31, v119, v7, v0
    v_fma_f32 v36, v108, v36, v28
    v_fma_f32 v37, v109, v37, v29
    v_fma_f32 v38, v110, v38, v30
    v_fma_f32 v39, v111, v39, v31
    v_mul_f32 v22, v36, v36
    v_mul_f32 v23, v37, v37
    v_mul_f32 v2, v38, v38
    v_mul_f32 v5, v39, v39
    v_fma_f32 v22, v22, s48, v20
    v_fma_f32 v23, v23, s48, v20
    v_fma_f32 v2, v2, s48, v20
    v_fma_f32 v5, v5, s48, v20
    v_mul_f32 v22, v22, v36
    v_mul_f32 v23, v23, v37
    v_mul_f32 v2, v2, v38
    v_mul_f32 v5, v5, v39
    v_exp_f32 v22, v22
    v_exp_f32 v23, v23
    v_exp_f32 v2, v2
    v_exp_f32 v5, v5
    v_add_f32 v22, 1.0, v22
    v_add_f32 v23, 1.0, v23
    v_add_f32 v2, 1.0, v2
    v_add_f32 v5, 1.0, v5
    v_rcp_f32 v22, v22
    v_rcp_f32 v23, v23
    v_rcp_f32 v2, v2
    v_rcp_f32 v5, v5
    v_mul_f32 v36, v36, v22
    v_mul_f32 v37, v37, v23
    v_mul_f32 v38, v38, v2
    v_mul_f32 v39, v39, v5
    v_add_f32 v16, v16, v36
    v_fmac_f32 v17, v36, v36
    v_add_f32 v18, v18, v37
    v_fmac_f32 v19, v37, v37
    v_add_f32 v24, v24, v38
    v_fmac_f32 v25, v38, v38
    v_add_f32 v26, v26, v39
    v_fmac_f32 v27, v39, v39
    v_accvgpr_read_b32 v7, a2
    v_accvgpr_read_b32 v0, a3
    v_fma_f32 v28, v112, v7, v0
    v_fma_f32 v29, v113, v7, v0
    v_fma_f32 v30, v114, v7, v0
    v_fma_f32 v31, v115, v7, v0
    v_fma_f32 v40, v104, v40, v28
    v_fma_f32 v41, v105, v41, v29
    v_fma_f32 v42, v106, v42, v30
    v_fma_f32 v43, v107, v43, v31
    v_mul_f32 v22, v40, v40
    v_mul_f32 v23, v41, v41
    v_mul_f32 v2, v42, v42
    v_mul_f32 v5, v43, v43
    v_fma_f32 v22, v22, s48, v20
    v_fma_f32 v23, v23, s48, v20
    v_fma_f32 v2, v2, s48, v20
    v_fma_f32 v5, v5, s48, v20
    v_mul_f32 v22, v22, v40
    v_mul_f32 v23, v23, v41
    v_mul_f32 v2, v2, v42
    v_mul_f32 v5, v5, v43
    v_exp_f32 v22, v22
    v_exp_f32 v23, v23
    v_exp_f32 v2, v2
    v_exp_f32 v5, v5
    v_add_f32 v22, 1.0, v22
    v_add_f32 v23, 1.0, v23
    v_add_f32 v2, 1.0, v2
    v_add_f32 v5, 1.0, v5
    v_rcp_f32 v22, v22
    v_rcp_f32 v23, v23
    v_rcp_f32 v2, v2
    v_rcp_f32 v5, v5
    v_mul_f32 v40, v40, v22
    v_mul_f32 v41, v41, v23
    v_mul_f32 v42, v42, v2
    v_mul_f32 v43, v43, v5
    v_add_f32 v8, v8, v40
    v_fmac_f32 v9, v40, v40
    v_add_f32 v10, v10, v41
    v_fmac_f32 v11, v41, v41
    v_add_f32 v12, v12, v42
    v_fmac_f32 v13, v42, v42
    v_add_f32 v14, v14, v43
    v_fmac_f32 v15, v43, v43
    v_fma_f32 v28, v116, v7, v0
    v_fma_f32 v29, v117, v7, v0
    v_fma_f32 v30, v118, v7, v0
    v_fma_f32 v31, v119, v7, v0
    v_fma_f32 v44, v108, v44, v28
    v_fma_f32 v45, v109, v45, v29
    v_fma_f32 v46, v110, v46, v30
    v_fma_f32 v47, v111, v47, v31
    v_mul_f32 v22, v44, v44
    v_mul_f32 v23, v45, v45
    v_mul_f32 v2, v46, v46
    v_mul_f32 v5, v47, v47
    v_fma_f32 v22, v22, s48, v20
    v_fma_f32 v23, v23, s48, v20
    v_fma_f32 v2, v2, s48, v20
    v_fma_f32 v5, v5, s48, v20
    v_mul_f32 v22, v22, v44
    v_mul_f32 v23, v23, v45
    v_mul_f32 v2, v2, v46
    v_mul_f32 v5, v5, v47
    v_exp_f32 v22, v22
    v_exp_f32 v23, v23
    v_exp_f32 v2, v2
    v_exp_f32 v5, v5
    v_add_f32 v22, 1.0, v22
    v_add_f32 v23, 1.0, v23
    v_add_f32 v2, 1.0, v2
    v_add_f32 v5, 1.0, v5
    v_rcp_f32 v22, v22
    v_rcp_f32 v23, v23
    v_rcp_f32 v2, v2
    v_rcp_f32 v5, v5
    v_mul_f32 v44, v44, v22
    v_mul_f32 v45, v45, v23
    v_mul_f32 v46, v46, v2
    v_mul_f32 v47, v47, v5
    v_add_f32 v16, v16, v44
    v_fmac_f32 v17, v44, v44
    v_add_f32 v18, v18, v45
    v_fmac_f32 v19, v45, v45
    v_add_f32 v24, v24, v46
    v_fmac_f32 v25, v46, v46
    v_add_f32 v26, v26, v47
    v_fmac_f32 v27, v47, v47
    v_accvgpr_read_b32 v7, a4
    v_accvgpr_read_b32 v0, a5
    v_fma_f32 v28, v112, v7, v0
    v_fma_f32 v29, v113, v7, v0
    v_fma_f32 v30, v114, v7, v0
    v_fma_f32 v31, v115, v7, v0
    v_fma_f32 v48, v104, v48, v28
    v_fma_f32 v49, v105, v49, v29
    v_fma_f32 v50, v106, v50, v30
    v_fma_f32 v51, v107, v51, v31
    v_mul_f32 v22, v48, v48
    v_mul_f32 v23, v49, v49
    v_mul_f32 v2, v50, v50
    v_mul_f32 v5, v51, v51
    v_fma_f32 v22, v22, s48, v20
    v_fma_f32 v23, v23, s48, v20
    v_fma_f32 v2, v2, s48, v20
    v_fma_f32 v5, v5, s48, v20
    v_mul_f32 v22, v22, v48
    v_mul_f32 v23, v23, v49
    v_mul_f32 v2, v2, v50
    v_mul_f32 v5, v5, v51
    v_exp_f32 v22, v22
    v_exp_f32 v23, v23
    v_exp_f32 v2, v2
    v_exp_f32 v5, v5
    v_add_f32 v22, 1.0, v22
    v_add_f32 v23, 1.0, v23
    v_add_f32 v2, 1.0, v2
    v_add_f32 v5, 1.0, v5
    v_rcp_f32 v22, v22
    v_rcp_f32 v23, v23
    v_rcp_f32 v2, v2
    v_rcp_f32 v5, v5
    v_mul_f32 v48, v48, v22
    v_mul_f32 v49, v49, v23
    v_mul_f32 v50, v50, v2
    v_mul_f32 v51, v51, v5
    v_add_f32 v8, v8, v48
    v_fmac_f32 v9, v48, v48
    v_add_f32 v10, v10, v49
    v_fmac_f32 v11, v49, v49
    v_add_f32 v12, v12, v50
    v_fmac_f32 v13, v50, v50
    v_add_f32 v14, v14, v51
    v_fmac_f32 v15, v51, v51
    v_fma_f32 v28, v116, v7, v0
    v_fma_f32 v29, v117, v7, v0
    v_fma_f32 v30, v118, v7, v0
    v_fma_f32 v31, v119, v7, v0
    v_fma_f32 v52, v108, v52, v28
    v_fma_f32 v53, v109, v53, v29
    v_fma_f32 v54, v110, v54, v30
    v_fma_f32 v55, v111, v55, v31
    v_mul_f32 v22, v52, v52
    v_mul_f32 v23, v53, v53
    v_mul_f32 v2, v54, v54
    v_mul_f32 v5, v55, v55
    v_fma_f32 v22, v22, s48, v20
    v_fma_f32 v23, v23, s48, v20
    v_fma_f32 v2, v2, s48, v20
    v_fma_f32 v5, v5, s48, v20
    v_mul_f32 v22, v22, v52
    v_mul_f32 v23, v23, v53
    v_mul_f32 v2, v2, v54
    v_mul_f32 v5, v5, v55
    v_exp_f32 v22, v22
    v_exp_f32 v23, v23
    v_exp_f32 v2, v2
    v_exp_f32 v5, v5
    v_add_f32 v22, 1.0, v22
    v_add_f32 v23, 1.0, v23
    v_add_f32 v2, 1.0, v2
    v_add_f32 v5, 1.0, v5
    v_rcp_f32 v22, v22
    v_rcp_f32 v23, v23
    v_rcp_f32 v2, v2
    v_rcp_f32 v5, v5
    v_mul_f32 v52, v52, v22
    v_mul_f32 v53, v53, v23
    v_mul_f32 v54, v54, v2
    v_mul_f32 v55, v55, v5
    v_add_f32 v16, v16, v52
    v_fmac_f32 v17, v52, v52
    v_add_f32 v18, v18, v53
    v_fmac_f32 v19, v53, v53
    v_add_f32 v24, v24, v54
    v_fmac_f32 v25, v54, v54
    v_add_f32 v26, v26, v55
    v_fmac_f32 v27, v55, v55
    v_accvgpr_read_b32 v7, a6
    v_accvgpr_read_b32 v0, a7
    v_fma_f32 v28, v112, v7, v0
    v_fma_f32 v29, v113, v7, v0
    v_fma_f32 v30, v114, v7, v0
    v_fma_f32 v31, v115, v7, v0
    v_fma_f32 v56, v104, v56, v28
    v_fma_f32 v57, v105, v57, v29
    v_fma_f32 v58, v106, v58, v30
    v_fma_f32 v59, v107, v59, v31
    v_mul_f32 v22, v56, v56
    v_mul_f32 v23, v57, v57
    v_mul_f32 v2, v58, v58
    v_mul_f32 v5, v59, v59
    v_fma_f32 v22, v22, s48, v20
    v_fma_f32 v23, v23, s48, v20
    v_fma_f32 v2, v2, s48, v20
    v_fma_f32 v5, v5, s48, v20
    v_mul_f32 v22, v22, v56
    v_mul_f32 v23, v23, v57
    v_mul_f32 v2, v2, v58
    v_mul_f32 v5, v5, v59
    v_exp_f32 v22, v22
    v_exp_f32 v23, v23
    v_exp_f32 v2, v2
    v_exp_f32 v5, v5
    v_add_f32 v22, 1.0, v22
    v_add_f32 v23, 1.0, v23
    v_add_f32 v2, 1.0, v2
    v_add_f32 v5, 1.0, v5
    v_rcp_f32 v22, v22
    v_rcp_f32 v23, v23
    v_rcp_f32 v2, v2
    v_rcp_f32 v5, v5
    v_mul_f32 v56, v56, v22
    v_mul_f32 v57, v57, v23
    v_mul_f32 v58, v58, v2
    v_mul_f32 v59, v59, v5
    v_add_f32 v8, v8, v56
    v_fmac_f32 v9, v56, v56
    v_add_f32 v10, v10, v57
    v_fmac_f32 v11, v57, v57
    v_add_f32 v12, v12, v58
    v_fmac_f32 v13, v58, v58
    v_add_f32 v14, v14, v59
    v_fmac_f32 v15, v59, v59
    v_fma_f32 v28, v116, v7, v0
    v_fma_f32 v29, v117, v7, v0
    v_fma_f32 v30, v118, v7, v0
    v_fma_f32 v31, v119, v7, v0
    v_fma_f32 v60, v108, v60, v28
    v_fma_f32 v61, v109, v61, v29
    v_fma_f32 v62, v110, v62, v30
    v_fma_f32 v63, v111, v63, v31
    v_mul_f32 v22, v60, v60
    v_mul_f32 v23, v61, v61
    v_mul_f32 v2, v62, v62
    v_mul_f32 v5, v63, v63
    v_fma_f32 v22, v22, s48, v20
    v_fma_f32 v23, v23, s48, v20
    v_fma_f32 v2, v2, s48, v20
    v_fma_f32 v5, v5, s48, v20
    v_mul_f32 v22, v22, v60
    v_mul_f32 v23, v23, v61
    v_mul_f32 v2, v2, v62
    v_mul_f32 v5, v5, v63
    v_exp_f32 v22, v22
    v_exp_f32 v23, v23
    v_exp_f32 v2, v2
    v_exp_f32 v5, v5
    v_add_f32 v22, 1.0, v22
    v_add_f32 v23, 1.0, v23
    v_add_f32 v2, 1.0, v2
    v_add_f32 v5, 1.0, v5
    v_rcp_f32 v22, v22
    v_rcp_f32 v23, v23
    v_rcp_f32 v2, v2
    v_rcp_f32 v5, v5
    v_mul_f32 v60, v60, v22
    v_mul_f32 v61, v61, v23
    v_mul_f32 v62, v62, v2
    v_mul_f32 v63, v63, v5
    v_add_f32 v16, v16, v60
    v_fmac_f32 v17, v60, v60
    v_add_f32 v18, v18, v61
    v_fmac_f32 v19, v61, v61
    v_add_f32 v24, v24, v62
    v_fmac_f32 v25, v62, v62
    v_add_f32 v26, v26, v63
    v_fmac_f32 v27, v63, v63
    v_accvgpr_read_b32 v7, a8
    v_accvgpr_read_b32 v0, a9
    v_fma_f32 v28, v112, v7, v0
    v_fma_f32 v29, v113, v7, v0
    v_fma_f32 v30, v114, v7, v0
    v_fma_f32 v31, v115, v7, v0
    v_fma_f32 v64, v104, v64, v28
    v_fma_f32 v65, v105, v65, v29
    v_fma_f32 v66, v106, v66, v30
    v_fma_f32 v67, v107, v67, v31
    v_mul_f32 v22, v64, v64
    v_mul_f32 v23, v65, v65
    v_mul_f32 v2, v66, v66
    v_mul_f32 v5, v67, v67
    v_fma_f32 v22, v22, s48, v20
    v_fma_f32 v23, v23, s48, v20
    v_fma_f32 v2, v2, s48, v20
    v_fma_f32 v5, v5, s48, v20
    v_mul_f32 v22, v22, v64
    v_mul_f32 v23, v23, v65
    v_mul_f32 v2, v2, v66
    v_mul_f32 v5, v5, v67
    v_exp_f32 v22, v22
    v_exp_f32 v23, v23
    v_exp_f32 v2, v2
    v_exp_f32 v5, v5
    v_add_f32 v22, 1.0, v22
    v_add_f32 v23, 1.0, v23
    v_add_f32 v2, 1.0, v2
    v_add_f32 v5, 1.0, v5
    v_rcp_f32 v22, v22
    v_rcp_f32 v23, v23
    v_rcp_f32 v2, v2
    v_rcp_f32 v5, v5
    v_mul_f32 v64, v64, v22
    v_mul_f32 v65, v65, v23
    v_mul_f32 v66, v66, v2
    v_mul_f32 v67, v67, v5
    v_add_f32 v8, v8, v64
    v_fmac_f32 v9, v64, v64
    v_add_f32 v10, v10, v65
    v_fmac_f32 v11, v65, v65
    v_add_f32 v12, v12, v66
    v_fmac_f32 v13, v66, v66
    v_add_f32 v14, v14, v67
    v_fmac_f32 v15, v67, v67
    v_fma_f32 v28, v116, v7, v0
    v_fma_f32 v29, v117, v7, v0
    v_fma_f32 v30, v118, v7, v0
    v_fma_f32 v31, v119, v7, v0
    v_fma_f32 v68, v108, v68, v28
    v_fma_f32 v69, v109, v69, v29
    v_fma_f32 v70, v110, v70, v30
    v_fma_f32 v71, v111, v71, v31
    v_mul_f32 v22, v68, v68
    v_mul_f32 v23, v69, v69
    v_mul_f32 v2, v70, v70
    v_mul_f32 v5, v71, v71
    v_fma_f32 v22, v22, s48, v20
    v_fma_f32 v23, v23, s48, v20
    v_fma_f32 v2, v2, s48, v20
    v_fma_f32 v5, v5, s48, v20
    v_mul_f32 v22, v22, v68
    v_mul_f32 v23, v23, v69
    v_mul_f32 v2, v2, v70
    v_mul_f32 v5, v5, v71
    v_exp_f32 v22, v22
    v_exp_f32 v23, v23
    v_exp_f32 v2, v2
    v_exp_f32 v5, v5
    v_add_f32 v22, 1.0, v22
    v_add_f32 v23, 1.0, v23
    v_add_f32 v2, 1.0, v2
    v_add_f32 v5, 1.0, v5
    v_rcp_f32 v22, v22
    v_rcp_f32 v23, v23
    v_rcp_f32 v2, v2
    v_rcp_f32 v5, v5
    v_mul_f32 v68, v68, v22
    v_mul_f32 v69, v69, v23
    v_mul_f32 v70, v70, v2
    v_mul_f32 v71, v71, v5
    v_add_f32 v16, v16, v68
    v_fmac_f32 v17, v68, v68
    v_add_f32 v18, v18, v69
    v_fmac_f32 v19, v69, v69
    v_add_f32 v24, v24, v70
    v_fmac_f32 v25, v70, v70
    v_add_f32 v26, v26, v71
    v_fmac_f32 v27, v71, v71
    s_nop 1
    v_add_f32_dpp v8, v8, v8 row_ror:8 row_mask:0xf bank_mask:0xf
    v_add_f32_dpp v9, v9, v9 row_ror:8 row_mask:0xf bank_mask:0xf
    v_add_f32_dpp v10, v10, v10 row_ror:8 row_mask:0xf bank_mask:0xf
    v_add_f32_dpp v11, v11, v11 row_ror:8 row_mask:0xf bank_mask:0xf
    v_add_f32_dpp v12, v12, v12 row_ror:8 row_mask:0xf bank_mask:0xf
    v_add_f32_dpp v13, v13, v13 row_ror:8 row_mask:0xf bank_mask:0xf
    v_add_f32_dpp v14, v14, v14 row_ror:8 row_mask:0xf bank_mask:0xf
    v_add_f32_dpp v15, v15, v15 row_ror:8 row_mask:0xf bank_mask:0xf
    v_add_f32_dpp v16, v16, v16 row_ror:8 row_mask:0xf bank_mask:0xf
    v_add_f32_dpp v17, v17, v17 row_ror:8 row_mask:0xf bank_mask:0xf
    v_add_f32_dpp v18, v18, v18 row_ror:8 row_mask:0xf bank_mask:0xf
    v_add_f32_dpp v19, v19, v19 row_ror:8 row_mask:0xf bank_mask:0xf
    v_add_f32_dpp v24, v24, v24 row_ror:8 row_mask:0xf bank_mask:0xf
    v_add_f32_dpp v25, v25, v25 row_ror:8 row_mask:0xf bank_mask:0xf
    v_add_f32_dpp v26, v26, v26 row_ror:8 row_mask:0xf bank_mask:0xf
    v_add_f32_dpp v27, v27, v27 row_ror:8 row_mask:0xf bank_mask:0xf
    v_add_f32_dpp v8, v8, v8 row_ror:4 row_mask:0xf bank_mask:0xf
    v_add_f32_dpp v9, v9, v9 row_ror:4 row_mask:0xf bank_mask:0xf
    v_add_f32_dpp v10, v10, v10 row_ror:4 row_mask:0xf bank_mask:0xf
    v_add_f32_dpp v11, v11, v11 row_ror:4 row_mask:0xf bank_mask:0xf
    v_add_f32_dpp v12, v12, v12 row_ror:4 row_mask:0xf bank_mask:0xf
    v_add_f32_dpp v13, v13, v13 row_ror:4 row_mask:0xf bank_mask:0xf
    v_add_f32_dpp v14, v14, v14 row_ror:4 row_mask:0xf bank_mask:0xf
    v_add_f32_dpp v15, v15, v15 row_ror:4 row_mask:0xf bank_mask:0xf
    v_add_f32_dpp v16, v16, v16 row_ror:4 row_mask:0xf bank_mask:0xf
    v_add_f32_dpp v17, v17, v17 row_ror:4 row_mask:0xf bank_mask:0xf
    v_add_f32_dpp v18, v18, v18 row_ror:4 row_mask:0xf bank_mask:0xf
    v_add_f32_dpp v19, v19, v19 row_ror:4 row_mask:0xf bank_mask:0xf
    v_add_f32_dpp v24, v24, v24 row_ror:4 row_mask:0xf bank_mask:0xf
    v_add_f32_dpp v25, v25, v25 row_ror:4 row_mask:0xf bank_mask:0xf
    v_add_f32_dpp v26, v26, v26 row_ror:4 row_mask:0xf bank_mask:0xf
    v_add_f32_dpp v27, v27, v27 row_ror:4 row_mask:0xf bank_mask:0xf
    v_add_f32_dpp v8, v8, v8 row_ror:2 row_mask:0xf bank_mask:0xf
    v_add_f32_dpp v9, v9, v9 row_ror:2 row_mask:0xf bank_mask:0xf
    v_add_f32_dpp v10, v10, v10 row_ror:2 row_mask:0xf bank_mask:0xf
    v_add_f32_dpp v11, v11, v11 row_ror:2 row_mask:0xf bank_mask:0xf
    v_add_f32_dpp v12, v12, v12 row_ror:2 row_mask:0xf bank_mask:0xf
    v_add_f32_dpp v13, v13, v13 row_ror:2 row_mask:0xf bank_mask:0xf
    v_add_f32_dpp v14, v14, v14 row_ror:2 row_mask:0xf bank_mask:0xf
    v_add_f32_dpp v15, v15, v15 row_ror:2 row_mask:0xf bank_mask:0xf
    v_add_f32_dpp v16, v16, v16 row_ror:2 row_mask:0xf bank_mask:0xf
    v_add_f32_dpp v17, v17, v17 row_ror:2 row_mask:0xf bank_mask:0xf
    v_add_f32_dpp v18, v18, v18 row_ror:2 row_mask:0xf bank_mask:0xf
    v_add_f32_dpp v19, v19, v19 row_ror:2 row_mask:0xf bank_mask:0xf
    v_add_f32_dpp v24, v24, v24 row_ror:2 row_mask:0xf bank_mask:0xf
    v_add_f32_dpp v25, v25, v25 row_ror:2 row_mask:0xf bank_mask:0xf
    v_add_f32_dpp v26, v26, v26 row_ror:2 row_mask:0xf bank_mask:0xf
    v_add_f32_dpp v27, v27, v27 row_ror:2 row_mask:0xf bank_mask:0xf
    v_add_f32_dpp v8, v8, v8 row_ror:1 row_mask:0xf bank_mask:0xf
    v_add_f32_dpp v9, v9, v9 row_ror:1 row_mask:0xf bank_mask:0xf
    v_add_f32_dpp v10, v10, v10 row_ror:1 row_mask:0xf bank_mask:0xf
    v_add_f32_dpp v11, v11, v11 row_ror:1 row_mask:0xf bank_mask:0xf
    v_add_f32_dpp v12, v12, v12 row_ror:1 row_mask:0xf bank_mask:0xf
    v_add_f32_dpp v13, v13, v13 row_ror:1 row_mask:0xf bank_mask:0xf
    v_add_f32_dpp v14, v14, v14 row_ror:1 row_mask:0xf bank_mask:0xf
    v_add_f32_dpp v15, v15, v15 row_ror:1 row_mask:0xf bank_mask:0xf
    v_add_f32_dpp v16, v16, v16 row_ror:1 row_mask:0xf bank_mask:0xf
    v_add_f32_dpp v17, v17, v17 row_ror:1 row_mask:0xf bank_mask:0xf
    v_add_f32_dpp v18, v18, v18 row_ror:1 row_mask:0xf bank_mask:0xf
    v_add_f32_dpp v19, v19, v19 row_ror:1 row_mask:0xf bank_mask:0xf
    v_add_f32_dpp v24, v24, v24 row_ror:1 row_mask:0xf bank_mask:0xf
    v_add_f32_dpp v25, v25, v25 row_ror:1 row_mask:0xf bank_mask:0xf
    v_add_f32_dpp v26, v26, v26 row_ror:1 row_mask:0xf bank_mask:0xf
    v_add_f32_dpp v27, v27, v27 row_ror:1 row_mask:0xf bank_mask:0xf
    v_lshlrev_b32 v3, 5, v4
    s_lshl_b32 s39, s28, 14
    s_lshl_b32 s51, s37, 7
    s_add_u32 s39, s39, s51
    v_cmp_eq_u32 vcc, 0, v6
    s_and_saveexec_b64 s[60:61], vcc
    buffer_store_dwordx4 v[8:11], v3, s[24:27], s39 offen sc0 sc1
    buffer_store_dwordx4 v[12:15], v3, s[24:27], s39 offen offset:16 sc0 sc1
    buffer_store_dwordx4 v[16:19], v3, s[24:27], s39 offen offset:128 sc0 sc1
    buffer_store_dwordx4 v[24:27], v3, s[24:27], s39 offen offset:144 sc0 sc1
    s_or_b64 exec, exec, s[60:61]
    v_lshl_add_u32 v3, v6, 2, s30
    ds_read_b32 v104, v3
    ds_read_b32 v105, v3 offset:64
    ds_read_b32 v106, v3 offset:128
    ds_read_b32 v107, v3 offset:192
    v_lshlrev_b32 v22, 4, v4
    v_add_u32 v22, 102400, v22
    ds_read_b128 a[0:3], v22 offset:0
    ds_read_b128 a[4:7], v22 offset:1024
    ds_read_b128 a[8:11], v22 offset:64
    ds_read_b128 a[12:15], v22 offset:1088
    ds_read_b128 a[16:19], v22 offset:128
    ds_read_b128 a[20:23], v22 offset:1152
    ds_read_b128 a[24:27], v22 offset:192
    ds_read_b128 a[28:31], v22 offset:1216
    s_mul_i32 s49, s37, 73728
    s_lshl_b32 s50, s53, 9
    s_add_u32 s49, s49, s50
    s_waitcnt lgkmcnt(0)
    v_accvgpr_read_b32 v108, a0
    v_accvgpr_read_b32 v109, a1
    v_accvgpr_read_b32 v110, a2
    v_accvgpr_read_b32 v111, a3
    v_accvgpr_read_b32 v112, a4
    v_accvgpr_read_b32 v113, a5
    v_accvgpr_read_b32 v114, a6
    v_accvgpr_read_b32 v115, a7
    v_fma_f32 v116, v106, v108, v112
    v_fma_f32 v117, v106, v109, v113
    v_fma_f32 v118, v106, v110, v114
    v_fma_f32 v119, v106, v111, v115
    v_fma_f32 v72, v104, v72, v116
    v_fma_f32 v73, v104, v73, v117
    v_fma_f32 v74, v104, v74, v118
    v_fma_f32 v75, v104, v75, v119
    v_mul_f32 v28, v72, v72
    v_mul_f32 v29, v73, v73
    v_mul_f32 v30, v74, v74
    v_mul_f32 v31, v75, v75
    v_fma_f32 v28, v28, s48, v20
    v_fma_f32 v29, v29, s48, v20
    v_fma_f32 v30, v30, s48, v20
    v_fma_f32 v31, v31, s48, v20
    v_mul_f32 v28, v28, v72
    v_mul_f32 v29, v29, v73
    v_mul_f32 v30, v30, v74
    v_mul_f32 v31, v31, v75
    v_exp_f32 v28, v28
    v_exp_f32 v29, v29
    v_exp_f32 v30, v30
    v_exp_f32 v31, v31
    v_add_f32 v28, 1.0, v28
    v_add_f32 v29, 1.0, v29
    v_add_f32 v30, 1.0, v30
    v_add_f32 v31, 1.0, v31
    v_rcp_f32 v28, v28
    v_rcp_f32 v29, v29
    v_rcp_f32 v30, v30
    v_rcp_f32 v31, v31
    v_mul_f32 v72, v72, v28
    v_mul_f32 v73, v73, v29
    v_mul_f32 v74, v74, v30
    v_mul_f32 v75, v75, v31
    v_cvt_pk_bf16_f32 v72, v72, v73
    v_cvt_pk_bf16_f32 v73, v74, v75
    s_add_u32 s50, s49, 0
    buffer_store_dwordx2 v[72:73], v21, s[8:11], s50 offen sc0 sc1
    v_fma_f32 v116, v107, v108, v112
    v_fma_f32 v117, v107, v109, v113
    v_fma_f32 v118, v107, v110, v114
    v_fma_f32 v119, v107, v111, v115
    v_fma_f32 v76, v105, v76, v116
    v_fma_f32 v77, v105, v77, v117
    v_fma_f32 v78, v105, v78, v118
    v_fma_f32 v79, v105, v79, v119
    v_mul_f32 v28, v76, v76
    v_mul_f32 v29, v77, v77
    v_mul_f32 v30, v78, v78
    v_mul_f32 v31, v79, v79
    v_fma_f32 v28, v28, s48, v20
    v_fma_f32 v29, v29, s48, v20
    v_fma_f32 v30, v30, s48, v20
    v_fma_f32 v31, v31, s48, v20
    v_mul_f32 v28, v28, v76
    v_mul_f32 v29, v29, v77
    v_mul_f32 v30, v30, v78
    v_mul_f32 v31, v31, v79
    v_exp_f32 v28, v28
    v_exp_f32 v29, v29
    v_exp_f32 v30, v30
    v_exp_f32 v31, v31
    v_add_f32 v28, 1.0, v28
    v_add_f32 v29, 1.0, v29
    v_add_f32 v30, 1.0, v30
    v_add_f32 v31, 1.0, v31
    v_rcp_f32 v28, v28
    v_rcp_f32 v29, v29
    v_rcp_f32 v30, v30
    v_rcp_f32 v31, v31
    v_mul_f32 v76, v76, v28
    v_mul_f32 v77, v77, v29
    v_mul_f32 v78, v78, v30
    v_mul_f32 v79, v79, v31
    v_cvt_pk_bf16_f32 v76, v76, v77
    v_cvt_pk_bf16_f32 v77, v78, v79
    s_add_u32 s50, s49, 73728
    buffer_store_dwordx2 v[76:77], v21, s[8:11], s50 offen sc0 sc1
    v_accvgpr_read_b32 v108, a8
    v_accvgpr_read_b32 v109, a9
    v_accvgpr_read_b32 v110, a10
    v_accvgpr_read_b32 v111, a11
    v_accvgpr_read_b32 v112, a12
    v_accvgpr_read_b32 v113, a13
    v_accvgpr_read_b32 v114, a14
    v_accvgpr_read_b32 v115, a15
    v_fma_f32 v116, v106, v108, v112
    v_fma_f32 v117, v106, v109, v113
    v_fma_f32 v118, v106, v110, v114
    v_fma_f32 v119, v106, v111, v115
    v_fma_f32 v80, v104, v80, v116
    v_fma_f32 v81, v104, v81, v117
    v_fma_f32 v82, v104, v82, v118
    v_fma_f32 v83, v104, v83, v119
    v_mul_f32 v28, v80, v80
    v_mul_f32 v29, v81, v81
    v_mul_f32 v30, v82, v82
    v_mul_f32 v31, v83, v83
    v_fma_f32 v28, v28, s48, v20
    v_fma_f32 v29, v29, s48, v20
    v_fma_f32 v30, v30, s48, v20
    v_fma_f32 v31, v31, s48, v20
    v_mul_f32 v28, v28, v80
    v_mul_f32 v29, v29, v81
    v_mul_f32 v30, v30, v82
    v_mul_f32 v31, v31, v83
    v_exp_f32 v28, v28
    v_exp_f32 v29, v29
    v_exp_f32 v30, v30
    v_exp_f32 v31, v31
    v_add_f32 v28, 1.0, v28
    v_add_f32 v29, 1.0, v29
    v_add_f32 v30, 1.0, v30
    v_add_f32 v31, 1.0, v31
    v_rcp_f32 v28, v28
    v_rcp_f32 v29, v29
    v_rcp_f32 v30, v30
    v_rcp_f32 v31, v31
    v_mul_f32 v80, v80, v28
    v_mul_f32 v81, v81, v29
    v_mul_f32 v82, v82, v30
    v_mul_f32 v83, v83, v31
    v_cvt_pk_bf16_f32 v80, v80, v81
    v_cvt_pk_bf16_f32 v81, v82, v83
    s_add_u32 s50, s49, 512
    buffer_store_dwordx2 v[80:81], v21, s[8:11], s50 offen sc0 sc1
    v_fma_f32 v116, v107, v108, v112
    v_fma_f32 v117, v107, v109, v113
    v_fma_f32 v118, v107, v110, v114
    v_fma_f32 v119, v107, v111, v115
    v_fma_f32 v84, v105, v84, v116
    v_fma_f32 v85, v105, v85, v117
    v_fma_f32 v86, v105, v86, v118
    v_fma_f32 v87, v105, v87, v119
    v_mul_f32 v28, v84, v84
    v_mul_f32 v29, v85, v85
    v_mul_f32 v30, v86, v86
    v_mul_f32 v31, v87, v87
    v_fma_f32 v28, v28, s48, v20
    v_fma_f32 v29, v29, s48, v20
    v_fma_f32 v30, v30, s48, v20
    v_fma_f32 v31, v31, s48, v20
    v_mul_f32 v28, v28, v84
    v_mul_f32 v29, v29, v85
    v_mul_f32 v30, v30, v86
    v_mul_f32 v31, v31, v87
    v_exp_f32 v28, v28
    v_exp_f32 v29, v29
    v_exp_f32 v30, v30
    v_exp_f32 v31, v31
    v_add_f32 v28, 1.0, v28
    v_add_f32 v29, 1.0, v29
    v_add_f32 v30, 1.0, v30
    v_add_f32 v31, 1.0, v31
    v_rcp_f32 v28, v28
    v_rcp_f32 v29, v29
    v_rcp_f32 v30, v30
    v_rcp_f32 v31, v31
    v_mul_f32 v84, v84, v28
    v_mul_f32 v85, v85, v29
    v_mul_f32 v86, v86, v30
    v_mul_f32 v87, v87, v31
    v_cvt_pk_bf16_f32 v84, v84, v85
    v_cvt_pk_bf16_f32 v85, v86, v87
    s_add_u32 s50, s49, 74240
    buffer_store_dwordx2 v[84:85], v21, s[8:11], s50 offen sc0 sc1
    v_accvgpr_read_b32 v108, a16
    v_accvgpr_read_b32 v109, a17
    v_accvgpr_read_b32 v110, a18
    v_accvgpr_read_b32 v111, a19
    v_accvgpr_read_b32 v112, a20
    v_accvgpr_read_b32 v113, a21
    v_accvgpr_read_b32 v114, a22
    v_accvgpr_read_b32 v115, a23
    v_fma_f32 v116, v106, v108, v112
    v_fma_f32 v117, v106, v109, v113
    v_fma_f32 v118, v106, v110, v114
    v_fma_f32 v119, v106, v111, v115
    v_fma_f32 v88, v104, v88, v116
    v_fma_f32 v89, v104, v89, v117
    v_fma_f32 v90, v104, v90, v118
    v_fma_f32 v91, v104, v91, v119
    v_mul_f32 v28, v88, v88
    v_mul_f32 v29, v89, v89
    v_mul_f32 v30, v90, v90
    v_mul_f32 v31, v91, v91
    v_fma_f32 v28, v28, s48, v20
    v_fma_f32 v29, v29, s48, v20
    v_fma_f32 v30, v30, s48, v20
    v_fma_f32 v31, v31, s48, v20
    v_mul_f32 v28, v28, v88
    v_mul_f32 v29, v29, v89
    v_mul_f32 v30, v30, v90
    v_mul_f32 v31, v31, v91
    v_exp_f32 v28, v28
    v_exp_f32 v29, v29
    v_exp_f32 v30, v30
    v_exp_f32 v31, v31
    v_add_f32 v28, 1.0, v28
    v_add_f32 v29, 1.0, v29
    v_add_f32 v30, 1.0, v30
    v_add_f32 v31, 1.0, v31
    v_rcp_f32 v28, v28
    v_rcp_f32 v29, v29
    v_rcp_f32 v30, v30
    v_rcp_f32 v31, v31
    v_mul_f32 v88, v88, v28
    v_mul_f32 v89, v89, v29
    v_mul_f32 v90, v90, v30
    v_mul_f32 v91, v91, v31
    v_cvt_pk_bf16_f32 v88, v88, v89
    v_cvt_pk_bf16_f32 v89, v90, v91
    s_add_u32 s50, s49, 1024
    buffer_store_dwordx2 v[88:89], v21, s[8:11], s50 offen sc0 sc1
    v_fma_f32 v116, v107, v108, v112
    v_fma_f32 v117, v107, v109, v113
    v_fma_f32 v118, v107, v110, v114
    v_fma_f32 v119, v107, v111, v115
    v_fma_f32 v92, v105, v92, v116
    v_fma_f32 v93, v105, v93, v117
    v_fma_f32 v94, v105, v94, v118
    v_fma_f32 v95, v105, v95, v119
    v_mul_f32 v28, v92, v92
    v_mul_f32 v29, v93, v93
    v_mul_f32 v30, v94, v94
    v_mul_f32 v31, v95, v95
    v_fma_f32 v28, v28, s48, v20
    v_fma_f32 v29, v29, s48, v20
    v_fma_f32 v30, v30, s48, v20
    v_fma_f32 v31, v31, s48, v20
    v_mul_f32 v28, v28, v92
    v_mul_f32 v29, v29, v93
    v_mul_f32 v30, v30, v94
    v_mul_f32 v31, v31, v95
    v_exp_f32 v28, v28
    v_exp_f32 v29, v29
    v_exp_f32 v30, v30
    v_exp_f32 v31, v31
    v_add_f32 v28, 1.0, v28
    v_add_f32 v29, 1.0, v29
    v_add_f32 v30, 1.0, v30
    v_add_f32 v31, 1.0, v31
    v_rcp_f32 v28, v28
    v_rcp_f32 v29, v29
    v_rcp_f32 v30, v30
    v_rcp_f32 v31, v31
    v_mul_f32 v92, v92, v28
    v_mul_f32 v93, v93, v29
    v_mul_f32 v94, v94, v30
    v_mul_f32 v95, v95, v31
    v_cvt_pk_bf16_f32 v92, v92, v93
    v_cvt_pk_bf16_f32 v93, v94, v95
    s_add_u32 s50, s49, 74752
    buffer_store_dwordx2 v[92:93], v21, s[8:11], s50 offen sc0 sc1
    v_accvgpr_read_b32 v108, a24
    v_accvgpr_read_b32 v109, a25
    v_accvgpr_read_b32 v110, a26
    v_accvgpr_read_b32 v111, a27
    v_accvgpr_read_b32 v112, a28
    v_accvgpr_read_b32 v113, a29
    v_accvgpr_read_b32 v114, a30
    v_accvgpr_read_b32 v115, a31
    v_fma_f32 v116, v106, v108, v112
    v_fma_f32 v117, v106, v109, v113
    v_fma_f32 v118, v106, v110, v114
    v_fma_f32 v119, v106, v111, v115
    v_fma_f32 v96, v104, v96, v116
    v_fma_f32 v97, v104, v97, v117
    v_fma_f32 v98, v104, v98, v118
    v_fma_f32 v99, v104, v99, v119
    v_mul_f32 v28, v96, v96
    v_mul_f32 v29, v97, v97
    v_mul_f32 v30, v98, v98
    v_mul_f32 v31, v99, v99
    v_fma_f32 v28, v28, s48, v20
    v_fma_f32 v29, v29, s48, v20
    v_fma_f32 v30, v30, s48, v20
    v_fma_f32 v31, v31, s48, v20
    v_mul_f32 v28, v28, v96
    v_mul_f32 v29, v29, v97
    v_mul_f32 v30, v30, v98
    v_mul_f32 v31, v31, v99
    v_exp_f32 v28, v28
    v_exp_f32 v29, v29
    v_exp_f32 v30, v30
    v_exp_f32 v31, v31
    v_add_f32 v28, 1.0, v28
    v_add_f32 v29, 1.0, v29
    v_add_f32 v30, 1.0, v30
    v_add_f32 v31, 1.0, v31
    v_rcp_f32 v28, v28
    v_rcp_f32 v29, v29
    v_rcp_f32 v30, v30
    v_rcp_f32 v31, v31
    v_mul_f32 v96, v96, v28
    v_mul_f32 v97, v97, v29
    v_mul_f32 v98, v98, v30
    v_mul_f32 v99, v99, v31
    v_cvt_pk_bf16_f32 v96, v96, v97
    v_cvt_pk_bf16_f32 v97, v98, v99
    s_add_u32 s50, s49, 1536
    buffer_store_dwordx2 v[96:97], v21, s[8:11], s50 offen sc0 sc1
    v_fma_f32 v116, v107, v108, v112
    v_fma_f32 v117, v107, v109, v113
    v_fma_f32 v118, v107, v110, v114
    v_fma_f32 v119, v107, v111, v115
    v_fma_f32 v100, v105, v100, v116
    v_fma_f32 v101, v105, v101, v117
    v_fma_f32 v102, v105, v102, v118
    v_fma_f32 v103, v105, v103, v119
    v_mul_f32 v28, v100, v100
    v_mul_f32 v29, v101, v101
    v_mul_f32 v30, v102, v102
    v_mul_f32 v31, v103, v103
    v_fma_f32 v28, v28, s48, v20
    v_fma_f32 v29, v29, s48, v20
    v_fma_f32 v30, v30, s48, v20
    v_fma_f32 v31, v31, s48, v20
    v_mul_f32 v28, v28, v100
    v_mul_f32 v29, v29, v101
    v_mul_f32 v30, v30, v102
    v_mul_f32 v31, v31, v103
    v_exp_f32 v28, v28
    v_exp_f32 v29, v29
    v_exp_f32 v30, v30
    v_exp_f32 v31, v31
    v_add_f32 v28, 1.0, v28
    v_add_f32 v29, 1.0, v29
    v_add_f32 v30, 1.0, v30
    v_add_f32 v31, 1.0, v31
    v_rcp_f32 v28, v28
    v_rcp_f32 v29, v29
    v_rcp_f32 v30, v30
    v_rcp_f32 v31, v31
    v_mul_f32 v100, v100, v28
    v_mul_f32 v101, v101, v29
    v_mul_f32 v102, v102, v30
    v_mul_f32 v103, v103, v31
    v_cvt_pk_bf16_f32 v100, v100, v101
    v_cvt_pk_bf16_f32 v101, v102, v103
    s_add_u32 s50, s49, 75264
    buffer_store_dwordx2 v[100:101], v21, s[8:11], s50 offen sc0 sc1
    v_and_b32 v3, 31, v1
    v_lshlrev_b32 v3, 3, v3
    v_lshrrev_b32 v5, 5, v1
    v_lshl_add_u32 v3, v5, 18, v3
    s_mov_b32 s33, 200000
K3_polle:
    s_mov_b32 s39, s51
    buffer_load_dwordx2 v[8:9], v3, s[24:27], s39 offen sc0 sc1
    s_add_u32 s39, s39, 16384
    buffer_load_dwordx2 v[10:11], v3, s[24:27], s39 offen sc0 sc1
    s_add_u32 s39, s39, 16384
    buffer_load_dwordx2 v[12:13], v3, s[24:27], s39 offen sc0 sc1
    s_add_u32 s39, s39, 16384
    buffer_load_dwordx2 v[14:15], v3, s[24:27], s39 offen sc0 sc1
    s_add_u32 s39, s39, 16384
    buffer_load_dwordx2 v[16:17], v3, s[24:27], s39 offen sc0 sc1
    s_add_u32 s39, s39, 16384
    buffer_load_dwordx2 v[18:19], v3, s[24:27], s39 offen sc0 sc1
    s_add_u32 s39, s39, 16384
    buffer_load_dwordx2 v[24:25], v3, s[24:27], s39 offen sc0 sc1
    s_add_u32 s39, s39, 16384
    buffer_load_dwordx2 v[26:27], v3, s[24:27], s39 offen sc0 sc1
    s_add_u32 s39, s39, 16384
    buffer_load_dwordx2 v[104:105], v3, s[24:27], s39 offen sc0 sc1
    s_add_u32 s39, s39, 16384
    buffer_load_dwordx2 v[106:107], v3, s[24:27], s39 offen sc0 sc1
    s_add_u32 s39, s39, 16384
    buffer_load_dwordx2 v[108:109], v3, s[24:27], s39 offen sc0 sc1
    s_add_u32 s39, s39, 16384
    buffer_load_dwordx2 v[110:111], v3, s[24:27], s39 offen sc0 sc1
    s_add_u32 s39, s39, 16384
    buffer_load_dwordx2 v[112:113], v3, s[24:27], s39 offen sc0 sc1
    s_add_u32 s39, s39, 16384
    buffer_load_dwordx2 v[114:115], v3, s[24:27], s39 offen sc0 sc1
    s_add_u32 s39, s39, 16384
    buffer_load_dwordx2 v[116:117], v3, s[24:27], s39 offen sc0 sc1
    s_add_u32 s39, s39, 16384
    buffer_load_dwordx2 v[118:119], v3, s[24:27], s39 offen sc0 sc1
    s_waitcnt vmcnt(0)
    v_cmp_eq_u32 vcc, -1, v9
    v_cmp_eq_u32 s[60:61], -1, v11
    s_or_b64 vcc, vcc, s[60:61]
    v_cmp_eq_u32 s[60:61], -1, v13
    s_or_b64 vcc, vcc, s[60:61]
    v_cmp_eq_u32 s[60:61], -1, v15
    s_or_b64 vcc, vcc, s[60:61]
    v_cmp_eq_u32 s[60:61], -1, v17
    s_or_b64 vcc, vcc, s[60:61]
    v_cmp_eq_u32 s[60:61], -1, v19
    s_or_b64 vcc, vcc, s[60:61]
    v_cmp_eq_u32 s[60:61], -1, v25
    s_or_b64 vcc, vcc, s[60:61]
    v_cmp_eq_u32 s[60:61], -1, v27
    s_or_b64 vcc, vcc, s[60:61]
    v_cmp_eq_u32 s[60:61], -1, v105
    s_or_b64 vcc, vcc, s[60:61]
    v_cmp_eq_u32 s[60:61], -1, v107
    s_or_b64 vcc, vcc, s[60:61]
    v_cmp_eq_u32 s[60:61], -1, v109
    s_or_b64 vcc, vcc, s[60:61]
    v_cmp_eq_u32 s[60:61], -1, v111
    s_or_b64 vcc, vcc, s[60:61]
    v_cmp_eq_u32 s[60:61], -1, v113
    s_or_b64 vcc, vcc, s[60:61]
    v_cmp_eq_u32 s[60:61], -1, v115
    s_or_b64 vcc, vcc, s[60:61]
    v_cmp_eq_u32 s[60:61], -1, v117
    s_or_b64 vcc, vcc, s[60:61]
    v_cmp_eq_u32 s[60:61], -1, v119
    s_or_b64 vcc, vcc, s[60:61]
    s_cbranch_vccz K3_readye
    s_sleep 1
    s_sub_u32 s33, s33, 1
    s_cmp_lg_u32 s33, 0
    s_cbranch_scc1 K3_polle
K3_readye:
    v_add_f32 v8, v8, v10
    v_add_f32 v9, v9, v11
    v_add_f32 v8, v8, v12
    v_add_f32 v9, v9, v13
    v_add_f32 v8, v8, v14
    v_add_f32 v9, v9, v15
    v_add_f32 v8, v8, v16
    v_add_f32 v9, v9, v17
    v_add_f32 v8, v8, v18
    v_add_f32 v9, v9, v19
    v_add_f32 v8, v8, v24
    v_add_f32 v9, v9, v25
    v_add_f32 v8, v8, v26
    v_add_f32 v9, v9, v27
    v_add_f32 v8, v8, v104
    v_add_f32 v9, v9, v105
    v_add_f32 v8, v8, v106
    v_add_f32 v9, v9, v107
    v_add_f32 v8, v8, v108
    v_add_f32 v9, v9, v109
    v_add_f32 v8, v8, v110
    v_add_f32 v9, v9, v111
    v_add_f32 v8, v8, v112
    v_add_f32 v9, v9, v113
    v_add_f32 v8, v8, v114
    v_add_f32 v9, v9, v115
    v_add_f32 v8, v8, v116
    v_add_f32 v9, v9, v117
    v_add_f32 v8, v8, v118
    v_add_f32 v9, v9, v119
    v_mov_b32 v10, v8
    v_mov_b32 v11, v9
    s_nop 1
    v_permlane32_swap_b32 v8, v10
    v_permlane32_swap_b32 v9, v11
    v_add_f32 v8, v8, v10
    v_add_f32 v9, v9, v11
    s_mov_b32 s33, 971214393
    v_mul_f32 v8, s33, v8
    v_mul_f32 v9, s33, v9
    v_fma_f32 v9, -v8, v8, v9
    v_max_f32 v9, 0, v9
    v_add_f32 v9, 925353388, v9
    v_rsq_f32 v9, v9
    v_and_b32 v3, 31, v1
    v_mul_f32 v8, v8, v9
    v_sub_f32 v8, 0, v8
    v_lshl_add_u32 v3, v3, 2, s30
    ds_write_b32 v3, v9
    ds_write_b32 v3, v8 offset:128
    v_lshl_add_u32 v3, v4, 4, s30
    s_waitcnt lgkmcnt(0)
    ds_read_b128 v[104:107], v3
    ds_read_b128 v[108:111], v3 offset:64
    ds_read_b128 v[112:115], v3 offset:128
    ds_read_b128 v[116:119], v3 offset:192
    s_mul_i32 s49, s52, 65536
    s_lshl_b32 s51, s37, 9
    s_add_u32 s49, s49, s51
    s_waitcnt lgkmcnt(0)
    v_fma_f32 v32, v32, v104, v112
    v_fma_f32 v33, v33, v105, v113
    v_fma_f32 v34, v34, v106, v114
    v_fma_f32 v35, v35, v107, v115
    v_cvt_pk_bf16_f32 v32, v32, v33
    v_cvt_pk_bf16_f32 v33, v34, v35
    s_add_u32 s51, s49, 0
    buffer_store_dwordx2 v[32:33], v21, s[20:23], s51 offen sc0 sc1
    v_fma_f32 v36, v36, v108, v116
    v_fma_f32 v37, v37, v109, v117
    v_fma_f32 v38, v38, v110, v118
    v_fma_f32 v39, v39, v111, v119
    v_cvt_pk_bf16_f32 v36, v36, v37
    v_cvt_pk_bf16_f32 v37, v38, v39
    s_add_u32 s51, s49, 512
    buffer_store_dwordx2 v[36:37], v21, s[20:23], s51 offen sc0 sc1
    v_fma_f32 v40, v40, v104, v112
    v_fma_f32 v41, v41, v105, v113
    v_fma_f32 v42, v42, v106, v114
    v_fma_f32 v43, v43, v107, v115
    v_cvt_pk_bf16_f32 v40, v40, v41
    v_cvt_pk_bf16_f32 v41, v42, v43
    s_add_u32 s51, s49, 65536
    buffer_store_dwordx2 v[40:41], v21, s[20:23], s51 offen sc0 sc1
    v_fma_f32 v44, v44, v108, v116
    v_fma_f32 v45, v45, v109, v117
    v_fma_f32 v46, v46, v110, v118
    v_fma_f32 v47, v47, v111, v119
    v_cvt_pk_bf16_f32 v44, v44, v45
    v_cvt_pk_bf16_f32 v45, v46, v47
    s_add_u32 s51, s49, 66048
    buffer_store_dwordx2 v[44:45], v21, s[20:23], s51 offen sc0 sc1
    v_fma_f32 v48, v48, v104, v112
    v_fma_f32 v49, v49, v105, v113
    v_fma_f32 v50, v50, v106, v114
    v_fma_f32 v51, v51, v107, v115
    v_cvt_pk_bf16_f32 v48, v48, v49
    v_cvt_pk_bf16_f32 v49, v50, v51
    s_add_u32 s51, s49, 131072
    buffer_store_dwordx2 v[48:49], v21, s[20:23], s51 offen sc0 sc1
    v_fma_f32 v52, v52, v108, v116
    v_fma_f32 v53, v53, v109, v117
    v_fma_f32 v54, v54, v110, v118
    v_fma_f32 v55, v55, v111, v119
    v_cvt_pk_bf16_f32 v52, v52, v53
    v_cvt_pk_bf16_f32 v53, v54, v55
    s_add_u32 s51, s49, 131584
    buffer_store_dwordx2 v[52:53], v21, s[20:23], s51 offen sc0 sc1
    v_fma_f32 v56, v56, v104, v112
    v_fma_f32 v57, v57, v105, v113
    v_fma_f32 v58, v58, v106, v114
    v_fma_f32 v59, v59, v107, v115
    v_cvt_pk_bf16_f32 v56, v56, v57
    v_cvt_pk_bf16_f32 v57, v58, v59
    s_add_u32 s51, s49, 196608
    buffer_store_dwordx2 v[56:57], v21, s[20:23], s51 offen sc0 sc1
    v_fma_f32 v60, v60, v108, v116
    v_fma_f32 v61, v61, v109, v117
    v_fma_f32 v62, v62, v110, v118
    v_fma_f32 v63, v63, v111, v119
    v_cvt_pk_bf16_f32 v60, v60, v61
    v_cvt_pk_bf16_f32 v61, v62, v63
    s_add_u32 s51, s49, 197120
    buffer_store_dwordx2 v[60:61], v21, s[20:23], s51 offen sc0 sc1
    v_fma_f32 v64, v64, v104, v112
    v_fma_f32 v65, v65, v105, v113
    v_fma_f32 v66, v66, v106, v114
    v_fma_f32 v67, v67, v107, v115
    v_cvt_pk_bf16_f32 v64, v64, v65
    v_cvt_pk_bf16_f32 v65, v66, v67
    s_add_u32 s51, s49, 262144
    buffer_store_dwordx2 v[64:65], v21, s[20:23], s51 offen sc0 sc1
    v_fma_f32 v68, v68, v108, v116
    v_fma_f32 v69, v69, v109, v117
    v_fma_f32 v70, v70, v110, v118
    v_fma_f32 v71, v71, v111, v119
    v_cvt_pk_bf16_f32 v68, v68, v69
    v_cvt_pk_bf16_f32 v69, v70, v71
    s_add_u32 s51, s49, 262656
    buffer_store_dwordx2 v[68:69], v21, s[20:23], s51 offen sc0 sc1
    s_waitcnt vmcnt(0)
    s_endpgm
K3_odd:
    s_waitcnt lgkmcnt(14)
    v_mfma_f32_16x16x32_bf16 v[32:35], a[72:75], a[0:3], v[32:35]
    ds_read_b64_tr_b16 a[36:37], v8 offset:12288
    v_mfma_f32_16x16x32_bf16 v[36:39], a[80:83], a[0:3], v[36:39]
    ds_read_b64_tr_b16 a[38:39], v8 offset:12544
    s_add_u32 m0, s44, 49152
    s_nop 0
    buffer_load_dwordx4 v17, s[16:19], s40 offen lds
    s_add_u32 s40, s40, 589824
    v_mfma_f32_16x16x32_bf16 v[40:43], a[72:75], a[4:7], v[40:43]
    ds_read_b64_tr_b16 a[40:41], v9 offset:12288
    v_mfma_f32_16x16x32_bf16 v[44:47], a[80:83], a[4:7], v[44:47]
    ds_read_b64_tr_b16 a[42:43], v9 offset:12544
    buffer_load_dwordx4 a[104:107], v18, s[12:15], s38 offen offset:0
    s_waitcnt lgkmcnt(14)
    v_mfma_f32_16x16x32_bf16 v[48:51], a[72:75], a[8:11], v[48:51]
    ds_read_b64_tr_b16 a[44:45], v10 offset:12288
    v_mfma_f32_16x16x32_bf16 v[52:55], a[80:83], a[8:11], v[52:55]
    ds_read_b64_tr_b16 a[46:47], v10 offset:12544
    buffer_load_dwordx4 a[108:111], v18, s[12:15], s38 offen offset:1024
    v_mfma_f32_16x16x32_bf16 v[56:59], a[72:75], a[12:15], v[56:59]
    ds_read_b64_tr_b16 a[48:49], v11 offset:12288
    v_mfma_f32_16x16x32_bf16 v[60:63], a[80:83], a[12:15], v[60:63]
    ds_read_b64_tr_b16 a[50:51], v11 offset:12544
    s_add_u32 m0, s45, 49152
    s_nop 0
    buffer_load_dwordx4 v17, s[16:19], s41 offen lds
    s_add_u32 s41, s41, 589824
    s_waitcnt lgkmcnt(14)
    v_mfma_f32_16x16x32_bf16 v[64:67], a[16:19], a[72:75], v[64:67]
    ds_read_b64_tr_b16 a[52:53], v12 offset:12288
    v_mfma_f32_16x16x32_bf16 v[68:71], a[16:19], a[80:83], v[68:71]
    ds_read_b64_tr_b16 a[54:55], v12 offset:12544
    buffer_load_dwordx4 a[112:115], v19, s[12:15], s38 offen offset:0
    v_mfma_f32_16x16x32_bf16 v[72:75], a[20:23], a[72:75], v[72:75]
    ds_read_b64_tr_b16 a[56:57], v13 offset:12288
    v_mfma_f32_16x16x32_bf16 v[76:79], a[20:23], a[80:83], v[76:79]
    ds_read_b64_tr_b16 a[58:59], v13 offset:12544
    buffer_load_dwordx4 a[116:119], v19, s[12:15], s38 offen offset:1024
    s_add_u32 s38, s38, 2048
    s_waitcnt lgkmcnt(14)
    v_mfma_f32_16x16x32_bf16 v[80:83], a[24:27], a[72:75], v[80:83]
    ds_read_b64_tr_b16 a[60:61], v14 offset:12288
    v_mfma_f32_16x16x32_bf16 v[84:87], a[24:27], a[80:83], v[84:87]
    ds_read_b64_tr_b16 a[62:63], v14 offset:12544
    s_add_u32 m0, s46, 49152
    s_nop 0
    buffer_load_dwordx4 v17, s[16:19], s42 offen lds
    s_add_u32 s42, s42, 589824
    v_mfma_f32_16x16x32_bf16 v[88:91], a[28:31], a[72:75], v[88:91]
    ds_read_b64_tr_b16 a[64:65], v15 offset:12288
    v_mfma_f32_16x16x32_bf16 v[92:95], a[28:31], a[80:83], v[92:95]
    ds_read_b64_tr_b16 a[66:67], v15 offset:12544
    s_waitcnt lgkmcnt(15)
    v_mfma_f32_16x16x32_bf16 v[96:99], a[32:35], a[72:75], v[96:99]
    ds_read_b64_tr_b16 a[68:69], v16 offset:12288
    v_mfma_f32_16x16x32_bf16 v[100:103], a[32:35], a[80:83], v[100:103]
    ds_read_b64_tr_b16 a[70:71], v16 offset:12544
    s_waitcnt vmcnt(7)
    s_barrier
    s_waitcnt lgkmcnt(14)
    v_mfma_f32_16x16x32_bf16 v[32:35], a[76:79], a[36:39], v[32:35]
    ds_read_b64_tr_b16 a[0:1], v8 offset:24576
    v_mfma_f32_16x16x32_bf16 v[36:39], a[84:87], a[36:39], v[36:39]
    ds_read_b64_tr_b16 a[2:3], v8 offset:24832
    s_add_u32 m0, s44, 73728
    s_nop 0
    buffer_load_dwordx4 v17, s[16:19], s40 offen lds
    s_add_u32 s40, s40, 589824
    v_mfma_f32_16x16x32_bf16 v[40:43], a[76:79], a[40:43], v[40:43]
    ds_read_b64_tr_b16 a[4:5], v9 offset:24576
    v_mfma_f32_16x16x32_bf16 v[44:47], a[84:87], a[40:43], v[44:47]
    ds_read_b64_tr_b16 a[6:7], v9 offset:24832
    buffer_load_dwordx4 a[120:123], v18, s[12:15], s38 offen offset:0
    s_waitcnt lgkmcnt(14)
    v_mfma_f32_16x16x32_bf16 v[48:51], a[76:79], a[44:47], v[48:51]
    ds_read_b64_tr_b16 a[8:9], v10 offset:24576
    v_mfma_f32_16x16x32_bf16 v[52:55], a[84:87], a[44:47], v[52:55]
    ds_read_b64_tr_b16 a[10:11], v10 offset:24832
    buffer_load_dwordx4 a[124:127], v18, s[12:15], s38 offen offset:1024
    v_mfma_f32_16x16x32_bf16 v[56:59], a[76:79], a[48:51], v[56:59]
    ds_read_b64_tr_b16 a[12:13], v11 offset:24576
    v_mfma_f32_16x16x32_bf16 v[60:63], a[84:87], a[48:51], v[60:63]
    ds_read_b64_tr_b16 a[14:15], v11 offset:24832
    s_add_u32 m0, s45, 73728
    s_nop 0
    buffer_load_dwordx4 v17, s[16:19], s41 offen lds
    s_add_u32 s41, s41, 589824
    s_waitcnt lgkmcnt(14)
    v_mfma_f32_16x16x32_bf16 v[64:67], a[52:55], a[76:79], v[64:67]
    ds_read_b64_tr_b16 a[16:17], v12 offset:24576
    v_mfma_f32_16x16x32_bf16 v[68:71], a[52:55], a[84:87], v[68:71]
    ds_read_b64_tr_b16 a[18:19], v12 offset:24832
    buffer_load_dwordx4 a[128:131], v19, s[12:15], s38 offen offset:0
    v_mfma_f32_16x16x32_bf16 v[72:75], a[56:59], a[76:79], v[72:75]
    ds_read_b64_tr_b16 a[20:21], v13 offset:24576
    v_mfma_f32_16x16x32_bf16 v[76:79], a[56:59], a[84:87], v[76:79]
    ds_read_b64_tr_b16 a[22:23], v13 offset:24832
    buffer_load_dwordx4 a[132:135], v19, s[12:15], s38 offen offset:1024
    s_add_u32 s38, s38, 2048
    s_waitcnt lgkmcnt(14)
    v_mfma_f32_16x16x32_bf16 v[80:83], a[60:63], a[76:79], v[80:83]
    ds_read_b64_tr_b16 a[24:25], v14 offset:24576
    v_mfma_f32_16x16x32_bf16 v[84:87], a[60:63], a[84:87], v[84:87]
    ds_read_b64_tr_b16 a[26:27], v14 offset:24832
    s_add_u32 m0, s46, 73728
    s_nop 0
    buffer_load_dwordx4 v17, s[16:19], s42 offen lds
    s_add_u32 s42, s42, 589824
    v_mfma_f32_16x16x32_bf16 v[88:91], a[64:67], a[76:79], v[88:91]
    ds_read_b64_tr_b16 a[28:29], v15 offset:24576
    v_mfma_f32_16x16x32_bf16 v[92:95], a[64:67], a[84:87], v[92:95]
    ds_read_b64_tr_b16 a[30:31], v15 offset:24832
    s_waitcnt lgkmcnt(15)
    v_mfma_f32_16x16x32_bf16 v[96:99], a[68:71], a[76:79], v[96:99]
    ds_read_b64_tr_b16 a[32:33], v16 offset:24576
    v_mfma_f32_16x16x32_bf16 v[100:103], a[68:71], a[84:87], v[100:103]
    ds_read_b64_tr_b16 a[34:35], v16 offset:24832
    s_waitcnt vmcnt(7)
    s_barrier
    s_waitcnt lgkmcnt(14)
    v_mfma_f32_16x16x32_bf16 v[32:35], a[88:91], a[0:3], v[32:35]
    ds_read_b64_tr_b16 a[36:37], v8 offset:36864
    v_mfma_f32_16x16x32_bf16 v[36:39], a[96:99], a[0:3], v[36:39]
    ds_read_b64_tr_b16 a[38:39], v8 offset:37120
    v_mfma_f32_16x16x32_bf16 v[40:43], a[88:91], a[4:7], v[40:43]
    ds_read_b64_tr_b16 a[40:41], v9 offset:36864
    v_mfma_f32_16x16x32_bf16 v[44:47], a[96:99], a[4:7], v[44:47]
    ds_read_b64_tr_b16 a[42:43], v9 offset:37120
    s_add_u32 m0, s44, 0
    s_nop 0
    buffer_load_dwordx4 v17, s[16:19], s40 offen lds
    s_add_u32 s40, s40, 589824
    s_waitcnt lgkmcnt(14)
    v_mfma_f32_16x16x32_bf16 v[48:51], a[88:91], a[8:11], v[48:51]
    ds_read_b64_tr_b16 a[44:45], v10 offset:36864
    v_mfma_f32_16x16x32_bf16 v[52:55], a[96:99], a[8:11], v[52:55]
    ds_read_b64_tr_b16 a[46:47], v10 offset:37120
    v_mfma_f32_16x16x32_bf16 v[56:59], a[88:91], a[12:15], v[56:59]
    ds_read_b64_tr_b16 a[48:49], v11 offset:36864
    v_mfma_f32_16x16x32_bf16 v[60:63], a[96:99], a[12:15], v[60:63]
    ds_read_b64_tr_b16 a[50:51], v11 offset:37120
    buffer_load_dwordx4 a[72:75], v18, s[12:15], s38 offen offset:0
    s_waitcnt lgkmcnt(14)
    v_mfma_f32_16x16x32_bf16 v[64:67], a[16:19], a[88:91], v[64:67]
    ds_read_b64_tr_b16 a[52:53], v12 offset:36864
    v_mfma_f32_16x16x32_bf16 v[68:71], a[16:19], a[96:99], v[68:71]
    ds_read_b64_tr_b16 a[54:55], v12 offset:37120
    v_mfma_f32_16x16x32_bf16 v[72:75], a[20:23], a[88:91], v[72:75]
    ds_read_b64_tr_b16 a[56:57], v13 offset:36864
    v_mfma_f32_16x16x32_bf16 v[76:79], a[20:23], a[96:99], v[76:79]
    ds_read_b64_tr_b16 a[58:59], v13 offset:37120
    buffer_load_dwordx4 a[76:79], v18, s[12:15], s38 offen offset:1024
    s_waitcnt lgkmcnt(14)
    v_mfma_f32_16x16x32_bf16 v[80:83], a[24:27], a[88:91], v[80:83]
    ds_read_b64_tr_b16 a[60:61], v14 offset:36864
    v_mfma_f32_16x16x32_bf16 v[84:87], a[24:27], a[96:99], v[84:87]
    ds_read_b64_tr_b16 a[62:63], v14 offset:37120
    v_mfma_f32_16x16x32_bf16 v[88:91], a[28:31], a[88:91], v[88:91]
    ds_read_b64_tr_b16 a[64:65], v15 offset:36864
    v_mfma_f32_16x16x32_bf16 v[92:95], a[28:31], a[96:99], v[92:95]
    ds_read_b64_tr_b16 a[66:67], v15 offset:37120
    s_add_u32 m0, s45, 0
    s_nop 0
    buffer_load_dwordx4 v17, s[16:19], s41 offen lds
    s_add_u32 s41, s41, 589824
    s_waitcnt lgkmcnt(15)
    v_mfma_f32_16x16x32_bf16 v[96:99], a[32:35], a[88:91], v[96:99]
    ds_read_b64_tr_b16 a[68:69], v16 offset:36864
    v_mfma_f32_16x16x32_bf16 v[100:103], a[32:35], a[96:99], v[100:103]
    ds_read_b64_tr_b16 a[70:71], v16 offset:37120
    s_waitcnt lgkmcnt(14)
    v_mfma_f32_16x16x32_bf16 v[32:35], a[92:95], a[36:39], v[32:35]
    ds_read_b64_tr_b16 a[0:1], v23 offset:0
    v_mfma_f32_16x16x32_bf16 v[36:39], a[100:103], a[36:39], v[36:39]
    ds_read_b64_tr_b16 a[2:3], v23 offset:256
    v_mfma_f32_16x16x32_bf16 v[40:43], a[92:95], a[40:43], v[40:43]
    ds_read_b64_tr_b16 a[4:5], v24 offset:0
    v_mfma_f32_16x16x32_bf16 v[44:47], a[100:103], a[40:43], v[44:47]
    ds_read_b64_tr_b16 a[6:7], v24 offset:256
    buffer_load_dwordx4 a[80:83], v19, s[12:15], s38 offen offset:0
    s_waitcnt lgkmcnt(14)
    v_mfma_f32_16x16x32_bf16 v[48:51], a[92:95], a[44:47], v[48:51]
    ds_read_b64_tr_b16 a[8:9], v25 offset:0
    v_mfma_f32_16x16x32_bf16 v[52:55], a[100:103], a[44:47], v[52:55]
    ds_read_b64_tr_b16 a[10:11], v25 offset:256
    v_mfma_f32_16x16x32_bf16 v[56:59], a[92:95], a[48:51], v[56:59]
    ds_read_b64_tr_b16 a[12:13], v26 offset:0
    v_mfma_f32_16x16x32_bf16 v[60:63], a[100:103], a[48:51], v[60:63]
    ds_read_b64_tr_b16 a[14:15], v26 offset:256
    buffer_load_dwordx4 a[84:87], v19, s[12:15], s38 offen offset:1024
    s_add_u32 s38, s38, 2048
    s_waitcnt lgkmcnt(14)
    v_mfma_f32_16x16x32_bf16 v[64:67], a[52:55], a[92:95], v[64:67]
    ds_read_b64_tr_b16 a[16:17], v27 offset:0
    v_mfma_f32_16x16x32_bf16 v[68:71], a[52:55], a[100:103], v[68:71]
    ds_read_b64_tr_b16 a[18:19], v27 offset:256
    v_mfma_f32_16x16x32_bf16 v[72:75], a[56:59], a[92:95], v[72:75]
    ds_read_b64_tr_b16 a[20:21], v28 offset:0
    v_mfma_f32_16x16x32_bf16 v[76:79], a[56:59], a[100:103], v[76:79]
    ds_read_b64_tr_b16 a[22:23], v28 offset:256
    s_add_u32 m0, s46, 0
    s_nop 0
    buffer_load_dwordx4 v17, s[16:19], s42 offen lds
    s_add_u32 s42, s42, 589824
    s_waitcnt lgkmcnt(14)
    v_mfma_f32_16x16x32_bf16 v[80:83], a[60:63], a[92:95], v[80:83]
    ds_read_b64_tr_b16 a[24:25], v29 offset:0
    v_mfma_f32_16x16x32_bf16 v[84:87], a[60:63], a[100:103], v[84:87]
    ds_read_b64_tr_b16 a[26:27], v29 offset:256
    v_mfma_f32_16x16x32_bf16 v[88:91], a[64:67], a[92:95], v[88:91]
    ds_read_b64_tr_b16 a[28:29], v30 offset:0
    v_mfma_f32_16x16x32_bf16 v[92:95], a[64:67], a[100:103], v[92:95]
    ds_read_b64_tr_b16 a[30:31], v30 offset:256
    s_waitcnt lgkmcnt(15)
    v_mfma_f32_16x16x32_bf16 v[96:99], a[68:71], a[92:95], v[96:99]
    ds_read_b64_tr_b16 a[32:33], v31 offset:0
    v_mfma_f32_16x16x32_bf16 v[100:103], a[68:71], a[100:103], v[100:103]
    ds_read_b64_tr_b16 a[34:35], v31 offset:256
    s_waitcnt vmcnt(7)
    s_barrier
    s_waitcnt lgkmcnt(14)
    v_mfma_f32_16x16x32_bf16 v[32:35], a[104:107], a[0:3], v[32:35]
    ds_read_b64_tr_b16 a[36:37], v23 offset:12288
    v_mfma_f32_16x16x32_bf16 v[36:39], a[112:115], a[0:3], v[36:39]
    ds_read_b64_tr_b16 a[38:39], v23 offset:12544
    v_mfma_f32_16x16x32_bf16 v[40:43], a[104:107], a[4:7], v[40:43]
    ds_read_b64_tr_b16 a[40:41], v24 offset:12288
    v_mfma_f32_16x16x32_bf16 v[44:47], a[112:115], a[4:7], v[44:47]
    ds_read_b64_tr_b16 a[42:43], v24 offset:12544
    s_add_u32 m0, s44, 24576
    s_nop 0
    buffer_load_dwordx4 v17, s[16:19], s40 offen lds
    s_add_u32 s40, s40, 589824
    s_waitcnt lgkmcnt(14)
    v_mfma_f32_16x16x32_bf16 v[48:51], a[104:107], a[8:11], v[48:51]
    ds_read_b64_tr_b16 a[44:45], v25 offset:12288
    v_mfma_f32_16x16x32_bf16 v[52:55], a[112:115], a[8:11], v[52:55]
    ds_read_b64_tr_b16 a[46:47], v25 offset:12544
    v_mfma_f32_16x16x32_bf16 v[56:59], a[104:107], a[12:15], v[56:59]
    ds_read_b64_tr_b16 a[48:49], v26 offset:12288
    v_mfma_f32_16x16x32_bf16 v[60:63], a[112:115], a[12:15], v[60:63]
    ds_read_b64_tr_b16 a[50:51], v26 offset:12544
    buffer_load_dwordx4 a[88:91], v18, s[12:15], s38 offen offset:0
    s_waitcnt lgkmcnt(14)
    v_mfma_f32_16x16x32_bf16 v[64:67], a[16:19], a[104:107], v[64:67]
    ds_read_b64_tr_b16 a[52:53], v27 offset:12288
    v_mfma_f32_16x16x32_bf16 v[68:71], a[16:19], a[112:115], v[68:71]
    ds_read_b64_tr_b16 a[54:55], v27 offset:12544
    v_mfma_f32_16x16x32_bf16 v[72:75], a[20:23], a[104:107], v[72:75]
    ds_read_b64_tr_b16 a[56:57], v28 offset:12288
    v_mfma_f32_16x16x32_bf16 v[76:79], a[20:23], a[112:115], v[76:79]
    ds_read_b64_tr_b16 a[58:59], v28 offset:12544
    buffer_load_dwordx4 a[92:95], v18, s[12:15], s38 offen offset:1024
    s_waitcnt lgkmcnt(14)
    v_mfma_f32_16x16x32_bf16 v[80:83], a[24:27], a[104:107], v[80:83]
    ds_read_b64_tr_b16 a[60:61], v29 offset:12288
    v_mfma_f32_16x16x32_bf16 v[84:87], a[24:27], a[112:115], v[84:87]
    ds_read_b64_tr_b16 a[62:63], v29 offset:12544
    v_mfma_f32_16x16x32_bf16 v[88:91], a[28:31], a[104:107], v[88:91]
    ds_read_b64_tr_b16 a[64:65], v30 offset:12288
    v_mfma_f32_16x16x32_bf16 v[92:95], a[28:31], a[112:115], v[92:95]
    ds_read_b64_tr_b16 a[66:67], v30 offset:12544
    s_add_u32 m0, s45, 24576
    s_nop 0
    buffer_load_dwordx4 v17, s[16:19], s41 offen lds
    s_add_u32 s41, s41, 589824
    s_waitcnt lgkmcnt(15)
    v_mfma_f32_16x16x32_bf16 v[96:99], a[32:35], a[104:107], v[96:99]
    ds_read_b64_tr_b16 a[68:69], v31 offset:12288
    v_mfma_f32_16x16x32_bf16 v[100:103], a[32:35], a[112:115], v[100:103]
    ds_read_b64_tr_b16 a[70:71], v31 offset:12544
    s_waitcnt lgkmcnt(14)
    v_mfma_f32_16x16x32_bf16 v[32:35], a[108:111], a[36:39], v[32:35]
    ds_read_b64_tr_b16 a[0:1], v23 offset:24576
    v_mfma_f32_16x16x32_bf16 v[36:39], a[116:119], a[36:39], v[36:39]
    ds_read_b64_tr_b16 a[2:3], v23 offset:24832
    v_mfma_f32_16x16x32_bf16 v[40:43], a[108:111], a[40:43], v[40:43]
    ds_read_b64_tr_b16 a[4:5], v24 offset:24576
    v_mfma_f32_16x16x32_bf16 v[44:47], a[116:119], a[40:43], v[44:47]
    ds_read_b64_tr_b16 a[6:7], v24 offset:24832
    buffer_load_dwordx4 a[96:99], v19, s[12:15], s38 offen offset:0
    s_waitcnt lgkmcnt(14)
    v_mfma_f32_16x16x32_bf16 v[48:51], a[108:111], a[44:47], v[48:51]
    ds_read_b64_tr_b16 a[8:9], v25 offset:24576
    v_mfma_f32_16x16x32_bf16 v[52:55], a[116:119], a[44:47], v[52:55]
    ds_read_b64_tr_b16 a[10:11], v25 offset:24832
    v_mfma_f32_16x16x32_bf16 v[56:59], a[108:111], a[48:51], v[56:59]
    ds_read_b64_tr_b16 a[12:13], v26 offset:24576
    v_mfma_f32_16x16x32_bf16 v[60:63], a[116:119], a[48:51], v[60:63]
    ds_read_b64_tr_b16 a[14:15], v26 offset:24832
    buffer_load_dwordx4 a[100:103], v19, s[12:15], s38 offen offset:1024
    s_add_u32 s38, s38, 2048
    s_waitcnt lgkmcnt(14)
    v_mfma_f32_16x16x32_bf16 v[64:67], a[52:55], a[108:111], v[64:67]
    ds_read_b64_tr_b16 a[16:17], v27 offset:24576
    v_mfma_f32_16x16x32_bf16 v[68:71], a[52:55], a[116:119], v[68:71]
    ds_read_b64_tr_b16 a[18:19], v27 offset:24832
    v_mfma_f32_16x16x32_bf16 v[72:75], a[56:59], a[108:111], v[72:75]
    ds_read_b64_tr_b16 a[20:21], v28 offset:24576
    v_mfma_f32_16x16x32_bf16 v[76:79], a[56:59], a[116:119], v[76:79]
    ds_read_b64_tr_b16 a[22:23], v28 offset:24832
    s_add_u32 m0, s46, 24576
    s_nop 0
    buffer_load_dwordx4 v17, s[16:19], s42 offen lds
    s_add_u32 s42, s42, 589824
    s_waitcnt lgkmcnt(14)
    v_mfma_f32_16x16x32_bf16 v[80:83], a[60:63], a[108:111], v[80:83]
    ds_read_b64_tr_b16 a[24:25], v29 offset:24576
    v_mfma_f32_16x16x32_bf16 v[84:87], a[60:63], a[116:119], v[84:87]
    ds_read_b64_tr_b16 a[26:27], v29 offset:24832
    v_mfma_f32_16x16x32_bf16 v[88:91], a[64:67], a[108:111], v[88:91]
    ds_read_b64_tr_b16 a[28:29], v30 offset:24576
    v_mfma_f32_16x16x32_bf16 v[92:95], a[64:67], a[116:119], v[92:95]
    ds_read_b64_tr_b16 a[30:31], v30 offset:24832
    s_waitcnt lgkmcnt(15)
    v_mfma_f32_16x16x32_bf16 v[96:99], a[68:71], a[108:111], v[96:99]
    ds_read_b64_tr_b16 a[32:33], v31 offset:24576
    v_mfma_f32_16x16x32_bf16 v[100:103], a[68:71], a[116:119], v[100:103]
    ds_read_b64_tr_b16 a[34:35], v31 offset:24832
    s_waitcnt vmcnt(7)
    s_barrier
    s_waitcnt lgkmcnt(14)
    v_mfma_f32_16x16x32_bf16 v[32:35], a[120:123], a[0:3], v[32:35]
    ds_read_b64_tr_b16 a[36:37], v23 offset:36864
    v_mfma_f32_16x16x32_bf16 v[36:39], a[128:131], a[0:3], v[36:39]
    ds_read_b64_tr_b16 a[38:39], v23 offset:37120
    v_mfma_f32_16x16x32_bf16 v[40:43], a[120:123], a[4:7], v[40:43]
    ds_read_b64_tr_b16 a[40:41], v24 offset:36864
    v_mfma_f32_16x16x32_bf16 v[44:47], a[128:131], a[4:7], v[44:47]
    ds_read_b64_tr_b16 a[42:43], v24 offset:37120
    s_add_u32 m0, s44, 49152
    s_nop 0
    buffer_load_dwordx4 v17, s[16:19], s40 offen lds
    s_add_u32 s40, s40, 589824
    s_waitcnt lgkmcnt(14)
    v_mfma_f32_16x16x32_bf16 v[48:51], a[120:123], a[8:11], v[48:51]
    ds_read_b64_tr_b16 a[44:45], v25 offset:36864
    v_mfma_f32_16x16x32_bf16 v[52:55], a[128:131], a[8:11], v[52:55]
    ds_read_b64_tr_b16 a[46:47], v25 offset:37120
    v_mfma_f32_16x16x32_bf16 v[56:59], a[120:123], a[12:15], v[56:59]
    ds_read_b64_tr_b16 a[48:49], v26 offset:36864
    v_mfma_f32_16x16x32_bf16 v[60:63], a[128:131], a[12:15], v[60:63]
    ds_read_b64_tr_b16 a[50:51], v26 offset:37120
    buffer_load_dwordx4 a[104:107], v18, s[12:15], s38 offen offset:0
    s_waitcnt lgkmcnt(14)
    v_mfma_f32_16x16x32_bf16 v[64:67], a[16:19], a[120:123], v[64:67]
    ds_read_b64_tr_b16 a[52:53], v27 offset:36864
    v_mfma_f32_16x16x32_bf16 v[68:71], a[16:19], a[128:131], v[68:71]
    ds_read_b64_tr_b16 a[54:55], v27 offset:37120
    v_mfma_f32_16x16x32_bf16 v[72:75], a[20:23], a[120:123], v[72:75]
    ds_read_b64_tr_b16 a[56:57], v28 offset:36864
    v_mfma_f32_16x16x32_bf16 v[76:79], a[20:23], a[128:131], v[76:79]
    ds_read_b64_tr_b16 a[58:59], v28 offset:37120
    buffer_load_dwordx4 a[108:111], v18, s[12:15], s38 offen offset:1024
    s_waitcnt lgkmcnt(14)
    v_mfma_f32_16x16x32_bf16 v[80:83], a[24:27], a[120:123], v[80:83]
    ds_read_b64_tr_b16 a[60:61], v29 offset:36864
    v_mfma_f32_16x16x32_bf16 v[84:87], a[24:27], a[128:131], v[84:87]
    ds_read_b64_tr_b16 a[62:63], v29 offset:37120
    v_mfma_f32_16x16x32_bf16 v[88:91], a[28:31], a[120:123], v[88:91]
    ds_read_b64_tr_b16 a[64:65], v30 offset:36864
    v_mfma_f32_16x16x32_bf16 v[92:95], a[28:31], a[128:131], v[92:95]
    ds_read_b64_tr_b16 a[66:67], v30 offset:37120
    s_add_u32 m0, s45, 49152
    s_nop 0
    buffer_load_dwordx4 v17, s[16:19], s41 offen lds
    s_add_u32 s41, s41, 589824
    s_waitcnt lgkmcnt(15)
    v_mfma_f32_16x16x32_bf16 v[96:99], a[32:35], a[120:123], v[96:99]
    ds_read_b64_tr_b16 a[68:69], v31 offset:36864
    v_mfma_f32_16x16x32_bf16 v[100:103], a[32:35], a[128:131], v[100:103]
    ds_read_b64_tr_b16 a[70:71], v31 offset:37120
    s_waitcnt lgkmcnt(14)
    v_mfma_f32_16x16x32_bf16 v[32:35], a[124:127], a[36:39], v[32:35]
    ds_read_b64_tr_b16 a[0:1], v8 offset:0
    v_mfma_f32_16x16x32_bf16 v[36:39], a[132:135], a[36:39], v[36:39]
    ds_read_b64_tr_b16 a[2:3], v8 offset:256
    v_mfma_f32_16x16x32_bf16 v[40:43], a[124:127], a[40:43], v[40:43]
    ds_read_b64_tr_b16 a[4:5], v9 offset:0
    v_mfma_f32_16x16x32_bf16 v[44:47], a[132:135], a[40:43], v[44:47]
    ds_read_b64_tr_b16 a[6:7], v9 offset:256
    buffer_load_dwordx4 a[112:115], v19, s[12:15], s38 offen offset:0
    s_waitcnt lgkmcnt(14)
    v_mfma_f32_16x16x32_bf16 v[48:51], a[124:127], a[44:47], v[48:51]
    ds_read_b64_tr_b16 a[8:9], v10 offset:0
    v_mfma_f32_16x16x32_bf16 v[52:55], a[132:135], a[44:47], v[52:55]
    ds_read_b64_tr_b16 a[10:11], v10 offset:256
    v_mfma_f32_16x16x32_bf16 v[56:59], a[124:127], a[48:51], v[56:59]
    ds_read_b64_tr_b16 a[12:13], v11 offset:0
    v_mfma_f32_16x16x32_bf16 v[60:63], a[132:135], a[48:51], v[60:63]
    ds_read_b64_tr_b16 a[14:15], v11 offset:256
    buffer_load_dwordx4 a[116:119], v19, s[12:15], s38 offen offset:1024
    s_add_u32 s38, s38, 2048
    s_waitcnt lgkmcnt(14)
    v_mfma_f32_16x16x32_bf16 v[64:67], a[52:55], a[124:127], v[64:67]
    ds_read_b64_tr_b16 a[16:17], v12 offset:0
    v_mfma_f32_16x16x32_bf16 v[68:71], a[52:55], a[132:135], v[68:71]
    ds_read_b64_tr_b16 a[18:19], v12 offset:256
    v_mfma_f32_16x16x32_bf16 v[72:75], a[56:59], a[124:127], v[72:75]
    ds_read_b64_tr_b16 a[20:21], v13 offset:0
    v_mfma_f32_16x16x32_bf16 v[76:79], a[56:59], a[132:135], v[76:79]
    ds_read_b64_tr_b16 a[22:23], v13 offset:256
    s_add_u32 m0, s46, 49152
    s_nop 0
    buffer_load_dwordx4 v17, s[16:19], s42 offen lds
    s_add_u32 s42, s42, 589824
    s_waitcnt lgkmcnt(14)
    v_mfma_f32_16x16x32_bf16 v[80:83], a[60:63], a[124:127], v[80:83]
    ds_read_b64_tr_b16 a[24:25], v14 offset:0
    v_mfma_f32_16x16x32_bf16 v[84:87], a[60:63], a[132:135], v[84:87]
    ds_read_b64_tr_b16 a[26:27], v14 offset:256
    v_mfma_f32_16x16x32_bf16 v[88:91], a[64:67], a[124:127], v[88:91]
    ds_read_b64_tr_b16 a[28:29], v15 offset:0
    v_mfma_f32_16x16x32_bf16 v[92:95], a[64:67], a[132:135], v[92:95]
    ds_read_b64_tr_b16 a[30:31], v15 offset:256
    s_waitcnt lgkmcnt(15)
    v_mfma_f32_16x16x32_bf16 v[96:99], a[68:71], a[124:127], v[96:99]
    ds_read_b64_tr_b16 a[32:33], v16 offset:0
    v_mfma_f32_16x16x32_bf16 v[100:103], a[68:71], a[132:135], v[100:103]
    ds_read_b64_tr_b16 a[34:35], v16 offset:256
    s_waitcnt vmcnt(7)
    s_barrier
    s_waitcnt lgkmcnt(14)
    v_mfma_f32_16x16x32_bf16 v[32:35], a[72:75], a[0:3], v[32:35]
    ds_read_b64_tr_b16 a[36:37], v8 offset:12288
    v_mfma_f32_16x16x32_bf16 v[36:39], a[80:83], a[0:3], v[36:39]
    ds_read_b64_tr_b16 a[38:39], v8 offset:12544
    v_mfma_f32_16x16x32_bf16 v[40:43], a[72:75], a[4:7], v[40:43]
    ds_read_b64_tr_b16 a[40:41], v9 offset:12288
    v_mfma_f32_16x16x32_bf16 v[44:47], a[80:83], a[4:7], v[44:47]
    ds_read_b64_tr_b16 a[42:43], v9 offset:12544
    s_add_u32 m0, s44, 73728
    s_nop 0
    buffer_load_dwordx4 v17, s[16:19], s40 offen lds
    s_add_u32 s40, s40, 589824
    s_waitcnt lgkmcnt(14)
    v_mfma_f32_16x16x32_bf16 v[48:51], a[72:75], a[8:11], v[48:51]
    ds_read_b64_tr_b16 a[44:45], v10 offset:12288
    v_mfma_f32_16x16x32_bf16 v[52:55], a[80:83], a[8:11], v[52:55]
    ds_read_b64_tr_b16 a[46:47], v10 offset:12544
    v_mfma_f32_16x16x32_bf16 v[56:59], a[72:75], a[12:15], v[56:59]
    ds_read_b64_tr_b16 a[48:49], v11 offset:12288
    v_mfma_f32_16x16x32_bf16 v[60:63], a[80:83], a[12:15], v[60:63]
    ds_read_b64_tr_b16 a[50:51], v11 offset:12544
    buffer_load_dwordx4 a[120:123], v18, s[12:15], s38 offen offset:0
    s_waitcnt lgkmcnt(14)
    v_mfma_f32_16x16x32_bf16 v[64:67], a[16:19], a[72:75], v[64:67]
    ds_read_b64_tr_b16 a[52:53], v12 offset:12288
    v_mfma_f32_16x16x32_bf16 v[68:71], a[16:19], a[80:83], v[68:71]
    ds_read_b64_tr_b16 a[54:55], v12 offset:12544
    v_mfma_f32_16x16x32_bf16 v[72:75], a[20:23], a[72:75], v[72:75]
    ds_read_b64_tr_b16 a[56:57], v13 offset:12288
    v_mfma_f32_16x16x32_bf16 v[76:79], a[20:23], a[80:83], v[76:79]
    ds_read_b64_tr_b16 a[58:59], v13 offset:12544
    buffer_load_dwordx4 a[124:127], v18, s[12:15], s38 offen offset:1024
    s_waitcnt lgkmcnt(14)
    v_mfma_f32_16x16x32_bf16 v[80:83], a[24:27], a[72:75], v[80:83]
    ds_read_b64_tr_b16 a[60:61], v14 offset:12288
    v_mfma_f32_16x16x32_bf16 v[84:87], a[24:27], a[80:83], v[84:87]
    ds_read_b64_tr_b16 a[62:63], v14 offset:12544
    v_mfma_f32_16x16x32_bf16 v[88:91], a[28:31], a[72:75], v[88:91]
    ds_read_b64_tr_b16 a[64:65], v15 offset:12288
    v_mfma_f32_16x16x32_bf16 v[92:95], a[28:31], a[80:83], v[92:95]
    ds_read_b64_tr_b16 a[66:67], v15 offset:12544
    s_add_u32 m0, s45, 73728
    s_nop 0
    buffer_load_dwordx4 v17, s[16:19], s41 offen lds
    s_add_u32 s41, s41, 589824
    s_waitcnt lgkmcnt(15)
    v_mfma_f32_16x16x32_bf16 v[96:99], a[32:35], a[72:75], v[96:99]
    ds_read_b64_tr_b16 a[68:69], v16 offset:12288
    v_mfma_f32_16x16x32_bf16 v[100:103], a[32:35], a[80:83], v[100:103]
    ds_read_b64_tr_b16 a[70:71], v16 offset:12544
    s_waitcnt lgkmcnt(14)
    v_mfma_f32_16x16x32_bf16 v[32:35], a[76:79], a[36:39], v[32:35]
    ds_read_b64_tr_b16 a[0:1], v8 offset:24576
    v_mfma_f32_16x16x32_bf16 v[36:39], a[84:87], a[36:39], v[36:39]
    ds_read_b64_tr_b16 a[2:3], v8 offset:24832
    v_mfma_f32_16x16x32_bf16 v[40:43], a[76:79], a[40:43], v[40:43]
    ds_read_b64_tr_b16 a[4:5], v9 offset:24576
    v_mfma_f32_16x16x32_bf16 v[44:47], a[84:87], a[40:43], v[44:47]
    ds_read_b64_tr_b16 a[6:7], v9 offset:24832
    buffer_load_dwordx4 a[128:131], v19, s[12:15], s38 offen offset:0
    s_waitcnt lgkmcnt(14)
    v_mfma_f32_16x16x32_bf16 v[48:51], a[76:79], a[44:47], v[48:51]
    ds_read_b64_tr_b16 a[8:9], v10 offset:24576
    v_mfma_f32_16x16x32_bf16 v[52:55], a[84:87], a[44:47], v[52:55]
    ds_read_b64_tr_b16 a[10:11], v10 offset:24832
    v_mfma_f32_16x16x32_bf16 v[56:59], a[76:79], a[48:51], v[56:59]
    ds_read_b64_tr_b16 a[12:13], v11 offset:24576
    v_mfma_f32_16x16x32_bf16 v[60:63], a[84:87], a[48:51], v[60:63]
    ds_read_b64_tr_b16 a[14:15], v11 offset:24832
    buffer_load_dwordx4 a[132:135], v19, s[12:15], s38 offen offset:1024
    s_add_u32 s38, s38, 2048
    s_waitcnt lgkmcnt(14)
    v_mfma_f32_16x16x32_bf16 v[64:67], a[52:55], a[76:79], v[64:67]
    ds_read_b64_tr_b16 a[16:17], v12 offset:24576
    v_mfma_f32_16x16x32_bf16 v[68:71], a[52:55], a[84:87], v[68:71]
    ds_read_b64_tr_b16 a[18:19], v12 offset:24832
    v_mfma_f32_16x16x32_bf16 v[72:75], a[56:59], a[76:79], v[72:75]
    ds_read_b64_tr_b16 a[20:21], v13 offset:24576
    v_mfma_f32_16x16x32_bf16 v[76:79], a[56:59], a[84:87], v[76:79]
    ds_read_b64_tr_b16 a[22:23], v13 offset:24832
    s_add_u32 m0, s46, 73728
    s_nop 0
    buffer_load_dwordx4 v17, s[16:19], s42 offen lds
    s_add_u32 s42, s42, 589824
    s_waitcnt lgkmcnt(14)
    v_mfma_f32_16x16x32_bf16 v[80:83], a[60:63], a[76:79], v[80:83]
    ds_read_b64_tr_b16 a[24:25], v14 offset:24576
    v_mfma_f32_16x16x32_bf16 v[84:87], a[60:63], a[84:87], v[84:87]
    ds_read_b64_tr_b16 a[26:27], v14 offset:24832
    v_mfma_f32_16x16x32_bf16 v[88:91], a[64:67], a[76:79], v[88:91]
    ds_read_b64_tr_b16 a[28:29], v15 offset:24576
    v_mfma_f32_16x16x32_bf16 v[92:95], a[64:67], a[84:87], v[92:95]
    ds_read_b64_tr_b16 a[30:31], v15 offset:24832
    s_waitcnt lgkmcnt(15)
    v_mfma_f32_16x16x32_bf16 v[96:99], a[68:71], a[76:79], v[96:99]
    ds_read_b64_tr_b16 a[32:33], v16 offset:24576
    v_mfma_f32_16x16x32_bf16 v[100:103], a[68:71], a[84:87], v[100:103]
    ds_read_b64_tr_b16 a[34:35], v16 offset:24832
    s_waitcnt vmcnt(7)
    s_barrier
    s_waitcnt lgkmcnt(14)
    v_mfma_f32_16x16x32_bf16 v[32:35], a[88:91], a[0:3], v[32:35]
    ds_read_b64_tr_b16 a[36:37], v8 offset:36864
    v_mfma_f32_16x16x32_bf16 v[36:39], a[96:99], a[0:3], v[36:39]
    ds_read_b64_tr_b16 a[38:39], v8 offset:37120
    v_mfma_f32_16x16x32_bf16 v[40:43], a[88:91], a[4:7], v[40:43]
    ds_read_b64_tr_b16 a[40:41], v9 offset:36864
    v_mfma_f32_16x16x32_bf16 v[44:47], a[96:99], a[4:7], v[44:47]
    ds_read_b64_tr_b16 a[42:43], v9 offset:37120
    s_add_u32 m0, s44, 0
    s_nop 0
    buffer_load_dwordx4 v17, s[16:19], s40 offen lds
    s_add_u32 s40, s40, 589824
    s_waitcnt lgkmcnt(14)
    v_mfma_f32_16x16x32_bf16 v[48:51], a[88:91], a[8:11], v[48:51]
    ds_read_b64_tr_b16 a[44:45], v10 offset:36864
    v_mfma_f32_16x16x32_bf16 v[52:55], a[96:99], a[8:11], v[52:55]
    ds_read_b64_tr_b16 a[46:47], v10 offset:37120
    v_mfma_f32_16x16x32_bf16 v[56:59], a[88:91], a[12:15], v[56:59]
    ds_read_b64_tr_b16 a[48:49], v11 offset:36864
    v_mfma_f32_16x16x32_bf16 v[60:63], a[96:99], a[12:15], v[60:63]
    ds_read_b64_tr_b16 a[50:51], v11 offset:37120
    buffer_load_dwordx4 a[72:75], v18, s[12:15], s38 offen offset:0
    s_waitcnt lgkmcnt(14)
    v_mfma_f32_16x16x32_bf16 v[64:67], a[16:19], a[88:91], v[64:67]
    ds_read_b64_tr_b16 a[52:53], v12 offset:36864
    v_mfma_f32_16x16x32_bf16 v[68:71], a[16:19], a[96:99], v[68:71]
    ds_read_b64_tr_b16 a[54:55], v12 offset:37120
    v_mfma_f32_16x16x32_bf16 v[72:75], a[20:23], a[88:91], v[72:75]
    ds_read_b64_tr_b16 a[56:57], v13 offset:36864
    v_mfma_f32_16x16x32_bf16 v[76:79], a[20:23], a[96:99], v[76:79]
    ds_read_b64_tr_b16 a[58:59], v13 offset:37120
    buffer_load_dwordx4 a[76:79], v18, s[12:15], s38 offen offset:1024
    s_waitcnt lgkmcnt(14)
    v_mfma_f32_16x16x32_bf16 v[80:83], a[24:27], a[88:91], v[80:83]
    ds_read_b64_tr_b16 a[60:61], v14 offset:36864
    v_mfma_f32_16x16x32_bf16 v[84:87], a[24:27], a[96:99], v[84:87]
    ds_read_b64_tr_b16 a[62:63], v14 offset:37120
    v_mfma_f32_16x16x32_bf16 v[88:91], a[28:31], a[88:91], v[88:91]
    ds_read_b64_tr_b16 a[64:65], v15 offset:36864
    v_mfma_f32_16x16x32_bf16 v[92:95], a[28:31], a[96:99], v[92:95]
    ds_read_b64_tr_b16 a[66:67], v15 offset:37120
    s_add_u32 m0, s45, 0
    s_nop 0
    buffer_load_dwordx4 v17, s[16:19], s41 offen lds
    s_add_u32 s41, s41, 589824
    s_waitcnt lgkmcnt(15)
    v_mfma_f32_16x16x32_bf16 v[96:99], a[32:35], a[88:91], v[96:99]
    ds_read_b64_tr_b16 a[68:69], v16 offset:36864
    v_mfma_f32_16x16x32_bf16 v[100:103], a[32:35], a[96:99], v[100:103]
    ds_read_b64_tr_b16 a[70:71], v16 offset:37120
    s_waitcnt lgkmcnt(14)
    v_mfma_f32_16x16x32_bf16 v[32:35], a[92:95], a[36:39], v[32:35]
    ds_read_b64_tr_b16 a[0:1], v23 offset:0
    v_mfma_f32_16x16x32_bf16 v[36:39], a[100:103], a[36:39], v[36:39]
    ds_read_b64_tr_b16 a[2:3], v23 offset:256
    v_mfma_f32_16x16x32_bf16 v[40:43], a[92:95], a[40:43], v[40:43]
    ds_read_b64_tr_b16 a[4:5], v24 offset:0
    v_mfma_f32_16x16x32_bf16 v[44:47], a[100:103], a[40:43], v[44:47]
    ds_read_b64_tr_b16 a[6:7], v24 offset:256
    buffer_load_dwordx4 a[80:83], v19, s[12:15], s38 offen offset:0
    s_waitcnt lgkmcnt(14)
    v_mfma_f32_16x16x32_bf16 v[48:51], a[92:95], a[44:47], v[48:51]
    ds_read_b64_tr_b16 a[8:9], v25 offset:0
    v_mfma_f32_16x16x32_bf16 v[52:55], a[100:103], a[44:47], v[52:55]
    ds_read_b64_tr_b16 a[10:11], v25 offset:256
    v_mfma_f32_16x16x32_bf16 v[56:59], a[92:95], a[48:51], v[56:59]
    ds_read_b64_tr_b16 a[12:13], v26 offset:0
    v_mfma_f32_16x16x32_bf16 v[60:63], a[100:103], a[48:51], v[60:63]
    ds_read_b64_tr_b16 a[14:15], v26 offset:256
    buffer_load_dwordx4 a[84:87], v19, s[12:15], s38 offen offset:1024
    s_add_u32 s38, s38, 2048
    s_waitcnt lgkmcnt(14)
    v_mfma_f32_16x16x32_bf16 v[64:67], a[52:55], a[92:95], v[64:67]
    ds_read_b64_tr_b16 a[16:17], v27 offset:0
    v_mfma_f32_16x16x32_bf16 v[68:71], a[52:55], a[100:103], v[68:71]
    ds_read_b64_tr_b16 a[18:19], v27 offset:256
    v_mfma_f32_16x16x32_bf16 v[72:75], a[56:59], a[92:95], v[72:75]
    ds_read_b64_tr_b16 a[20:21], v28 offset:0
    v_mfma_f32_16x16x32_bf16 v[76:79], a[56:59], a[100:103], v[76:79]
    ds_read_b64_tr_b16 a[22:23], v28 offset:256
    s_add_u32 m0, s46, 0
    s_nop 0
    buffer_load_dwordx4 v17, s[16:19], s42 offen lds
    s_add_u32 s42, s42, 589824
    s_waitcnt lgkmcnt(14)
    v_mfma_f32_16x16x32_bf16 v[80:83], a[60:63], a[92:95], v[80:83]
    ds_read_b64_tr_b16 a[24:25], v29 offset:0
    v_mfma_f32_16x16x32_bf16 v[84:87], a[60:63], a[100:103], v[84:87]
    ds_read_b64_tr_b16 a[26:27], v29 offset:256
    v_mfma_f32_16x16x32_bf16 v[88:91], a[64:67], a[92:95], v[88:91]
    ds_read_b64_tr_b16 a[28:29], v30 offset:0
    v_mfma_f32_16x16x32_bf16 v[92:95], a[64:67], a[100:103], v[92:95]
    ds_read_b64_tr_b16 a[30:31], v30 offset:256
    s_waitcnt lgkmcnt(15)
    v_mfma_f32_16x16x32_bf16 v[96:99], a[68:71], a[92:95], v[96:99]
    ds_read_b64_tr_b16 a[32:33], v31 offset:0
    v_mfma_f32_16x16x32_bf16 v[100:103], a[68:71], a[100:103], v[100:103]
    ds_read_b64_tr_b16 a[34:35], v31 offset:256
    s_waitcnt vmcnt(7)
    s_barrier
    s_waitcnt lgkmcnt(14)
    v_mfma_f32_16x16x32_bf16 v[32:35], a[104:107], a[0:3], v[32:35]
    ds_read_b64_tr_b16 a[36:37], v23 offset:12288
    v_mfma_f32_16x16x32_bf16 v[36:39], a[112:115], a[0:3], v[36:39]
    ds_read_b64_tr_b16 a[38:39], v23 offset:12544
    v_mfma_f32_16x16x32_bf16 v[40:43], a[104:107], a[4:7], v[40:43]
    ds_read_b64_tr_b16 a[40:41], v24 offset:12288
    v_mfma_f32_16x16x32_bf16 v[44:47], a[112:115], a[4:7], v[44:47]
    ds_read_b64_tr_b16 a[42:43], v24 offset:12544
    s_waitcnt lgkmcnt(14)
    v_mfma_f32_16x16x32_bf16 v[48:51], a[104:107], a[8:11], v[48:51]
    ds_read_b64_tr_b16 a[44:45], v25 offset:12288
    v_mfma_f32_16x16x32_bf16 v[52:55], a[112:115], a[8:11], v[52:55]
    ds_read_b64_tr_b16 a[46:47], v25 offset:12544
    v_mfma_f32_16x16x32_bf16 v[56:59], a[104:107], a[12:15], v[56:59]
    ds_read_b64_tr_b16 a[48:49], v26 offset:12288
    v_mfma_f32_16x16x32_bf16 v[60:63], a[112:115], a[12:15], v[60:63]
    ds_read_b64_tr_b16 a[50:51], v26 offset:12544
    s_waitcnt lgkmcnt(14)
    v_mfma_f32_16x16x32_bf16 v[64:67], a[16:19], a[104:107], v[64:67]
    ds_read_b64_tr_b16 a[52:53], v27 offset:12288
    v_mfma_f32_16x16x32_bf16 v[68:71], a[16:19], a[112:115], v[68:71]
    ds_read_b64_tr_b16 a[54:55], v27 offset:12544
    v_mfma_f32_16x16x32_bf16 v[72:75], a[20:23], a[104:107], v[72:75]
    ds_read_b64_tr_b16 a[56:57], v28 offset:12288
    v_mfma_f32_16x16x32_bf16 v[76:79], a[20:23], a[112:115], v[76:79]
    ds_read_b64_tr_b16 a[58:59], v28 offset:12544
    s_waitcnt lgkmcnt(14)
    v_mfma_f32_16x16x32_bf16 v[80:83], a[24:27], a[104:107], v[80:83]
    ds_read_b64_tr_b16 a[60:61], v29 offset:12288
    v_mfma_f32_16x16x32_bf16 v[84:87], a[24:27], a[112:115], v[84:87]
    ds_read_b64_tr_b16 a[62:63], v29 offset:12544
    v_mfma_f32_16x16x32_bf16 v[88:91], a[28:31], a[104:107], v[88:91]
    ds_read_b64_tr_b16 a[64:65], v30 offset:12288
    v_mfma_f32_16x16x32_bf16 v[92:95], a[28:31], a[112:115], v[92:95]
    ds_read_b64_tr_b16 a[66:67], v30 offset:12544
    s_waitcnt lgkmcnt(15)
    v_mfma_f32_16x16x32_bf16 v[96:99], a[32:35], a[104:107], v[96:99]
    ds_read_b64_tr_b16 a[68:69], v31 offset:12288
    v_mfma_f32_16x16x32_bf16 v[100:103], a[32:35], a[112:115], v[100:103]
    ds_read_b64_tr_b16 a[70:71], v31 offset:12544
    s_waitcnt lgkmcnt(14)
    v_mfma_f32_16x16x32_bf16 v[32:35], a[108:111], a[36:39], v[32:35]
    ds_read_b64_tr_b16 a[0:1], v23 offset:24576
    v_mfma_f32_16x16x32_bf16 v[36:39], a[116:119], a[36:39], v[36:39]
    ds_read_b64_tr_b16 a[2:3], v23 offset:24832
    v_mfma_f32_16x16x32_bf16 v[40:43], a[108:111], a[40:43], v[40:43]
    ds_read_b64_tr_b16 a[4:5], v24 offset:24576
    v_mfma_f32_16x16x32_bf16 v[44:47], a[116:119], a[40:43], v[44:47]
    ds_read_b64_tr_b16 a[6:7], v24 offset:24832
    s_waitcnt lgkmcnt(14)
    v_mfma_f32_16x16x32_bf16 v[48:51], a[108:111], a[44:47], v[48:51]
    ds_read_b64_tr_b16 a[8:9], v25 offset:24576
    v_mfma_f32_16x16x32_bf16 v[52:55], a[116:119], a[44:47], v[52:55]
    ds_read_b64_tr_b16 a[10:11], v25 offset:24832
    v_mfma_f32_16x16x32_bf16 v[56:59], a[108:111], a[48:51], v[56:59]
    ds_read_b64_tr_b16 a[12:13], v26 offset:24576
    v_mfma_f32_16x16x32_bf16 v[60:63], a[116:119], a[48:51], v[60:63]
    ds_read_b64_tr_b16 a[14:15], v26 offset:24832
    s_waitcnt lgkmcnt(14)
    v_mfma_f32_16x16x32_bf16 v[64:67], a[52:55], a[108:111], v[64:67]
    ds_read_b64_tr_b16 a[16:17], v27 offset:24576
    v_mfma_f32_16x16x32_bf16 v[68:71], a[52:55], a[116:119], v[68:71]
    ds_read_b64_tr_b16 a[18:19], v27 offset:24832
    v_mfma_f32_16x16x32_bf16 v[72:75], a[56:59], a[108:111], v[72:75]
    ds_read_b64_tr_b16 a[20:21], v28 offset:24576
    v_mfma_f32_16x16x32_bf16 v[76:79], a[56:59], a[116:119], v[76:79]
    ds_read_b64_tr_b16 a[22:23], v28 offset:24832
    s_waitcnt lgkmcnt(14)
    v_mfma_f32_16x16x32_bf16 v[80:83], a[60:63], a[108:111], v[80:83]
    ds_read_b64_tr_b16 a[24:25], v29 offset:24576
    v_mfma_f32_16x16x32_bf16 v[84:87], a[60:63], a[116:119], v[84:87]
    ds_read_b64_tr_b16 a[26:27], v29 offset:24832
    v_mfma_f32_16x16x32_bf16 v[88:91], a[64:67], a[108:111], v[88:91]
    ds_read_b64_tr_b16 a[28:29], v30 offset:24576
    v_mfma_f32_16x16x32_bf16 v[92:95], a[64:67], a[116:119], v[92:95]
    ds_read_b64_tr_b16 a[30:31], v30 offset:24832
    s_waitcnt lgkmcnt(15)
    v_mfma_f32_16x16x32_bf16 v[96:99], a[68:71], a[108:111], v[96:99]
    ds_read_b64_tr_b16 a[32:33], v31 offset:24576
    v_mfma_f32_16x16x32_bf16 v[100:103], a[68:71], a[116:119], v[100:103]
    ds_read_b64_tr_b16 a[34:35], v31 offset:24832
    s_waitcnt vmcnt(0)
    s_barrier
    s_waitcnt lgkmcnt(14)
    v_mfma_f32_16x16x32_bf16 v[32:35], a[120:123], a[0:3], v[32:35]
    ds_read_b64_tr_b16 a[36:37], v23 offset:36864
    v_mfma_f32_16x16x32_bf16 v[36:39], a[128:131], a[0:3], v[36:39]
    ds_read_b64_tr_b16 a[38:39], v23 offset:37120
    v_mfma_f32_16x16x32_bf16 v[40:43], a[120:123], a[4:7], v[40:43]
    ds_read_b64_tr_b16 a[40:41], v24 offset:36864
    v_mfma_f32_16x16x32_bf16 v[44:47], a[128:131], a[4:7], v[44:47]
    ds_read_b64_tr_b16 a[42:43], v24 offset:37120
    s_waitcnt lgkmcnt(14)
    v_mfma_f32_16x16x32_bf16 v[48:51], a[120:123], a[8:11], v[48:51]
    ds_read_b64_tr_b16 a[44:45], v25 offset:36864
    v_mfma_f32_16x16x32_bf16 v[52:55], a[128:131], a[8:11], v[52:55]
    ds_read_b64_tr_b16 a[46:47], v25 offset:37120
    v_mfma_f32_16x16x32_bf16 v[56:59], a[120:123], a[12:15], v[56:59]
    ds_read_b64_tr_b16 a[48:49], v26 offset:36864
    v_mfma_f32_16x16x32_bf16 v[60:63], a[128:131], a[12:15], v[60:63]
    ds_read_b64_tr_b16 a[50:51], v26 offset:37120
    s_waitcnt lgkmcnt(14)
    v_mfma_f32_16x16x32_bf16 v[64:67], a[16:19], a[120:123], v[64:67]
    ds_read_b64_tr_b16 a[52:53], v27 offset:36864
    v_mfma_f32_16x16x32_bf16 v[68:71], a[16:19], a[128:131], v[68:71]
    ds_read_b64_tr_b16 a[54:55], v27 offset:37120
    v_mfma_f32_16x16x32_bf16 v[72:75], a[20:23], a[120:123], v[72:75]
    ds_read_b64_tr_b16 a[56:57], v28 offset:36864
    v_mfma_f32_16x16x32_bf16 v[76:79], a[20:23], a[128:131], v[76:79]
    ds_read_b64_tr_b16 a[58:59], v28 offset:37120
    s_waitcnt lgkmcnt(14)
    v_mfma_f32_16x16x32_bf16 v[80:83], a[24:27], a[120:123], v[80:83]
    ds_read_b64_tr_b16 a[60:61], v29 offset:36864
    v_mfma_f32_16x16x32_bf16 v[84:87], a[24:27], a[128:131], v[84:87]
    ds_read_b64_tr_b16 a[62:63], v29 offset:37120
    v_mfma_f32_16x16x32_bf16 v[88:91], a[28:31], a[120:123], v[88:91]
    ds_read_b64_tr_b16 a[64:65], v30 offset:36864
    v_mfma_f32_16x16x32_bf16 v[92:95], a[28:31], a[128:131], v[92:95]
    ds_read_b64_tr_b16 a[66:67], v30 offset:37120
    s_waitcnt lgkmcnt(15)
    v_mfma_f32_16x16x32_bf16 v[96:99], a[32:35], a[120:123], v[96:99]
    ds_read_b64_tr_b16 a[68:69], v31 offset:36864
    v_mfma_f32_16x16x32_bf16 v[100:103], a[32:35], a[128:131], v[100:103]
    ds_read_b64_tr_b16 a[70:71], v31 offset:37120
    s_waitcnt lgkmcnt(14)
    v_mfma_f32_16x16x32_bf16 v[32:35], a[124:127], a[36:39], v[32:35]
    ds_read_b64_tr_b16 a[0:1], v8 offset:0
    v_mfma_f32_16x16x32_bf16 v[36:39], a[132:135], a[36:39], v[36:39]
    ds_read_b64_tr_b16 a[2:3], v8 offset:256
    v_mfma_f32_16x16x32_bf16 v[40:43], a[124:127], a[40:43], v[40:43]
    ds_read_b64_tr_b16 a[4:5], v9 offset:0
    v_mfma_f32_16x16x32_bf16 v[44:47], a[132:135], a[40:43], v[44:47]
    ds_read_b64_tr_b16 a[6:7], v9 offset:256
    s_waitcnt lgkmcnt(14)
    v_mfma_f32_16x16x32_bf16 v[48:51], a[124:127], a[44:47], v[48:51]
    ds_read_b64_tr_b16 a[8:9], v10 offset:0
    v_mfma_f32_16x16x32_bf16 v[52:55], a[132:135], a[44:47], v[52:55]
    ds_read_b64_tr_b16 a[10:11], v10 offset:256
    v_mfma_f32_16x16x32_bf16 v[56:59], a[124:127], a[48:51], v[56:59]
    ds_read_b64_tr_b16 a[12:13], v11 offset:0
    v_mfma_f32_16x16x32_bf16 v[60:63], a[132:135], a[48:51], v[60:63]
    ds_read_b64_tr_b16 a[14:15], v11 offset:256
    s_waitcnt lgkmcnt(14)
    v_mfma_f32_16x16x32_bf16 v[64:67], a[52:55], a[124:127], v[64:67]
    ds_read_b64_tr_b16 a[16:17], v12 offset:0
    v_mfma_f32_16x16x32_bf16 v[68:71], a[52:55], a[132:135], v[68:71]
    ds_read_b64_tr_b16 a[18:19], v12 offset:256
    v_mfma_f32_16x16x32_bf16 v[72:75], a[56:59], a[124:127], v[72:75]
    ds_read_b64_tr_b16 a[20:21], v13 offset:0
    v_mfma_f32_16x16x32_bf16 v[76:79], a[56:59], a[132:135], v[76:79]
    ds_read_b64_tr_b16 a[22:23], v13 offset:256
    s_waitcnt lgkmcnt(14)
    v_mfma_f32_16x16x32_bf16 v[80:83], a[60:63], a[124:127], v[80:83]
    ds_read_b64_tr_b16 a[24:25], v14 offset:0
    v_mfma_f32_16x16x32_bf16 v[84:87], a[60:63], a[132:135], v[84:87]
    ds_read_b64_tr_b16 a[26:27], v14 offset:256
    v_mfma_f32_16x16x32_bf16 v[88:91], a[64:67], a[124:127], v[88:91]
    ds_read_b64_tr_b16 a[28:29], v15 offset:0
    v_mfma_f32_16x16x32_bf16 v[92:95], a[64:67], a[132:135], v[92:95]
    ds_read_b64_tr_b16 a[30:31], v15 offset:256
    s_waitcnt lgkmcnt(15)
    v_mfma_f32_16x16x32_bf16 v[96:99], a[68:71], a[124:127], v[96:99]
    ds_read_b64_tr_b16 a[32:33], v16 offset:0
    v_mfma_f32_16x16x32_bf16 v[100:103], a[68:71], a[132:135], v[100:103]
    ds_read_b64_tr_b16 a[34:35], v16 offset:256
    s_waitcnt lgkmcnt(14)
    v_mfma_f32_16x16x32_bf16 v[32:35], a[72:75], a[0:3], v[32:35]
    ds_read_b64_tr_b16 a[36:37], v8 offset:12288
    v_mfma_f32_16x16x32_bf16 v[36:39], a[80:83], a[0:3], v[36:39]
    ds_read_b64_tr_b16 a[38:39], v8 offset:12544
    v_mfma_f32_16x16x32_bf16 v[40:43], a[72:75], a[4:7], v[40:43]
    ds_read_b64_tr_b16 a[40:41], v9 offset:12288
    v_mfma_f32_16x16x32_bf16 v[44:47], a[80:83], a[4:7], v[44:47]
    ds_read_b64_tr_b16 a[42:43], v9 offset:12544
    s_waitcnt lgkmcnt(14)
    v_mfma_f32_16x16x32_bf16 v[48:51], a[72:75], a[8:11], v[48:51]
    ds_read_b64_tr_b16 a[44:45], v10 offset:12288
    v_mfma_f32_16x16x32_bf16 v[52:55], a[80:83], a[8:11], v[52:55]
    ds_read_b64_tr_b16 a[46:47], v10 offset:12544
    v_mfma_f32_16x16x32_bf16 v[56:59], a[72:75], a[12:15], v[56:59]
    ds_read_b64_tr_b16 a[48:49], v11 offset:12288
    v_mfma_f32_16x16x32_bf16 v[60:63], a[80:83], a[12:15], v[60:63]
    ds_read_b64_tr_b16 a[50:51], v11 offset:12544
    s_waitcnt lgkmcnt(14)
    v_mfma_f32_16x16x32_bf16 v[64:67], a[16:19], a[72:75], v[64:67]
    ds_read_b64_tr_b16 a[52:53], v12 offset:12288
    v_mfma_f32_16x16x32_bf16 v[68:71], a[16:19], a[80:83], v[68:71]
    ds_read_b64_tr_b16 a[54:55], v12 offset:12544
    v_mfma_f32_16x16x32_bf16 v[72:75], a[20:23], a[72:75], v[72:75]
    ds_read_b64_tr_b16 a[56:57], v13 offset:12288
    v_mfma_f32_16x16x32_bf16 v[76:79], a[20:23], a[80:83], v[76:79]
    ds_read_b64_tr_b16 a[58:59], v13 offset:12544
    s_waitcnt lgkmcnt(14)
    v_mfma_f32_16x16x32_bf16 v[80:83], a[24:27], a[72:75], v[80:83]
    ds_read_b64_tr_b16 a[60:61], v14 offset:12288
    v_mfma_f32_16x16x32_bf16 v[84:87], a[24:27], a[80:83], v[84:87]
    ds_read_b64_tr_b16 a[62:63], v14 offset:12544
    v_mfma_f32_16x16x32_bf16 v[88:91], a[28:31], a[72:75], v[88:91]
    ds_read_b64_tr_b16 a[64:65], v15 offset:12288
    v_mfma_f32_16x16x32_bf16 v[92:95], a[28:31], a[80:83], v[92:95]
    ds_read_b64_tr_b16 a[66:67], v15 offset:12544
    s_waitcnt lgkmcnt(15)
    v_mfma_f32_16x16x32_bf16 v[96:99], a[32:35], a[72:75], v[96:99]
    ds_read_b64_tr_b16 a[68:69], v16 offset:12288
    v_mfma_f32_16x16x32_bf16 v[100:103], a[32:35], a[80:83], v[100:103]
    ds_read_b64_tr_b16 a[70:71], v16 offset:12544
    s_waitcnt lgkmcnt(14)
    v_mfma_f32_16x16x32_bf16 v[32:35], a[76:79], a[36:39], v[32:35]
    v_mfma_f32_16x16x32_bf16 v[36:39], a[84:87], a[36:39], v[36:39]
    v_mfma_f32_16x16x32_bf16 v[40:43], a[76:79], a[40:43], v[40:43]
    v_mfma_f32_16x16x32_bf16 v[44:47], a[84:87], a[40:43], v[44:47]
    s_waitcnt lgkmcnt(10)
    v_mfma_f32_16x16x32_bf16 v[48:51], a[76:79], a[44:47], v[48:51]
    v_mfma_f32_16x16x32_bf16 v[52:55], a[84:87], a[44:47], v[52:55]
    v_mfma_f32_16x16x32_bf16 v[56:59], a[76:79], a[48:51], v[56:59]
    v_mfma_f32_16x16x32_bf16 v[60:63], a[84:87], a[48:51], v[60:63]
    s_waitcnt lgkmcnt(6)
    v_mfma_f32_16x16x32_bf16 v[64:67], a[52:55], a[76:79], v[64:67]
    v_mfma_f32_16x16x32_bf16 v[68:71], a[52:55], a[84:87], v[68:71]
    v_mfma_f32_16x16x32_bf16 v[72:75], a[56:59], a[76:79], v[72:75]
    v_mfma_f32_16x16x32_bf16 v[76:79], a[56:59], a[84:87], v[76:79]
    s_waitcnt lgkmcnt(2)
    v_mfma_f32_16x16x32_bf16 v[80:83], a[60:63], a[76:79], v[80:83]
    v_mfma_f32_16x16x32_bf16 v[84:87], a[60:63], a[84:87], v[84:87]
    v_mfma_f32_16x16x32_bf16 v[88:91], a[64:67], a[76:79], v[88:91]
    v_mfma_f32_16x16x32_bf16 v[92:95], a[64:67], a[84:87], v[92:95]
    s_waitcnt lgkmcnt(0)
    v_mfma_f32_16x16x32_bf16 v[96:99], a[68:71], a[76:79], v[96:99]
    v_mfma_f32_16x16x32_bf16 v[100:103], a[68:71], a[84:87], v[100:103]
    v_lshl_add_u32 v3, v4, 4, s30
    ds_read_b128 v[104:107], v3
    ds_read_b128 v[108:111], v3 offset:64
    ds_read_b128 v[112:115], v3 offset:128
    ds_read_b128 v[116:119], v3 offset:192
    v_lshlrev_b32 v22, 2, v6
    v_add_u32 v22, 100352, v22
    ds_read_b32 a0, v22 offset:0
    ds_read_b32 a1, v22 offset:1024
    ds_read_b32 a2, v22 offset:64
    ds_read_b32 a3, v22 offset:1088
    ds_read_b32 a4, v22 offset:128
    ds_read_b32 a5, v22 offset:1152
    ds_read_b32 a6, v22 offset:192
    ds_read_b32 a7, v22 offset:1216
    v_mov_b32 v8, 0
    v_mov_b32 v9, 0
    v_mov_b32 v10, 0
    v_mov_b32 v11, 0
    v_mov_b32 v12, 0
    v_mov_b32 v13, 0
    v_mov_b32 v14, 0
    v_mov_b32 v15, 0
    v_mov_b32 v16, 0
    v_mov_b32 v17, 0
    v_mov_b32 v18, 0
    v_mov_b32 v19, 0
    v_mov_b32 v24, 0
    v_mov_b32 v25, 0
    v_mov_b32 v26, 0
    v_mov_b32 v27, 0
    s_waitcnt lgkmcnt(0)
    v_accvgpr_read_b32 v7, a0
    v_accvgpr_read_b32 v0, a1
    v_fma_f32 v28, v112, v7, v0
    v_fma_f32 v29, v113, v7, v0
    v_fma_f32 v30, v114, v7, v0
    v_fma_f32 v31, v115, v7, v0
    v_fma_f32 v32, v104, v32, v28
    v_fma_f32 v33, v105, v33, v29
    v_fma_f32 v34, v106, v34, v30
    v_fma_f32 v35, v107, v35, v31
    v_mul_f32 v22, v32, v32
    v_mul_f32 v23, v33, v33
    v_mul_f32 v2, v34, v34
    v_mul_f32 v5, v35, v35
    v_fma_f32 v22, v22, s48, v20
    v_fma_f32 v23, v23, s48, v20
    v_fma_f32 v2, v2, s48, v20
    v_fma_f32 v5, v5, s48, v20
    v_mul_f32 v22, v22, v32
    v_mul_f32 v23, v23, v33
    v_mul_f32 v2, v2, v34
    v_mul_f32 v5, v5, v35
    v_exp_f32 v22, v22
    v_exp_f32 v23, v23
    v_exp_f32 v2, v2
    v_exp_f32 v5, v5
    v_add_f32 v22, 1.0, v22
    v_add_f32 v23, 1.0, v23
    v_add_f32 v2, 1.0, v2
    v_add_f32 v5, 1.0, v5
    v_rcp_f32 v22, v22
    v_rcp_f32 v23, v23
    v_rcp_f32 v2, v2
    v_rcp_f32 v5, v5
    v_mul_f32 v32, v32, v22
    v_mul_f32 v33, v33, v23
    v_mul_f32 v34, v34, v2
    v_mul_f32 v35, v35, v5
    v_add_f32 v8, v8, v32
    v_fmac_f32 v9, v32, v32
    v_add_f32 v10, v10, v33
    v_fmac_f32 v11, v33, v33
    v_add_f32 v12, v12, v34
    v_fmac_f32 v13, v34, v34
    v_add_f32 v14, v14, v35
    v_fmac_f32 v15, v35, v35
    v_fma_f32 v28, v116, v7, v0
    v_fma_f32 v29, v117, v7, v0
    v_fma_f32 v30, v118, v7, v0
    v_fma_f32 v31, v119, v7, v0
    v_fma_f32 v36, v108, v36, v28
    v_fma_f32 v37, v109, v37, v29
    v_fma_f32 v38, v110, v38, v30
    v_fma_f32 v39, v111, v39, v31
    v_mul_f32 v22, v36, v36
    v_mul_f32 v23, v37, v37
    v_mul_f32 v2, v38, v38
    v_mul_f32 v5, v39, v39
    v_fma_f32 v22, v22, s48, v20
    v_fma_f32 v23, v23, s48, v20
    v_fma_f32 v2, v2, s48, v20
    v_fma_f32 v5, v5, s48, v20
    v_mul_f32 v22, v22, v36
    v_mul_f32 v23, v23, v37
    v_mul_f32 v2, v2, v38
    v_mul_f32 v5, v5, v39
    v_exp_f32 v22, v22
    v_exp_f32 v23, v23
    v_exp_f32 v2, v2
    v_exp_f32 v5, v5
    v_add_f32 v22, 1.0, v22
    v_add_f32 v23, 1.0, v23
    v_add_f32 v2, 1.0, v2
    v_add_f32 v5, 1.0, v5
    v_rcp_f32 v22, v22
    v_rcp_f32 v23, v23
    v_rcp_f32 v2, v2
    v_rcp_f32 v5, v5
    v_mul_f32 v36, v36, v22
    v_mul_f32 v37, v37, v23
    v_mul_f32 v38, v38, v2
    v_mul_f32 v39, v39, v5
    v_add_f32 v16, v16, v36
    v_fmac_f32 v17, v36, v36
    v_add_f32 v18, v18, v37
    v_fmac_f32 v19, v37, v37
    v_add_f32 v24, v24, v38
    v_fmac_f32 v25, v38, v38
    v_add_f32 v26, v26, v39
    v_fmac_f32 v27, v39, v39
    v_accvgpr_read_b32 v7, a2
    v_accvgpr_read_b32 v0, a3
    v_fma_f32 v28, v112, v7, v0
    v_fma_f32 v29, v113, v7, v0
    v_fma_f32 v30, v114, v7, v0
    v_fma_f32 v31, v115, v7, v0
    v_fma_f32 v40, v104, v40, v28
    v_fma_f32 v41, v105, v41, v29
    v_fma_f32 v42, v106, v42, v30
    v_fma_f32 v43, v107, v43, v31
    v_mul_f32 v22, v40, v40
    v_mul_f32 v23, v41, v41
    v_mul_f32 v2, v42, v42
    v_mul_f32 v5, v43, v43
    v_fma_f32 v22, v22, s48, v20
    v_fma_f32 v23, v23, s48, v20
    v_fma_f32 v2, v2, s48, v20
    v_fma_f32 v5, v5, s48, v20
    v_mul_f32 v22, v22, v40
    v_mul_f32 v23, v23, v41
    v_mul_f32 v2, v2, v42
    v_mul_f32 v5, v5, v43
    v_exp_f32 v22, v22
    v_exp_f32 v23, v23
    v_exp_f32 v2, v2
    v_exp_f32 v5, v5
    v_add_f32 v22, 1.0, v22
    v_add_f32 v23, 1.0, v23
    v_add_f32 v2, 1.0, v2
    v_add_f32 v5, 1.0, v5
    v_rcp_f32 v22, v22
    v_rcp_f32 v23, v23
    v_rcp_f32 v2, v2
    v_rcp_f32 v5, v5
    v_mul_f32 v40, v40, v22
    v_mul_f32 v41, v41, v23
    v_mul_f32 v42, v42, v2
    v_mul_f32 v43, v43, v5
    v_add_f32 v8, v8, v40
    v_fmac_f32 v9, v40, v40
    v_add_f32 v10, v10, v41
    v_fmac_f32 v11, v41, v41
    v_add_f32 v12, v12, v42
    v_fmac_f32 v13, v42, v42
    v_add_f32 v14, v14, v43
    v_fmac_f32 v15, v43, v43
    v_fma_f32 v28, v116, v7, v0
    v_fma_f32 v29, v117, v7, v0
    v_fma_f32 v30, v118, v7, v0
    v_fma_f32 v31, v119, v7, v0
    v_fma_f32 v44, v108, v44, v28
    v_fma_f32 v45, v109, v45, v29
    v_fma_f32 v46, v110, v46, v30
    v_fma_f32 v47, v111, v47, v31
    v_mul_f32 v22, v44, v44
    v_mul_f32 v23, v45, v45
    v_mul_f32 v2, v46, v46
    v_mul_f32 v5, v47, v47
    v_fma_f32 v22, v22, s48, v20
    v_fma_f32 v23, v23, s48, v20
    v_fma_f32 v2, v2, s48, v20
    v_fma_f32 v5, v5, s48, v20
    v_mul_f32 v22, v22, v44
    v_mul_f32 v23, v23, v45
    v_mul_f32 v2, v2, v46
    v_mul_f32 v5, v5, v47
    v_exp_f32 v22, v22
    v_exp_f32 v23, v23
    v_exp_f32 v2, v2
    v_exp_f32 v5, v5
    v_add_f32 v22, 1.0, v22
    v_add_f32 v23, 1.0, v23
    v_add_f32 v2, 1.0, v2
    v_add_f32 v5, 1.0, v5
    v_rcp_f32 v22, v22
    v_rcp_f32 v23, v23
    v_rcp_f32 v2, v2
    v_rcp_f32 v5, v5
    v_mul_f32 v44, v44, v22
    v_mul_f32 v45, v45, v23
    v_mul_f32 v46, v46, v2
    v_mul_f32 v47, v47, v5
    v_add_f32 v16, v16, v44
    v_fmac_f32 v17, v44, v44
    v_add_f32 v18, v18, v45
    v_fmac_f32 v19, v45, v45
    v_add_f32 v24, v24, v46
    v_fmac_f32 v25, v46, v46
    v_add_f32 v26, v26, v47
    v_fmac_f32 v27, v47, v47
    v_accvgpr_read_b32 v7, a4
    v_accvgpr_read_b32 v0, a5
    v_fma_f32 v28, v112, v7, v0
    v_fma_f32 v29, v113, v7, v0
    v_fma_f32 v30, v114, v7, v0
    v_fma_f32 v31, v115, v7, v0
    v_fma_f32 v48, v104, v48, v28
    v_fma_f32 v49, v105, v49, v29
    v_fma_f32 v50, v106, v50, v30
    v_fma_f32 v51, v107, v51, v31
    v_mul_f32 v22, v48, v48
    v_mul_f32 v23, v49, v49
    v_mul_f32 v2, v50, v50
    v_mul_f32 v5, v51, v51
    v_fma_f32 v22, v22, s48, v20
    v_fma_f32 v23, v23, s48, v20
    v_fma_f32 v2, v2, s48, v20
    v_fma_f32 v5, v5, s48, v20
    v_mul_f32 v22, v22, v48
    v_mul_f32 v23, v23, v49
    v_mul_f32 v2, v2, v50
    v_mul_f32 v5, v5, v51
    v_exp_f32 v22, v22
    v_exp_f32 v23, v23
    v_exp_f32 v2, v2
    v_exp_f32 v5, v5
    v_add_f32 v22, 1.0, v22
    v_add_f32 v23, 1.0, v23
    v_add_f32 v2, 1.0, v2
    v_add_f32 v5, 1.0, v5
    v_rcp_f32 v22, v22
    v_rcp_f32 v23, v23
    v_rcp_f32 v2, v2
    v_rcp_f32 v5, v5
    v_mul_f32 v48, v48, v22
    v_mul_f32 v49, v49, v23
    v_mul_f32 v50, v50, v2
    v_mul_f32 v51, v51, v5
    v_add_f32 v8, v8, v48
    v_fmac_f32 v9, v48, v48
    v_add_f32 v10, v10, v49
    v_fmac_f32 v11, v49, v49
    v_add_f32 v12, v12, v50
    v_fmac_f32 v13, v50, v50
    v_add_f32 v14, v14, v51
    v_fmac_f32 v15, v51, v51
    v_fma_f32 v28, v116, v7, v0
    v_fma_f32 v29, v117, v7, v0
    v_fma_f32 v30, v118, v7, v0
    v_fma_f32 v31, v119, v7, v0
    v_fma_f32 v52, v108, v52, v28
    v_fma_f32 v53, v109, v53, v29
    v_fma_f32 v54, v110, v54, v30
    v_fma_f32 v55, v111, v55, v31
    v_mul_f32 v22, v52, v52
    v_mul_f32 v23, v53, v53
    v_mul_f32 v2, v54, v54
    v_mul_f32 v5, v55, v55
    v_fma_f32 v22, v22, s48, v20
    v_fma_f32 v23, v23, s48, v20
    v_fma_f32 v2, v2, s48, v20
    v_fma_f32 v5, v5, s48, v20
    v_mul_f32 v22, v22, v52
    v_mul_f32 v23, v23, v53
    v_mul_f32 v2, v2, v54
    v_mul_f32 v5, v5, v55
    v_exp_f32 v22, v22
    v_exp_f32 v23, v23
    v_exp_f32 v2, v2
    v_exp_f32 v5, v5
    v_add_f32 v22, 1.0, v22
    v_add_f32 v23, 1.0, v23
    v_add_f32 v2, 1.0, v2
    v_add_f32 v5, 1.0, v5
    v_rcp_f32 v22, v22
    v_rcp_f32 v23, v23
    v_rcp_f32 v2, v2
    v_rcp_f32 v5, v5
    v_mul_f32 v52, v52, v22
    v_mul_f32 v53, v53, v23
    v_mul_f32 v54, v54, v2
    v_mul_f32 v55, v55, v5
    v_add_f32 v16, v16, v52
    v_fmac_f32 v17, v52, v52
    v_add_f32 v18, v18, v53
    v_fmac_f32 v19, v53, v53
    v_add_f32 v24, v24, v54
    v_fmac_f32 v25, v54, v54
    v_add_f32 v26, v26, v55
    v_fmac_f32 v27, v55, v55
    v_accvgpr_read_b32 v7, a6
    v_accvgpr_read_b32 v0, a7
    v_fma_f32 v28, v112, v7, v0
    v_fma_f32 v29, v113, v7, v0
    v_fma_f32 v30, v114, v7, v0
    v_fma_f32 v31, v115, v7, v0
    v_fma_f32 v56, v104, v56, v28
    v_fma_f32 v57, v105, v57, v29
    v_fma_f32 v58, v106, v58, v30
    v_fma_f32 v59, v107, v59, v31
    v_mul_f32 v22, v56, v56
    v_mul_f32 v23, v57, v57
    v_mul_f32 v2, v58, v58
    v_mul_f32 v5, v59, v59
    v_fma_f32 v22, v22, s48, v20
    v_fma_f32 v23, v23, s48, v20
    v_fma_f32 v2, v2, s48, v20
    v_fma_f32 v5, v5, s48, v20
    v_mul_f32 v22, v22, v56
    v_mul_f32 v23, v23, v57
    v_mul_f32 v2, v2, v58
    v_mul_f32 v5, v5, v59
    v_exp_f32 v22, v22
    v_exp_f32 v23, v23
    v_exp_f32 v2, v2
    v_exp_f32 v5, v5
    v_add_f32 v22, 1.0, v22
    v_add_f32 v23, 1.0, v23
    v_add_f32 v2, 1.0, v2
    v_add_f32 v5, 1.0, v5
    v_rcp_f32 v22, v22
    v_rcp_f32 v23, v23
    v_rcp_f32 v2, v2
    v_rcp_f32 v5, v5
    v_mul_f32 v56, v56, v22
    v_mul_f32 v57, v57, v23
    v_mul_f32 v58, v58, v2
    v_mul_f32 v59, v59, v5
    v_add_f32 v8, v8, v56
    v_fmac_f32 v9, v56, v56
    v_add_f32 v10, v10, v57
    v_fmac_f32 v11, v57, v57
    v_add_f32 v12, v12, v58
    v_fmac_f32 v13, v58, v58
    v_add_f32 v14, v14, v59
    v_fmac_f32 v15, v59, v59
    v_fma_f32 v28, v116, v7, v0
    v_fma_f32 v29, v117, v7, v0
    v_fma_f32 v30, v118, v7, v0
    v_fma_f32 v31, v119, v7, v0
    v_fma_f32 v60, v108, v60, v28
    v_fma_f32 v61, v109, v61, v29
    v_fma_f32 v62, v110, v62, v30
    v_fma_f32 v63, v111, v63, v31
    v_mul_f32 v22, v60, v60
    v_mul_f32 v23, v61, v61
    v_mul_f32 v2, v62, v62
    v_mul_f32 v5, v63, v63
    v_fma_f32 v22, v22, s48, v20
    v_fma_f32 v23, v23, s48, v20
    v_fma_f32 v2, v2, s48, v20
    v_fma_f32 v5, v5, s48, v20
    v_mul_f32 v22, v22, v60
    v_mul_f32 v23, v23, v61
    v_mul_f32 v2, v2, v62
    v_mul_f32 v5, v5, v63
    v_exp_f32 v22, v22
    v_exp_f32 v23, v23
    v_exp_f32 v2, v2
    v_exp_f32 v5, v5
    v_add_f32 v22, 1.0, v22
    v_add_f32 v23, 1.0, v23
    v_add_f32 v2, 1.0, v2
    v_add_f32 v5, 1.0, v5
    v_rcp_f32 v22, v22
    v_rcp_f32 v23, v23
    v_rcp_f32 v2, v2
    v_rcp_f32 v5, v5
    v_mul_f32 v60, v60, v22
    v_mul_f32 v61, v61, v23
    v_mul_f32 v62, v62, v2
    v_mul_f32 v63, v63, v5
    v_add_f32 v16, v16, v60
    v_fmac_f32 v17, v60, v60
    v_add_f32 v18, v18, v61
    v_fmac_f32 v19, v61, v61
    v_add_f32 v24, v24, v62
    v_fmac_f32 v25, v62, v62
    v_add_f32 v26, v26, v63
    v_fmac_f32 v27, v63, v63
    s_nop 1
    v_add_f32_dpp v8, v8, v8 row_ror:8 row_mask:0xf bank_mask:0xf
    v_add_f32_dpp v9, v9, v9 row_ror:8 row_mask:0xf bank_mask:0xf
    v_add_f32_dpp v10, v10, v10 row_ror:8 row_mask:0xf bank_mask:0xf
    v_add_f32_dpp v11, v11, v11 row_ror:8 row_mask:0xf bank_mask:0xf
    v_add_f32_dpp v12, v12, v12 row_ror:8 row_mask:0xf bank_mask:0xf
    v_add_f32_dpp v13, v13, v13 row_ror:8 row_mask:0xf bank_mask:0xf
    v_add_f32_dpp v14, v14, v14 row_ror:8 row_mask:0xf bank_mask:0xf
    v_add_f32_dpp v15, v15, v15 row_ror:8 row_mask:0xf bank_mask:0xf
    v_add_f32_dpp v16, v16, v16 row_ror:8 row_mask:0xf bank_mask:0xf
    v_add_f32_dpp v17, v17, v17 row_ror:8 row_mask:0xf bank_mask:0xf
    v_add_f32_dpp v18, v18, v18 row_ror:8 row_mask:0xf bank_mask:0xf
    v_add_f32_dpp v19, v19, v19 row_ror:8 row_mask:0xf bank_mask:0xf
    v_add_f32_dpp v24, v24, v24 row_ror:8 row_mask:0xf bank_mask:0xf
    v_add_f32_dpp v25, v25, v25 row_ror:8 row_mask:0xf bank_mask:0xf
    v_add_f32_dpp v26, v26, v26 row_ror:8 row_mask:0xf bank_mask:0xf
    v_add_f32_dpp v27, v27, v27 row_ror:8 row_mask:0xf bank_mask:0xf
    v_add_f32_dpp v8, v8, v8 row_ror:4 row_mask:0xf bank_mask:0xf
    v_add_f32_dpp v9, v9, v9 row_ror:4 row_mask:0xf bank_mask:0xf
    v_add_f32_dpp v10, v10, v10 row_ror:4 row_mask:0xf bank_mask:0xf
    v_add_f32_dpp v11, v11, v11 row_ror:4 row_mask:0xf bank_mask:0xf
    v_add_f32_dpp v12, v12, v12 row_ror:4 row_mask:0xf bank_mask:0xf
    v_add_f32_dpp v13, v13, v13 row_ror:4 row_mask:0xf bank_mask:0xf
    v_add_f32_dpp v14, v14, v14 row_ror:4 row_mask:0xf bank_mask:0xf
    v_add_f32_dpp v15, v15, v15 row_ror:4 row_mask:0xf bank_mask:0xf
    v_add_f32_dpp v16, v16, v16 row_ror:4 row_mask:0xf bank_mask:0xf
    v_add_f32_dpp v17, v17, v17 row_ror:4 row_mask:0xf bank_mask:0xf
    v_add_f32_dpp v18, v18, v18 row_ror:4 row_mask:0xf bank_mask:0xf
    v_add_f32_dpp v19, v19, v19 row_ror:4 row_mask:0xf bank_mask:0xf
    v_add_f32_dpp v24, v24, v24 row_ror:4 row_mask:0xf bank_mask:0xf
    v_add_f32_dpp v25, v25, v25 row_ror:4 row_mask:0xf bank_mask:0xf
    v_add_f32_dpp v26, v26, v26 row_ror:4 row_mask:0xf bank_mask:0xf
    v_add_f32_dpp v27, v27, v27 row_ror:4 row_mask:0xf bank_mask:0xf
    v_add_f32_dpp v8, v8, v8 row_ror:2 row_mask:0xf bank_mask:0xf
    v_add_f32_dpp v9, v9, v9 row_ror:2 row_mask:0xf bank_mask:0xf
    v_add_f32_dpp v10, v10, v10 row_ror:2 row_mask:0xf bank_mask:0xf
    v_add_f32_dpp v11, v11, v11 row_ror:2 row_mask:0xf bank_mask:0xf
    v_add_f32_dpp v12, v12, v12 row_ror:2 row_mask:0xf bank_mask:0xf
    v_add_f32_dpp v13, v13, v13 row_ror:2 row_mask:0xf bank_mask:0xf
    v_add_f32_dpp v14, v14, v14 row_ror:2 row_mask:0xf bank_mask:0xf
    v_add_f32_dpp v15, v15, v15 row_ror:2 row_mask:0xf bank_mask:0xf
    v_add_f32_dpp v16, v16, v16 row_ror:2 row_mask:0xf bank_mask:0xf
    v_add_f32_dpp v17, v17, v17 row_ror:2 row_mask:0xf bank_mask:0xf
    v_add_f32_dpp v18, v18, v18 row_ror:2 row_mask:0xf bank_mask:0xf
    v_add_f32_dpp v19, v19, v19 row_ror:2 row_mask:0xf bank_mask:0xf
    v_add_f32_dpp v24, v24, v24 row_ror:2 row_mask:0xf bank_mask:0xf
    v_add_f32_dpp v25, v25, v25 row_ror:2 row_mask:0xf bank_mask:0xf
    v_add_f32_dpp v26, v26, v26 row_ror:2 row_mask:0xf bank_mask:0xf
    v_add_f32_dpp v27, v27, v27 row_ror:2 row_mask:0xf bank_mask:0xf
    v_add_f32_dpp v8, v8, v8 row_ror:1 row_mask:0xf bank_mask:0xf
    v_add_f32_dpp v9, v9, v9 row_ror:1 row_mask:0xf bank_mask:0xf
    v_add_f32_dpp v10, v10, v10 row_ror:1 row_mask:0xf bank_mask:0xf
    v_add_f32_dpp v11, v11, v11 row_ror:1 row_mask:0xf bank_mask:0xf
    v_add_f32_dpp v12, v12, v12 row_ror:1 row_mask:0xf bank_mask:0xf
    v_add_f32_dpp v13, v13, v13 row_ror:1 row_mask:0xf bank_mask:0xf
    v_add_f32_dpp v14, v14, v14 row_ror:1 row_mask:0xf bank_mask:0xf
    v_add_f32_dpp v15, v15, v15 row_ror:1 row_mask:0xf bank_mask:0xf
    v_add_f32_dpp v16, v16, v16 row_ror:1 row_mask:0xf bank_mask:0xf
    v_add_f32_dpp v17, v17, v17 row_ror:1 row_mask:0xf bank_mask:0xf
    v_add_f32_dpp v18, v18, v18 row_ror:1 row_mask:0xf bank_mask:0xf
    v_add_f32_dpp v19, v19, v19 row_ror:1 row_mask:0xf bank_mask:0xf
    v_add_f32_dpp v24, v24, v24 row_ror:1 row_mask:0xf bank_mask:0xf
    v_add_f32_dpp v25, v25, v25 row_ror:1 row_mask:0xf bank_mask:0xf
    v_add_f32_dpp v26, v26, v26 row_ror:1 row_mask:0xf bank_mask:0xf
    v_add_f32_dpp v27, v27, v27 row_ror:1 row_mask:0xf bank_mask:0xf
    v_lshlrev_b32 v3, 5, v4
    s_lshl_b32 s39, s28, 14
    s_lshl_b32 s51, s37, 7
    s_add_u32 s39, s39, s51
    v_cmp_eq_u32 vcc, 0, v6
    s_and_saveexec_b64 s[60:61], vcc
    buffer_store_dwordx4 v[8:11], v3, s[24:27], s39 offen sc0 sc1
    buffer_store_dwordx4 v[12:15], v3, s[24:27], s39 offen offset:16 sc0 sc1
    buffer_store_dwordx4 v[16:19], v3, s[24:27], s39 offen offset:128 sc0 sc1
    buffer_store_dwordx4 v[24:27], v3, s[24:27], s39 offen offset:144 sc0 sc1
    s_or_b64 exec, exec, s[60:61]
    v_lshl_add_u32 v3, v6, 2, s30
    ds_read_b32 v104, v3
    ds_read_b32 v105, v3 offset:64
    ds_read_b32 v106, v3 offset:128
    ds_read_b32 v107, v3 offset:192
    v_lshlrev_b32 v22, 4, v4
    v_add_u32 v22, 102400, v22
    ds_read_b128 a[0:3], v22 offset:0
    ds_read_b128 a[4:7], v22 offset:1024
    ds_read_b128 a[8:11], v22 offset:64
    ds_read_b128 a[12:15], v22 offset:1088
    ds_read_b128 a[16:19], v22 offset:128
    ds_read_b128 a[20:23], v22 offset:1152
    ds_read_b128 a[24:27], v22 offset:192
    ds_read_b128 a[28:31], v22 offset:1216
    ds_read_b128 a[32:35], v22 offset:256
    ds_read_b128 a[36:39], v22 offset:1280
    s_mul_i32 s49, s37, 73728
    s_lshl_b32 s50, s53, 9
    s_add_u32 s49, s49, s50
    s_waitcnt lgkmcnt(0)
    v_accvgpr_read_b32 v108, a0
    v_accvgpr_read_b32 v109, a1
    v_accvgpr_read_b32 v110, a2
    v_accvgpr_read_b32 v111, a3
    v_accvgpr_read_b32 v112, a4
    v_accvgpr_read_b32 v113, a5
    v_accvgpr_read_b32 v114, a6
    v_accvgpr_read_b32 v115, a7
    v_fma_f32 v116, v106, v108, v112
    v_fma_f32 v117, v106, v109, v113
    v_fma_f32 v118, v106, v110, v114
    v_fma_f32 v119, v106, v111, v115
    v_fma_f32 v64, v104, v64, v116
    v_fma_f32 v65, v104, v65, v117
    v_fma_f32 v66, v104, v66, v118
    v_fma_f32 v67, v104, v67, v119
    v_mul_f32 v28, v64, v64
    v_mul_f32 v29, v65, v65
    v_mul_f32 v30, v66, v66
    v_mul_f32 v31, v67, v67
    v_fma_f32 v28, v28, s48, v20
    v_fma_f32 v29, v29, s48, v20
    v_fma_f32 v30, v30, s48, v20
    v_fma_f32 v31, v31, s48, v20
    v_mul_f32 v28, v28, v64
    v_mul_f32 v29, v29, v65
    v_mul_f32 v30, v30, v66
    v_mul_f32 v31, v31, v67
    v_exp_f32 v28, v28
    v_exp_f32 v29, v29
    v_exp_f32 v30, v30
    v_exp_f32 v31, v31
    v_add_f32 v28, 1.0, v28
    v_add_f32 v29, 1.0, v29
    v_add_f32 v30, 1.0, v30
    v_add_f32 v31, 1.0, v31
    v_rcp_f32 v28, v28
    v_rcp_f32 v29, v29
    v_rcp_f32 v30, v30
    v_rcp_f32 v31, v31
    v_mul_f32 v64, v64, v28
    v_mul_f32 v65, v65, v29
    v_mul_f32 v66, v66, v30
    v_mul_f32 v67, v67, v31
    v_cvt_pk_bf16_f32 v64, v64, v65
    v_cvt_pk_bf16_f32 v65, v66, v67
    s_add_u32 s50, s49, 0
    buffer_store_dwordx2 v[64:65], v21, s[8:11], s50 offen sc0 sc1
    v_fma_f32 v116, v107, v108, v112
    v_fma_f32 v117, v107, v109, v113
    v_fma_f32 v118, v107, v110, v114
    v_fma_f32 v119, v107, v111, v115
    v_fma_f32 v68, v105, v68, v116
    v_fma_f32 v69, v105, v69, v117
    v_fma_f32 v70, v105, v70, v118
    v_fma_f32 v71, v105, v71, v119
    v_mul_f32 v28, v68, v68
    v_mul_f32 v29, v69, v69
    v_mul_f32 v30, v70, v70
    v_mul_f32 v31, v71, v71
    v_fma_f32 v28, v28, s48, v20
    v_fma_f32 v29, v29, s48, v20
    v_fma_f32 v30, v30, s48, v20
    v_fma_f32 v31, v31, s48, v20
    v_mul_f32 v28, v28, v68
    v_mul_f32 v29, v29, v69
    v_mul_f32 v30, v30, v70
    v_mul_f32 v31, v31, v71
    v_exp_f32 v28, v28
    v_exp_f32 v29, v29
    v_exp_f32 v30, v30
    v_exp_f32 v31, v31
    v_add_f32 v28, 1.0, v28
    v_add_f32 v29, 1.0, v29
    v_add_f32 v30, 1.0, v30
    v_add_f32 v31, 1.0, v31
    v_rcp_f32 v28, v28
    v_rcp_f32 v29, v29
    v_rcp_f32 v30, v30
    v_rcp_f32 v31, v31
    v_mul_f32 v68, v68, v28
    v_mul_f32 v69, v69, v29
    v_mul_f32 v70, v70, v30
    v_mul_f32 v71, v71, v31
    v_cvt_pk_bf16_f32 v68, v68, v69
    v_cvt_pk_bf16_f32 v69, v70, v71
    s_add_u32 s50, s49, 73728
    buffer_store_dwordx2 v[68:69], v21, s[8:11], s50 offen sc0 sc1
    v_accvgpr_read_b32 v108, a8
    v_accvgpr_read_b32 v109, a9
    v_accvgpr_read_b32 v110, a10
    v_accvgpr_read_b32 v111, a11
    v_accvgpr_read_b32 v112, a12
    v_accvgpr_read_b32 v113, a13
    v_accvgpr_read_b32 v114, a14
    v_accvgpr_read_b32 v115, a15
    v_fma_f32 v116, v106, v108, v112
    v_fma_f32 v117, v106, v109, v113
    v_fma_f32 v118, v106, v110, v114
    v_fma_f32 v119, v106, v111, v115
    v_fma_f32 v72, v104, v72, v116
    v_fma_f32 v73, v104, v73, v117
    v_fma_f32 v74, v104, v74, v118
    v_fma_f32 v75, v104, v75, v119
    v_mul_f32 v28, v72, v72
    v_mul_f32 v29, v73, v73
    v_mul_f32 v30, v74, v74
    v_mul_f32 v31, v75, v75
    v_fma_f32 v28, v28, s48, v20
    v_fma_f32 v29, v29, s48, v20
    v_fma_f32 v30, v30, s48, v20
    v_fma_f32 v31, v31, s48, v20
    v_mul_f32 v28, v28, v72
    v_mul_f32 v29, v29, v73
    v_mul_f32 v30, v30, v74
    v_mul_f32 v31, v31, v75
    v_exp_f32 v28, v28
    v_exp_f32 v29, v29
    v_exp_f32 v30, v30
    v_exp_f32 v31, v31
    v_add_f32 v28, 1.0, v28
    v_add_f32 v29, 1.0, v29
    v_add_f32 v30, 1.0, v30
    v_add_f32 v31, 1.0, v31
    v_rcp_f32 v28, v28
    v_rcp_f32 v29, v29
    v_rcp_f32 v30, v30
    v_rcp_f32 v31, v31
    v_mul_f32 v72, v72, v28
    v_mul_f32 v73, v73, v29
    v_mul_f32 v74, v74, v30
    v_mul_f32 v75, v75, v31
    v_cvt_pk_bf16_f32 v72, v72, v73
    v_cvt_pk_bf16_f32 v73, v74, v75
    s_add_u32 s50, s49, 512
    buffer_store_dwordx2 v[72:73], v21, s[8:11], s50 offen sc0 sc1
    v_fma_f32 v116, v107, v108, v112
    v_fma_f32 v117, v107, v109, v113
    v_fma_f32 v118, v107, v110, v114
    v_fma_f32 v119, v107, v111, v115
    v_fma_f32 v76, v105, v76, v116
    v_fma_f32 v77, v105, v77, v117
    v_fma_f32 v78, v105, v78, v118
    v_fma_f32 v79, v105, v79, v119
    v_mul_f32 v28, v76, v76
    v_mul_f32 v29, v77, v77
    v_mul_f32 v30, v78, v78
    v_mul_f32 v31, v79, v79
    v_fma_f32 v28, v28, s48, v20
    v_fma_f32 v29, v29, s48, v20
    v_fma_f32 v30, v30, s48, v20
    v_fma_f32 v31, v31, s48, v20
    v_mul_f32 v28, v28, v76
    v_mul_f32 v29, v29, v77
    v_mul_f32 v30, v30, v78
    v_mul_f32 v31, v31, v79
    v_exp_f32 v28, v28
    v_exp_f32 v29, v29
    v_exp_f32 v30, v30
    v_exp_f32 v31, v31
    v_add_f32 v28, 1.0, v28
    v_add_f32 v29, 1.0, v29
    v_add_f32 v30, 1.0, v30
    v_add_f32 v31, 1.0, v31
    v_rcp_f32 v28, v28
    v_rcp_f32 v29, v29
    v_rcp_f32 v30, v30
    v_rcp_f32 v31, v31
    v_mul_f32 v76, v76, v28
    v_mul_f32 v77, v77, v29
    v_mul_f32 v78, v78, v30
    v_mul_f32 v79, v79, v31
    v_cvt_pk_bf16_f32 v76, v76, v77
    v_cvt_pk_bf16_f32 v77, v78, v79
    s_add_u32 s50, s49, 74240
    buffer_store_dwordx2 v[76:77], v21, s[8:11], s50 offen sc0 sc1
    v_accvgpr_read_b32 v108, a16
    v_accvgpr_read_b32 v109, a17
    v_accvgpr_read_b32 v110, a18
    v_accvgpr_read_b32 v111, a19
    v_accvgpr_read_b32 v112, a20
    v_accvgpr_read_b32 v113, a21
    v_accvgpr_read_b32 v114, a22
    v_accvgpr_read_b32 v115, a23
    v_fma_f32 v116, v106, v108, v112
    v_fma_f32 v117, v106, v109, v113
    v_fma_f32 v118, v106, v110, v114
    v_fma_f32 v119, v106, v111, v115
    v_fma_f32 v80, v104, v80, v116
    v_fma_f32 v81, v104, v81, v117
    v_fma_f32 v82, v104, v82, v118
    v_fma_f32 v83, v104, v83, v119
    v_mul_f32 v28, v80, v80
    v_mul_f32 v29, v81, v81
    v_mul_f32 v30, v82, v82
    v_mul_f32 v31, v83, v83
    v_fma_f32 v28, v28, s48, v20
    v_fma_f32 v29, v29, s48, v20
    v_fma_f32 v30, v30, s48, v20
    v_fma_f32 v31, v31, s48, v20
    v_mul_f32 v28, v28, v80
    v_mul_f32 v29, v29, v81
    v_mul_f32 v30, v30, v82
    v_mul_f32 v31, v31, v83
    v_exp_f32 v28, v28
    v_exp_f32 v29, v29
    v_exp_f32 v30, v30
    v_exp_f32 v31, v31
    v_add_f32 v28, 1.0, v28
    v_add_f32 v29, 1.0, v29
    v_add_f32 v30, 1.0, v30
    v_add_f32 v31, 1.0, v31
    v_rcp_f32 v28, v28
    v_rcp_f32 v29, v29
    v_rcp_f32 v30, v30
    v_rcp_f32 v31, v31
    v_mul_f32 v80, v80, v28
    v_mul_f32 v81, v81, v29
    v_mul_f32 v82, v82, v30
    v_mul_f32 v83, v83, v31
    v_cvt_pk_bf16_f32 v80, v80, v81
    v_cvt_pk_bf16_f32 v81, v82, v83
    s_add_u32 s50, s49, 1024
    buffer_store_dwordx2 v[80:81], v21, s[8:11], s50 offen sc0 sc1
    v_fma_f32 v116, v107, v108, v112
    v_fma_f32 v117, v107, v109, v113
    v_fma_f32 v118, v107, v110, v114
    v_fma_f32 v119, v107, v111, v115
    v_fma_f32 v84, v105, v84, v116
    v_fma_f32 v85, v105, v85, v117
    v_fma_f32 v86, v105, v86, v118
    v_fma_f32 v87, v105, v87, v119
    v_mul_f32 v28, v84, v84
    v_mul_f32 v29, v85, v85
    v_mul_f32 v30, v86, v86
    v_mul_f32 v31, v87, v87
    v_fma_f32 v28, v28, s48, v20
    v_fma_f32 v29, v29, s48, v20
    v_fma_f32 v30, v30, s48, v20
    v_fma_f32 v31, v31, s48, v20
    v_mul_f32 v28, v28, v84
    v_mul_f32 v29, v29, v85
    v_mul_f32 v30, v30, v86
    v_mul_f32 v31, v31, v87
    v_exp_f32 v28, v28
    v_exp_f32 v29, v29
    v_exp_f32 v30, v30
    v_exp_f32 v31, v31
    v_add_f32 v28, 1.0, v28
    v_add_f32 v29, 1.0, v29
    v_add_f32 v30, 1.0, v30
    v_add_f32 v31, 1.0, v31
    v_rcp_f32 v28, v28
    v_rcp_f32 v29, v29
    v_rcp_f32 v30, v30
    v_rcp_f32 v31, v31
    v_mul_f32 v84, v84, v28
    v_mul_f32 v85, v85, v29
    v_mul_f32 v86, v86, v30
    v_mul_f32 v87, v87, v31
    v_cvt_pk_bf16_f32 v84, v84, v85
    v_cvt_pk_bf16_f32 v85, v86, v87
    s_add_u32 s50, s49, 74752
    buffer_store_dwordx2 v[84:85], v21, s[8:11], s50 offen sc0 sc1
    v_accvgpr_read_b32 v108, a24
    v_accvgpr_read_b32 v109, a25
    v_accvgpr_read_b32 v110, a26
    v_accvgpr_read_b32 v111, a27
    v_accvgpr_read_b32 v112, a28
    v_accvgpr_read_b32 v113, a29
    v_accvgpr_read_b32 v114, a30
    v_accvgpr_read_b32 v115, a31
    v_fma_f32 v116, v106, v108, v112
    v_fma_f32 v117, v106, v109, v113
    v_fma_f32 v118, v106, v110, v114
    v_fma_f32 v119, v106, v111, v115
    v_fma_f32 v88, v104, v88, v116
    v_fma_f32 v89, v104, v89, v117
    v_fma_f32 v90, v104, v90, v118
    v_fma_f32 v91, v104, v91, v119
    v_mul_f32 v28, v88, v88
    v_mul_f32 v29, v89, v89
    v_mul_f32 v30, v90, v90
    v_mul_f32 v31, v91, v91
    v_fma_f32 v28, v28, s48, v20
    v_fma_f32 v29, v29, s48, v20
    v_fma_f32 v30, v30, s48, v20
    v_fma_f32 v31, v31, s48, v20
    v_mul_f32 v28, v28, v88
    v_mul_f32 v29, v29, v89
    v_mul_f32 v30, v30, v90
    v_mul_f32 v31, v31, v91
    v_exp_f32 v28, v28
    v_exp_f32 v29, v29
    v_exp_f32 v30, v30
    v_exp_f32 v31, v31
    v_add_f32 v28, 1.0, v28
    v_add_f32 v29, 1.0, v29
    v_add_f32 v30, 1.0, v30
    v_add_f32 v31, 1.0, v31
    v_rcp_f32 v28, v28
    v_rcp_f32 v29, v29
    v_rcp_f32 v30, v30
    v_rcp_f32 v31, v31
    v_mul_f32 v88, v88, v28
    v_mul_f32 v89, v89, v29
    v_mul_f32 v90, v90, v30
    v_mul_f32 v91, v91, v31
    v_cvt_pk_bf16_f32 v88, v88, v89
    v_cvt_pk_bf16_f32 v89, v90, v91
    s_add_u32 s50, s49, 1536
    buffer_store_dwordx2 v[88:89], v21, s[8:11], s50 offen sc0 sc1
    v_fma_f32 v116, v107, v108, v112
    v_fma_f32 v117, v107, v109, v113
    v_fma_f32 v118, v107, v110, v114
    v_fma_f32 v119, v107, v111, v115
    v_fma_f32 v92, v105, v92, v116
    v_fma_f32 v93, v105, v93, v117
    v_fma_f32 v94, v105, v94, v118
    v_fma_f32 v95, v105, v95, v119
    v_mul_f32 v28, v92, v92
    v_mul_f32 v29, v93, v93
    v_mul_f32 v30, v94, v94
    v_mul_f32 v31, v95, v95
    v_fma_f32 v28, v28, s48, v20
    v_fma_f32 v29, v29, s48, v20
    v_fma_f32 v30, v30, s48, v20
    v_fma_f32 v31, v31, s48, v20
    v_mul_f32 v28, v28, v92
    v_mul_f32 v29, v29, v93
    v_mul_f32 v30, v30, v94
    v_mul_f32 v31, v31, v95
    v_exp_f32 v28, v28
    v_exp_f32 v29, v29
    v_exp_f32 v30, v30
    v_exp_f32 v31, v31
    v_add_f32 v28, 1.0, v28
    v_add_f32 v29, 1.0, v29
    v_add_f32 v30, 1.0, v30
    v_add_f32 v31, 1.0, v31
    v_rcp_f32 v28, v28
    v_rcp_f32 v29, v29
    v_rcp_f32 v30, v30
    v_rcp_f32 v31, v31
    v_mul_f32 v92, v92, v28
    v_mul_f32 v93, v93, v29
    v_mul_f32 v94, v94, v30
    v_mul_f32 v95, v95, v31
    v_cvt_pk_bf16_f32 v92, v92, v93
    v_cvt_pk_bf16_f32 v93, v94, v95
    s_add_u32 s50, s49, 75264
    buffer_store_dwordx2 v[92:93], v21, s[8:11], s50 offen sc0 sc1
    v_accvgpr_read_b32 v108, a32
    v_accvgpr_read_b32 v109, a33
    v_accvgpr_read_b32 v110, a34
    v_accvgpr_read_b32 v111, a35
    v_accvgpr_read_b32 v112, a36
    v_accvgpr_read_b32 v113, a37
    v_accvgpr_read_b32 v114, a38
    v_accvgpr_read_b32 v115, a39
    v_fma_f32 v116, v106, v108, v112
    v_fma_f32 v117, v106, v109, v113
    v_fma_f32 v118, v106, v110, v114
    v_fma_f32 v119, v106, v111, v115
    v_fma_f32 v96, v104, v96, v116
    v_fma_f32 v97, v104, v97, v117
    v_fma_f32 v98, v104, v98, v118
    v_fma_f32 v99, v104, v99, v119
    v_mul_f32 v28, v96, v96
    v_mul_f32 v29, v97, v97
    v_mul_f32 v30, v98, v98
    v_mul_f32 v31, v99, v99
    v_fma_f32 v28, v28, s48, v20
    v_fma_f32 v29, v29, s48, v20
    v_fma_f32 v30, v30, s48, v20
    v_fma_f32 v31, v31, s48, v20
    v_mul_f32 v28, v28, v96
    v_mul_f32 v29, v29, v97
    v_mul_f32 v30, v30, v98
    v_mul_f32 v31, v31, v99
    v_exp_f32 v28, v28
    v_exp_f32 v29, v29
    v_exp_f32 v30, v30
    v_exp_f32 v31, v31
    v_add_f32 v28, 1.0, v28
    v_add_f32 v29, 1.0, v29
    v_add_f32 v30, 1.0, v30
    v_add_f32 v31, 1.0, v31
    v_rcp_f32 v28, v28
    v_rcp_f32 v29, v29
    v_rcp_f32 v30, v30
    v_rcp_f32 v31, v31
    v_mul_f32 v96, v96, v28
    v_mul_f32 v97, v97, v29
    v_mul_f32 v98, v98, v30
    v_mul_f32 v99, v99, v31
    v_cvt_pk_bf16_f32 v96, v96, v97
    v_cvt_pk_bf16_f32 v97, v98, v99
    s_add_u32 s50, s49, 2048
    buffer_store_dwordx2 v[96:97], v21, s[8:11], s50 offen sc0 sc1
    v_fma_f32 v116, v107, v108, v112
    v_fma_f32 v117, v107, v109, v113
    v_fma_f32 v118, v107, v110, v114
    v_fma_f32 v119, v107, v111, v115
    v_fma_f32 v100, v105, v100, v116
    v_fma_f32 v101, v105, v101, v117
    v_fma_f32 v102, v105, v102, v118
    v_fma_f32 v103, v105, v103, v119
    v_mul_f32 v28, v100, v100
    v_mul_f32 v29, v101, v101
    v_mul_f32 v30, v102, v102
    v_mul_f32 v31, v103, v103
    v_fma_f32 v28, v28, s48, v20
    v_fma_f32 v29, v29, s48, v20
    v_fma_f32 v30, v30, s48, v20
    v_fma_f32 v31, v31, s48, v20
    v_mul_f32 v28, v28, v100
    v_mul_f32 v29, v29, v101
    v_mul_f32 v30, v30, v102
    v_mul_f32 v31, v31, v103
    v_exp_f32 v28, v28
    v_exp_f32 v29, v29
    v_exp_f32 v30, v30
    v_exp_f32 v31, v31
    v_add_f32 v28, 1.0, v28
    v_add_f32 v29, 1.0, v29
    v_add_f32 v30, 1.0, v30
    v_add_f32 v31, 1.0, v31
    v_rcp_f32 v28, v28
    v_rcp_f32 v29, v29
    v_rcp_f32 v30, v30
    v_rcp_f32 v31, v31
    v_mul_f32 v100, v100, v28
    v_mul_f32 v101, v101, v29
    v_mul_f32 v102, v102, v30
    v_mul_f32 v103, v103, v31
    v_cvt_pk_bf16_f32 v100, v100, v101
    v_cvt_pk_bf16_f32 v101, v102, v103
    s_add_u32 s50, s49, 75776
    buffer_store_dwordx2 v[100:101], v21, s[8:11], s50 offen sc0 sc1
    v_and_b32 v3, 31, v1
    v_lshlrev_b32 v3, 3, v3
    v_lshrrev_b32 v5, 5, v1
    v_lshl_add_u32 v3, v5, 18, v3
    s_mov_b32 s33, 200000
K3_pollo:
    s_mov_b32 s39, s51
    buffer_load_dwordx2 v[8:9], v3, s[24:27], s39 offen sc0 sc1
    s_add_u32 s39, s39, 16384
    buffer_load_dwordx2 v[10:11], v3, s[24:27], s39 offen sc0 sc1
    s_add_u32 s39, s39, 16384
    buffer_load_dwordx2 v[12:13], v3, s[24:27], s39 offen sc0 sc1
    s_add_u32 s39, s39, 16384
    buffer_load_dwordx2 v[14:15], v3, s[24:27], s39 offen sc0 sc1
    s_add_u32 s39, s39, 16384
    buffer_load_dwordx2 v[16:17], v3, s[24:27], s39 offen sc0 sc1
    s_add_u32 s39, s39, 16384
    buffer_load_dwordx2 v[18:19], v3, s[24:27], s39 offen sc0 sc1
    s_add_u32 s39, s39, 16384
    buffer_load_dwordx2 v[24:25], v3, s[24:27], s39 offen sc0 sc1
    s_add_u32 s39, s39, 16384
    buffer_load_dwordx2 v[26:27], v3, s[24:27], s39 offen sc0 sc1
    s_add_u32 s39, s39, 16384
    buffer_load_dwordx2 v[104:105], v3, s[24:27], s39 offen sc0 sc1
    s_add_u32 s39, s39, 16384
    buffer_load_dwordx2 v[106:107], v3, s[24:27], s39 offen sc0 sc1
    s_add_u32 s39, s39, 16384
    buffer_load_dwordx2 v[108:109], v3, s[24:27], s39 offen sc0 sc1
    s_add_u32 s39, s39, 16384
    buffer_load_dwordx2 v[110:111], v3, s[24:27], s39 offen sc0 sc1
    s_add_u32 s39, s39, 16384
    buffer_load_dwordx2 v[112:113], v3, s[24:27], s39 offen sc0 sc1
    s_add_u32 s39, s39, 16384
    buffer_load_dwordx2 v[114:115], v3, s[24:27], s39 offen sc0 sc1
    s_add_u32 s39, s39, 16384
    buffer_load_dwordx2 v[116:117], v3, s[24:27], s39 offen sc0 sc1
    s_add_u32 s39, s39, 16384
    buffer_load_dwordx2 v[118:119], v3, s[24:27], s39 offen sc0 sc1
    s_waitcnt vmcnt(0)
    v_cmp_eq_u32 vcc, -1, v9
    v_cmp_eq_u32 s[60:61], -1, v11
    s_or_b64 vcc, vcc, s[60:61]
    v_cmp_eq_u32 s[60:61], -1, v13
    s_or_b64 vcc, vcc, s[60:61]
    v_cmp_eq_u32 s[60:61], -1, v15
    s_or_b64 vcc, vcc, s[60:61]
    v_cmp_eq_u32 s[60:61], -1, v17
    s_or_b64 vcc, vcc, s[60:61]
    v_cmp_eq_u32 s[60:61], -1, v19
    s_or_b64 vcc, vcc, s[60:61]
    v_cmp_eq_u32 s[60:61], -1, v25
    s_or_b64 vcc, vcc, s[60:61]
    v_cmp_eq_u32 s[60:61], -1, v27
    s_or_b64 vcc, vcc, s[60:61]
    v_cmp_eq_u32 s[60:61], -1, v105
    s_or_b64 vcc, vcc, s[60:61]
    v_cmp_eq_u32 s[60:61], -1, v107
    s_or_b64 vcc, vcc, s[60:61]
    v_cmp_eq_u32 s[60:61], -1, v109
    s_or_b64 vcc, vcc, s[60:61]
    v_cmp_eq_u32 s[60:61], -1, v111
    s_or_b64 vcc, vcc, s[60:61]
    v_cmp_eq_u32 s[60:61], -1, v113
    s_or_b64 vcc, vcc, s[60:61]
    v_cmp_eq_u32 s[60:61], -1, v115
    s_or_b64 vcc, vcc, s[60:61]
    v_cmp_eq_u32 s[60:61], -1, v117
    s_or_b64 vcc, vcc, s[60:61]
    v_cmp_eq_u32 s[60:61], -1, v119
    s_or_b64 vcc, vcc, s[60:61]
    s_cbranch_vccz K3_readyo
    s_sleep 1
    s_sub_u32 s33, s33, 1
    s_cmp_lg_u32 s33, 0
    s_cbranch_scc1 K3_pollo
K3_readyo:
    v_add_f32 v8, v8, v10
    v_add_f32 v9, v9, v11
    v_add_f32 v8, v8, v12
    v_add_f32 v9, v9, v13
    v_add_f32 v8, v8, v14
    v_add_f32 v9, v9, v15
    v_add_f32 v8, v8, v16
    v_add_f32 v9, v9, v17
    v_add_f32 v8, v8, v18
    v_add_f32 v9, v9, v19
    v_add_f32 v8, v8, v24
    v_add_f32 v9, v9, v25
    v_add_f32 v8, v8, v26
    v_add_f32 v9, v9, v27
    v_add_f32 v8, v8, v104
    v_add_f32 v9, v9, v105
    v_add_f32 v8, v8, v106
    v_add_f32 v9, v9, v107
    v_add_f32 v8, v8, v108
    v_add_f32 v9, v9, v109
    v_add_f32 v8, v8, v110
    v_add_f32 v9, v9, v111
    v_add_f32 v8, v8, v112
    v_add_f32 v9, v9, v113
    v_add_f32 v8, v8, v114
    v_add_f32 v9, v9, v115
    v_add_f32 v8, v8, v116
    v_add_f32 v9, v9, v117
    v_add_f32 v8, v8, v118
    v_add_f32 v9, v9, v119
    v_mov_b32 v10, v8
    v_mov_b32 v11, v9
    s_nop 1
    v_permlane32_swap_b32 v8, v10
    v_permlane32_swap_b32 v9, v11
    v_add_f32 v8, v8, v10
    v_add_f32 v9, v9, v11
    s_mov_b32 s33, 971214393
    v_mul_f32 v8, s33, v8
    v_mul_f32 v9, s33, v9
    v_fma_f32 v9, -v8, v8, v9
    v_max_f32 v9, 0, v9
    v_add_f32 v9, 925353388, v9
    v_rsq_f32 v9, v9
    v_and_b32 v3, 31, v1
    v_mul_f32 v8, v8, v9
    v_sub_f32 v8, 0, v8
    v_lshl_add_u32 v3, v3, 2, s30
    ds_write_b32 v3, v9
    ds_write_b32 v3, v8 offset:128
    v_lshl_add_u32 v3, v4, 4, s30
    s_waitcnt lgkmcnt(0)
    ds_read_b128 v[104:107], v3
    ds_read_b128 v[108:111], v3 offset:64
    ds_read_b128 v[112:115], v3 offset:128
    ds_read_b128 v[116:119], v3 offset:192
    s_mul_i32 s49, s52, 65536
    s_lshl_b32 s51, s37, 9
    s_add_u32 s49, s49, s51
    s_waitcnt lgkmcnt(0)
    v_fma_f32 v32, v32, v104, v112
    v_fma_f32 v33, v33, v105, v113
    v_fma_f32 v34, v34, v106, v114
    v_fma_f32 v35, v35, v107, v115
    v_cvt_pk_bf16_f32 v32, v32, v33
    v_cvt_pk_bf16_f32 v33, v34, v35
    s_add_u32 s51, s49, 0
    buffer_store_dwordx2 v[32:33], v21, s[20:23], s51 offen sc0 sc1
    v_fma_f32 v36, v36, v108, v116
    v_fma_f32 v37, v37, v109, v117
    v_fma_f32 v38, v38, v110, v118
    v_fma_f32 v39, v39, v111, v119
    v_cvt_pk_bf16_f32 v36, v36, v37
    v_cvt_pk_bf16_f32 v37, v38, v39
    s_add_u32 s51, s49, 512
    buffer_store_dwordx2 v[36:37], v21, s[20:23], s51 offen sc0 sc1
    v_fma_f32 v40, v40, v104, v112
    v_fma_f32 v41, v41, v105, v113
    v_fma_f32 v42, v42, v106, v114
    v_fma_f32 v43, v43, v107, v115
    v_cvt_pk_bf16_f32 v40, v40, v41
    v_cvt_pk_bf16_f32 v41, v42, v43
    s_add_u32 s51, s49, 65536
    buffer_store_dwordx2 v[40:41], v21, s[20:23], s51 offen sc0 sc1
    v_fma_f32 v44, v44, v108, v116
    v_fma_f32 v45, v45, v109, v117
    v_fma_f32 v46, v46, v110, v118
    v_fma_f32 v47, v47, v111, v119
    v_cvt_pk_bf16_f32 v44, v44, v45
    v_cvt_pk_bf16_f32 v45, v46, v47
    s_add_u32 s51, s49, 66048
    buffer_store_dwordx2 v[44:45], v21, s[20:23], s51 offen sc0 sc1
    v_fma_f32 v48, v48, v104, v112
    v_fma_f32 v49, v49, v105, v113
    v_fma_f32 v50, v50, v106, v114
    v_fma_f32 v51, v51, v107, v115
    v_cvt_pk_bf16_f32 v48, v48, v49
    v_cvt_pk_bf16_f32 v49, v50, v51
    s_add_u32 s51, s49, 131072
    buffer_store_dwordx2 v[48:49], v21, s[20:23], s51 offen sc0 sc1
    v_fma_f32 v52, v52, v108, v116
    v_fma_f32 v53, v53, v109, v117
    v_fma_f32 v54, v54, v110, v118
    v_fma_f32 v55, v55, v111, v119
    v_cvt_pk_bf16_f32 v52, v52, v53
    v_cvt_pk_bf16_f32 v53, v54, v55
    s_add_u32 s51, s49, 131584
    buffer_store_dwordx2 v[52:53], v21, s[20:23], s51 offen sc0 sc1
    v_fma_f32 v56, v56, v104, v112
    v_fma_f32 v57, v57, v105, v113
    v_fma_f32 v58, v58, v106, v114
    v_fma_f32 v59, v59, v107, v115
    v_cvt_pk_bf16_f32 v56, v56, v57
    v_cvt_pk_bf16_f32 v57, v58, v59
    s_add_u32 s51, s49, 196608
    buffer_store_dwordx2 v[56:57], v21, s[20:23], s51 offen sc0 sc1
    v_fma_f32 v60, v60, v108, v116
    v_fma_f32 v61, v61, v109, v117
    v_fma_f32 v62, v62, v110, v118
    v_fma_f32 v63, v63, v111, v119
    v_cvt_pk_bf16_f32 v60, v60, v61
    v_cvt_pk_bf16_f32 v61, v62, v63
    s_add_u32 s51, s49, 197120
    buffer_store_dwordx2 v[60:61], v21, s[20:23], s51 offen sc0 sc1
    s_waitcnt vmcnt(0)
K3_end:
    s_endpgm
.text
.globl k4_sp_kernel
.p2align 8
.type k4_sp_kernel,@function
k4_sp_kernel:
    s_cmp_ge_u32 s2, 256
    s_cbranch_scc1 K4_end
    s_load_dwordx2 s[4:5], s[0:1], 112
    s_load_dwordx2 s[6:7], s[0:1], 64
    v_and_b32 v1, 63, v0
    v_lshrrev_b32 v2, 6, v0
    s_nop 0
    v_readfirstlane_b32 s3, v2
    s_and_b32 s28, s2, 3
    s_lshl_b32 s28, s28, 2
    s_bfe_u32 s29, s2, 0x20003
    s_add_u32 s28, s28, s29
    s_bfe_u32 s29, s2, 0x10002
    s_lshl_b32 s29, s29, 3
    s_lshr_b32 s30, s2, 5
    s_add_u32 s29, s29, s30
    s_and_b32 s31, s3, 3
    s_lshr_b32 s32, s3, 2
    v_lshlrev_b32 v8, 4, v1
    v_add_u32 v9, 65536, v8
    s_lshl_b32 s33, s28, 3
    s_lshl_b32 s34, s31, 1
    s_add_u32 s40, s33, s34
    s_mul_i32 s33, s40, 65536
    s_lshl_b32 s34, s32, 15
    s_add_u32 s33, s33, s34
    s_and_b32 s36, s31, 1
    s_lshr_b32 s37, s31, 1
    s_mul_i32 s37, s37, 5
    s_mul_i32 s35, s29, 9
    s_add_u32 s35, s35, s37
    s_mul_i32 s35, s35, 65536
    s_add_u32 s35, s35, s34
    s_lshl_b32 s38, s36, 10
    s_add_u32 s35, s35, s38
    s_mul_i32 s38, s36, 9
    s_add_u32 s38, s38, s37
    s_lshl_b32 s38, s38, 10
    s_mul_i32 s37, s32, 18432
    s_add_u32 s38, s38, s37
    v_add_u32 v10, s37, v8
    v_add_u32 v11, 73728, v10
    s_waitcnt lgkmcnt(0)
    s_add_u32 s12, s4, 83886080
    s_addc_u32 s13, s5, 0
    s_mov_b32 s14, 8388608
    s_mov_b32 s15, 0x00020000
    s_add_u32 s16, s4, 37748736
    s_addc_u32 s17, s5, 0
    s_mov_b32 s18, 9437184
    s_mov_b32 s19, 0x00020000
    buffer_load_dwordx4 a[72:75], v8, s[12:15], s33 offen offset:0
    s_add_u32 m0, s38, 0
    s_add_u32 s39, s35, 0
    buffer_load_dwordx4 v8, s[16:19], s39 offen lds
    s_add_u32 m0, s38, 1024
    s_add_u32 s39, s35, 65536
    buffer_load_dwordx4 v8, s[16:19], s39 offen lds
    buffer_load_dwordx4 a[76:79], v8, s[12:15], s33 offen offset:1024
    s_add_u32 m0, s38, 2048
    s_add_u32 s39, s35, 131072
    buffer_load_dwordx4 v8, s[16:19], s39 offen lds
    buffer_load_dwordx4 a[80:83], v9, s[12:15], s33 offen offset:0
    s_add_u32 m0, s38, 3072
    s_add_u32 s39, s35, 196608
    buffer_load_dwordx4 v8, s[16:19], s39 offen lds
    buffer_load_dwordx4 a[84:87], v9, s[12:15], s33 offen offset:1024
    s_add_u32 s33, s33, 2048
    s_cmp_ge_u32 s31, 2
    s_cbranch_scc1 K4_skip_1
    s_add_u32 m0, s38, 4096
    s_add_u32 s39, s35, 262144
    buffer_load_dwordx4 v8, s[16:19], s39 offen lds
K4_skip_1:
    s_add_u32 s35, s35, 2048
    buffer_load_dwordx4 a[88:91], v8, s[12:15], s33 offen offset:0
    s_add_u32 m0, s38, 36864
    s_add_u32 s39, s35, 0
    buffer_load_dwordx4 v8, s[16:19], s39 offen lds
    s_add_u32 m0, s38, 37888
    s_add_u32 s39, s35, 65536
    buffer_load_dwordx4 v8, s[16:19], s39 offen lds
    buffer_load_dwordx4 a[92:95], v8, s[12:15], s33 offen offset:1024
    s_add_u32 m0, s38, 38912
    s_add_u32 s39, s35, 131072
    buffer_load_dwordx4 v8, s[16:19], s39 offen lds
    buffer_load_dwordx4 a[96:99], v9, s[12:15], s33 offen offset:0
    s_add_u32 m0, s38, 39936
    s_add_u32 s39, s35, 196608
    buffer_load_dwordx4 v8, s[16:19], s39 offen lds
    buffer_load_dwordx4 a[100:103], v9, s[12:15], s33 offen offset:1024
    s_add_u32 s33, s33, 2048
    s_cmp_ge_u32 s31, 2
    s_cbranch_scc1 K4_skip_2
    s_add_u32 m0, s38, 40960
    s_add_u32 s39, s35, 262144
    buffer_load_dwordx4 v8, s[16:19], s39 offen lds
K4_skip_2:
    s_add_u32 s35, s35, 2048
    buffer_load_dwordx4 a[104:107], v8, s[12:15], s33 offen offset:0
    s_add_u32 m0, s38, 73728
    s_add_u32 s39, s35, 0
    buffer_load_dwordx4 v8, s[16:19], s39 offen lds
    s_add_u32 m0, s38, 74752
    s_add_u32 s39, s35, 65536
    buffer_load_dwordx4 v8, s[16:19], s39 offen lds
    buffer_load_dwordx4 a[108:111], v8, s[12:15], s33 offen offset:1024
    s_add_u32 m0, s38, 75776
    s_add_u32 s39, s35, 131072
    buffer_load_dwordx4 v8, s[16:19], s39 offen lds
    buffer_load_dwordx4 a[112:115], v9, s[12:15], s33 offen offset:0
    s_add_u32 m0, s38, 76800
    s_add_u32 s39, s35, 196608
    buffer_load_dwordx4 v8, s[16:19], s39 offen lds
    buffer_load_dwordx4 a[116:119], v9, s[12:15], s33 offen offset:1024
    s_add_u32 s33, s33, 2048
    s_cmp_ge_u32 s31, 2
    s_cbranch_scc1 K4_skip_3
    s_add_u32 m0, s38, 77824
    s_add_u32 s39, s35, 262144
    buffer_load_dwordx4 v8, s[16:19], s39 offen lds
K4_skip_3:
    s_add_u32 s35, s35, 2048
    v_mov_b32 v16, 0
    v_mov_b32 v17, 0
    v_mov_b32 v18, 0
    v_mov_b32 v19, 0
    v_mov_b32 v20, 0
    v_mov_b32 v21, 0
    v_mov_b32 v22, 0
    v_mov_b32 v23, 0
    v_mov_b32 v24, 0
    v_mov_b32 v25, 0
    v_mov_b32 v26, 0
    v_mov_b32 v27, 0
    v_mov_b32 v28, 0
    v_mov_b32 v29, 0
    v_mov_b32 v30, 0
    v_mov_b32 v31, 0
    v_mov_b32 v32, 0
    v_mov_b32 v33, 0
    v_mov_b32 v34, 0
    v_mov_b32 v35, 0
    v_mov_b32 v36, 0
    v_mov_b32 v37, 0
    v_mov_b32 v38, 0
    v_mov_b32 v39, 0
    v_mov_b32 v40, 0
    v_mov_b32 v41, 0
    v_mov_b32 v42, 0
    v_mov_b32 v43, 0
    v_mov_b32 v44, 0
    v_mov_b32 v45, 0
    v_mov_b32 v46, 0
    v_mov_b32 v47, 0
    v_mov_b32 v48, 0
    v_mov_b32 v49, 0
    v_mov_b32 v50, 0
    v_mov_b32 v51, 0
    v_mov_b32 v52, 0
    v_mov_b32 v53, 0
    v_mov_b32 v54, 0
    v_mov_b32 v55, 0
    v_mov_b32 v56, 0
    v_mov_b32 v57, 0
    v_mov_b32 v58, 0
    v_mov_b32 v59, 0
    v_mov_b32 v60, 0
    v_mov_b32 v61, 0
    v_mov_b32 v62, 0
    v_mov_b32 v63, 0
    v_mov_b32 v64, 0
    v_mov_b32 v65, 0
    v_mov_b32 v66, 0
    v_mov_b32 v67, 0
    v_mov_b32 v68, 0
    v_mov_b32 v69, 0
    v_mov_b32 v70, 0
    v_mov_b32 v71, 0
    v_mov_b32 v72, 0
    v_mov_b32 v73, 0
    v_mov_b32 v74, 0
    v_mov_b32 v75, 0
    v_mov_b32 v76, 0
    v_mov_b32 v77, 0
    v_mov_b32 v78, 0
    v_mov_b32 v79, 0
    v_mov_b32 v80, 0
    v_mov_b32 v81, 0
    v_mov_b32 v82, 0
    v_mov_b32 v83, 0
    v_mov_b32 v84, 0
    v_mov_b32 v85, 0
    v_mov_b32 v86, 0
    v_mov_b32 v87, 0
    s_add_u32 s20, s4, 25165824
    s_addc_u32 s21, s5, 0
    s_mov_b32 s22, 9437184
    s_mov_b32 s23, 0x00020000
    s_add_u32 s24, s4, 67108864
    s_addc_u32 s25, s5, 0
    s_mov_b32 s26, 9437184
    s_mov_b32 s27, 0x00020000
    s_add_u32 s44, s4, 94371840
    s_addc_u32 s45, s5, 0
    s_mov_b32 s46, 131072
    s_mov_b32 s47, 0x00020000
    s_mov_b32 s48, s6
    s_mov_b32 s49, s7
    s_mov_b32 s50, 4096
    s_mov_b32 s51, 0x00020000
    v_lshrrev_b32 v4, 4, v1
    v_lshrrev_b32 v5, 1, v4
    v_lshlrev_b32 v5, 8, v5
    v_and_b32 v6, 15, v1
    v_lshl_add_u32 v5, v6, 4, v5
    v_and_b32 v7, 1, v4
    v_lshl_add_u32 v12, v7, 3, v5
    s_add_u32 s41, s40, s32
    s_mul_i32 s42, s41, 73728
    s_mul_i32 s43, s29, 4608
    s_add_u32 s42, s42, s43
    v_lshlrev_b32 v13, 6, v6
    v_lshl_add_u32 v13, v4, 4, v13
    v_lshlrev_b32 v15, 1, v6
    s_waitcnt vmcnt(16)
    s_barrier
    ds_read_b128 a[0:3], v10 offset:0
    ds_read_b128 a[4:7], v10 offset:1024
    ds_read_b128 a[8:11], v10 offset:2048
    ds_read_b128 a[12:15], v10 offset:3072
    ds_read_b128 a[16:19], v10 offset:4096
    ds_read_b128 a[20:23], v10 offset:5120
    ds_read_b128 a[24:27], v10 offset:6144
    ds_read_b128 a[28:31], v10 offset:7168
    ds_read_b128 a[32:35], v10 offset:8192
    s_waitcnt vmcnt(8)
    s_barrier
    s_waitcnt lgkmcnt(8)
    v_mfma_f32_16x16x32_bf16 v[16:19], a[0:3], a[72:75], v[16:19]
    ds_read_b128 a[36:39], v10 offset:9216
    v_mfma_f32_16x16x32_bf16 v[20:23], a[0:3], a[80:83], v[20:23]
    buffer_load_dwordx4 a[120:123], v8, s[12:15], s33 offen offset:0
    s_waitcnt lgkmcnt(8)
    v_mfma_f32_16x16x32_bf16 v[24:27], a[4:7], a[72:75], v[24:27]
    ds_read_b128 a[40:43], v10 offset:10240
    v_mfma_f32_16x16x32_bf16 v[28:31], a[4:7], a[80:83], v[28:31]
    ds_read_b128 a[44:47], v10 offset:11264
    s_waitcnt lgkmcnt(9)
    v_mfma_f32_16x16x32_bf16 v[32:35], a[8:11], a[72:75], v[32:35]
    s_add_u32 m0, s38, 110592
    s_add_u32 s39, s35, 0
    buffer_load_dwordx4 v8, s[16:19], s39 offen lds
    v_mfma_f32_16x16x32_bf16 v[36:39], a[8:11], a[80:83], v[36:39]
    ds_read_b128 a[48:51], v10 offset:12288
    s_waitcnt lgkmcnt(9)
    v_mfma_f32_16x16x32_bf16 v[40:43], a[12:15], a[72:75], v[40:43]
    ds_read_b128 a[52:55], v10 offset:13312
    v_mfma_f32_16x16x32_bf16 v[44:47], a[12:15], a[80:83], v[44:47]
    s_add_u32 m0, s38, 111616
    s_add_u32 s39, s35, 65536
    buffer_load_dwordx4 v8, s[16:19], s39 offen lds
    s_waitcnt lgkmcnt(9)
    v_mfma_f32_16x16x32_bf16 v[48:51], a[16:19], a[72:75], v[48:51]
    ds_read_b128 a[56:59], v10 offset:14336
    v_mfma_f32_16x16x32_bf16 v[52:55], a[16:19], a[80:83], v[52:55]
    ds_read_b128 a[60:63], v10 offset:15360
    s_waitcnt lgkmcnt(10)
    v_mfma_f32_16x16x32_bf16 v[56:59], a[20:23], a[72:75], v[56:59]
    buffer_load_dwordx4 a[124:127], v8, s[12:15], s33 offen offset:1024
    v_mfma_f32_16x16x32_bf16 v[60:63], a[20:23], a[80:83], v[60:63]
    ds_read_b128 a[64:67], v10 offset:16384
    s_waitcnt lgkmcnt(10)
    v_mfma_f32_16x16x32_bf16 v[64:67], a[24:27], a[72:75], v[64:67]
    ds_read_b128 a[68:71], v10 offset:17408
    v_mfma_f32_16x16x32_bf16 v[68:71], a[24:27], a[80:83], v[68:71]
    s_waitcnt lgkmcnt(10)
    v_mfma_f32_16x16x32_bf16 v[72:75], a[28:31], a[72:75], v[72:75]
    v_mfma_f32_16x16x32_bf16 v[76:79], a[28:31], a[80:83], v[76:79]
    s_waitcnt lgkmcnt(9)
    v_mfma_f32_16x16x32_bf16 v[80:83], a[32:35], a[72:75], v[80:83]
    v_mfma_f32_16x16x32_bf16 v[84:87], a[32:35], a[80:83], v[84:87]
    s_waitcnt lgkmcnt(8)
    v_mfma_f32_16x16x32_bf16 v[16:19], a[36:39], a[76:79], v[16:19]
    ds_read_b128 a[0:3], v10 offset:36864
    v_mfma_f32_16x16x32_bf16 v[20:23], a[36:39], a[84:87], v[20:23]
    s_add_u32 m0, s38, 112640
    s_add_u32 s39, s35, 131072
    buffer_load_dwordx4 v8, s[16:19], s39 offen lds
    s_waitcnt lgkmcnt(8)
    v_mfma_f32_16x16x32_bf16 v[24:27], a[40:43], a[76:79], v[24:27]
    ds_read_b128 a[4:7], v10 offset:37888
    v_mfma_f32_16x16x32_bf16 v[28:31], a[40:43], a[84:87], v[28:31]
    buffer_load_dwordx4 a[128:131], v9, s[12:15], s33 offen offset:0
    s_waitcnt lgkmcnt(8)
    v_mfma_f32_16x16x32_bf16 v[32:35], a[44:47], a[76:79], v[32:35]
    ds_read_b128 a[8:11], v10 offset:38912
    v_mfma_f32_16x16x32_bf16 v[36:39], a[44:47], a[84:87], v[36:39]
    ds_read_b128 a[12:15], v10 offset:39936
    s_waitcnt lgkmcnt(9)
    v_mfma_f32_16x16x32_bf16 v[40:43], a[48:51], a[76:79], v[40:43]
    s_add_u32 m0, s38, 113664
    s_add_u32 s39, s35, 196608
    buffer_load_dwordx4 v8, s[16:19], s39 offen lds
    v_mfma_f32_16x16x32_bf16 v[44:47], a[48:51], a[84:87], v[44:47]
    ds_read_b128 a[16:19], v10 offset:40960
    s_waitcnt lgkmcnt(9)
    v_mfma_f32_16x16x32_bf16 v[48:51], a[52:55], a[76:79], v[48:51]
    ds_read_b128 a[20:23], v10 offset:41984
    v_mfma_f32_16x16x32_bf16 v[52:55], a[52:55], a[84:87], v[52:55]
    buffer_load_dwordx4 a[132:135], v9, s[12:15], s33 offen offset:1024
    s_add_u32 s33, s33, 2048
    s_waitcnt lgkmcnt(9)
    v_mfma_f32_16x16x32_bf16 v[56:59], a[56:59], a[76:79], v[56:59]
    ds_read_b128 a[24:27], v10 offset:43008
    v_mfma_f32_16x16x32_bf16 v[60:63], a[56:59], a[84:87], v[60:63]
    ds_read_b128 a[28:31], v10 offset:44032
    s_waitcnt lgkmcnt(10)
    v_mfma_f32_16x16x32_bf16 v[64:67], a[60:63], a[76:79], v[64:67]
    s_cmp_ge_u32 s31, 2
    s_cbranch_scc1 K4_skip_4
    s_add_u32 m0, s38, 114688
    s_add_u32 s39, s35, 262144
    buffer_load_dwordx4 v8, s[16:19], s39 offen lds
K4_skip_4:
    s_add_u32 s35, s35, 2048
    v_mfma_f32_16x16x32_bf16 v[68:71], a[60:63], a[84:87], v[68:71]
    ds_read_b128 a[32:35], v10 offset:45056
    s_waitcnt lgkmcnt(10)
    v_mfma_f32_16x16x32_bf16 v[72:75], a[64:67], a[76:79], v[72:75]
    v_mfma_f32_16x16x32_bf16 v[76:79], a[64:67], a[84:87], v[76:79]
    s_waitcnt lgkmcnt(9)
    v_mfma_f32_16x16x32_bf16 v[80:83], a[68:71], a[76:79], v[80:83]
    v_mfma_f32_16x16x32_bf16 v[84:87], a[68:71], a[84:87], v[84:87]
    s_waitcnt vmcnt(8)
    s_barrier
    s_waitcnt lgkmcnt(8)
    v_mfma_f32_16x16x32_bf16 v[16:19], a[0:3], a[88:91], v[16:19]
    ds_read_b128 a[36:39], v10 offset:46080
    v_mfma_f32_16x16x32_bf16 v[20:23], a[0:3], a[96:99], v[20:23]
    buffer_load_dwordx4 a[72:75], v8, s[12:15], s33 offen offset:0
    s_waitcnt lgkmcnt(8)
    v_mfma_f32_16x16x32_bf16 v[24:27], a[4:7], a[88:91], v[24:27]
    ds_read_b128 a[40:43], v10 offset:47104
    v_mfma_f32_16x16x32_bf16 v[28:31], a[4:7], a[96:99], v[28:31]
    ds_read_b128 a[44:47], v10 offset:48128
    s_waitcnt lgkmcnt(9)
    v_mfma_f32_16x16x32_bf16 v[32:35], a[8:11], a[88:91], v[32:35]
    s_add_u32 m0, s38, 0
    s_add_u32 s39, s35, 0
    buffer_load_dwordx4 v8, s[16:19], s39 offen lds
    v_mfma_f32_16x16x32_bf16 v[36:39], a[8:11], a[96:99], v[36:39]
    ds_read_b128 a[48:51], v10 offset:49152
    s_waitcnt lgkmcnt(9)
    v_mfma_f32_16x16x32_bf16 v[40:43], a[12:15], a[88:91], v[40:43]
    ds_read_b128 a[52:55], v10 offset:50176
    v_mfma_f32_16x16x32_bf16 v[44:47], a[12:15], a[96:99], v[44:47]
    s_add_u32 m0, s38, 1024
    s_add_u32 s39, s35, 65536
    buffer_load_dwordx4 v8, s[16:19], s39 offen lds
    s_waitcnt lgkmcnt(9)
    v_mfma_f32_16x16x32_bf16 v[48:51], a[16:19], a[88:91], v[48:51]
    ds_read_b128 a[56:59], v10 offset:51200
    v_mfma_f32_16x16x32_bf16 v[52:55], a[16:19], a[96:99], v[52:55]
    ds_read_b128 a[60:63], v10 offset:52224
    s_waitcnt lgkmcnt(10)
    v_mfma_f32_16x16x32_bf16 v[56:59], a[20:23], a[88:91], v[56:59]
    buffer_load_dwordx4 a[76:79], v8, s[12:15], s33 offen offset:1024
    v_mfma_f32_16x16x32_bf16 v[60:63], a[20:23], a[96:99], v[60:63]
    ds_read_b128 a[64:67], v10 offset:53248
    s_waitcnt lgkmcnt(10)
    v_mfma_f32_16x16x32_bf16 v[64:67], a[24:27], a[88:91], v[64:67]
    ds_read_b128 a[68:71], v10 offset:54272
    v_mfma_f32_16x16x32_bf16 v[68:71], a[24:27], a[96:99], v[68:71]
    s_waitcnt lgkmcnt(10)
    v_mfma_f32_16x16x32_bf16 v[72:75], a[28:31], a[88:91], v[72:75]
    v_mfma_f32_16x16x32_bf16 v[76:79], a[28:31], a[96:99], v[76:79]
    s_waitcnt lgkmcnt(9)
    v_mfma_f32_16x16x32_bf16 v[80:83], a[32:35], a[88:91], v[80:83]
    v_mfma_f32_16x16x32_bf16 v[84:87], a[32:35], a[96:99], v[84:87]
    s_waitcnt lgkmcnt(8)
    v_mfma_f32_16x16x32_bf16 v[16:19], a[36:39], a[92:95], v[16:19]
    ds_read_b128 a[0:3], v11 offset:0
    v_mfma_f32_16x16x32_bf16 v[20:23], a[36:39], a[100:103], v[20:23]
    s_add_u32 m0, s38, 2048
    s_add_u32 s39, s35, 131072
    buffer_load_dwordx4 v8, s[16:19], s39 offen lds
    s_waitcnt lgkmcnt(8)
    v_mfma_f32_16x16x32_bf16 v[24:27], a[40:43], a[92:95], v[24:27]
    ds_read_b128 a[4:7], v11 offset:1024
    v_mfma_f32_16x16x32_bf16 v[28:31], a[40:43], a[100:103], v[28:31]
    buffer_load_dwordx4 a[80:83], v9, s[12:15], s33 offen offset:0
    s_waitcnt lgkmcnt(8)
    v_mfma_f32_16x16x32_bf16 v[32:35], a[44:47], a[92:95], v[32:35]
    ds_read_b128 a[8:11], v11 offset:2048
    v_mfma_f32_16x16x32_bf16 v[36:39], a[44:47], a[100:103], v[36:39]
    ds_read_b128 a[12:15], v11 offset:3072
    s_waitcnt lgkmcnt(9)
    v_mfma_f32_16x16x32_bf16 v[40:43], a[48:51], a[92:95], v[40:43]
    s_add_u32 m0, s38, 3072
    s_add_u32 s39, s35, 196608
    buffer_load_dwordx4 v8, s[16:19], s39 offen lds
    v_mfma_f32_16x16x32_bf16 v[44:47], a[48:51], a[100:103], v[44:47]
    ds_read_b128 a[16:19], v11 offset:4096
    s_waitcnt lgkmcnt(9)
    v_mfma_f32_16x16x32_bf16 v[48:51], a[52:55], a[92:95], v[48:51]
    ds_read_b128 a[20:23], v11 offset:5120
    v_mfma_f32_16x16x32_bf16 v[52:55], a[52:55], a[100:103], v[52:55]
    buffer_load_dwordx4 a[84:87], v9, s[12:15], s33 offen offset:1024
    s_add_u32 s33, s33, 2048
    s_waitcnt lgkmcnt(9)
    v_mfma_f32_16x16x32_bf16 v[56:59], a[56:59], a[92:95], v[56:59]
    ds_read_b128 a[24:27], v11 offset:6144
    v_mfma_f32_16x16x32_bf16 v[60:63], a[56:59], a[100:103], v[60:63]
    ds_read_b128 a[28:31], v11 offset:7168
    s_waitcnt lgkmcnt(10)
    v_mfma_f32_16x16x32_bf16 v[64:67], a[60:63], a[92:95], v[64:67]
    s_cmp_ge_u32 s31, 2
    s_cbranch_scc1 K4_skip_5
    s_add_u32 m0, s38, 4096
    s_add_u32 s39, s35, 262144
    buffer_load_dwordx4 v8, s[16:19], s39 offen lds
K4_skip_5:
    s_add_u32 s35, s35, 2048
    v_mfma_f32_16x16x32_bf16 v[68:71], a[60:63], a[100:103], v[68:71]
    ds_read_b128 a[32:35], v11 offset:8192
    s_waitcnt lgkmcnt(10)
    v_mfma_f32_16x16x32_bf16 v[72:75], a[64:67], a[92:95], v[72:75]
    v_mfma_f32_16x16x32_bf16 v[76:79], a[64:67], a[100:103], v[76:79]
    s_waitcnt lgkmcnt(9)
    v_mfma_f32_16x16x32_bf16 v[80:83], a[68:71], a[92:95], v[80:83]
    v_mfma_f32_16x16x32_bf16 v[84:87], a[68:71], a[100:103], v[84:87]
    s_waitcnt vmcnt(8)
    s_barrier
    s_waitcnt lgkmcnt(8)
    v_mfma_f32_16x16x32_bf16 v[16:19], a[0:3], a[104:107], v[16:19]
    ds_read_b128 a[36:39], v11 offset:9216
    v_mfma_f32_16x16x32_bf16 v[20:23], a[0:3], a[112:115], v[20:23]
    buffer_load_dwordx4 a[88:91], v8, s[12:15], s33 offen offset:0
    s_waitcnt lgkmcnt(8)
    v_mfma_f32_16x16x32_bf16 v[24:27], a[4:7], a[104:107], v[24:27]
    ds_read_b128 a[40:43], v11 offset:10240
    v_mfma_f32_16x16x32_bf16 v[28:31], a[4:7], a[112:115], v[28:31]
    ds_read_b128 a[44:47], v11 offset:11264
    s_waitcnt lgkmcnt(9)
    v_mfma_f32_16x16x32_bf16 v[32:35], a[8:11], a[104:107], v[32:35]
    s_add_u32 m0, s38, 36864
    s_add_u32 s39, s35, 0
    buffer_load_dwordx4 v8, s[16:19], s39 offen lds
    v_mfma_f32_16x16x32_bf16 v[36:39], a[8:11], a[112:115], v[36:39]
    ds_read_b128 a[48:51], v11 offset:12288
    s_waitcnt lgkmcnt(9)
    v_mfma_f32_16x16x32_bf16 v[40:43], a[12:15], a[104:107], v[40:43]
    ds_read_b128 a[52:55], v11 offset:13312
    v_mfma_f32_16x16x32_bf16 v[44:47], a[12:15], a[112:115], v[44:47]
    s_add_u32 m0, s38, 37888
    s_add_u32 s39, s35, 65536
    buffer_load_dwordx4 v8, s[16:19], s39 offen lds
    s_waitcnt lgkmcnt(9)
    v_mfma_f32_16x16x32_bf16 v[48:51], a[16:19], a[104:107], v[48:51]
    ds_read_b128 a[56:59], v11 offset:14336
    v_mfma_f32_16x16x32_bf16 v[52:55], a[16:19], a[112:115], v[52:55]
    ds_read_b128 a[60:63], v11 offset:15360
    s_waitcnt lgkmcnt(10)
    v_mfma_f32_16x16x32_bf16 v[56:59], a[20:23], a[104:107], v[56:59]
    buffer_load_dwordx4 a[92:95], v8, s[12:15], s33 offen offset:1024
    v_mfma_f32_16x16x32_bf16 v[60:63], a[20:23], a[112:115], v[60:63]
    ds_read_b128 a[64:67], v11 offset:16384
    s_waitcnt lgkmcnt(10)
    v_mfma_f32_16x16x32_bf16 v[64:67], a[24:27], a[104:107], v[64:67]
    ds_read_b128 a[68:71], v11 offset:17408
    v_mfma_f32_16x16x32_bf16 v[68:71], a[24:27], a[112:115], v[68:71]
    s_waitcnt lgkmcnt(10)
    v_mfma_f32_16x16x32_bf16 v[72:75], a[28:31], a[104:107], v[72:75]
    v_mfma_f32_16x16x32_bf16 v[76:79], a[28:31], a[112:115], v[76:79]
    s_waitcnt lgkmcnt(9)
    v_mfma_f32_16x16x32_bf16 v[80:83], a[32:35], a[104:107], v[80:83]
    v_mfma_f32_16x16x32_bf16 v[84:87], a[32:35], a[112:115], v[84:87]
    s_waitcnt lgkmcnt(8)
    v_mfma_f32_16x16x32_bf16 v[16:19], a[36:39], a[108:111], v[16:19]
    ds_read_b128 a[0:3], v11 offset:36864
    v_mfma_f32_16x16x32_bf16 v[20:23], a[36:39], a[116:119], v[20:23]
    s_add_u32 m0, s38, 38912
    s_add_u32 s39, s35, 131072
    buffer_load_dwordx4 v8, s[16:19], s39 offen lds
    s_waitcnt lgkmcnt(8)
    v_mfma_f32_16x16x32_bf16 v[24:27], a[40:43], a[108:111], v[24:27]
    ds_read_b128 a[4:7], v11 offset:37888
    v_mfma_f32_16x16x32_bf16 v[28:31], a[40:43], a[116:119], v[28:31]
    buffer_load_dwordx4 a[96:99], v9, s[12:15], s33 offen offset:0
    s_waitcnt lgkmcnt(8)
    v_mfma_f32_16x16x32_bf16 v[32:35], a[44:47], a[108:111], v[32:35]
    ds_read_b128 a[8:11], v11 offset:38912
    v_mfma_f32_16x16x32_bf16 v[36:39], a[44:47], a[116:119], v[36:39]
    ds_read_b128 a[12:15], v11 offset:39936
    s_waitcnt lgkmcnt(9)
    v_mfma_f32_16x16x32_bf16 v[40:43], a[48:51], a[108:111], v[40:43]
    s_add_u32 m0, s38, 39936
    s_add_u32 s39, s35, 196608
    buffer_load_dwordx4 v8, s[16:19], s39 offen lds
    v_mfma_f32_16x16x32_bf16 v[44:47], a[48:51], a[116:119], v[44:47]
    ds_read_b128 a[16:19], v11 offset:40960
    s_waitcnt lgkmcnt(9)
    v_mfma_f32_16x16x32_bf16 v[48:51], a[52:55], a[108:111], v[48:51]
    ds_read_b128 a[20:23], v11 offset:41984
    v_mfma_f32_16x16x32_bf16 v[52:55], a[52:55], a[116:119], v[52:55]
    buffer_load_dwordx4 a[100:103], v9, s[12:15], s33 offen offset:1024
    s_add_u32 s33, s33, 2048
    s_waitcnt lgkmcnt(9)
    v_mfma_f32_16x16x32_bf16 v[56:59], a[56:59], a[108:111], v[56:59]
    ds_read_b128 a[24:27], v11 offset:43008
    v_mfma_f32_16x16x32_bf16 v[60:63], a[56:59], a[116:119], v[60:63]
    ds_read_b128 a[28:31], v11 offset:44032
    s_waitcnt lgkmcnt(10)
    v_mfma_f32_16x16x32_bf16 v[64:67], a[60:63], a[108:111], v[64:67]
    s_cmp_ge_u32 s31, 2
    s_cbranch_scc1 K4_skip_6
    s_add_u32 m0, s38, 40960
    s_add_u32 s39, s35, 262144
    buffer_load_dwordx4 v8, s[16:19], s39 offen lds
K4_skip_6:
    s_add_u32 s35, s35, 2048
    v_mfma_f32_16x16x32_bf16 v[68:71], a[60:63], a[116:119], v[68:71]
    ds_read_b128 a[32:35], v11 offset:45056
    s_waitcnt lgkmcnt(10)
    v_mfma_f32_16x16x32_bf16 v[72:75], a[64:67], a[108:111], v[72:75]
    v_mfma_f32_16x16x32_bf16 v[76:79], a[64:67], a[116:119], v[76:79]
    s_waitcnt lgkmcnt(9)
    v_mfma_f32_16x16x32_bf16 v[80:83], a[68:71], a[108:111], v[80:83]
    v_mfma_f32_16x16x32_bf16 v[84:87], a[68:71], a[116:119], v[84:87]
    s_waitcnt vmcnt(8)
    s_barrier
    s_waitcnt lgkmcnt(8)
    v_mfma_f32_16x16x32_bf16 v[16:19], a[0:3], a[120:123], v[16:19]
    ds_read_b128 a[36:39], v11 offset:46080
    v_mfma_f32_16x16x32_bf16 v[20:23], a[0:3], a[128:131], v[20:23]
    buffer_load_dwordx4 a[104:107], v8, s[12:15], s33 offen offset:0
    s_waitcnt lgkmcnt(8)
    v_mfma_f32_16x16x32_bf16 v[24:27], a[4:7], a[120:123], v[24:27]
    ds_read_b128 a[40:43], v11 offset:47104
    v_mfma_f32_16x16x32_bf16 v[28:31], a[4:7], a[128:131], v[28:31]
    ds_read_b128 a[44:47], v11 offset:48128
    s_waitcnt lgkmcnt(9)
    v_mfma_f32_16x16x32_bf16 v[32:35], a[8:11], a[120:123], v[32:35]
    s_add_u32 m0, s38, 73728
    s_add_u32 s39, s35, 0
    buffer_load_dwordx4 v8, s[16:19], s39 offen lds
    v_mfma_f32_16x16x32_bf16 v[36:39], a[8:11], a[128:131], v[36:39]
    ds_read_b128 a[48:51], v11 offset:49152
    s_waitcnt lgkmcnt(9)
    v_mfma_f32_16x16x32_bf16 v[40:43], a[12:15], a[120:123], v[40:43]
    ds_read_b128 a[52:55], v11 offset:50176
    v_mfma_f32_16x16x32_bf16 v[44:47], a[12:15], a[128:131], v[44:47]
    s_add_u32 m0, s38, 74752
    s_add_u32 s39, s35, 65536
    buffer_load_dwordx4 v8, s[16:19], s39 offen lds
    s_waitcnt lgkmcnt(9)
    v_mfma_f32_16x16x32_bf16 v[48:51], a[16:19], a[120:123], v[48:51]
    ds_read_b128 a[56:59], v11 offset:51200
    v_mfma_f32_16x16x32_bf16 v[52:55], a[16:19], a[128:131], v[52:55]
    ds_read_b128 a[60:63], v11 offset:52224
    s_waitcnt lgkmcnt(10)
    v_mfma_f32_16x16x32_bf16 v[56:59], a[20:23], a[120:123], v[56:59]
    buffer_load_dwordx4 a[108:111], v8, s[12:15], s33 offen offset:1024
    v_mfma_f32_16x16x32_bf16 v[60:63], a[20:23], a[128:131], v[60:63]
    ds_read_b128 a[64:67], v11 offset:53248
    s_waitcnt lgkmcnt(10)
    v_mfma_f32_16x16x32_bf16 v[64:67], a[24:27], a[120:123], v[64:67]
    ds_read_b128 a[68:71], v11 offset:54272
    v_mfma_f32_16x16x32_bf16 v[68:71], a[24:27], a[128:131], v[68:71]
    s_waitcnt lgkmcnt(10)
    v_mfma_f32_16x16x32_bf16 v[72:75], a[28:31], a[120:123], v[72:75]
    v_mfma_f32_16x16x32_bf16 v[76:79], a[28:31], a[128:131], v[76:79]
    s_waitcnt lgkmcnt(9)
    v_mfma_f32_16x16x32_bf16 v[80:83], a[32:35], a[120:123], v[80:83]
    v_mfma_f32_16x16x32_bf16 v[84:87], a[32:35], a[128:131], v[84:87]
    s_waitcnt lgkmcnt(8)
    v_mfma_f32_16x16x32_bf16 v[16:19], a[36:39], a[124:127], v[16:19]
    ds_read_b128 a[0:3], v10 offset:0
    v_mfma_f32_16x16x32_bf16 v[20:23], a[36:39], a[132:135], v[20:23]
    s_add_u32 m0, s38, 75776
    s_add_u32 s39, s35, 131072
    buffer_load_dwordx4 v8, s[16:19], s39 offen lds
    s_waitcnt lgkmcnt(8)
    v_mfma_f32_16x16x32_bf16 v[24:27], a[40:43], a[124:127], v[24:27]
    ds_read_b128 a[4:7], v10 offset:1024
    v_mfma_f32_16x16x32_bf16 v[28:31], a[40:43], a[132:135], v[28:31]
    buffer_load_dwordx4 a[112:115], v9, s[12:15], s33 offen offset:0
    s_waitcnt lgkmcnt(8)
    v_mfma_f32_16x16x32_bf16 v[32:35], a[44:47], a[124:127], v[32:35]
    ds_read_b128 a[8:11], v10 offset:2048
    v_mfma_f32_16x16x32_bf16 v[36:39], a[44:47], a[132:135], v[36:39]
    ds_read_b128 a[12:15], v10 offset:3072
    s_waitcnt lgkmcnt(9)
    v_mfma_f32_16x16x32_bf16 v[40:43], a[48:51], a[124:127], v[40:43]
    s_add_u32 m0, s38, 76800
    s_add_u32 s39, s35, 196608
    buffer_load_dwordx4 v8, s[16:19], s39 offen lds
    v_mfma_f32_16x16x32_bf16 v[44:47], a[48:51], a[132:135], v[44:47]
    ds_read_b128 a[16:19], v10 offset:4096
    s_waitcnt lgkmcnt(9)
    v_mfma_f32_16x16x32_bf16 v[48:51], a[52:55], a[124:127], v[48:51]
    ds_read_b128 a[20:23], v10 offset:5120
    v_mfma_f32_16x16x32_bf16 v[52:55], a[52:55], a[132:135], v[52:55]
    buffer_load_dwordx4 a[116:119], v9, s[12:15], s33 offen offset:1024
    s_add_u32 s33, s33, 2048
    s_waitcnt lgkmcnt(9)
    v_mfma_f32_16x16x32_bf16 v[56:59], a[56:59], a[124:127], v[56:59]
    ds_read_b128 a[24:27], v10 offset:6144
    v_mfma_f32_16x16x32_bf16 v[60:63], a[56:59], a[132:135], v[60:63]
    ds_read_b128 a[28:31], v10 offset:7168
    s_waitcnt lgkmcnt(10)
    v_mfma_f32_16x16x32_bf16 v[64:67], a[60:63], a[124:127], v[64:67]
    s_cmp_ge_u32 s31, 2
    s_cbranch_scc1 K4_skip_7
    s_add_u32 m0, s38, 77824
    s_add_u32 s39, s35, 262144
    buffer_load_dwordx4 v8, s[16:19], s39 offen lds
K4_skip_7:
    s_add_u32 s35, s35, 2048
    v_mfma_f32_16x16x32_bf16 v[68:71], a[60:63], a[132:135], v[68:71]
    ds_read_b128 a[32:35], v10 offset:8192
    s_waitcnt lgkmcnt(10)
    v_mfma_f32_16x16x32_bf16 v[72:75], a[64:67], a[124:127], v[72:75]
    v_mfma_f32_16x16x32_bf16 v[76:79], a[64:67], a[132:135], v[76:79]
    s_waitcnt lgkmcnt(9)
    v_mfma_f32_16x16x32_bf16 v[80:83], a[68:71], a[124:127], v[80:83]
    v_mfma_f32_16x16x32_bf16 v[84:87], a[68:71], a[132:135], v[84:87]
    s_waitcnt vmcnt(8)
    s_barrier
    s_waitcnt lgkmcnt(8)
    v_mfma_f32_16x16x32_bf16 v[16:19], a[0:3], a[72:75], v[16:19]
    ds_read_b128 a[36:39], v10 offset:9216
    v_mfma_f32_16x16x32_bf16 v[20:23], a[0:3], a[80:83], v[20:23]
    buffer_load_dwordx4 a[120:123], v8, s[12:15], s33 offen offset:0
    s_waitcnt lgkmcnt(8)
    v_mfma_f32_16x16x32_bf16 v[24:27], a[4:7], a[72:75], v[24:27]
    ds_read_b128 a[40:43], v10 offset:10240
    v_mfma_f32_16x16x32_bf16 v[28:31], a[4:7], a[80:83], v[28:31]
    ds_read_b128 a[44:47], v10 offset:11264
    s_waitcnt lgkmcnt(9)
    v_mfma_f32_16x16x32_bf16 v[32:35], a[8:11], a[72:75], v[32:35]
    s_add_u32 m0, s38, 110592
    s_add_u32 s39, s35, 0
    buffer_load_dwordx4 v8, s[16:19], s39 offen lds
    v_mfma_f32_16x16x32_bf16 v[36:39], a[8:11], a[80:83], v[36:39]
    ds_read_b128 a[48:51], v10 offset:12288
    s_waitcnt lgkmcnt(9)
    v_mfma_f32_16x16x32_bf16 v[40:43], a[12:15], a[72:75], v[40:43]
    ds_read_b128 a[52:55], v10 offset:13312
    v_mfma_f32_16x16x32_bf16 v[44:47], a[12:15], a[80:83], v[44:47]
    s_add_u32 m0, s38, 111616
    s_add_u32 s39, s35, 65536
    buffer_load_dwordx4 v8, s[16:19], s39 offen lds
    s_waitcnt lgkmcnt(9)
    v_mfma_f32_16x16x32_bf16 v[48:51], a[16:19], a[72:75], v[48:51]
    ds_read_b128 a[56:59], v10 offset:14336
    v_mfma_f32_16x16x32_bf16 v[52:55], a[16:19], a[80:83], v[52:55]
    ds_read_b128 a[60:63], v10 offset:15360
    s_waitcnt lgkmcnt(10)
    v_mfma_f32_16x16x32_bf16 v[56:59], a[20:23], a[72:75], v[56:59]
    buffer_load_dwordx4 a[124:127], v8, s[12:15], s33 offen offset:1024
    v_mfma_f32_16x16x32_bf16 v[60:63], a[20:23], a[80:83], v[60:63]
    ds_read_b128 a[64:67], v10 offset:16384
    s_waitcnt lgkmcnt(10)
    v_mfma_f32_16x16x32_bf16 v[64:67], a[24:27], a[72:75], v[64:67]
    ds_read_b128 a[68:71], v10 offset:17408
    v_mfma_f32_16x16x32_bf16 v[68:71], a[24:27], a[80:83], v[68:71]
    s_waitcnt lgkmcnt(10)
    v_mfma_f32_16x16x32_bf16 v[72:75], a[28:31], a[72:75], v[72:75]
    v_mfma_f32_16x16x32_bf16 v[76:79], a[28:31], a[80:83], v[76:79]
    s_waitcnt lgkmcnt(9)
    v_mfma_f32_16x16x32_bf16 v[80:83], a[32:35], a[72:75], v[80:83]
    v_mfma_f32_16x16x32_bf16 v[84:87], a[32:35], a[80:83], v[84:87]
    s_waitcnt lgkmcnt(8)
    v_mfma_f32_16x16x32_bf16 v[16:19], a[36:39], a[76:79], v[16:19]
    ds_read_b128 a[0:3], v10 offset:36864
    v_mfma_f32_16x16x32_bf16 v[20:23], a[36:39], a[84:87], v[20:23]
    s_add_u32 m0, s38, 112640
    s_add_u32 s39, s35, 131072
    buffer_load_dwordx4 v8, s[16:19], s39 offen lds
    s_waitcnt lgkmcnt(8)
    v_mfma_f32_16x16x32_bf16 v[24:27], a[40:43], a[76:79], v[24:27]
    ds_read_b128 a[4:7], v10 offset:37888
    v_mfma_f32_16x16x32_bf16 v[28:31], a[40:43], a[84:87], v[28:31]
    buffer_load_dwordx4 a[128:131], v9, s[12:15], s33 offen offset:0
    s_waitcnt lgkmcnt(8)
    v_mfma_f32_16x16x32_bf16 v[32:35], a[44:47], a[76:79], v[32:35]
    ds_read_b128 a[8:11], v10 offset:38912
    v_mfma_f32_16x16x32_bf16 v[36:39], a[44:47], a[84:87], v[36:39]
    ds_read_b128 a[12:15], v10 offset:39936
    s_waitcnt lgkmcnt(9)
    v_mfma_f32_16x16x32_bf16 v[40:43], a[48:51], a[76:79], v[40:43]
    s_add_u32 m0, s38, 113664
    s_add_u32 s39, s35, 196608
    buffer_load_dwordx4 v8, s[16:19], s39 offen lds
    v_mfma_f32_16x16x32_bf16 v[44:47], a[48:51], a[84:87], v[44:47]
    ds_read_b128 a[16:19], v10 offset:40960
    s_waitcnt lgkmcnt(9)
    v_mfma_f32_16x16x32_bf16 v[48:51], a[52:55], a[76:79], v[48:51]
    ds_read_b128 a[20:23], v10 offset:41984
    v_mfma_f32_16x16x32_bf16 v[52:55], a[52:55], a[84:87], v[52:55]
    buffer_load_dwordx4 a[132:135], v9, s[12:15], s33 offen offset:1024
    s_add_u32 s33, s33, 2048
    s_waitcnt lgkmcnt(9)
    v_mfma_f32_16x16x32_bf16 v[56:59], a[56:59], a[76:79], v[56:59]
    ds_read_b128 a[24:27], v10 offset:43008
    v_mfma_f32_16x16x32_bf16 v[60:63], a[56:59], a[84:87], v[60:63]
    ds_read_b128 a[28:31], v10 offset:44032
    s_waitcnt lgkmcnt(10)
    v_mfma_f32_16x16x32_bf16 v[64:67], a[60:63], a[76:79], v[64:67]
    s_cmp_ge_u32 s31, 2
    s_cbranch_scc1 K4_skip_8
    s_add_u32 m0, s38, 114688
    s_add_u32 s39, s35, 262144
    buffer_load_dwordx4 v8, s[16:19], s39 offen lds
K4_skip_8:
    s_add_u32 s35, s35, 2048
    v_mfma_f32_16x16x32_bf16 v[68:71], a[60:63], a[84:87], v[68:71]
    ds_read_b128 a[32:35], v10 offset:45056
    s_waitcnt lgkmcnt(10)
    v_mfma_f32_16x16x32_bf16 v[72:75], a[64:67], a[76:79], v[72:75]
    v_mfma_f32_16x16x32_bf16 v[76:79], a[64:67], a[84:87], v[76:79]
    s_waitcnt lgkmcnt(9)
    v_mfma_f32_16x16x32_bf16 v[80:83], a[68:71], a[76:79], v[80:83]
    v_mfma_f32_16x16x32_bf16 v[84:87], a[68:71], a[84:87], v[84:87]
    s_waitcnt vmcnt(8)
    s_barrier
    s_waitcnt lgkmcnt(8)
    v_mfma_f32_16x16x32_bf16 v[16:19], a[0:3], a[88:91], v[16:19]
    ds_read_b128 a[36:39], v10 offset:46080
    v_mfma_f32_16x16x32_bf16 v[20:23], a[0:3], a[96:99], v[20:23]
    buffer_load_dwordx4 a[72:75], v8, s[12:15], s33 offen offset:0
    s_waitcnt lgkmcnt(8)
    v_mfma_f32_16x16x32_bf16 v[24:27], a[4:7], a[88:91], v[24:27]
    ds_read_b128 a[40:43], v10 offset:47104
    v_mfma_f32_16x16x32_bf16 v[28:31], a[4:7], a[96:99], v[28:31]
    ds_read_b128 a[44:47], v10 offset:48128
    s_waitcnt lgkmcnt(9)
    v_mfma_f32_16x16x32_bf16 v[32:35], a[8:11], a[88:91], v[32:35]
    s_add_u32 m0, s38, 0
    s_add_u32 s39, s35, 0
    buffer_load_dwordx4 v8, s[16:19], s39 offen lds
    v_mfma_f32_16x16x32_bf16 v[36:39], a[8:11], a[96:99], v[36:39]
    ds_read_b128 a[48:51], v10 offset:49152
    s_waitcnt lgkmcnt(9)
    v_mfma_f32_16x16x32_bf16 v[40:43], a[12:15], a[88:91], v[40:43]
    ds_read_b128 a[52:55], v10 offset:50176
    v_mfma_f32_16x16x32_bf16 v[44:47], a[12:15], a[96:99], v[44:47]
    s_add_u32 m0, s38, 1024
    s_add_u32 s39, s35, 65536
    buffer_load_dwordx4 v8, s[16:19], s39 offen lds
    s_waitcnt lgkmcnt(9)
    v_mfma_f32_16x16x32_bf16 v[48:51], a[16:19], a[88:91], v[48:51]
    ds_read_b128 a[56:59], v10 offset:51200
    v_mfma_f32_16x16x32_bf16 v[52:55], a[16:19], a[96:99], v[52:55]
    ds_read_b128 a[60:63], v10 offset:52224
    s_waitcnt lgkmcnt(10)
    v_mfma_f32_16x16x32_bf16 v[56:59], a[20:23], a[88:91], v[56:59]
    buffer_load_dwordx4 a[76:79], v8, s[12:15], s33 offen offset:1024
    v_mfma_f32_16x16x32_bf16 v[60:63], a[20:23], a[96:99], v[60:63]
    ds_read_b128 a[64:67], v10 offset:53248
    s_waitcnt lgkmcnt(10)
    v_mfma_f32_16x16x32_bf16 v[64:67], a[24:27], a[88:91], v[64:67]
    ds_read_b128 a[68:71], v10 offset:54272
    v_mfma_f32_16x16x32_bf16 v[68:71], a[24:27], a[96:99], v[68:71]
    s_waitcnt lgkmcnt(10)
    v_mfma_f32_16x16x32_bf16 v[72:75], a[28:31], a[88:91], v[72:75]
    v_mfma_f32_16x16x32_bf16 v[76:79], a[28:31], a[96:99], v[76:79]
    s_waitcnt lgkmcnt(9)
    v_mfma_f32_16x16x32_bf16 v[80:83], a[32:35], a[88:91], v[80:83]
    v_mfma_f32_16x16x32_bf16 v[84:87], a[32:35], a[96:99], v[84:87]
    s_waitcnt lgkmcnt(8)
    v_mfma_f32_16x16x32_bf16 v[16:19], a[36:39], a[92:95], v[16:19]
    ds_read_b128 a[0:3], v11 offset:0
    v_mfma_f32_16x16x32_bf16 v[20:23], a[36:39], a[100:103], v[20:23]
    s_add_u32 m0, s38, 2048
    s_add_u32 s39, s35, 131072
    buffer_load_dwordx4 v8, s[16:19], s39 offen lds
    s_waitcnt lgkmcnt(8)
    v_mfma_f32_16x16x32_bf16 v[24:27], a[40:43], a[92:95], v[24:27]
    ds_read_b128 a[4:7], v11 offset:1024
    v_mfma_f32_16x16x32_bf16 v[28:31], a[40:43], a[100:103], v[28:31]
    buffer_load_dwordx4 a[80:83], v9, s[12:15], s33 offen offset:0
    s_waitcnt lgkmcnt(8)
    v_mfma_f32_16x16x32_bf16 v[32:35], a[44:47], a[92:95], v[32:35]
    ds_read_b128 a[8:11], v11 offset:2048
    v_mfma_f32_16x16x32_bf16 v[36:39], a[44:47], a[100:103], v[36:39]
    ds_read_b128 a[12:15], v11 offset:3072
    s_waitcnt lgkmcnt(9)
    v_mfma_f32_16x16x32_bf16 v[40:43], a[48:51], a[92:95], v[40:43]
    s_add_u32 m0, s38, 3072
    s_add_u32 s39, s35, 196608
    buffer_load_dwordx4 v8, s[16:19], s39 offen lds
    v_mfma_f32_16x16x32_bf16 v[44:47], a[48:51], a[100:103], v[44:47]
    ds_read_b128 a[16:19], v11 offset:4096
    s_waitcnt lgkmcnt(9)
    v_mfma_f32_16x16x32_bf16 v[48:51], a[52:55], a[92:95], v[48:51]
    ds_read_b128 a[20:23], v11 offset:5120
    v_mfma_f32_16x16x32_bf16 v[52:55], a[52:55], a[100:103], v[52:55]
    buffer_load_dwordx4 a[84:87], v9, s[12:15], s33 offen offset:1024
    s_add_u32 s33, s33, 2048
    s_waitcnt lgkmcnt(9)
    v_mfma_f32_16x16x32_bf16 v[56:59], a[56:59], a[92:95], v[56:59]
    ds_read_b128 a[24:27], v11 offset:6144
    v_mfma_f32_16x16x32_bf16 v[60:63], a[56:59], a[100:103], v[60:63]
    ds_read_b128 a[28:31], v11 offset:7168
    s_waitcnt lgkmcnt(10)
    v_mfma_f32_16x16x32_bf16 v[64:67], a[60:63], a[92:95], v[64:67]
    s_cmp_ge_u32 s31, 2
    s_cbranch_scc1 K4_skip_9
    s_add_u32 m0, s38, 4096
    s_add_u32 s39, s35, 262144
    buffer_load_dwordx4 v8, s[16:19], s39 offen lds
K4_skip_9:
    s_add_u32 s35, s35, 2048
    v_mfma_f32_16x16x32_bf16 v[68:71], a[60:63], a[100:103], v[68:71]
    ds_read_b128 a[32:35], v11 offset:8192
    s_waitcnt lgkmcnt(10)
    v_mfma_f32_16x16x32_bf16 v[72:75], a[64:67], a[92:95], v[72:75]
    v_mfma_f32_16x16x32_bf16 v[76:79], a[64:67], a[100:103], v[76:79]
    s_waitcnt lgkmcnt(9)
    v_mfma_f32_16x16x32_bf16 v[80:83], a[68:71], a[92:95], v[80:83]
    v_mfma_f32_16x16x32_bf16 v[84:87], a[68:71], a[100:103], v[84:87]
    s_waitcnt vmcnt(8)
    s_barrier
    s_waitcnt lgkmcnt(8)
    v_mfma_f32_16x16x32_bf16 v[16:19], a[0:3], a[104:107], v[16:19]
    ds_read_b128 a[36:39], v11 offset:9216
    v_mfma_f32_16x16x32_bf16 v[20:23], a[0:3], a[112:115], v[20:23]
    buffer_load_dwordx4 a[88:91], v8, s[12:15], s33 offen offset:0
    s_waitcnt lgkmcnt(8)
    v_mfma_f32_16x16x32_bf16 v[24:27], a[4:7], a[104:107], v[24:27]
    ds_read_b128 a[40:43], v11 offset:10240
    v_mfma_f32_16x16x32_bf16 v[28:31], a[4:7], a[112:115], v[28:31]
    ds_read_b128 a[44:47], v11 offset:11264
    s_waitcnt lgkmcnt(9)
    v_mfma_f32_16x16x32_bf16 v[32:35], a[8:11], a[104:107], v[32:35]
    s_add_u32 m0, s38, 36864
    s_add_u32 s39, s35, 0
    buffer_load_dwordx4 v8, s[16:19], s39 offen lds
    v_mfma_f32_16x16x32_bf16 v[36:39], a[8:11], a[112:115], v[36:39]
    ds_read_b128 a[48:51], v11 offset:12288
    s_waitcnt lgkmcnt(9)
    v_mfma_f32_16x16x32_bf16 v[40:43], a[12:15], a[104:107], v[40:43]
    ds_read_b128 a[52:55], v11 offset:13312
    v_mfma_f32_16x16x32_bf16 v[44:47], a[12:15], a[112:115], v[44:47]
    s_add_u32 m0, s38, 37888
    s_add_u32 s39, s35, 65536
    buffer_load_dwordx4 v8, s[16:19], s39 offen lds
    s_waitcnt lgkmcnt(9)
    v_mfma_f32_16x16x32_bf16 v[48:51], a[16:19], a[104:107], v[48:51]
    ds_read_b128 a[56:59], v11 offset:14336
    v_mfma_f32_16x16x32_bf16 v[52:55], a[16:19], a[112:115], v[52:55]
    ds_read_b128 a[60:63], v11 offset:15360
    s_waitcnt lgkmcnt(10)
    v_mfma_f32_16x16x32_bf16 v[56:59], a[20:23], a[104:107], v[56:59]
    buffer_load_dwordx4 a[92:95], v8, s[12:15], s33 offen offset:1024
    v_mfma_f32_16x16x32_bf16 v[60:63], a[20:23], a[112:115], v[60:63]
    ds_read_b128 a[64:67], v11 offset:16384
    s_waitcnt lgkmcnt(10)
    v_mfma_f32_16x16x32_bf16 v[64:67], a[24:27], a[104:107], v[64:67]
    ds_read_b128 a[68:71], v11 offset:17408
    v_mfma_f32_16x16x32_bf16 v[68:71], a[24:27], a[112:115], v[68:71]
    s_waitcnt lgkmcnt(10)
    v_mfma_f32_16x16x32_bf16 v[72:75], a[28:31], a[104:107], v[72:75]
    v_mfma_f32_16x16x32_bf16 v[76:79], a[28:31], a[112:115], v[76:79]
    s_waitcnt lgkmcnt(9)
    v_mfma_f32_16x16x32_bf16 v[80:83], a[32:35], a[104:107], v[80:83]
    v_mfma_f32_16x16x32_bf16 v[84:87], a[32:35], a[112:115], v[84:87]
    s_waitcnt lgkmcnt(8)
    v_mfma_f32_16x16x32_bf16 v[16:19], a[36:39], a[108:111], v[16:19]
    ds_read_b128 a[0:3], v11 offset:36864
    v_mfma_f32_16x16x32_bf16 v[20:23], a[36:39], a[116:119], v[20:23]
    s_add_u32 m0, s38, 38912
    s_add_u32 s39, s35, 131072
    buffer_load_dwordx4 v8, s[16:19], s39 offen lds
    s_waitcnt lgkmcnt(8)
    v_mfma_f32_16x16x32_bf16 v[24:27], a[40:43], a[108:111], v[24:27]
    ds_read_b128 a[4:7], v11 offset:37888
    v_mfma_f32_16x16x32_bf16 v[28:31], a[40:43], a[116:119], v[28:31]
    buffer_load_dwordx4 a[96:99], v9, s[12:15], s33 offen offset:0
    s_waitcnt lgkmcnt(8)
    v_mfma_f32_16x16x32_bf16 v[32:35], a[44:47], a[108:111], v[32:35]
    ds_read_b128 a[8:11], v11 offset:38912
    v_mfma_f32_16x16x32_bf16 v[36:39], a[44:47], a[116:119], v[36:39]
    ds_read_b128 a[12:15], v11 offset:39936
    s_waitcnt lgkmcnt(9)
    v_mfma_f32_16x16x32_bf16 v[40:43], a[48:51], a[108:111], v[40:43]
    s_add_u32 m0, s38, 39936
    s_add_u32 s39, s35, 196608
    buffer_load_dwordx4 v8, s[16:19], s39 offen lds
    v_mfma_f32_16x16x32_bf16 v[44:47], a[48:51], a[116:119], v[44:47]
    ds_read_b128 a[16:19], v11 offset:40960
    s_waitcnt lgkmcnt(9)
    v_mfma_f32_16x16x32_bf16 v[48:51], a[52:55], a[108:111], v[48:51]
    ds_read_b128 a[20:23], v11 offset:41984
    v_mfma_f32_16x16x32_bf16 v[52:55], a[52:55], a[116:119], v[52:55]
    buffer_load_dwordx4 a[100:103], v9, s[12:15], s33 offen offset:1024
    s_add_u32 s33, s33, 2048
    s_waitcnt lgkmcnt(9)
    v_mfma_f32_16x16x32_bf16 v[56:59], a[56:59], a[108:111], v[56:59]
    ds_read_b128 a[24:27], v11 offset:43008
    v_mfma_f32_16x16x32_bf16 v[60:63], a[56:59], a[116:119], v[60:63]
    ds_read_b128 a[28:31], v11 offset:44032
    s_waitcnt lgkmcnt(10)
    v_mfma_f32_16x16x32_bf16 v[64:67], a[60:63], a[108:111], v[64:67]
    s_cmp_ge_u32 s31, 2
    s_cbranch_scc1 K4_skip_10
    s_add_u32 m0, s38, 40960
    s_add_u32 s39, s35, 262144
    buffer_load_dwordx4 v8, s[16:19], s39 offen lds
K4_skip_10:
    s_add_u32 s35, s35, 2048
    v_mfma_f32_16x16x32_bf16 v[68:71], a[60:63], a[116:119], v[68:71]
    ds_read_b128 a[32:35], v11 offset:45056
    s_waitcnt lgkmcnt(10)
    v_mfma_f32_16x16x32_bf16 v[72:75], a[64:67], a[108:111], v[72:75]
    v_mfma_f32_16x16x32_bf16 v[76:79], a[64:67], a[116:119], v[76:79]
    s_waitcnt lgkmcnt(9)
    v_mfma_f32_16x16x32_bf16 v[80:83], a[68:71], a[108:111], v[80:83]
    v_mfma_f32_16x16x32_bf16 v[84:87], a[68:71], a[116:119], v[84:87]
    s_waitcnt vmcnt(8)
    s_barrier
    s_waitcnt lgkmcnt(8)
    v_mfma_f32_16x16x32_bf16 v[16:19], a[0:3], a[120:123], v[16:19]
    ds_read_b128 a[36:39], v11 offset:46080
    v_mfma_f32_16x16x32_bf16 v[20:23], a[0:3], a[128:131], v[20:23]
    buffer_load_dwordx4 a[104:107], v8, s[12:15], s33 offen offset:0
    s_waitcnt lgkmcnt(8)
    v_mfma_f32_16x16x32_bf16 v[24:27], a[4:7], a[120:123], v[24:27]
    ds_read_b128 a[40:43], v11 offset:47104
    v_mfma_f32_16x16x32_bf16 v[28:31], a[4:7], a[128:131], v[28:31]
    ds_read_b128 a[44:47], v11 offset:48128
    s_waitcnt lgkmcnt(9)
    v_mfma_f32_16x16x32_bf16 v[32:35], a[8:11], a[120:123], v[32:35]
    s_add_u32 m0, s38, 73728
    s_add_u32 s39, s35, 0
    buffer_load_dwordx4 v8, s[16:19], s39 offen lds
    v_mfma_f32_16x16x32_bf16 v[36:39], a[8:11], a[128:131], v[36:39]
    ds_read_b128 a[48:51], v11 offset:49152
    s_waitcnt lgkmcnt(9)
    v_mfma_f32_16x16x32_bf16 v[40:43], a[12:15], a[120:123], v[40:43]
    ds_read_b128 a[52:55], v11 offset:50176
    v_mfma_f32_16x16x32_bf16 v[44:47], a[12:15], a[128:131], v[44:47]
    s_add_u32 m0, s38, 74752
    s_add_u32 s39, s35, 65536
    buffer_load_dwordx4 v8, s[16:19], s39 offen lds
    s_waitcnt lgkmcnt(9)
    v_mfma_f32_16x16x32_bf16 v[48:51], a[16:19], a[120:123], v[48:51]
    ds_read_b128 a[56:59], v11 offset:51200
    v_mfma_f32_16x16x32_bf16 v[52:55], a[16:19], a[128:131], v[52:55]
    ds_read_b128 a[60:63], v11 offset:52224
    s_waitcnt lgkmcnt(10)
    v_mfma_f32_16x16x32_bf16 v[56:59], a[20:23], a[120:123], v[56:59]
    buffer_load_dwordx4 a[108:111], v8, s[12:15], s33 offen offset:1024
    v_mfma_f32_16x16x32_bf16 v[60:63], a[20:23], a[128:131], v[60:63]
    ds_read_b128 a[64:67], v11 offset:53248
    s_waitcnt lgkmcnt(10)
    v_mfma_f32_16x16x32_bf16 v[64:67], a[24:27], a[120:123], v[64:67]
    ds_read_b128 a[68:71], v11 offset:54272
    v_mfma_f32_16x16x32_bf16 v[68:71], a[24:27], a[128:131], v[68:71]
    s_waitcnt lgkmcnt(10)
    v_mfma_f32_16x16x32_bf16 v[72:75], a[28:31], a[120:123], v[72:75]
    v_mfma_f32_16x16x32_bf16 v[76:79], a[28:31], a[128:131], v[76:79]
    s_waitcnt lgkmcnt(9)
    v_mfma_f32_16x16x32_bf16 v[80:83], a[32:35], a[120:123], v[80:83]
    v_mfma_f32_16x16x32_bf16 v[84:87], a[32:35], a[128:131], v[84:87]
    s_waitcnt lgkmcnt(8)
    v_mfma_f32_16x16x32_bf16 v[16:19], a[36:39], a[124:127], v[16:19]
    ds_read_b128 a[0:3], v10 offset:0
    v_mfma_f32_16x16x32_bf16 v[20:23], a[36:39], a[132:135], v[20:23]
    s_add_u32 m0, s38, 75776
    s_add_u32 s39, s35, 131072
    buffer_load_dwordx4 v8, s[16:19], s39 offen lds
    s_waitcnt lgkmcnt(8)
    v_mfma_f32_16x16x32_bf16 v[24:27], a[40:43], a[124:127], v[24:27]
    ds_read_b128 a[4:7], v10 offset:1024
    v_mfma_f32_16x16x32_bf16 v[28:31], a[40:43], a[132:135], v[28:31]
    buffer_load_dwordx4 a[112:115], v9, s[12:15], s33 offen offset:0
    s_waitcnt lgkmcnt(8)
    v_mfma_f32_16x16x32_bf16 v[32:35], a[44:47], a[124:127], v[32:35]
    ds_read_b128 a[8:11], v10 offset:2048
    v_mfma_f32_16x16x32_bf16 v[36:39], a[44:47], a[132:135], v[36:39]
    ds_read_b128 a[12:15], v10 offset:3072
    s_waitcnt lgkmcnt(9)
    v_mfma_f32_16x16x32_bf16 v[40:43], a[48:51], a[124:127], v[40:43]
    s_add_u32 m0, s38, 76800
    s_add_u32 s39, s35, 196608
    buffer_load_dwordx4 v8, s[16:19], s39 offen lds
    v_mfma_f32_16x16x32_bf16 v[44:47], a[48:51], a[132:135], v[44:47]
    ds_read_b128 a[16:19], v10 offset:4096
    s_waitcnt lgkmcnt(9)
    v_mfma_f32_16x16x32_bf16 v[48:51], a[52:55], a[124:127], v[48:51]
    ds_read_b128 a[20:23], v10 offset:5120
    v_mfma_f32_16x16x32_bf16 v[52:55], a[52:55], a[132:135], v[52:55]
    buffer_load_dwordx4 a[116:119], v9, s[12:15], s33 offen offset:1024
    s_add_u32 s33, s33, 2048
    s_waitcnt lgkmcnt(9)
    v_mfma_f32_16x16x32_bf16 v[56:59], a[56:59], a[124:127], v[56:59]
    ds_read_b128 a[24:27], v10 offset:6144
    v_mfma_f32_16x16x32_bf16 v[60:63], a[56:59], a[132:135], v[60:63]
    ds_read_b128 a[28:31], v10 offset:7168
    s_waitcnt lgkmcnt(10)
    v_mfma_f32_16x16x32_bf16 v[64:67], a[60:63], a[124:127], v[64:67]
    s_cmp_ge_u32 s31, 2
    s_cbranch_scc1 K4_skip_11
    s_add_u32 m0, s38, 77824
    s_add_u32 s39, s35, 262144
    buffer_load_dwordx4 v8, s[16:19], s39 offen lds
K4_skip_11:
    s_add_u32 s35, s35, 2048
    v_mfma_f32_16x16x32_bf16 v[68:71], a[60:63], a[132:135], v[68:71]
    ds_read_b128 a[32:35], v10 offset:8192
    s_waitcnt lgkmcnt(10)
    v_mfma_f32_16x16x32_bf16 v[72:75], a[64:67], a[124:127], v[72:75]
    v_mfma_f32_16x16x32_bf16 v[76:79], a[64:67], a[132:135], v[76:79]
    s_waitcnt lgkmcnt(9)
    v_mfma_f32_16x16x32_bf16 v[80:83], a[68:71], a[124:127], v[80:83]
    v_mfma_f32_16x16x32_bf16 v[84:87], a[68:71], a[132:135], v[84:87]
    s_waitcnt vmcnt(8)
    s_barrier
    s_waitcnt lgkmcnt(8)
    v_mfma_f32_16x16x32_bf16 v[16:19], a[0:3], a[72:75], v[16:19]
    ds_read_b128 a[36:39], v10 offset:9216
    v_mfma_f32_16x16x32_bf16 v[20:23], a[0:3], a[80:83], v[20:23]
    buffer_load_dwordx4 a[120:123], v8, s[12:15], s33 offen offset:0
    s_waitcnt lgkmcnt(8)
    v_mfma_f32_16x16x32_bf16 v[24:27], a[4:7], a[72:75], v[24:27]
    ds_read_b128 a[40:43], v10 offset:10240
    v_mfma_f32_16x16x32_bf16 v[28:31], a[4:7], a[80:83], v[28:31]
    ds_read_b128 a[44:47], v10 offset:11264
    s_waitcnt lgkmcnt(9)
    v_mfma_f32_16x16x32_bf16 v[32:35], a[8:11], a[72:75], v[32:35]
    s_add_u32 m0, s38, 110592
    s_add_u32 s39, s35, 0
    buffer_load_dwordx4 v8, s[16:19], s39 offen lds
    v_mfma_f32_16x16x32_bf16 v[36:39], a[8:11], a[80:83], v[36:39]
    ds_read_b128 a[48:51], v10 offset:12288
    s_waitcnt lgkmcnt(9)
    v_mfma_f32_16x16x32_bf16 v[40:43], a[12:15], a[72:75], v[40:43]
    ds_read_b128 a[52:55], v10 offset:13312
    v_mfma_f32_16x16x32_bf16 v[44:47], a[12:15], a[80:83], v[44:47]
    s_add_u32 m0, s38, 111616
    s_add_u32 s39, s35, 65536
    buffer_load_dwordx4 v8, s[16:19], s39 offen lds
    s_waitcnt lgkmcnt(9)
    v_mfma_f32_16x16x32_bf16 v[48:51], a[16:19], a[72:75], v[48:51]
    ds_read_b128 a[56:59], v10 offset:14336
    v_mfma_f32_16x16x32_bf16 v[52:55], a[16:19], a[80:83], v[52:55]
    ds_read_b128 a[60:63], v10 offset:15360
    s_waitcnt lgkmcnt(10)
    v_mfma_f32_16x16x32_bf16 v[56:59], a[20:23], a[72:75], v[56:59]
    buffer_load_dwordx4 a[124:127], v8, s[12:15], s33 offen offset:1024
    v_mfma_f32_16x16x32_bf16 v[60:63], a[20:23], a[80:83], v[60:63]
    ds_read_b128 a[64:67], v10 offset:16384
    s_waitcnt lgkmcnt(10)
    v_mfma_f32_16x16x32_bf16 v[64:67], a[24:27], a[72:75], v[64:67]
    ds_read_b128 a[68:71], v10 offset:17408
    v_mfma_f32_16x16x32_bf16 v[68:71], a[24:27], a[80:83], v[68:71]
    s_waitcnt lgkmcnt(10)
    v_mfma_f32_16x16x32_bf16 v[72:75], a[28:31], a[72:75], v[72:75]
    v_mfma_f32_16x16x32_bf16 v[76:79], a[28:31], a[80:83], v[76:79]
    s_waitcnt lgkmcnt(9)
    v_mfma_f32_16x16x32_bf16 v[80:83], a[32:35], a[72:75], v[80:83]
    v_mfma_f32_16x16x32_bf16 v[84:87], a[32:35], a[80:83], v[84:87]
    s_waitcnt lgkmcnt(8)
    v_mfma_f32_16x16x32_bf16 v[16:19], a[36:39], a[76:79], v[16:19]
    ds_read_b128 a[0:3], v10 offset:36864
    v_mfma_f32_16x16x32_bf16 v[20:23], a[36:39], a[84:87], v[20:23]
    s_add_u32 m0, s38, 112640
    s_add_u32 s39, s35, 131072
    buffer_load_dwordx4 v8, s[16:19], s39 offen lds
    s_waitcnt lgkmcnt(8)
    v_mfma_f32_16x16x32_bf16 v[24:27], a[40:43], a[76:79], v[24:27]
    ds_read_b128 a[4:7], v10 offset:37888
    v_mfma_f32_16x16x32_bf16 v[28:31], a[40:43], a[84:87], v[28:31]
    buffer_load_dwordx4 a[128:131], v9, s[12:15], s33 offen offset:0
    s_waitcnt lgkmcnt(8)
    v_mfma_f32_16x16x32_bf16 v[32:35], a[44:47], a[76:79], v[32:35]
    ds_read_b128 a[8:11], v10 offset:38912
    v_mfma_f32_16x16x32_bf16 v[36:39], a[44:47], a[84:87], v[36:39]
    ds_read_b128 a[12:15], v10 offset:39936
    s_waitcnt lgkmcnt(9)
    v_mfma_f32_16x16x32_bf16 v[40:43], a[48:51], a[76:79], v[40:43]
    s_add_u32 m0, s38, 113664
    s_add_u32 s39, s35, 196608
    buffer_load_dwordx4 v8, s[16:19], s39 offen lds
    v_mfma_f32_16x16x32_bf16 v[44:47], a[48:51], a[84:87], v[44:47]
    ds_read_b128 a[16:19], v10 offset:40960
    s_waitcnt lgkmcnt(9)
    v_mfma_f32_16x16x32_bf16 v[48:51], a[52:55], a[76:79], v[48:51]
    ds_read_b128 a[20:23], v10 offset:41984
    v_mfma_f32_16x16x32_bf16 v[52:55], a[52:55], a[84:87], v[52:55]
    buffer_load_dwordx4 a[132:135], v9, s[12:15], s33 offen offset:1024
    s_add_u32 s33, s33, 2048
    s_waitcnt lgkmcnt(9)
    v_mfma_f32_16x16x32_bf16 v[56:59], a[56:59], a[76:79], v[56:59]
    ds_read_b128 a[24:27], v10 offset:43008
    v_mfma_f32_16x16x32_bf16 v[60:63], a[56:59], a[84:87], v[60:63]
    ds_read_b128 a[28:31], v10 offset:44032
    s_waitcnt lgkmcnt(10)
    v_mfma_f32_16x16x32_bf16 v[64:67], a[60:63], a[76:79], v[64:67]
    s_cmp_ge_u32 s31, 2
    s_cbranch_scc1 K4_skip_12
    s_add_u32 m0, s38, 114688
    s_add_u32 s39, s35, 262144
    buffer_load_dwordx4 v8, s[16:19], s39 offen lds
K4_skip_12:
    s_add_u32 s35, s35, 2048
    v_mfma_f32_16x16x32_bf16 v[68:71], a[60:63], a[84:87], v[68:71]
    ds_read_b128 a[32:35], v10 offset:45056
    s_waitcnt lgkmcnt(10)
    v_mfma_f32_16x16x32_bf16 v[72:75], a[64:67], a[76:79], v[72:75]
    v_mfma_f32_16x16x32_bf16 v[76:79], a[64:67], a[84:87], v[76:79]
    s_waitcnt lgkmcnt(9)
    v_mfma_f32_16x16x32_bf16 v[80:83], a[68:71], a[76:79], v[80:83]
    v_mfma_f32_16x16x32_bf16 v[84:87], a[68:71], a[84:87], v[84:87]
    s_waitcnt vmcnt(8)
    s_barrier
    s_waitcnt lgkmcnt(8)
    v_mfma_f32_16x16x32_bf16 v[16:19], a[0:3], a[88:91], v[16:19]
    ds_read_b128 a[36:39], v10 offset:46080
    v_mfma_f32_16x16x32_bf16 v[20:23], a[0:3], a[96:99], v[20:23]
    buffer_load_dwordx4 a[72:75], v8, s[12:15], s33 offen offset:0
    s_waitcnt lgkmcnt(8)
    v_mfma_f32_16x16x32_bf16 v[24:27], a[4:7], a[88:91], v[24:27]
    ds_read_b128 a[40:43], v10 offset:47104
    v_mfma_f32_16x16x32_bf16 v[28:31], a[4:7], a[96:99], v[28:31]
    ds_read_b128 a[44:47], v10 offset:48128
    s_waitcnt lgkmcnt(9)
    v_mfma_f32_16x16x32_bf16 v[32:35], a[8:11], a[88:91], v[32:35]
    s_add_u32 m0, s38, 0
    s_add_u32 s39, s35, 0
    buffer_load_dwordx4 v8, s[16:19], s39 offen lds
    v_mfma_f32_16x16x32_bf16 v[36:39], a[8:11], a[96:99], v[36:39]
    ds_read_b128 a[48:51], v10 offset:49152
    s_waitcnt lgkmcnt(9)
    v_mfma_f32_16x16x32_bf16 v[40:43], a[12:15], a[88:91], v[40:43]
    ds_read_b128 a[52:55], v10 offset:50176
    v_mfma_f32_16x16x32_bf16 v[44:47], a[12:15], a[96:99], v[44:47]
    s_add_u32 m0, s38, 1024
    s_add_u32 s39, s35, 65536
    buffer_load_dwordx4 v8, s[16:19], s39 offen lds
    s_waitcnt lgkmcnt(9)
    v_mfma_f32_16x16x32_bf16 v[48:51], a[16:19], a[88:91], v[48:51]
    ds_read_b128 a[56:59], v10 offset:51200
    v_mfma_f32_16x16x32_bf16 v[52:55], a[16:19], a[96:99], v[52:55]
    ds_read_b128 a[60:63], v10 offset:52224
    s_waitcnt lgkmcnt(10)
    v_mfma_f32_16x16x32_bf16 v[56:59], a[20:23], a[88:91], v[56:59]
    buffer_load_dwordx4 a[76:79], v8, s[12:15], s33 offen offset:1024
    v_mfma_f32_16x16x32_bf16 v[60:63], a[20:23], a[96:99], v[60:63]
    ds_read_b128 a[64:67], v10 offset:53248
    s_waitcnt lgkmcnt(10)
    v_mfma_f32_16x16x32_bf16 v[64:67], a[24:27], a[88:91], v[64:67]
    ds_read_b128 a[68:71], v10 offset:54272
    v_mfma_f32_16x16x32_bf16 v[68:71], a[24:27], a[96:99], v[68:71]
    s_waitcnt lgkmcnt(10)
    v_mfma_f32_16x16x32_bf16 v[72:75], a[28:31], a[88:91], v[72:75]
    v_mfma_f32_16x16x32_bf16 v[76:79], a[28:31], a[96:99], v[76:79]
    s_waitcnt lgkmcnt(9)
    v_mfma_f32_16x16x32_bf16 v[80:83], a[32:35], a[88:91], v[80:83]
    v_mfma_f32_16x16x32_bf16 v[84:87], a[32:35], a[96:99], v[84:87]
    s_waitcnt lgkmcnt(8)
    v_mfma_f32_16x16x32_bf16 v[16:19], a[36:39], a[92:95], v[16:19]
    ds_read_b128 a[0:3], v11 offset:0
    v_mfma_f32_16x16x32_bf16 v[20:23], a[36:39], a[100:103], v[20:23]
    s_add_u32 m0, s38, 2048
    s_add_u32 s39, s35, 131072
    buffer_load_dwordx4 v8, s[16:19], s39 offen lds
    s_waitcnt lgkmcnt(8)
    v_mfma_f32_16x16x32_bf16 v[24:27], a[40:43], a[92:95], v[24:27]
    ds_read_b128 a[4:7], v11 offset:1024
    v_mfma_f32_16x16x32_bf16 v[28:31], a[40:43], a[100:103], v[28:31]
    buffer_load_dwordx4 a[80:83], v9, s[12:15], s33 offen offset:0
    s_waitcnt lgkmcnt(8)
    v_mfma_f32_16x16x32_bf16 v[32:35], a[44:47], a[92:95], v[32:35]
    ds_read_b128 a[8:11], v11 offset:2048
    v_mfma_f32_16x16x32_bf16 v[36:39], a[44:47], a[100:103], v[36:39]
    ds_read_b128 a[12:15], v11 offset:3072
    s_waitcnt lgkmcnt(9)
    v_mfma_f32_16x16x32_bf16 v[40:43], a[48:51], a[92:95], v[40:43]
    s_add_u32 m0, s38, 3072
    s_add_u32 s39, s35, 196608
    buffer_load_dwordx4 v8, s[16:19], s39 offen lds
    v_mfma_f32_16x16x32_bf16 v[44:47], a[48:51], a[100:103], v[44:47]
    ds_read_b128 a[16:19], v11 offset:4096
    s_waitcnt lgkmcnt(9)
    v_mfma_f32_16x16x32_bf16 v[48:51], a[52:55], a[92:95], v[48:51]
    ds_read_b128 a[20:23], v11 offset:5120
    v_mfma_f32_16x16x32_bf16 v[52:55], a[52:55], a[100:103], v[52:55]
    buffer_load_dwordx4 a[84:87], v9, s[12:15], s33 offen offset:1024
    s_add_u32 s33, s33, 2048
    s_waitcnt lgkmcnt(9)
    v_mfma_f32_16x16x32_bf16 v[56:59], a[56:59], a[92:95], v[56:59]
    ds_read_b128 a[24:27], v11 offset:6144
    v_mfma_f32_16x16x32_bf16 v[60:63], a[56:59], a[100:103], v[60:63]
    ds_read_b128 a[28:31], v11 offset:7168
    s_waitcnt lgkmcnt(10)
    v_mfma_f32_16x16x32_bf16 v[64:67], a[60:63], a[92:95], v[64:67]
    s_cmp_ge_u32 s31, 2
    s_cbranch_scc1 K4_skip_13
    s_add_u32 m0, s38, 4096
    s_add_u32 s39, s35, 262144
    buffer_load_dwordx4 v8, s[16:19], s39 offen lds
K4_skip_13:
    s_add_u32 s35, s35, 2048
    v_mfma_f32_16x16x32_bf16 v[68:71], a[60:63], a[100:103], v[68:71]
    ds_read_b128 a[32:35], v11 offset:8192
    s_waitcnt lgkmcnt(10)
    v_mfma_f32_16x16x32_bf16 v[72:75], a[64:67], a[92:95], v[72:75]
    v_mfma_f32_16x16x32_bf16 v[76:79], a[64:67], a[100:103], v[76:79]
    s_waitcnt lgkmcnt(9)
    v_mfma_f32_16x16x32_bf16 v[80:83], a[68:71], a[92:95], v[80:83]
    v_mfma_f32_16x16x32_bf16 v[84:87], a[68:71], a[100:103], v[84:87]
    s_waitcnt vmcnt(8)
    s_barrier
    s_waitcnt lgkmcnt(8)
    v_mfma_f32_16x16x32_bf16 v[16:19], a[0:3], a[104:107], v[16:19]
    ds_read_b128 a[36:39], v11 offset:9216
    v_mfma_f32_16x16x32_bf16 v[20:23], a[0:3], a[112:115], v[20:23]
    buffer_load_dwordx4 a[88:91], v8, s[12:15], s33 offen offset:0
    s_waitcnt lgkmcnt(8)
    v_mfma_f32_16x16x32_bf16 v[24:27], a[4:7], a[104:107], v[24:27]
    ds_read_b128 a[40:43], v11 offset:10240
    v_mfma_f32_16x16x32_bf16 v[28:31], a[4:7], a[112:115], v[28:31]
    ds_read_b128 a[44:47], v11 offset:11264
    s_waitcnt lgkmcnt(9)
    v_mfma_f32_16x16x32_bf16 v[32:35], a[8:11], a[104:107], v[32:35]
    s_add_u32 m0, s38, 36864
    s_add_u32 s39, s35, 0
    buffer_load_dwordx4 v8, s[16:19], s39 offen lds
    v_mfma_f32_16x16x32_bf16 v[36:39], a[8:11], a[112:115], v[36:39]
    ds_read_b128 a[48:51], v11 offset:12288
    s_waitcnt lgkmcnt(9)
    v_mfma_f32_16x16x32_bf16 v[40:43], a[12:15], a[104:107], v[40:43]
    ds_read_b128 a[52:55], v11 offset:13312
    v_mfma_f32_16x16x32_bf16 v[44:47], a[12:15], a[112:115], v[44:47]
    s_add_u32 m0, s38, 37888
    s_add_u32 s39, s35, 65536
    buffer_load_dwordx4 v8, s[16:19], s39 offen lds
    s_waitcnt lgkmcnt(9)
    v_mfma_f32_16x16x32_bf16 v[48:51], a[16:19], a[104:107], v[48:51]
    ds_read_b128 a[56:59], v11 offset:14336
    v_mfma_f32_16x16x32_bf16 v[52:55], a[16:19], a[112:115], v[52:55]
    ds_read_b128 a[60:63], v11 offset:15360
    s_waitcnt lgkmcnt(10)
    v_mfma_f32_16x16x32_bf16 v[56:59], a[20:23], a[104:107], v[56:59]
    buffer_load_dwordx4 a[92:95], v8, s[12:15], s33 offen offset:1024
    v_mfma_f32_16x16x32_bf16 v[60:63], a[20:23], a[112:115], v[60:63]
    ds_read_b128 a[64:67], v11 offset:16384
    s_waitcnt lgkmcnt(10)
    v_mfma_f32_16x16x32_bf16 v[64:67], a[24:27], a[104:107], v[64:67]
    ds_read_b128 a[68:71], v11 offset:17408
    v_mfma_f32_16x16x32_bf16 v[68:71], a[24:27], a[112:115], v[68:71]
    s_waitcnt lgkmcnt(10)
    v_mfma_f32_16x16x32_bf16 v[72:75], a[28:31], a[104:107], v[72:75]
    v_mfma_f32_16x16x32_bf16 v[76:79], a[28:31], a[112:115], v[76:79]
    s_waitcnt lgkmcnt(9)
    v_mfma_f32_16x16x32_bf16 v[80:83], a[32:35], a[104:107], v[80:83]
    v_mfma_f32_16x16x32_bf16 v[84:87], a[32:35], a[112:115], v[84:87]
    s_waitcnt lgkmcnt(8)
    v_mfma_f32_16x16x32_bf16 v[16:19], a[36:39], a[108:111], v[16:19]
    ds_read_b128 a[0:3], v11 offset:36864
    v_mfma_f32_16x16x32_bf16 v[20:23], a[36:39], a[116:119], v[20:23]
    s_add_u32 m0, s38, 38912
    s_add_u32 s39, s35, 131072
    buffer_load_dwordx4 v8, s[16:19], s39 offen lds
    s_waitcnt lgkmcnt(8)
    v_mfma_f32_16x16x32_bf16 v[24:27], a[40:43], a[108:111], v[24:27]
    ds_read_b128 a[4:7], v11 offset:37888
    v_mfma_f32_16x16x32_bf16 v[28:31], a[40:43], a[116:119], v[28:31]
    buffer_load_dwordx4 a[96:99], v9, s[12:15], s33 offen offset:0
    s_waitcnt lgkmcnt(8)
    v_mfma_f32_16x16x32_bf16 v[32:35], a[44:47], a[108:111], v[32:35]
    ds_read_b128 a[8:11], v11 offset:38912
    v_mfma_f32_16x16x32_bf16 v[36:39], a[44:47], a[116:119], v[36:39]
    ds_read_b128 a[12:15], v11 offset:39936
    s_waitcnt lgkmcnt(9)
    v_mfma_f32_16x16x32_bf16 v[40:43], a[48:51], a[108:111], v[40:43]
    s_add_u32 m0, s38, 39936
    s_add_u32 s39, s35, 196608
    buffer_load_dwordx4 v8, s[16:19], s39 offen lds
    v_mfma_f32_16x16x32_bf16 v[44:47], a[48:51], a[116:119], v[44:47]
    ds_read_b128 a[16:19], v11 offset:40960
    s_waitcnt lgkmcnt(9)
    v_mfma_f32_16x16x32_bf16 v[48:51], a[52:55], a[108:111], v[48:51]
    ds_read_b128 a[20:23], v11 offset:41984
    v_mfma_f32_16x16x32_bf16 v[52:55], a[52:55], a[116:119], v[52:55]
    buffer_load_dwordx4 a[100:103], v9, s[12:15], s33 offen offset:1024
    s_add_u32 s33, s33, 2048
    s_waitcnt lgkmcnt(9)
    v_mfma_f32_16x16x32_bf16 v[56:59], a[56:59], a[108:111], v[56:59]
    ds_read_b128 a[24:27], v11 offset:43008
    v_mfma_f32_16x16x32_bf16 v[60:63], a[56:59], a[116:119], v[60:63]
    ds_read_b128 a[28:31], v11 offset:44032
    s_waitcnt lgkmcnt(10)
    v_mfma_f32_16x16x32_bf16 v[64:67], a[60:63], a[108:111], v[64:67]
    s_cmp_ge_u32 s31, 2
    s_cbranch_scc1 K4_skip_14
    s_add_u32 m0, s38, 40960
    s_add_u32 s39, s35, 262144
    buffer_load_dwordx4 v8, s[16:19], s39 offen lds
K4_skip_14:
    s_add_u32 s35, s35, 2048
    v_mfma_f32_16x16x32_bf16 v[68:71], a[60:63], a[116:119], v[68:71]
    ds_read_b128 a[32:35], v11 offset:45056
    s_waitcnt lgkmcnt(10)
    v_mfma_f32_16x16x32_bf16 v[72:75], a[64:67], a[108:111], v[72:75]
    v_mfma_f32_16x16x32_bf16 v[76:79], a[64:67], a[116:119], v[76:79]
    s_waitcnt lgkmcnt(9)
    v_mfma_f32_16x16x32_bf16 v[80:83], a[68:71], a[108:111], v[80:83]
    v_mfma_f32_16x16x32_bf16 v[84:87], a[68:71], a[116:119], v[84:87]
    s_waitcnt vmcnt(8)
    s_barrier
    s_waitcnt lgkmcnt(8)
    v_mfma_f32_16x16x32_bf16 v[16:19], a[0:3], a[120:123], v[16:19]
    ds_read_b128 a[36:39], v11 offset:46080
    v_mfma_f32_16x16x32_bf16 v[20:23], a[0:3], a[128:131], v[20:23]
    buffer_load_dwordx4 a[104:107], v8, s[12:15], s33 offen offset:0
    s_waitcnt lgkmcnt(8)
    v_mfma_f32_16x16x32_bf16 v[24:27], a[4:7], a[120:123], v[24:27]
    ds_read_b128 a[40:43], v11 offset:47104
    v_mfma_f32_16x16x32_bf16 v[28:31], a[4:7], a[128:131], v[28:31]
    ds_read_b128 a[44:47], v11 offset:48128
    s_waitcnt lgkmcnt(9)
    v_mfma_f32_16x16x32_bf16 v[32:35], a[8:11], a[120:123], v[32:35]
    s_add_u32 m0, s38, 73728
    s_add_u32 s39, s35, 0
    buffer_load_dwordx4 v8, s[16:19], s39 offen lds
    v_mfma_f32_16x16x32_bf16 v[36:39], a[8:11], a[128:131], v[36:39]
    ds_read_b128 a[48:51], v11 offset:49152
    s_waitcnt lgkmcnt(9)
    v_mfma_f32_16x16x32_bf16 v[40:43], a[12:15], a[120:123], v[40:43]
    ds_read_b128 a[52:55], v11 offset:50176
    v_mfma_f32_16x16x32_bf16 v[44:47], a[12:15], a[128:131], v[44:47]
    s_add_u32 m0, s38, 74752
    s_add_u32 s39, s35, 65536
    buffer_load_dwordx4 v8, s[16:19], s39 offen lds
    s_waitcnt lgkmcnt(9)
    v_mfma_f32_16x16x32_bf16 v[48:51], a[16:19], a[120:123], v[48:51]
    ds_read_b128 a[56:59], v11 offset:51200
    v_mfma_f32_16x16x32_bf16 v[52:55], a[16:19], a[128:131], v[52:55]
    ds_read_b128 a[60:63], v11 offset:52224
    s_waitcnt lgkmcnt(10)
    v_mfma_f32_16x16x32_bf16 v[56:59], a[20:23], a[120:123], v[56:59]
    buffer_load_dwordx4 a[108:111], v8, s[12:15], s33 offen offset:1024
    v_mfma_f32_16x16x32_bf16 v[60:63], a[20:23], a[128:131], v[60:63]
    ds_read_b128 a[64:67], v11 offset:53248
    s_waitcnt lgkmcnt(10)
    v_mfma_f32_16x16x32_bf16 v[64:67], a[24:27], a[120:123], v[64:67]
    ds_read_b128 a[68:71], v11 offset:54272
    v_mfma_f32_16x16x32_bf16 v[68:71], a[24:27], a[128:131], v[68:71]
    s_waitcnt lgkmcnt(10)
    v_mfma_f32_16x16x32_bf16 v[72:75], a[28:31], a[120:123], v[72:75]
    v_mfma_f32_16x16x32_bf16 v[76:79], a[28:31], a[128:131], v[76:79]
    s_waitcnt lgkmcnt(9)
    v_mfma_f32_16x16x32_bf16 v[80:83], a[32:35], a[120:123], v[80:83]
    v_mfma_f32_16x16x32_bf16 v[84:87], a[32:35], a[128:131], v[84:87]
    s_waitcnt lgkmcnt(8)
    v_mfma_f32_16x16x32_bf16 v[16:19], a[36:39], a[124:127], v[16:19]
    ds_read_b128 a[0:3], v10 offset:0
    v_mfma_f32_16x16x32_bf16 v[20:23], a[36:39], a[132:135], v[20:23]
    s_add_u32 m0, s38, 75776
    s_add_u32 s39, s35, 131072
    buffer_load_dwordx4 v8, s[16:19], s39 offen lds
    s_waitcnt lgkmcnt(8)
    v_mfma_f32_16x16x32_bf16 v[24:27], a[40:43], a[124:127], v[24:27]
    ds_read_b128 a[4:7], v10 offset:1024
    v_mfma_f32_16x16x32_bf16 v[28:31], a[40:43], a[132:135], v[28:31]
    buffer_load_dwordx4 a[112:115], v9, s[12:15], s33 offen offset:0
    s_waitcnt lgkmcnt(8)
    v_mfma_f32_16x16x32_bf16 v[32:35], a[44:47], a[124:127], v[32:35]
    ds_read_b128 a[8:11], v10 offset:2048
    v_mfma_f32_16x16x32_bf16 v[36:39], a[44:47], a[132:135], v[36:39]
    ds_read_b128 a[12:15], v10 offset:3072
    s_waitcnt lgkmcnt(9)
    v_mfma_f32_16x16x32_bf16 v[40:43], a[48:51], a[124:127], v[40:43]
    s_add_u32 m0, s38, 76800
    s_add_u32 s39, s35, 196608
    buffer_load_dwordx4 v8, s[16:19], s39 offen lds
    v_mfma_f32_16x16x32_bf16 v[44:47], a[48:51], a[132:135], v[44:47]
    ds_read_b128 a[16:19], v10 offset:4096
    s_waitcnt lgkmcnt(9)
    v_mfma_f32_16x16x32_bf16 v[48:51], a[52:55], a[124:127], v[48:51]
    ds_read_b128 a[20:23], v10 offset:5120
    v_mfma_f32_16x16x32_bf16 v[52:55], a[52:55], a[132:135], v[52:55]
    buffer_load_dwordx4 a[116:119], v9, s[12:15], s33 offen offset:1024
    s_add_u32 s33, s33, 2048
    s_waitcnt lgkmcnt(9)
    v_mfma_f32_16x16x32_bf16 v[56:59], a[56:59], a[124:127], v[56:59]
    ds_read_b128 a[24:27], v10 offset:6144
    v_mfma_f32_16x16x32_bf16 v[60:63], a[56:59], a[132:135], v[60:63]
    ds_read_b128 a[28:31], v10 offset:7168
    s_waitcnt lgkmcnt(10)
    v_mfma_f32_16x16x32_bf16 v[64:67], a[60:63], a[124:127], v[64:67]
    s_cmp_ge_u32 s31, 2
    s_cbranch_scc1 K4_skip_15
    s_add_u32 m0, s38, 77824
    s_add_u32 s39, s35, 262144
    buffer_load_dwordx4 v8, s[16:19], s39 offen lds
K4_skip_15:
    s_add_u32 s35, s35, 2048
    v_mfma_f32_16x16x32_bf16 v[68:71], a[60:63], a[132:135], v[68:71]
    ds_read_b128 a[32:35], v10 offset:8192
    s_waitcnt lgkmcnt(10)
    v_mfma_f32_16x16x32_bf16 v[72:75], a[64:67], a[124:127], v[72:75]
    v_mfma_f32_16x16x32_bf16 v[76:79], a[64:67], a[132:135], v[76:79]
    s_waitcnt lgkmcnt(9)
    v_mfma_f32_16x16x32_bf16 v[80:83], a[68:71], a[124:127], v[80:83]
    v_mfma_f32_16x16x32_bf16 v[84:87], a[68:71], a[132:135], v[84:87]
    s_waitcnt vmcnt(8)
    s_barrier
    s_waitcnt lgkmcnt(8)
    v_mfma_f32_16x16x32_bf16 v[16:19], a[0:3], a[72:75], v[16:19]
    ds_read_b128 a[36:39], v10 offset:9216
    v_mfma_f32_16x16x32_bf16 v[20:23], a[0:3], a[80:83], v[20:23]
    buffer_load_dwordx4 a[120:123], v8, s[12:15], s33 offen offset:0
    s_waitcnt lgkmcnt(8)
    v_mfma_f32_16x16x32_bf16 v[24:27], a[4:7], a[72:75], v[24:27]
    ds_read_b128 a[40:43], v10 offset:10240
    v_mfma_f32_16x16x32_bf16 v[28:31], a[4:7], a[80:83], v[28:31]
    ds_read_b128 a[44:47], v10 offset:11264
    s_waitcnt lgkmcnt(9)
    v_mfma_f32_16x16x32_bf16 v[32:35], a[8:11], a[72:75], v[32:35]
    s_add_u32 m0, s38, 110592
    s_add_u32 s39, s35, 0
    buffer_load_dwordx4 v8, s[16:19], s39 offen lds
    v_mfma_f32_16x16x32_bf16 v[36:39], a[8:11], a[80:83], v[36:39]
    ds_read_b128 a[48:51], v10 offset:12288
    s_waitcnt lgkmcnt(9)
    v_mfma_f32_16x16x32_bf16 v[40:43], a[12:15], a[72:75], v[40:43]
    ds_read_b128 a[52:55], v10 offset:13312
    v_mfma_f32_16x16x32_bf16 v[44:47], a[12:15], a[80:83], v[44:47]
    s_add_u32 m0, s38, 111616
    s_add_u32 s39, s35, 65536
    buffer_load_dwordx4 v8, s[16:19], s39 offen lds
    s_waitcnt lgkmcnt(9)
    v_mfma_f32_16x16x32_bf16 v[48:51], a[16:19], a[72:75], v[48:51]
    ds_read_b128 a[56:59], v10 offset:14336
    v_mfma_f32_16x16x32_bf16 v[52:55], a[16:19], a[80:83], v[52:55]
    ds_read_b128 a[60:63], v10 offset:15360
    s_waitcnt lgkmcnt(10)
    v_mfma_f32_16x16x32_bf16 v[56:59], a[20:23], a[72:75], v[56:59]
    buffer_load_dwordx4 a[124:127], v8, s[12:15], s33 offen offset:1024
    v_mfma_f32_16x16x32_bf16 v[60:63], a[20:23], a[80:83], v[60:63]
    ds_read_b128 a[64:67], v10 offset:16384
    s_waitcnt lgkmcnt(10)
    v_mfma_f32_16x16x32_bf16 v[64:67], a[24:27], a[72:75], v[64:67]
    ds_read_b128 a[68:71], v10 offset:17408
    v_mfma_f32_16x16x32_bf16 v[68:71], a[24:27], a[80:83], v[68:71]
    s_waitcnt lgkmcnt(10)
    v_mfma_f32_16x16x32_bf16 v[72:75], a[28:31], a[72:75], v[72:75]
    v_mfma_f32_16x16x32_bf16 v[76:79], a[28:31], a[80:83], v[76:79]
    s_waitcnt lgkmcnt(9)
    v_mfma_f32_16x16x32_bf16 v[80:83], a[32:35], a[72:75], v[80:83]
    v_mfma_f32_16x16x32_bf16 v[84:87], a[32:35], a[80:83], v[84:87]
    s_waitcnt lgkmcnt(8)
    v_mfma_f32_16x16x32_bf16 v[16:19], a[36:39], a[76:79], v[16:19]
    ds_read_b128 a[0:3], v10 offset:36864
    v_mfma_f32_16x16x32_bf16 v[20:23], a[36:39], a[84:87], v[20:23]
    s_add_u32 m0, s38, 112640
    s_add_u32 s39, s35, 131072
    buffer_load_dwordx4 v8, s[16:19], s39 offen lds
    s_waitcnt lgkmcnt(8)
    v_mfma_f32_16x16x32_bf16 v[24:27], a[40:43], a[76:79], v[24:27]
    ds_read_b128 a[4:7], v10 offset:37888
    v_mfma_f32_16x16x32_bf16 v[28:31], a[40:43], a[84:87], v[28:31]
    buffer_load_dwordx4 a[128:131], v9, s[12:15], s33 offen offset:0
    s_waitcnt lgkmcnt(8)
    v_mfma_f32_16x16x32_bf16 v[32:35], a[44:47], a[76:79], v[32:35]
    ds_read_b128 a[8:11], v10 offset:38912
    v_mfma_f32_16x16x32_bf16 v[36:39], a[44:47], a[84:87], v[36:39]
    ds_read_b128 a[12:15], v10 offset:39936
    s_waitcnt lgkmcnt(9)
    v_mfma_f32_16x16x32_bf16 v[40:43], a[48:51], a[76:79], v[40:43]
    s_add_u32 m0, s38, 113664
    s_add_u32 s39, s35, 196608
    buffer_load_dwordx4 v8, s[16:19], s39 offen lds
    v_mfma_f32_16x16x32_bf16 v[44:47], a[48:51], a[84:87], v[44:47]
    ds_read_b128 a[16:19], v10 offset:40960
    s_waitcnt lgkmcnt(9)
    v_mfma_f32_16x16x32_bf16 v[48:51], a[52:55], a[76:79], v[48:51]
    ds_read_b128 a[20:23], v10 offset:41984
    v_mfma_f32_16x16x32_bf16 v[52:55], a[52:55], a[84:87], v[52:55]
    buffer_load_dwordx4 a[132:135], v9, s[12:15], s33 offen offset:1024
    s_add_u32 s33, s33, 2048
    s_waitcnt lgkmcnt(9)
    v_mfma_f32_16x16x32_bf16 v[56:59], a[56:59], a[76:79], v[56:59]
    ds_read_b128 a[24:27], v10 offset:43008
    v_mfma_f32_16x16x32_bf16 v[60:63], a[56:59], a[84:87], v[60:63]
    ds_read_b128 a[28:31], v10 offset:44032
    s_waitcnt lgkmcnt(10)
    v_mfma_f32_16x16x32_bf16 v[64:67], a[60:63], a[76:79], v[64:67]
    s_cmp_ge_u32 s31, 2
    s_cbranch_scc1 K4_skip_16
    s_add_u32 m0, s38, 114688
    s_add_u32 s39, s35, 262144
    buffer_load_dwordx4 v8, s[16:19], s39 offen lds
K4_skip_16:
    s_add_u32 s35, s35, 2048
    v_mfma_f32_16x16x32_bf16 v[68:71], a[60:63], a[84:87], v[68:71]
    ds_read_b128 a[32:35], v10 offset:45056
    s_waitcnt lgkmcnt(10)
    v_mfma_f32_16x16x32_bf16 v[72:75], a[64:67], a[76:79], v[72:75]
    v_mfma_f32_16x16x32_bf16 v[76:79], a[64:67], a[84:87], v[76:79]
    s_waitcnt lgkmcnt(9)
    v_mfma_f32_16x16x32_bf16 v[80:83], a[68:71], a[76:79], v[80:83]
    v_mfma_f32_16x16x32_bf16 v[84:87], a[68:71], a[84:87], v[84:87]
    s_waitcnt vmcnt(8)
    s_barrier
    s_waitcnt lgkmcnt(8)
    v_mfma_f32_16x16x32_bf16 v[16:19], a[0:3], a[88:91], v[16:19]
    ds_read_b128 a[36:39], v10 offset:46080
    v_mfma_f32_16x16x32_bf16 v[20:23], a[0:3], a[96:99], v[20:23]
    s_add_u32 s43, s42, 0
    buffer_load_dwordx2 v[88:89], v12, s[20:23], s43 offen
    s_waitcnt lgkmcnt(8)
    v_mfma_f32_16x16x32_bf16 v[24:27], a[4:7], a[88:91], v[24:27]
    ds_read_b128 a[40:43], v10 offset:47104
    v_mfma_f32_16x16x32_bf16 v[28:31], a[4:7], a[96:99], v[28:31]
    s_add_u32 s43, s42, 512
    buffer_load_dwordx2 v[90:91], v12, s[20:23], s43 offen
    s_waitcnt lgkmcnt(8)
    v_mfma_f32_16x16x32_bf16 v[32:35], a[8:11], a[88:91], v[32:35]
    ds_read_b128 a[44:47], v10 offset:48128
    v_mfma_f32_16x16x32_bf16 v[36:39], a[8:11], a[96:99], v[36:39]
    ds_read_b128 a[48:51], v10 offset:49152
    s_waitcnt lgkmcnt(9)
    v_mfma_f32_16x16x32_bf16 v[40:43], a[12:15], a[88:91], v[40:43]
    s_add_u32 s43, s42, 1024
    buffer_load_dwordx2 v[92:93], v12, s[20:23], s43 offen
    v_mfma_f32_16x16x32_bf16 v[44:47], a[12:15], a[96:99], v[44:47]
    ds_read_b128 a[52:55], v10 offset:50176
    s_waitcnt lgkmcnt(9)
    v_mfma_f32_16x16x32_bf16 v[48:51], a[16:19], a[88:91], v[48:51]
    ds_read_b128 a[56:59], v10 offset:51200
    v_mfma_f32_16x16x32_bf16 v[52:55], a[16:19], a[96:99], v[52:55]
    s_add_u32 s43, s42, 1536
    buffer_load_dwordx2 v[94:95], v12, s[20:23], s43 offen
    s_waitcnt lgkmcnt(9)
    v_mfma_f32_16x16x32_bf16 v[56:59], a[20:23], a[88:91], v[56:59]
    ds_read_b128 a[60:63], v10 offset:52224
    v_mfma_f32_16x16x32_bf16 v[60:63], a[20:23], a[96:99], v[60:63]
    ds_read_b128 a[64:67], v10 offset:53248
    s_waitcnt lgkmcnt(10)
    v_mfma_f32_16x16x32_bf16 v[64:67], a[24:27], a[88:91], v[64:67]
    s_add_u32 s43, s42, 2048
    buffer_load_dwordx2 v[96:97], v12, s[20:23], s43 offen
    v_mfma_f32_16x16x32_bf16 v[68:71], a[24:27], a[96:99], v[68:71]
    ds_read_b128 a[68:71], v10 offset:54272
    s_waitcnt lgkmcnt(10)
    v_mfma_f32_16x16x32_bf16 v[72:75], a[28:31], a[88:91], v[72:75]
    v_mfma_f32_16x16x32_bf16 v[76:79], a[28:31], a[96:99], v[76:79]
    s_waitcnt lgkmcnt(9)
    v_mfma_f32_16x16x32_bf16 v[80:83], a[32:35], a[88:91], v[80:83]
    v_mfma_f32_16x16x32_bf16 v[84:87], a[32:35], a[96:99], v[84:87]
    s_waitcnt lgkmcnt(8)
    v_mfma_f32_16x16x32_bf16 v[16:19], a[36:39], a[92:95], v[16:19]
    ds_read_b128 a[0:3], v11 offset:0
    v_mfma_f32_16x16x32_bf16 v[20:23], a[36:39], a[100:103], v[20:23]
    s_add_u32 s43, s42, 2560
    buffer_load_dwordx2 v[98:99], v12, s[20:23], s43 offen
    s_waitcnt lgkmcnt(8)
    v_mfma_f32_16x16x32_bf16 v[24:27], a[40:43], a[92:95], v[24:27]
    ds_read_b128 a[4:7], v11 offset:1024
    v_mfma_f32_16x16x32_bf16 v[28:31], a[40:43], a[100:103], v[28:31]
    s_add_u32 s43, s42, 3072
    buffer_load_dwordx2 v[100:101], v12, s[20:23], s43 offen
    s_waitcnt lgkmcnt(8)
    v_mfma_f32_16x16x32_bf16 v[32:35], a[44:47], a[92:95], v[32:35]
    ds_read_b128 a[8:11], v11 offset:2048
    v_mfma_f32_16x16x32_bf16 v[36:39], a[44:47], a[100:103], v[36:39]
    ds_read_b128 a[12:15], v11 offset:3072
    s_waitcnt lgkmcnt(9)
    v_mfma_f32_16x16x32_bf16 v[40:43], a[48:51], a[92:95], v[40:43]
    s_add_u32 s43, s42, 3584
    buffer_load_dwordx2 v[102:103], v12, s[20:23], s43 offen
    v_mfma_f32_16x16x32_bf16 v[44:47], a[48:51], a[100:103], v[44:47]
    ds_read_b128 a[16:19], v11 offset:4096
    s_waitcnt lgkmcnt(9)
    v_mfma_f32_16x16x32_bf16 v[48:51], a[52:55], a[92:95], v[48:51]
    ds_read_b128 a[20:23], v11 offset:5120
    v_mfma_f32_16x16x32_bf16 v[52:55], a[52:55], a[100:103], v[52:55]
    s_add_u32 s43, s42, 4096
    buffer_load_dwordx2 v[104:105], v12, s[20:23], s43 offen
    s_waitcnt lgkmcnt(9)
    v_mfma_f32_16x16x32_bf16 v[56:59], a[56:59], a[92:95], v[56:59]
    ds_read_b128 a[24:27], v11 offset:6144
    v_mfma_f32_16x16x32_bf16 v[60:63], a[56:59], a[100:103], v[60:63]
    ds_read_b128 a[28:31], v11 offset:7168
    s_waitcnt lgkmcnt(10)
    v_mfma_f32_16x16x32_bf16 v[64:67], a[60:63], a[92:95], v[64:67]
    s_lshl_b32 s43, s41, 5
    buffer_load_ushort v14, v15, s[48:51], s43 offen
    v_mfma_f32_16x16x32_bf16 v[68:71], a[60:63], a[100:103], v[68:71]
    ds_read_b128 a[32:35], v11 offset:8192
    s_waitcnt lgkmcnt(10)
    v_mfma_f32_16x16x32_bf16 v[72:75], a[64:67], a[92:95], v[72:75]
    v_mfma_f32_16x16x32_bf16 v[76:79], a[64:67], a[100:103], v[76:79]
    s_waitcnt lgkmcnt(9)
    v_mfma_f32_16x16x32_bf16 v[80:83], a[68:71], a[92:95], v[80:83]
    v_mfma_f32_16x16x32_bf16 v[84:87], a[68:71], a[100:103], v[84:87]
    s_waitcnt vmcnt(10)
    s_barrier
    s_waitcnt lgkmcnt(8)
    v_mfma_f32_16x16x32_bf16 v[16:19], a[0:3], a[104:107], v[16:19]
    ds_read_b128 a[36:39], v11 offset:9216
    v_mfma_f32_16x16x32_bf16 v[20:23], a[0:3], a[112:115], v[20:23]
    ds_read_b128 a[40:43], v11 offset:10240
    s_waitcnt lgkmcnt(9)
    v_mfma_f32_16x16x32_bf16 v[24:27], a[4:7], a[104:107], v[24:27]
    ds_read_b128 a[44:47], v11 offset:11264
    v_mfma_f32_16x16x32_bf16 v[28:31], a[4:7], a[112:115], v[28:31]
    ds_read_b128 a[48:51], v11 offset:12288
    s_waitcnt lgkmcnt(10)
    v_mfma_f32_16x16x32_bf16 v[32:35], a[8:11], a[104:107], v[32:35]
    ds_read_b128 a[52:55], v11 offset:13312
    v_mfma_f32_16x16x32_bf16 v[36:39], a[8:11], a[112:115], v[36:39]
    ds_read_b128 a[56:59], v11 offset:14336
    s_waitcnt lgkmcnt(11)
    v_mfma_f32_16x16x32_bf16 v[40:43], a[12:15], a[104:107], v[40:43]
    ds_read_b128 a[60:63], v11 offset:15360
    v_mfma_f32_16x16x32_bf16 v[44:47], a[12:15], a[112:115], v[44:47]
    ds_read_b128 a[64:67], v11 offset:16384
    s_waitcnt lgkmcnt(12)
    v_mfma_f32_16x16x32_bf16 v[48:51], a[16:19], a[104:107], v[48:51]
    ds_read_b128 a[68:71], v11 offset:17408
    v_mfma_f32_16x16x32_bf16 v[52:55], a[16:19], a[112:115], v[52:55]
    s_waitcnt lgkmcnt(12)
    v_mfma_f32_16x16x32_bf16 v[56:59], a[20:23], a[104:107], v[56:59]
    v_mfma_f32_16x16x32_bf16 v[60:63], a[20:23], a[112:115], v[60:63]
    s_waitcnt lgkmcnt(11)
    v_mfma_f32_16x16x32_bf16 v[64:67], a[24:27], a[104:107], v[64:67]
    v_mfma_f32_16x16x32_bf16 v[68:71], a[24:27], a[112:115], v[68:71]
    s_waitcnt lgkmcnt(10)
    v_mfma_f32_16x16x32_bf16 v[72:75], a[28:31], a[104:107], v[72:75]
    v_mfma_f32_16x16x32_bf16 v[76:79], a[28:31], a[112:115], v[76:79]
    s_waitcnt lgkmcnt(9)
    v_mfma_f32_16x16x32_bf16 v[80:83], a[32:35], a[104:107], v[80:83]
    v_mfma_f32_16x16x32_bf16 v[84:87], a[32:35], a[112:115], v[84:87]
    s_waitcnt lgkmcnt(8)
    v_mfma_f32_16x16x32_bf16 v[16:19], a[36:39], a[108:111], v[16:19]
    ds_read_b128 a[0:3], v11 offset:36864
    v_mfma_f32_16x16x32_bf16 v[20:23], a[36:39], a[116:119], v[20:23]
    ds_read_b128 a[4:7], v11 offset:37888
    s_waitcnt lgkmcnt(9)
    v_mfma_f32_16x16x32_bf16 v[24:27], a[40:43], a[108:111], v[24:27]
    ds_read_b128 a[8:11], v11 offset:38912
    v_mfma_f32_16x16x32_bf16 v[28:31], a[40:43], a[116:119], v[28:31]
    ds_read_b128 a[12:15], v11 offset:39936
    s_waitcnt lgkmcnt(10)
    v_mfma_f32_16x16x32_bf16 v[32:35], a[44:47], a[108:111], v[32:35]
    ds_read_b128 a[16:19], v11 offset:40960
    v_mfma_f32_16x16x32_bf16 v[36:39], a[44:47], a[116:119], v[36:39]
    ds_read_b128 a[20:23], v11 offset:41984
    s_waitcnt lgkmcnt(11)
    v_mfma_f32_16x16x32_bf16 v[40:43], a[48:51], a[108:111], v[40:43]
    ds_read_b128 a[24:27], v11 offset:43008
    v_mfma_f32_16x16x32_bf16 v[44:47], a[48:51], a[116:119], v[44:47]
    ds_read_b128 a[28:31], v11 offset:44032
    s_waitcnt lgkmcnt(12)
    v_mfma_f32_16x16x32_bf16 v[48:51], a[52:55], a[108:111], v[48:51]
    ds_read_b128 a[32:35], v11 offset:45056
    v_mfma_f32_16x16x32_bf16 v[52:55], a[52:55], a[116:119], v[52:55]
    s_waitcnt lgkmcnt(12)
    v_mfma_f32_16x16x32_bf16 v[56:59], a[56:59], a[108:111], v[56:59]
    v_mfma_f32_16x16x32_bf16 v[60:63], a[56:59], a[116:119], v[60:63]
    s_waitcnt lgkmcnt(11)
    v_mfma_f32_16x16x32_bf16 v[64:67], a[60:63], a[108:111], v[64:67]
    v_mfma_f32_16x16x32_bf16 v[68:71], a[60:63], a[116:119], v[68:71]
    s_waitcnt lgkmcnt(10)
    v_mfma_f32_16x16x32_bf16 v[72:75], a[64:67], a[108:111], v[72:75]
    v_mfma_f32_16x16x32_bf16 v[76:79], a[64:67], a[116:119], v[76:79]
    s_waitcnt lgkmcnt(9)
    v_mfma_f32_16x16x32_bf16 v[80:83], a[68:71], a[108:111], v[80:83]
    v_mfma_f32_16x16x32_bf16 v[84:87], a[68:71], a[116:119], v[84:87]
    s_waitcnt lgkmcnt(8)
    v_mfma_f32_16x16x32_bf16 v[16:19], a[0:3], a[120:123], v[16:19]
    ds_read_b128 a[36:39], v11 offset:46080
    v_mfma_f32_16x16x32_bf16 v[20:23], a[0:3], a[128:131], v[20:23]
    ds_read_b128 a[40:43], v11 offset:47104
    s_waitcnt lgkmcnt(9)
    v_mfma_f32_16x16x32_bf16 v[24:27], a[4:7], a[120:123], v[24:27]
    ds_read_b128 a[44:47], v11 offset:48128
    v_mfma_f32_16x16x32_bf16 v[28:31], a[4:7], a[128:131], v[28:31]
    ds_read_b128 a[48:51], v11 offset:49152
    s_waitcnt lgkmcnt(10)
    v_mfma_f32_16x16x32_bf16 v[32:35], a[8:11], a[120:123], v[32:35]
    ds_read_b128 a[52:55], v11 offset:50176
    v_mfma_f32_16x16x32_bf16 v[36:39], a[8:11], a[128:131], v[36:39]
    ds_read_b128 a[56:59], v11 offset:51200
    s_waitcnt lgkmcnt(11)
    v_mfma_f32_16x16x32_bf16 v[40:43], a[12:15], a[120:123], v[40:43]
    ds_read_b128 a[60:63], v11 offset:52224
    v_mfma_f32_16x16x32_bf16 v[44:47], a[12:15], a[128:131], v[44:47]
    ds_read_b128 a[64:67], v11 offset:53248
    s_waitcnt lgkmcnt(12)
    v_mfma_f32_16x16x32_bf16 v[48:51], a[16:19], a[120:123], v[48:51]
    ds_read_b128 a[68:71], v11 offset:54272
    v_mfma_f32_16x16x32_bf16 v[52:55], a[16:19], a[128:131], v[52:55]
    s_waitcnt lgkmcnt(12)
    v_mfma_f32_16x16x32_bf16 v[56:59], a[20:23], a[120:123], v[56:59]
    v_mfma_f32_16x16x32_bf16 v[60:63], a[20:23], a[128:131], v[60:63]
    s_waitcnt lgkmcnt(11)
    v_mfma_f32_16x16x32_bf16 v[64:67], a[24:27], a[120:123], v[64:67]
    v_mfma_f32_16x16x32_bf16 v[68:71], a[24:27], a[128:131], v[68:71]
    s_waitcnt lgkmcnt(10)
    v_mfma_f32_16x16x32_bf16 v[72:75], a[28:31], a[120:123], v[72:75]
    v_mfma_f32_16x16x32_bf16 v[76:79], a[28:31], a[128:131], v[76:79]
    s_waitcnt lgkmcnt(9)
    v_mfma_f32_16x16x32_bf16 v[80:83], a[32:35], a[120:123], v[80:83]
    v_mfma_f32_16x16x32_bf16 v[84:87], a[32:35], a[128:131], v[84:87]
    s_waitcnt lgkmcnt(8)
    v_mfma_f32_16x16x32_bf16 v[16:19], a[36:39], a[124:127], v[16:19]
    v_mfma_f32_16x16x32_bf16 v[20:23], a[36:39], a[132:135], v[20:23]
    s_waitcnt lgkmcnt(7)
    v_mfma_f32_16x16x32_bf16 v[24:27], a[40:43], a[124:127], v[24:27]
    v_mfma_f32_16x16x32_bf16 v[28:31], a[40:43], a[132:135], v[28:31]
    s_waitcnt lgkmcnt(6)
    v_mfma_f32_16x16x32_bf16 v[32:35], a[44:47], a[124:127], v[32:35]
    v_mfma_f32_16x16x32_bf16 v[36:39], a[44:47], a[132:135], v[36:39]
    s_waitcnt lgkmcnt(5)
    v_mfma_f32_16x16x32_bf16 v[40:43], a[48:51], a[124:127], v[40:43]
    v_mfma_f32_16x16x32_bf16 v[44:47], a[48:51], a[132:135], v[44:47]
    s_waitcnt lgkmcnt(4)
    v_mfma_f32_16x16x32_bf16 v[48:51], a[52:55], a[124:127], v[48:51]
    v_mfma_f32_16x16x32_bf16 v[52:55], a[52:55], a[132:135], v[52:55]
    s_waitcnt lgkmcnt(3)
    v_mfma_f32_16x16x32_bf16 v[56:59], a[56:59], a[124:127], v[56:59]
    v_mfma_f32_16x16x32_bf16 v[60:63], a[56:59], a[132:135], v[60:63]
    s_waitcnt lgkmcnt(2)
    v_mfma_f32_16x16x32_bf16 v[64:67], a[60:63], a[124:127], v[64:67]
    v_mfma_f32_16x16x32_bf16 v[68:71], a[60:63], a[132:135], v[68:71]
    s_waitcnt lgkmcnt(1)
    v_mfma_f32_16x16x32_bf16 v[72:75], a[64:67], a[124:127], v[72:75]
    v_mfma_f32_16x16x32_bf16 v[76:79], a[64:67], a[132:135], v[76:79]
    s_waitcnt lgkmcnt(0)
    v_mfma_f32_16x16x32_bf16 v[80:83], a[68:71], a[124:127], v[80:83]
    v_mfma_f32_16x16x32_bf16 v[84:87], a[68:71], a[132:135], v[84:87]
    s_barrier
    s_lshl_b32 s43, s31, 1
    s_add_u32 s43, s43, s32
    s_xor_b32 s39, s43, 1
    s_mul_i32 s39, s39, 9216
    s_mul_i32 s43, s43, 9216
    v_add_u32 v3, s39, v8
    v_add_u32 v4, s43, v8
    s_cmp_eq_u32 s32, 0
    s_cbranch_scc1 K4_w1
    ds_write_b128 v3, v[16:19] offset:0
    ds_write_b128 v3, v[24:27] offset:1024
    ds_write_b128 v3, v[32:35] offset:2048
    ds_write_b128 v3, v[40:43] offset:3072
    ds_write_b128 v3, v[48:51] offset:4096
    ds_write_b128 v3, v[56:59] offset:5120
    ds_write_b128 v3, v[64:67] offset:6144
    ds_write_b128 v3, v[72:75] offset:7168
    ds_write_b128 v3, v[80:83] offset:8192
    v_mov_b32 v16, v20
    v_mov_b32 v17, v21
    v_mov_b32 v18, v22
    v_mov_b32 v19, v23
    v_mov_b32 v24, v28
    v_mov_b32 v25, v29
    v_mov_b32 v26, v30
    v_mov_b32 v27, v31
    v_mov_b32 v32, v36
    v_mov_b32 v33, v37
    v_mov_b32 v34, v38
    v_mov_b32 v35, v39
    v_mov_b32 v40, v44
    v_mov_b32 v41, v45
    v_mov_b32 v42, v46
    v_mov_b32 v43, v47
    v_mov_b32 v48, v52
    v_mov_b32 v49, v53
    v_mov_b32 v50, v54
    v_mov_b32 v51, v55
    v_mov_b32 v56, v60
    v_mov_b32 v57, v61
    v_mov_b32 v58, v62
    v_mov_b32 v59, v63
    v_mov_b32 v64, v68
    v_mov_b32 v65, v69
    v_mov_b32 v66, v70
    v_mov_b32 v67, v71
    v_mov_b32 v72, v76
    v_mov_b32 v73, v77
    v_mov_b32 v74, v78
    v_mov_b32 v75, v79
    v_mov_b32 v80, v84
    v_mov_b32 v81, v85
    v_mov_b32 v82, v86
    v_mov_b32 v83, v87
    s_branch K4_w2
K4_w1:
    ds_write_b128 v3, v[20:23] offset:0
    ds_write_b128 v3, v[28:31] offset:1024
    ds_write_b128 v3, v[36:39] offset:2048
    ds_write_b128 v3, v[44:47] offset:3072
    ds_write_b128 v3, v[52:55] offset:4096
    ds_write_b128 v3, v[60:63] offset:5120
    ds_write_b128 v3, v[68:71] offset:6144
    ds_write_b128 v3, v[76:79] offset:7168
    ds_write_b128 v3, v[84:87] offset:8192
K4_w2:
    s_waitcnt vmcnt(0)
    v_lshlrev_b32 v14, 16, v14
    s_waitcnt lgkmcnt(0)
    s_barrier
    ds_read_b128 v[20:23], v4 offset:0
    ds_read_b128 v[28:31], v4 offset:1024
    ds_read_b128 v[36:39], v4 offset:2048
    ds_read_b128 v[44:47], v4 offset:3072
    ds_read_b128 v[52:55], v4 offset:4096
    ds_read_b128 v[60:63], v4 offset:5120
    ds_read_b128 v[68:71], v4 offset:6144
    ds_read_b128 v[76:79], v4 offset:7168
    ds_read_b128 v[84:87], v4 offset:8192
    v_add_f32 v16, v16, v14
    v_add_f32 v17, v17, v14
    v_add_f32 v18, v18, v14
    v_add_f32 v19, v19, v14
    s_waitcnt lgkmcnt(8)
    v_add_f32 v16, v16, v20
    v_add_f32 v17, v17, v21
    v_add_f32 v18, v18, v22
    v_add_f32 v19, v19, v23
    v_lshlrev_b32 v20, 16, v88
    v_and_b32 v21, 0xffff0000, v88
    v_lshlrev_b32 v22, 16, v89
    v_and_b32 v23, 0xffff0000, v89
    v_mul_f32 v16, v16, v20
    v_mul_f32 v17, v17, v21
    v_mul_f32 v18, v18, v22
    v_mul_f32 v19, v19, v23
    v_cvt_pk_bf16_f32 v16, v16, v17
    v_cvt_pk_bf16_f32 v17, v18, v19
    s_add_u32 s43, s42, 0
    buffer_store_dwordx2 v[16:17], v12, s[24:27], s43 offen sc0 sc1
    v_add_f32 v24, v24, v14
    v_add_f32 v25, v25, v14
    v_add_f32 v26, v26, v14
    v_add_f32 v27, v27, v14
    s_waitcnt lgkmcnt(7)
    v_add_f32 v24, v24, v28
    v_add_f32 v25, v25, v29
    v_add_f32 v26, v26, v30
    v_add_f32 v27, v27, v31
    v_lshlrev_b32 v28, 16, v90
    v_and_b32 v29, 0xffff0000, v90
    v_lshlrev_b32 v30, 16, v91
    v_and_b32 v31, 0xffff0000, v91
    v_mul_f32 v24, v24, v28
    v_mul_f32 v25, v25, v29
    v_mul_f32 v26, v26, v30
    v_mul_f32 v27, v27, v31
    v_cvt_pk_bf16_f32 v24, v24, v25
    v_cvt_pk_bf16_f32 v25, v26, v27
    s_add_u32 s43, s42, 512
    buffer_store_dwordx2 v[24:25], v12, s[24:27], s43 offen sc0 sc1
    v_add_f32 v32, v32, v14
    v_add_f32 v33, v33, v14
    v_add_f32 v34, v34, v14
    v_add_f32 v35, v35, v14
    s_waitcnt lgkmcnt(6)
    v_add_f32 v32, v32, v36
    v_add_f32 v33, v33, v37
    v_add_f32 v34, v34, v38
    v_add_f32 v35, v35, v39
    v_lshlrev_b32 v36, 16, v92
    v_and_b32 v37, 0xffff0000, v92
    v_lshlrev_b32 v38, 16, v93
    v_and_b32 v39, 0xffff0000, v93
    v_mul_f32 v32, v32, v36
    v_mul_f32 v33, v33, v37
    v_mul_f32 v34, v34, v38
    v_mul_f32 v35, v35, v39
    v_cvt_pk_bf16_f32 v32, v32, v33
    v_cvt_pk_bf16_f32 v33, v34, v35
    s_add_u32 s43, s42, 1024
    buffer_store_dwordx2 v[32:33], v12, s[24:27], s43 offen sc0 sc1
    v_add_f32 v40, v40, v14
    v_add_f32 v41, v41, v14
    v_add_f32 v42, v42, v14
    v_add_f32 v43, v43, v14
    s_waitcnt lgkmcnt(5)
    v_add_f32 v40, v40, v44
    v_add_f32 v41, v41, v45
    v_add_f32 v42, v42, v46
    v_add_f32 v43, v43, v47
    v_lshlrev_b32 v44, 16, v94
    v_and_b32 v45, 0xffff0000, v94
    v_lshlrev_b32 v46, 16, v95
    v_and_b32 v47, 0xffff0000, v95
    v_mul_f32 v40, v40, v44
    v_mul_f32 v41, v41, v45
    v_mul_f32 v42, v42, v46
    v_mul_f32 v43, v43, v47
    v_cvt_pk_bf16_f32 v40, v40, v41
    v_cvt_pk_bf16_f32 v41, v42, v43
    s_add_u32 s43, s42, 1536
    buffer_store_dwordx2 v[40:41], v12, s[24:27], s43 offen sc0 sc1
    v_add_f32 v48, v48, v14
    v_add_f32 v49, v49, v14
    v_add_f32 v50, v50, v14
    v_add_f32 v51, v51, v14
    s_waitcnt lgkmcnt(4)
    v_add_f32 v48, v48, v52
    v_add_f32 v49, v49, v53
    v_add_f32 v50, v50, v54
    v_add_f32 v51, v51, v55
    v_lshlrev_b32 v52, 16, v96
    v_and_b32 v53, 0xffff0000, v96
    v_lshlrev_b32 v54, 16, v97
    v_and_b32 v55, 0xffff0000, v97
    v_mul_f32 v48, v48, v52
    v_mul_f32 v49, v49, v53
    v_mul_f32 v50, v50, v54
    v_mul_f32 v51, v51, v55
    v_cvt_pk_bf16_f32 v48, v48, v49
    v_cvt_pk_bf16_f32 v49, v50, v51
    s_add_u32 s43, s42, 2048
    buffer_store_dwordx2 v[48:49], v12, s[24:27], s43 offen sc0 sc1
    v_add_f32 v56, v56, v14
    v_add_f32 v57, v57, v14
    v_add_f32 v58, v58, v14
    v_add_f32 v59, v59, v14
    s_waitcnt lgkmcnt(3)
    v_add_f32 v56, v56, v60
    v_add_f32 v57, v57, v61
    v_add_f32 v58, v58, v62
    v_add_f32 v59, v59, v63
    v_lshlrev_b32 v60, 16, v98
    v_and_b32 v61, 0xffff0000, v98
    v_lshlrev_b32 v62, 16, v99
    v_and_b32 v63, 0xffff0000, v99
    v_mul_f32 v56, v56, v60
    v_mul_f32 v57, v57, v61
    v_mul_f32 v58, v58, v62
    v_mul_f32 v59, v59, v63
    v_cvt_pk_bf16_f32 v56, v56, v57
    v_cvt_pk_bf16_f32 v57, v58, v59
    s_add_u32 s43, s42, 2560
    buffer_store_dwordx2 v[56:57], v12, s[24:27], s43 offen sc0 sc1
    v_add_f32 v64, v64, v14
    v_add_f32 v65, v65, v14
    v_add_f32 v66, v66, v14
    v_add_f32 v67, v67, v14
    s_waitcnt lgkmcnt(2)
    v_add_f32 v64, v64, v68
    v_add_f32 v65, v65, v69
    v_add_f32 v66, v66, v70
    v_add_f32 v67, v67, v71
    v_lshlrev_b32 v68, 16, v100
    v_and_b32 v69, 0xffff0000, v100
    v_lshlrev_b32 v70, 16, v101
    v_and_b32 v71, 0xffff0000, v101
    v_mul_f32 v64, v64, v68
    v_mul_f32 v65, v65, v69
    v_mul_f32 v66, v66, v70
    v_mul_f32 v67, v67, v71
    v_cvt_pk_bf16_f32 v64, v64, v65
    v_cvt_pk_bf16_f32 v65, v66, v67
    s_add_u32 s43, s42, 3072
    buffer_store_dwordx2 v[64:65], v12, s[24:27], s43 offen sc0 sc1
    v_add_f32 v72, v72, v14
    v_add_f32 v73, v73, v14
    v_add_f32 v74, v74, v14
    v_add_f32 v75, v75, v14
    s_waitcnt lgkmcnt(1)
    v_add_f32 v72, v72, v76
    v_add_f32 v73, v73, v77
    v_add_f32 v74, v74, v78
    v_add_f32 v75, v75, v79
    v_lshlrev_b32 v76, 16, v102
    v_and_b32 v77, 0xffff0000, v102
    v_lshlrev_b32 v78, 16, v103
    v_and_b32 v79, 0xffff0000, v103
    v_mul_f32 v72, v72, v76
    v_mul_f32 v73, v73, v77
    v_mul_f32 v74, v74, v78
    v_mul_f32 v75, v75, v79
    v_cvt_pk_bf16_f32 v72, v72, v73
    v_cvt_pk_bf16_f32 v73, v74, v75
    s_add_u32 s43, s42, 3584
    buffer_store_dwordx2 v[72:73], v12, s[24:27], s43 offen sc0 sc1
    v_add_f32 v80, v80, v14
    v_add_f32 v81, v81, v14
    v_add_f32 v82, v82, v14
    v_add_f32 v83, v83, v14
    s_waitcnt lgkmcnt(0)
    v_add_f32 v80, v80, v84
    v_add_f32 v81, v81, v85
    v_add_f32 v82, v82, v86
    v_add_f32 v83, v83, v87
    v_lshlrev_b32 v84, 16, v104
    v_and_b32 v85, 0xffff0000, v104
    v_lshlrev_b32 v86, 16, v105
    v_and_b32 v87, 0xffff0000, v105
    v_mul_f32 v80, v80, v84
    v_mul_f32 v81, v81, v85
    v_mul_f32 v82, v82, v86
    v_mul_f32 v83, v83, v87
    v_cvt_pk_bf16_f32 v80, v80, v81
    v_cvt_pk_bf16_f32 v81, v82, v83
    s_add_u32 s43, s42, 4096
    buffer_store_dwordx2 v[80:81], v12, s[24:27], s43 offen sc0 sc1
    s_waitcnt vmcnt(0)
K4_end:
    s_endpgm
.text
.globl k5_oproj_kernel
.p2align 8
.type k5_oproj_kernel,@function
k5_oproj_kernel:
    s_sub_u32 s3, s2, 240
    s_cmp_ge_u32 s2, 240
    s_cbranch_scc1 K5_end
    s_and_b32 s28, s2, 7
    s_mul_i32 s28, s28, 30
    s_lshr_b32 s29, s2, 3
    s_add_u32 s29, s28, s29
    s_sub_u32 s3, s29, 218
    s_cmp_ge_u32 s29, 234
    s_cbranch_scc1 K5_end
    s_mul_i32 s28, s29, 7282
    s_lshr_b32 s28, s28, 16
    s_mul_i32 s30, s28, 9
    s_sub_u32 s29, s29, s30
    s_load_dwordx2 s[4:5], s[0:1], 112
    s_load_dwordx2 s[6:7], s[0:1], 72
    s_load_dwordx2 s[8:9], s[0:1], 0
    s_load_dwordx2 s[10:11], s[0:1], 96
    v_and_b32 v1, 63, v0
    v_lshrrev_b32 v2, 6, v0
    s_nop 0
    v_readfirstlane_b32 s3, v2
    s_waitcnt lgkmcnt(0)
    s_add_u32 s12, s4, 67108864
    s_addc_u32 s13, s5, 0
    s_mov_b32 s14, 9437184
    s_mov_b32 s15, 0x00020000
    s_mov_b32 s16, s6
    s_mov_b32 s17, s7
    s_mov_b32 s18, 2654208
    s_mov_b32 s19, 0x00020000
    s_add_u32 s20, s4, 20971520
    s_addc_u32 s21, s5, 0
    s_mov_b32 s22, 2359296
    s_mov_b32 s23, 0x00020000
    s_mov_b32 s24, s10
    s_mov_b32 s25, s11
    s_mov_b32 s26, 2359296
    s_mov_b32 s27, 0x00020000
    s_add_u32 s40, s4, 0
    s_addc_u32 s41, s5, 0
    s_mov_b32 s42, 13824
    s_mov_b32 s43, 0x00020000
    v_and_b32 v3, 3, v1
    v_bfe_u32 v4, v1, 2, 1
    v_bfe_u32 v6, v1, 4, 1
    v_xor_b32 v4, v4, v6
    v_lshl_add_u32 v3, v4, 2, v3
    v_lshlrev_b32 v3, 4, v3
    v_xor_b32 v5, 32, v3
    v_lshrrev_b32 v4, 3, v1
    s_mov_b32 s30, 1152
    v_mul_lo_u32 v4, v4, s30
    v_add_u32 v5, v5, v4
    v_add_u32 v4, v3, v4
    v_add_u32 v8, 0, v4
    v_add_u32 v9, 9216, v5
    v_add_u32 v10, 18432, v4
    v_add_u32 v11, 27648, v5
    v_add_u32 v12, 36864, v4
    v_add_u32 v13, 46080, v5
    v_add_u32 v14, 55296, v4
    v_add_u32 v15, 64512, v5
    s_mul_i32 s31, s3, 663552
    s_lshl_b32 s32, s29, 7
    s_add_u32 s31, s31, s32
    v_lshlrev_b32 v17, 4, v1
    v_add_u32 v18, 73728, v17
    v_add_u32 v19, 147456, v17
    v_add_u32 v20, 221184, v17
    v_add_u32 v21, 294912, v17
    s_mul_i32 s33, s28, 368640
    s_mul_i32 s32, s3, 18432
    s_add_u32 s33, s33, s32
    s_mul_i32 s34, s3, 32768
    v_lshrrev_b32 v4, 4, v1
    v_bfe_u32 v3, v1, 2, 2
    v_lshlrev_b32 v3, 7, v3
    v_lshl_add_u32 v3, v4, 10, v3
    v_and_b32 v5, 3, v1
    v_lshl_add_u32 v3, v5, 3, v3
    v_add_u32 v3, s34, v3
    v_and_b32 v5, 1, v4
    v_lshlrev_b32 v5, 5, v5
    v_bfe_u32 v6, v1, 3, 1
    v_lshl_add_u32 v5, v6, 6, v5
    v_xor_b32 v6, 0, v5
    v_add_u32 v144, v3, v6
    v_xor_b32 v6, 32, v5
    v_add_u32 v145, v3, v6
    v_xor_b32 v6, 64, v5
    v_add_u32 v146, v3, v6
    v_xor_b32 v6, 96, v5
    v_add_u32 v147, v3, v6
    s_add_u32 m0, s34, 0
    s_nop 0
    buffer_load_dwordx4 v8, s[16:19], s31 offen lds
    buffer_load_dwordx4 a[0:3], v17, s[12:15], s33 offen offset:0
    buffer_load_dwordx4 a[4:7], v17, s[12:15], s33 offen offset:1024
    s_add_u32 m0, s34, 1024
    s_nop 0
    buffer_load_dwordx4 v9, s[16:19], s31 offen lds
    buffer_load_dwordx4 a[8:11], v18, s[12:15], s33 offen offset:0
    buffer_load_dwordx4 a[12:15], v18, s[12:15], s33 offen offset:1024
    s_add_u32 m0, s34, 2048
    s_nop 0
    buffer_load_dwordx4 v10, s[16:19], s31 offen lds
    buffer_load_dwordx4 a[16:19], v19, s[12:15], s33 offen offset:0
    buffer_load_dwordx4 a[20:23], v19, s[12:15], s33 offen offset:1024
    s_add_u32 m0, s34, 3072
    s_nop 0
    buffer_load_dwordx4 v11, s[16:19], s31 offen lds
    buffer_load_dwordx4 a[24:27], v20, s[12:15], s33 offen offset:0
    buffer_load_dwordx4 a[28:31], v20, s[12:15], s33 offen offset:1024
    s_add_u32 m0, s34, 4096
    s_nop 0
    buffer_load_dwordx4 v12, s[16:19], s31 offen lds
    buffer_load_dwordx4 a[32:35], v21, s[12:15], s33 offen offset:0
    buffer_load_dwordx4 a[36:39], v21, s[12:15], s33 offen offset:1024
    s_add_u32 m0, s34, 5120
    s_nop 0
    buffer_load_dwordx4 v13, s[16:19], s31 offen lds
    s_add_u32 m0, s34, 6144
    s_nop 0
    buffer_load_dwordx4 v14, s[16:19], s31 offen lds
    s_add_u32 m0, s34, 7168
    s_nop 0
    buffer_load_dwordx4 v15, s[16:19], s31 offen lds
    s_add_u32 s31, s31, 73728
    s_add_u32 s33, s33, 2048
    s_add_u32 m0, s34, 8192
    s_nop 0
    buffer_load_dwordx4 v8, s[16:19], s31 offen lds
    buffer_load_dwordx4 a[40:43], v17, s[12:15], s33 offen offset:0
    buffer_load_dwordx4 a[44:47], v17, s[12:15], s33 offen offset:1024
    s_add_u32 m0, s34, 9216
    s_nop 0
    buffer_load_dwordx4 v9, s[16:19], s31 offen lds
    buffer_load_dwordx4 a[48:51], v18, s[12:15], s33 offen offset:0
    buffer_load_dwordx4 a[52:55], v18, s[12:15], s33 offen offset:1024
    s_add_u32 m0, s34, 10240
    s_nop 0
    buffer_load_dwordx4 v10, s[16:19], s31 offen lds
    buffer_load_dwordx4 a[56:59], v19, s[12:15], s33 offen offset:0
    buffer_load_dwordx4 a[60:63], v19, s[12:15], s33 offen offset:1024
    s_add_u32 m0, s34, 11264
    s_nop 0
    buffer_load_dwordx4 v11, s[16:19], s31 offen lds
    buffer_load_dwordx4 a[64:67], v20, s[12:15], s33 offen offset:0
    buffer_load_dwordx4 a[68:71], v20, s[12:15], s33 offen offset:1024
    s_add_u32 m0, s34, 12288
    s_nop 0
    buffer_load_dwordx4 v12, s[16:19], s31 offen lds
    buffer_load_dwordx4 a[72:75], v21, s[12:15], s33 offen offset:0
    buffer_load_dwordx4 a[76:79], v21, s[12:15], s33 offen offset:1024
    s_add_u32 m0, s34, 13312
    s_nop 0
    buffer_load_dwordx4 v13, s[16:19], s31 offen lds
    s_add_u32 m0, s34, 14336
    s_nop 0
    buffer_load_dwordx4 v14, s[16:19], s31 offen lds
    s_add_u32 m0, s34, 15360
    s_nop 0
    buffer_load_dwordx4 v15, s[16:19], s31 offen lds
    s_add_u32 s31, s31, 73728
    s_add_u32 s33, s33, 2048
    s_add_u32 m0, s34, 16384
    s_nop 0
    buffer_load_dwordx4 v8, s[16:19], s31 offen lds
    buffer_load_dwordx4 a[80:83], v17, s[12:15], s33 offen offset:0
    buffer_load_dwordx4 a[84:87], v17, s[12:15], s33 offen offset:1024
    s_add_u32 m0, s34, 17408
    s_nop 0
    buffer_load_dwordx4 v9, s[16:19], s31 offen lds
    buffer_load_dwordx4 a[88:91], v18, s[12:15], s33 offen offset:0
    buffer_load_dwordx4 a[92:95], v18, s[12:15], s33 offen offset:1024
    s_add_u32 m0, s34, 18432
    s_nop 0
    buffer_load_dwordx4 v10, s[16:19], s31 offen lds
    buffer_load_dwordx4 a[96:99], v19, s[12:15], s33 offen offset:0
    buffer_load_dwordx4 a[100:103], v19, s[12:15], s33 offen offset:1024
    s_add_u32 m0, s34, 19456
    s_nop 0
    buffer_load_dwordx4 v11, s[16:19], s31 offen lds
    buffer_load_dwordx4 a[104:107], v20, s[12:15], s33 offen offset:0
    buffer_load_dwordx4 a[108:111], v20, s[12:15], s33 offen offset:1024
    s_add_u32 m0, s34, 20480
    s_nop 0
    buffer_load_dwordx4 v12, s[16:19], s31 offen lds
    buffer_load_dwordx4 a[112:115], v21, s[12:15], s33 offen offset:0
    buffer_load_dwordx4 a[116:119], v21, s[12:15], s33 offen offset:1024
    s_add_u32 m0, s34, 21504
    s_nop 0
    buffer_load_dwordx4 v13, s[16:19], s31 offen lds
    s_add_u32 m0, s34, 22528
    s_nop 0
    buffer_load_dwordx4 v14, s[16:19], s31 offen lds
    s_add_u32 m0, s34, 23552
    s_nop 0
    buffer_load_dwordx4 v15, s[16:19], s31 offen lds
    s_add_u32 s31, s31, 73728
    s_add_u32 s33, s33, 2048
    v_mov_b32 v32, 0
    v_mov_b32 v33, 0
    v_mov_b32 v34, 0
    v_mov_b32 v35, 0
    v_mov_b32 v36, 0
    v_mov_b32 v37, 0
    v_mov_b32 v38, 0
    v_mov_b32 v39, 0
    v_mov_b32 v40, 0
    v_mov_b32 v41, 0
    v_mov_b32 v42, 0
    v_mov_b32 v43, 0
    v_mov_b32 v44, 0
    v_mov_b32 v45, 0
    v_mov_b32 v46, 0
    v_mov_b32 v47, 0
    v_mov_b32 v48, 0
    v_mov_b32 v49, 0
    v_mov_b32 v50, 0
    v_mov_b32 v51, 0
    v_mov_b32 v52, 0
    v_mov_b32 v53, 0
    v_mov_b32 v54, 0
    v_mov_b32 v55, 0
    v_mov_b32 v56, 0
    v_mov_b32 v57, 0
    v_mov_b32 v58, 0
    v_mov_b32 v59, 0
    v_mov_b32 v60, 0
    v_mov_b32 v61, 0
    v_mov_b32 v62, 0
    v_mov_b32 v63, 0
    v_mov_b32 v64, 0
    v_mov_b32 v65, 0
    v_mov_b32 v66, 0
    v_mov_b32 v67, 0
    v_mov_b32 v68, 0
    v_mov_b32 v69, 0
    v_mov_b32 v70, 0
    v_mov_b32 v71, 0
    v_mov_b32 v72, 0
    v_mov_b32 v73, 0
    v_mov_b32 v74, 0
    v_mov_b32 v75, 0
    v_mov_b32 v76, 0
    v_mov_b32 v77, 0
    v_mov_b32 v78, 0
    v_mov_b32 v79, 0
    v_mov_b32 v80, 0
    v_mov_b32 v81, 0
    v_mov_b32 v82, 0
    v_mov_b32 v83, 0
    v_mov_b32 v84, 0
    v_mov_b32 v85, 0
    v_mov_b32 v86, 0
    v_mov_b32 v87, 0
    v_mov_b32 v88, 0
    v_mov_b32 v89, 0
    v_mov_b32 v90, 0
    v_mov_b32 v91, 0
    v_mov_b32 v92, 0
    v_mov_b32 v93, 0
    v_mov_b32 v94, 0
    v_mov_b32 v95, 0
    v_mov_b32 v96, 0
    v_mov_b32 v97, 0
    v_mov_b32 v98, 0
    v_mov_b32 v99, 0
    v_mov_b32 v100, 0
    v_mov_b32 v101, 0
    v_mov_b32 v102, 0
    v_mov_b32 v103, 0
    v_mov_b32 v104, 0
    v_mov_b32 v105, 0
    v_mov_b32 v106, 0
    v_mov_b32 v107, 0
    v_mov_b32 v108, 0
    v_mov_b32 v109, 0
    v_mov_b32 v110, 0
    v_mov_b32 v111, 0
    v_and_b32 v3, 15, v1
    v_lshrrev_b32 v4, 4, v1
    s_mov_b32 s30, 1152
    v_mul_lo_u32 v24, v3, s30
    v_lshl_add_u32 v24, v4, 3, v24
    s_lshl_b32 s35, s29, 2
    s_add_u32 s35, s35, s3
    s_mul_i32 s36, s28, 92160
    s_lshl_b32 s37, s35, 5
    s_add_u32 s36, s36, s37
    v_lshrrev_b32 v5, 1, v4
    v_lshlrev_b32 v5, 8, v5
    v_lshl_add_u32 v5, v3, 4, v5
    v_and_b32 v6, 1, v4
    v_lshl_add_u32 v25, v6, 3, v5
    s_mul_i32 s37, s28, 92160
    s_lshl_b32 s38, s35, 9
    s_add_u32 s37, s37, s38
    v_lshlrev_b32 v26, 4, v4
    s_lshl_b32 s38, s35, 6
    s_add_u32 s38, s38, 11520
    s_waitcnt vmcnt(36)
    ds_read_b64_tr_b16 v[112:113], v144 offset:0
    ds_read_b64_tr_b16 v[114:115], v144 offset:512
    ds_read_b64_tr_b16 v[116:117], v145 offset:0
    ds_read_b64_tr_b16 v[118:119], v145 offset:512
    ds_read_b64_tr_b16 v[120:121], v146 offset:0
    ds_read_b64_tr_b16 v[122:123], v146 offset:512
    ds_read_b64_tr_b16 v[124:125], v147 offset:0
    ds_read_b64_tr_b16 v[126:127], v147 offset:512
    ds_read_b64_tr_b16 v[128:129], v144 offset:4096
    ds_read_b64_tr_b16 v[130:131], v144 offset:4608
    ds_read_b64_tr_b16 v[132:133], v145 offset:4096
    ds_read_b64_tr_b16 v[134:135], v145 offset:4608
    ds_read_b64_tr_b16 v[136:137], v146 offset:4096
    ds_read_b64_tr_b16 v[138:139], v146 offset:4608
    ds_read_b64_tr_b16 v[140:141], v147 offset:4096
    ds_read_b64_tr_b16 v[142:143], v147 offset:4608
    s_waitcnt lgkmcnt(14)
    v_mfma_f32_16x16x32_bf16 v[32:35], v[112:115], a[0:3], v[32:35]
    v_mfma_f32_16x16x32_bf16 v[36:39], v[112:115], a[8:11], v[36:39]
    s_add_u32 m0, s34, 24576
    s_nop 0
    buffer_load_dwordx4 v8, s[16:19], s31 offen lds
    v_mfma_f32_16x16x32_bf16 v[40:43], v[112:115], a[16:19], v[40:43]
    v_mfma_f32_16x16x32_bf16 v[44:47], v[112:115], a[24:27], v[44:47]
    buffer_load_dwordx4 a[120:123], v17, s[12:15], s33 offen offset:0
    v_mfma_f32_16x16x32_bf16 v[48:51], v[112:115], a[32:35], v[48:51]
    s_waitcnt lgkmcnt(12)
    v_mfma_f32_16x16x32_bf16 v[52:55], v[116:119], a[0:3], v[52:55]
    buffer_load_dwordx4 a[124:127], v17, s[12:15], s33 offen offset:1024
    v_mfma_f32_16x16x32_bf16 v[56:59], v[116:119], a[8:11], v[56:59]
    v_mfma_f32_16x16x32_bf16 v[60:63], v[116:119], a[16:19], v[60:63]
    s_add_u32 m0, s34, 25600
    s_nop 0
    buffer_load_dwordx4 v9, s[16:19], s31 offen lds
    v_mfma_f32_16x16x32_bf16 v[64:67], v[116:119], a[24:27], v[64:67]
    v_mfma_f32_16x16x32_bf16 v[68:71], v[116:119], a[32:35], v[68:71]
    buffer_load_dwordx4 a[128:131], v18, s[12:15], s33 offen offset:0
    s_waitcnt lgkmcnt(10)
    v_mfma_f32_16x16x32_bf16 v[72:75], v[120:123], a[0:3], v[72:75]
    v_mfma_f32_16x16x32_bf16 v[76:79], v[120:123], a[8:11], v[76:79]
    buffer_load_dwordx4 a[132:135], v18, s[12:15], s33 offen offset:1024
    v_mfma_f32_16x16x32_bf16 v[80:83], v[120:123], a[16:19], v[80:83]
    v_mfma_f32_16x16x32_bf16 v[84:87], v[120:123], a[24:27], v[84:87]
    s_add_u32 m0, s34, 26624
    s_nop 0
    buffer_load_dwordx4 v10, s[16:19], s31 offen lds
    v_mfma_f32_16x16x32_bf16 v[88:91], v[120:123], a[32:35], v[88:91]
    s_waitcnt lgkmcnt(8)
    v_mfma_f32_16x16x32_bf16 v[92:95], v[124:127], a[0:3], v[92:95]
    buffer_load_dwordx4 a[136:139], v19, s[12:15], s33 offen offset:0
    v_mfma_f32_16x16x32_bf16 v[96:99], v[124:127], a[8:11], v[96:99]
    v_mfma_f32_16x16x32_bf16 v[100:103], v[124:127], a[16:19], v[100:103]
    buffer_load_dwordx4 a[140:143], v19, s[12:15], s33 offen offset:1024
    v_mfma_f32_16x16x32_bf16 v[104:107], v[124:127], a[24:27], v[104:107]
    v_mfma_f32_16x16x32_bf16 v[108:111], v[124:127], a[32:35], v[108:111]
    s_add_u32 m0, s34, 27648
    s_nop 0
    buffer_load_dwordx4 v11, s[16:19], s31 offen lds
    s_waitcnt lgkmcnt(6)
    v_mfma_f32_16x16x32_bf16 v[32:35], v[128:131], a[4:7], v[32:35]
    v_mfma_f32_16x16x32_bf16 v[36:39], v[128:131], a[12:15], v[36:39]
    buffer_load_dwordx4 a[144:147], v20, s[12:15], s33 offen offset:0
    v_mfma_f32_16x16x32_bf16 v[40:43], v[128:131], a[20:23], v[40:43]
    v_mfma_f32_16x16x32_bf16 v[44:47], v[128:131], a[28:31], v[44:47]
    buffer_load_dwordx4 a[148:151], v20, s[12:15], s33 offen offset:1024
    v_mfma_f32_16x16x32_bf16 v[48:51], v[128:131], a[36:39], v[48:51]
    s_waitcnt lgkmcnt(4)
    v_mfma_f32_16x16x32_bf16 v[52:55], v[132:135], a[4:7], v[52:55]
    s_add_u32 m0, s34, 28672
    s_nop 0
    buffer_load_dwordx4 v12, s[16:19], s31 offen lds
    v_mfma_f32_16x16x32_bf16 v[56:59], v[132:135], a[12:15], v[56:59]
    v_mfma_f32_16x16x32_bf16 v[60:63], v[132:135], a[20:23], v[60:63]
    buffer_load_dwordx4 a[152:155], v21, s[12:15], s33 offen offset:0
    v_mfma_f32_16x16x32_bf16 v[64:67], v[132:135], a[28:31], v[64:67]
    v_mfma_f32_16x16x32_bf16 v[68:71], v[132:135], a[36:39], v[68:71]
    buffer_load_dwordx4 a[156:159], v21, s[12:15], s33 offen offset:1024
    s_waitcnt lgkmcnt(2)
    v_mfma_f32_16x16x32_bf16 v[72:75], v[136:139], a[4:7], v[72:75]
    v_mfma_f32_16x16x32_bf16 v[76:79], v[136:139], a[12:15], v[76:79]
    s_add_u32 m0, s34, 29696
    s_nop 0
    buffer_load_dwordx4 v13, s[16:19], s31 offen lds
    v_mfma_f32_16x16x32_bf16 v[80:83], v[136:139], a[20:23], v[80:83]
    v_mfma_f32_16x16x32_bf16 v[84:87], v[136:139], a[28:31], v[84:87]
    s_add_u32 m0, s34, 30720
    s_nop 0
    buffer_load_dwordx4 v14, s[16:19], s31 offen lds
    v_mfma_f32_16x16x32_bf16 v[88:91], v[136:139], a[36:39], v[88:91]
    s_waitcnt lgkmcnt(0)
    v_mfma_f32_16x16x32_bf16 v[92:95], v[140:143], a[4:7], v[92:95]
    s_add_u32 m0, s34, 31744
    s_nop 0
    buffer_load_dwordx4 v15, s[16:19], s31 offen lds
    s_add_u32 s31, s31, 73728
    s_add_u32 s33, s33, 2048
    v_mfma_f32_16x16x32_bf16 v[96:99], v[140:143], a[12:15], v[96:99]
    v_mfma_f32_16x16x32_bf16 v[100:103], v[140:143], a[20:23], v[100:103]
    v_mfma_f32_16x16x32_bf16 v[104:107], v[140:143], a[28:31], v[104:107]
    v_mfma_f32_16x16x32_bf16 v[108:111], v[140:143], a[36:39], v[108:111]
    s_waitcnt vmcnt(36)
    ds_read_b64_tr_b16 v[112:113], v144 offset:8192
    ds_read_b64_tr_b16 v[114:115], v144 offset:8704
    ds_read_b64_tr_b16 v[116:117], v145 offset:8192
    ds_read_b64_tr_b16 v[118:119], v145 offset:8704
    ds_read_b64_tr_b16 v[120:121], v146 offset:8192
    ds_read_b64_tr_b16 v[122:123], v146 offset:8704
    ds_read_b64_tr_b16 v[124:125], v147 offset:8192
    ds_read_b64_tr_b16 v[126:127], v147 offset:8704
    ds_read_b64_tr_b16 v[128:129], v144 offset:12288
    ds_read_b64_tr_b16 v[130:131], v144 offset:12800
    ds_read_b64_tr_b16 v[132:133], v145 offset:12288
    ds_read_b64_tr_b16 v[134:135], v145 offset:12800
    ds_read_b64_tr_b16 v[136:137], v146 offset:12288
    ds_read_b64_tr_b16 v[138:139], v146 offset:12800
    ds_read_b64_tr_b16 v[140:141], v147 offset:12288
    ds_read_b64_tr_b16 v[142:143], v147 offset:12800
    s_waitcnt lgkmcnt(14)
    v_mfma_f32_16x16x32_bf16 v[32:35], v[112:115], a[40:43], v[32:35]
    v_mfma_f32_16x16x32_bf16 v[36:39], v[112:115], a[48:51], v[36:39]
    s_add_u32 m0, s34, 0
    s_nop 0
    buffer_load_dwordx4 v8, s[16:19], s31 offen lds
    v_mfma_f32_16x16x32_bf16 v[40:43], v[112:115], a[56:59], v[40:43]
    v_mfma_f32_16x16x32_bf16 v[44:47], v[112:115], a[64:67], v[44:47]
    buffer_load_dwordx4 a[0:3], v17, s[12:15], s33 offen offset:0
    v_mfma_f32_16x16x32_bf16 v[48:51], v[112:115], a[72:75], v[48:51]
    s_waitcnt lgkmcnt(12)
    v_mfma_f32_16x16x32_bf16 v[52:55], v[116:119], a[40:43], v[52:55]
    buffer_load_dwordx4 a[4:7], v17, s[12:15], s33 offen offset:1024
    v_mfma_f32_16x16x32_bf16 v[56:59], v[116:119], a[48:51], v[56:59]
    v_mfma_f32_16x16x32_bf16 v[60:63], v[116:119], a[56:59], v[60:63]
    s_add_u32 m0, s34, 1024
    s_nop 0
    buffer_load_dwordx4 v9, s[16:19], s31 offen lds
    v_mfma_f32_16x16x32_bf16 v[64:67], v[116:119], a[64:67], v[64:67]
    v_mfma_f32_16x16x32_bf16 v[68:71], v[116:119], a[72:75], v[68:71]
    buffer_load_dwordx4 a[8:11], v18, s[12:15], s33 offen offset:0
    s_waitcnt lgkmcnt(10)
    v_mfma_f32_16x16x32_bf16 v[72:75], v[120:123], a[40:43], v[72:75]
    v_mfma_f32_16x16x32_bf16 v[76:79], v[120:123], a[48:51], v[76:79]
    buffer_load_dwordx4 a[12:15], v18, s[12:15], s33 offen offset:1024
    v_mfma_f32_16x16x32_bf16 v[80:83], v[120:123], a[56:59], v[80:83]
    v_mfma_f32_16x16x32_bf16 v[84:87], v[120:123], a[64:67], v[84:87]
    s_add_u32 m0, s34, 2048
    s_nop 0
    buffer_load_dwordx4 v10, s[16:19], s31 offen lds
    v_mfma_f32_16x16x32_bf16 v[88:91], v[120:123], a[72:75], v[88:91]
    s_waitcnt lgkmcnt(8)
    v_mfma_f32_16x16x32_bf16 v[92:95], v[124:127], a[40:43], v[92:95]
    buffer_load_dwordx4 a[16:19], v19, s[12:15], s33 offen offset:0
    v_mfma_f32_16x16x32_bf16 v[96:99], v[124:127], a[48:51], v[96:99]
    v_mfma_f32_16x16x32_bf16 v[100:103], v[124:127], a[56:59], v[100:103]
    buffer_load_dwordx4 a[20:23], v19, s[12:15], s33 offen offset:1024
    v_mfma_f32_16x16x32_bf16 v[104:107], v[124:127], a[64:67], v[104:107]
    v_mfma_f32_16x16x32_bf16 v[108:111], v[124:127], a[72:75], v[108:111]
    s_add_u32 m0, s34, 3072
    s_nop 0
    buffer_load_dwordx4 v11, s[16:19], s31 offen lds
    s_waitcnt lgkmcnt(6)
    v_mfma_f32_16x16x32_bf16 v[32:35], v[128:131], a[44:47], v[32:35]
    v_mfma_f32_16x16x32_bf16 v[36:39], v[128:131], a[52:55], v[36:39]
    buffer_load_dwordx4 a[24:27], v20, s[12:15], s33 offen offset:0
    v_mfma_f32_16x16x32_bf16 v[40:43], v[128:131], a[60:63], v[40:43]
    v_mfma_f32_16x16x32_bf16 v[44:47], v[128:131], a[68:71], v[44:47]
    buffer_load_dwordx4 a[28:31], v20, s[12:15], s33 offen offset:1024
    v_mfma_f32_16x16x32_bf16 v[48:51], v[128:131], a[76:79], v[48:51]
    s_waitcnt lgkmcnt(4)
    v_mfma_f32_16x16x32_bf16 v[52:55], v[132:135], a[44:47], v[52:55]
    s_add_u32 m0, s34, 4096
    s_nop 0
    buffer_load_dwordx4 v12, s[16:19], s31 offen lds
    v_mfma_f32_16x16x32_bf16 v[56:59], v[132:135], a[52:55], v[56:59]
    v_mfma_f32_16x16x32_bf16 v[60:63], v[132:135], a[60:63], v[60:63]
    buffer_load_dwordx4 a[32:35], v21, s[12:15], s33 offen offset:0
    v_mfma_f32_16x16x32_bf16 v[64:67], v[132:135], a[68:71], v[64:67]
    v_mfma_f32_16x16x32_bf16 v[68:71], v[132:135], a[76:79], v[68:71]
    buffer_load_dwordx4 a[36:39], v21, s[12:15], s33 offen offset:1024
    s_waitcnt lgkmcnt(2)
    v_mfma_f32_16x16x32_bf16 v[72:75], v[136:139], a[44:47], v[72:75]
    v_mfma_f32_16x16x32_bf16 v[76:79], v[136:139], a[52:55], v[76:79]
    s_add_u32 m0, s34, 5120
    s_nop 0
    buffer_load_dwordx4 v13, s[16:19], s31 offen lds
    v_mfma_f32_16x16x32_bf16 v[80:83], v[136:139], a[60:63], v[80:83]
    v_mfma_f32_16x16x32_bf16 v[84:87], v[136:139], a[68:71], v[84:87]
    s_add_u32 m0, s34, 6144
    s_nop 0
    buffer_load_dwordx4 v14, s[16:19], s31 offen lds
    v_mfma_f32_16x16x32_bf16 v[88:91], v[136:139], a[76:79], v[88:91]
    s_waitcnt lgkmcnt(0)
    v_mfma_f32_16x16x32_bf16 v[92:95], v[140:143], a[44:47], v[92:95]
    s_add_u32 m0, s34, 7168
    s_nop 0
    buffer_load_dwordx4 v15, s[16:19], s31 offen lds
    s_add_u32 s31, s31, 73728
    s_add_u32 s33, s33, 2048
    v_mfma_f32_16x16x32_bf16 v[96:99], v[140:143], a[52:55], v[96:99]
    v_mfma_f32_16x16x32_bf16 v[100:103], v[140:143], a[60:63], v[100:103]
    v_mfma_f32_16x16x32_bf16 v[104:107], v[140:143], a[68:71], v[104:107]
    v_mfma_f32_16x16x32_bf16 v[108:111], v[140:143], a[76:79], v[108:111]
    s_waitcnt vmcnt(36)
    ds_read_b64_tr_b16 v[112:113], v144 offset:16384
    ds_read_b64_tr_b16 v[114:115], v144 offset:16896
    ds_read_b64_tr_b16 v[116:117], v145 offset:16384
    ds_read_b64_tr_b16 v[118:119], v145 offset:16896
    ds_read_b64_tr_b16 v[120:121], v146 offset:16384
    ds_read_b64_tr_b16 v[122:123], v146 offset:16896
    ds_read_b64_tr_b16 v[124:125], v147 offset:16384
    ds_read_b64_tr_b16 v[126:127], v147 offset:16896
    ds_read_b64_tr_b16 v[128:129], v144 offset:20480
    ds_read_b64_tr_b16 v[130:131], v144 offset:20992
    ds_read_b64_tr_b16 v[132:133], v145 offset:20480
    ds_read_b64_tr_b16 v[134:135], v145 offset:20992
    ds_read_b64_tr_b16 v[136:137], v146 offset:20480
    ds_read_b64_tr_b16 v[138:139], v146 offset:20992
    ds_read_b64_tr_b16 v[140:141], v147 offset:20480
    ds_read_b64_tr_b16 v[142:143], v147 offset:20992
    s_waitcnt lgkmcnt(14)
    v_mfma_f32_16x16x32_bf16 v[32:35], v[112:115], a[80:83], v[32:35]
    v_mfma_f32_16x16x32_bf16 v[36:39], v[112:115], a[88:91], v[36:39]
    s_add_u32 m0, s34, 8192
    s_nop 0
    buffer_load_dwordx4 v8, s[16:19], s31 offen lds
    v_mfma_f32_16x16x32_bf16 v[40:43], v[112:115], a[96:99], v[40:43]
    v_mfma_f32_16x16x32_bf16 v[44:47], v[112:115], a[104:107], v[44:47]
    buffer_load_dwordx4 a[40:43], v17, s[12:15], s33 offen offset:0
    v_mfma_f32_16x16x32_bf16 v[48:51], v[112:115], a[112:115], v[48:51]
    s_waitcnt lgkmcnt(12)
    v_mfma_f32_16x16x32_bf16 v[52:55], v[116:119], a[80:83], v[52:55]
    buffer_load_dwordx4 a[44:47], v17, s[12:15], s33 offen offset:1024
    v_mfma_f32_16x16x32_bf16 v[56:59], v[116:119], a[88:91], v[56:59]
    v_mfma_f32_16x16x32_bf16 v[60:63], v[116:119], a[96:99], v[60:63]
    s_add_u32 m0, s34, 9216
    s_nop 0
    buffer_load_dwordx4 v9, s[16:19], s31 offen lds
    v_mfma_f32_16x16x32_bf16 v[64:67], v[116:119], a[104:107], v[64:67]
    v_mfma_f32_16x16x32_bf16 v[68:71], v[116:119], a[112:115], v[68:71]
    buffer_load_dwordx4 a[48:51], v18, s[12:15], s33 offen offset:0
    s_waitcnt lgkmcnt(10)
    v_mfma_f32_16x16x32_bf16 v[72:75], v[120:123], a[80:83], v[72:75]
    v_mfma_f32_16x16x32_bf16 v[76:79], v[120:123], a[88:91], v[76:79]
    buffer_load_dwordx4 a[52:55], v18, s[12:15], s33 offen offset:1024
    v_mfma_f32_16x16x32_bf16 v[80:83], v[120:123], a[96:99], v[80:83]
    v_mfma_f32_16x16x32_bf16 v[84:87], v[120:123], a[104:107], v[84:87]
    s_add_u32 m0, s34, 10240
    s_nop 0
    buffer_load_dwordx4 v10, s[16:19], s31 offen lds
    v_mfma_f32_16x16x32_bf16 v[88:91], v[120:123], a[112:115], v[88:91]
    s_waitcnt lgkmcnt(8)
    v_mfma_f32_16x16x32_bf16 v[92:95], v[124:127], a[80:83], v[92:95]
    buffer_load_dwordx4 a[56:59], v19, s[12:15], s33 offen offset:0
    v_mfma_f32_16x16x32_bf16 v[96:99], v[124:127], a[88:91], v[96:99]
    v_mfma_f32_16x16x32_bf16 v[100:103], v[124:127], a[96:99], v[100:103]
    buffer_load_dwordx4 a[60:63], v19, s[12:15], s33 offen offset:1024
    v_mfma_f32_16x16x32_bf16 v[104:107], v[124:127], a[104:107], v[104:107]
    v_mfma_f32_16x16x32_bf16 v[108:111], v[124:127], a[112:115], v[108:111]
    s_add_u32 m0, s34, 11264
    s_nop 0
    buffer_load_dwordx4 v11, s[16:19], s31 offen lds
    s_waitcnt lgkmcnt(6)
    v_mfma_f32_16x16x32_bf16 v[32:35], v[128:131], a[84:87], v[32:35]
    v_mfma_f32_16x16x32_bf16 v[36:39], v[128:131], a[92:95], v[36:39]
    buffer_load_dwordx4 a[64:67], v20, s[12:15], s33 offen offset:0
    v_mfma_f32_16x16x32_bf16 v[40:43], v[128:131], a[100:103], v[40:43]
    v_mfma_f32_16x16x32_bf16 v[44:47], v[128:131], a[108:111], v[44:47]
    buffer_load_dwordx4 a[68:71], v20, s[12:15], s33 offen offset:1024
    v_mfma_f32_16x16x32_bf16 v[48:51], v[128:131], a[116:119], v[48:51]
    s_waitcnt lgkmcnt(4)
    v_mfma_f32_16x16x32_bf16 v[52:55], v[132:135], a[84:87], v[52:55]
    s_add_u32 m0, s34, 12288
    s_nop 0
    buffer_load_dwordx4 v12, s[16:19], s31 offen lds
    v_mfma_f32_16x16x32_bf16 v[56:59], v[132:135], a[92:95], v[56:59]
    v_mfma_f32_16x16x32_bf16 v[60:63], v[132:135], a[100:103], v[60:63]
    buffer_load_dwordx4 a[72:75], v21, s[12:15], s33 offen offset:0
    v_mfma_f32_16x16x32_bf16 v[64:67], v[132:135], a[108:111], v[64:67]
    v_mfma_f32_16x16x32_bf16 v[68:71], v[132:135], a[116:119], v[68:71]
    buffer_load_dwordx4 a[76:79], v21, s[12:15], s33 offen offset:1024
    s_waitcnt lgkmcnt(2)
    v_mfma_f32_16x16x32_bf16 v[72:75], v[136:139], a[84:87], v[72:75]
    v_mfma_f32_16x16x32_bf16 v[76:79], v[136:139], a[92:95], v[76:79]
    s_add_u32 m0, s34, 13312
    s_nop 0
    buffer_load_dwordx4 v13, s[16:19], s31 offen lds
    v_mfma_f32_16x16x32_bf16 v[80:83], v[136:139], a[100:103], v[80:83]
    v_mfma_f32_16x16x32_bf16 v[84:87], v[136:139], a[108:111], v[84:87]
    s_add_u32 m0, s34, 14336
    s_nop 0
    buffer_load_dwordx4 v14, s[16:19], s31 offen lds
    v_mfma_f32_16x16x32_bf16 v[88:91], v[136:139], a[116:119], v[88:91]
    s_waitcnt lgkmcnt(0)
    v_mfma_f32_16x16x32_bf16 v[92:95], v[140:143], a[84:87], v[92:95]
    s_add_u32 m0, s34, 15360
    s_nop 0
    buffer_load_dwordx4 v15, s[16:19], s31 offen lds
    s_add_u32 s31, s31, 73728
    s_add_u32 s33, s33, 2048
    v_mfma_f32_16x16x32_bf16 v[96:99], v[140:143], a[92:95], v[96:99]
    v_mfma_f32_16x16x32_bf16 v[100:103], v[140:143], a[100:103], v[100:103]
    v_mfma_f32_16x16x32_bf16 v[104:107], v[140:143], a[108:111], v[104:107]
    v_mfma_f32_16x16x32_bf16 v[108:111], v[140:143], a[116:119], v[108:111]
    s_waitcnt vmcnt(36)
    ds_read_b64_tr_b16 v[112:113], v144 offset:24576
    ds_read_b64_tr_b16 v[114:115], v144 offset:25088
    ds_read_b64_tr_b16 v[116:117], v145 offset:24576
    ds_read_b64_tr_b16 v[118:119], v145 offset:25088
    ds_read_b64_tr_b16 v[120:121], v146 offset:24576
    ds_read_b64_tr_b16 v[122:123], v146 offset:25088
    ds_read_b64_tr_b16 v[124:125], v147 offset:24576
    ds_read_b64_tr_b16 v[126:127], v147 offset:25088
    ds_read_b64_tr_b16 v[128:129], v144 offset:28672
    ds_read_b64_tr_b16 v[130:131], v144 offset:29184
    ds_read_b64_tr_b16 v[132:133], v145 offset:28672
    ds_read_b64_tr_b16 v[134:135], v145 offset:29184
    ds_read_b64_tr_b16 v[136:137], v146 offset:28672
    ds_read_b64_tr_b16 v[138:139], v146 offset:29184
    ds_read_b64_tr_b16 v[140:141], v147 offset:28672
    ds_read_b64_tr_b16 v[142:143], v147 offset:29184
    s_waitcnt lgkmcnt(14)
    v_mfma_f32_16x16x32_bf16 v[32:35], v[112:115], a[120:123], v[32:35]
    v_mfma_f32_16x16x32_bf16 v[36:39], v[112:115], a[128:131], v[36:39]
    s_add_u32 m0, s34, 16384
    s_nop 0
    buffer_load_dwordx4 v8, s[16:19], s31 offen lds
    v_mfma_f32_16x16x32_bf16 v[40:43], v[112:115], a[136:139], v[40:43]
    v_mfma_f32_16x16x32_bf16 v[44:47], v[112:115], a[144:147], v[44:47]
    buffer_load_dwordx4 a[80:83], v17, s[12:15], s33 offen offset:0
    v_mfma_f32_16x16x32_bf16 v[48:51], v[112:115], a[152:155], v[48:51]
    s_waitcnt lgkmcnt(12)
    v_mfma_f32_16x16x32_bf16 v[52:55], v[116:119], a[120:123], v[52:55]
    buffer_load_dwordx4 a[84:87], v17, s[12:15], s33 offen offset:1024
    v_mfma_f32_16x16x32_bf16 v[56:59], v[116:119], a[128:131], v[56:59]
    v_mfma_f32_16x16x32_bf16 v[60:63], v[116:119], a[136:139], v[60:63]
    s_add_u32 m0, s34, 17408
    s_nop 0
    buffer_load_dwordx4 v9, s[16:19], s31 offen lds
    v_mfma_f32_16x16x32_bf16 v[64:67], v[116:119], a[144:147], v[64:67]
    v_mfma_f32_16x16x32_bf16 v[68:71], v[116:119], a[152:155], v[68:71]
    buffer_load_dwordx4 a[88:91], v18, s[12:15], s33 offen offset:0
    s_waitcnt lgkmcnt(10)
    v_mfma_f32_16x16x32_bf16 v[72:75], v[120:123], a[120:123], v[72:75]
    v_mfma_f32_16x16x32_bf16 v[76:79], v[120:123], a[128:131], v[76:79]
    buffer_load_dwordx4 a[92:95], v18, s[12:15], s33 offen offset:1024
    v_mfma_f32_16x16x32_bf16 v[80:83], v[120:123], a[136:139], v[80:83]
    v_mfma_f32_16x16x32_bf16 v[84:87], v[120:123], a[144:147], v[84:87]
    s_add_u32 m0, s34, 18432
    s_nop 0
    buffer_load_dwordx4 v10, s[16:19], s31 offen lds
    v_mfma_f32_16x16x32_bf16 v[88:91], v[120:123], a[152:155], v[88:91]
    s_waitcnt lgkmcnt(8)
    v_mfma_f32_16x16x32_bf16 v[92:95], v[124:127], a[120:123], v[92:95]
    buffer_load_dwordx4 a[96:99], v19, s[12:15], s33 offen offset:0
    v_mfma_f32_16x16x32_bf16 v[96:99], v[124:127], a[128:131], v[96:99]
    v_mfma_f32_16x16x32_bf16 v[100:103], v[124:127], a[136:139], v[100:103]
    buffer_load_dwordx4 a[100:103], v19, s[12:15], s33 offen offset:1024
    v_mfma_f32_16x16x32_bf16 v[104:107], v[124:127], a[144:147], v[104:107]
    v_mfma_f32_16x16x32_bf16 v[108:111], v[124:127], a[152:155], v[108:111]
    s_add_u32 m0, s34, 19456
    s_nop 0
    buffer_load_dwordx4 v11, s[16:19], s31 offen lds
    s_waitcnt lgkmcnt(6)
    v_mfma_f32_16x16x32_bf16 v[32:35], v[128:131], a[124:127], v[32:35]
    v_mfma_f32_16x16x32_bf16 v[36:39], v[128:131], a[132:135], v[36:39]
    buffer_load_dwordx4 a[104:107], v20, s[12:15], s33 offen offset:0
    v_mfma_f32_16x16x32_bf16 v[40:43], v[128:131], a[140:143], v[40:43]
    v_mfma_f32_16x16x32_bf16 v[44:47], v[128:131], a[148:151], v[44:47]
    buffer_load_dwordx4 a[108:111], v20, s[12:15], s33 offen offset:1024
    v_mfma_f32_16x16x32_bf16 v[48:51], v[128:131], a[156:159], v[48:51]
    s_waitcnt lgkmcnt(4)
    v_mfma_f32_16x16x32_bf16 v[52:55], v[132:135], a[124:127], v[52:55]
    s_add_u32 m0, s34, 20480
    s_nop 0
    buffer_load_dwordx4 v12, s[16:19], s31 offen lds
    v_mfma_f32_16x16x32_bf16 v[56:59], v[132:135], a[132:135], v[56:59]
    v_mfma_f32_16x16x32_bf16 v[60:63], v[132:135], a[140:143], v[60:63]
    buffer_load_dwordx4 a[112:115], v21, s[12:15], s33 offen offset:0
    v_mfma_f32_16x16x32_bf16 v[64:67], v[132:135], a[148:151], v[64:67]
    v_mfma_f32_16x16x32_bf16 v[68:71], v[132:135], a[156:159], v[68:71]
    buffer_load_dwordx4 a[116:119], v21, s[12:15], s33 offen offset:1024
    s_waitcnt lgkmcnt(2)
    v_mfma_f32_16x16x32_bf16 v[72:75], v[136:139], a[124:127], v[72:75]
    v_mfma_f32_16x16x32_bf16 v[76:79], v[136:139], a[132:135], v[76:79]
    s_add_u32 m0, s34, 21504
    s_nop 0
    buffer_load_dwordx4 v13, s[16:19], s31 offen lds
    v_mfma_f32_16x16x32_bf16 v[80:83], v[136:139], a[140:143], v[80:83]
    v_mfma_f32_16x16x32_bf16 v[84:87], v[136:139], a[148:151], v[84:87]
    s_add_u32 m0, s34, 22528
    s_nop 0
    buffer_load_dwordx4 v14, s[16:19], s31 offen lds
    v_mfma_f32_16x16x32_bf16 v[88:91], v[136:139], a[156:159], v[88:91]
    s_waitcnt lgkmcnt(0)
    v_mfma_f32_16x16x32_bf16 v[92:95], v[140:143], a[124:127], v[92:95]
    s_add_u32 m0, s34, 23552
    s_nop 0
    buffer_load_dwordx4 v15, s[16:19], s31 offen lds
    s_add_u32 s31, s31, 73728
    s_add_u32 s33, s33, 2048
    v_mfma_f32_16x16x32_bf16 v[96:99], v[140:143], a[132:135], v[96:99]
    v_mfma_f32_16x16x32_bf16 v[100:103], v[140:143], a[140:143], v[100:103]
    v_mfma_f32_16x16x32_bf16 v[104:107], v[140:143], a[148:151], v[104:107]
    v_mfma_f32_16x16x32_bf16 v[108:111], v[140:143], a[156:159], v[108:111]
    s_waitcnt vmcnt(36)
    ds_read_b64_tr_b16 v[112:113], v144 offset:0
    ds_read_b64_tr_b16 v[114:115], v144 offset:512
    ds_read_b64_tr_b16 v[116:117], v145 offset:0
    ds_read_b64_tr_b16 v[118:119], v145 offset:512
    ds_read_b64_tr_b16 v[120:121], v146 offset:0
    ds_read_b64_tr_b16 v[122:123], v146 offset:512
    ds_read_b64_tr_b16 v[124:125], v147 offset:0
    ds_read_b64_tr_b16 v[126:127], v147 offset:512
    ds_read_b64_tr_b16 v[128:129], v144 offset:4096
    ds_read_b64_tr_b16 v[130:131], v144 offset:4608
    ds_read_b64_tr_b16 v[132:133], v145 offset:4096
    ds_read_b64_tr_b16 v[134:135], v145 offset:4608
    ds_read_b64_tr_b16 v[136:137], v146 offset:4096
    ds_read_b64_tr_b16 v[138:139], v146 offset:4608
    ds_read_b64_tr_b16 v[140:141], v147 offset:4096
    ds_read_b64_tr_b16 v[142:143], v147 offset:4608
    s_waitcnt lgkmcnt(14)
    v_mfma_f32_16x16x32_bf16 v[32:35], v[112:115], a[0:3], v[32:35]
    v_mfma_f32_16x16x32_bf16 v[36:39], v[112:115], a[8:11], v[36:39]
    s_add_u32 m0, s34, 24576
    s_nop 0
    buffer_load_dwordx4 v8, s[16:19], s31 offen lds
    v_mfma_f32_16x16x32_bf16 v[40:43], v[112:115], a[16:19], v[40:43]
    v_mfma_f32_16x16x32_bf16 v[44:47], v[112:115], a[24:27], v[44:47]
    buffer_load_dwordx4 a[120:123], v17, s[12:15], s33 offen offset:0
    v_mfma_f32_16x16x32_bf16 v[48:51], v[112:115], a[32:35], v[48:51]
    s_waitcnt lgkmcnt(12)
    v_mfma_f32_16x16x32_bf16 v[52:55], v[116:119], a[0:3], v[52:55]
    buffer_load_dwordx4 a[124:127], v17, s[12:15], s33 offen offset:1024
    v_mfma_f32_16x16x32_bf16 v[56:59], v[116:119], a[8:11], v[56:59]
    v_mfma_f32_16x16x32_bf16 v[60:63], v[116:119], a[16:19], v[60:63]
    s_add_u32 m0, s34, 25600
    s_nop 0
    buffer_load_dwordx4 v9, s[16:19], s31 offen lds
    v_mfma_f32_16x16x32_bf16 v[64:67], v[116:119], a[24:27], v[64:67]
    v_mfma_f32_16x16x32_bf16 v[68:71], v[116:119], a[32:35], v[68:71]
    buffer_load_dwordx4 a[128:131], v18, s[12:15], s33 offen offset:0
    s_waitcnt lgkmcnt(10)
    v_mfma_f32_16x16x32_bf16 v[72:75], v[120:123], a[0:3], v[72:75]
    v_mfma_f32_16x16x32_bf16 v[76:79], v[120:123], a[8:11], v[76:79]
    buffer_load_dwordx4 a[132:135], v18, s[12:15], s33 offen offset:1024
    v_mfma_f32_16x16x32_bf16 v[80:83], v[120:123], a[16:19], v[80:83]
    v_mfma_f32_16x16x32_bf16 v[84:87], v[120:123], a[24:27], v[84:87]
    s_add_u32 m0, s34, 26624
    s_nop 0
    buffer_load_dwordx4 v10, s[16:19], s31 offen lds
    v_mfma_f32_16x16x32_bf16 v[88:91], v[120:123], a[32:35], v[88:91]
    s_waitcnt lgkmcnt(8)
    v_mfma_f32_16x16x32_bf16 v[92:95], v[124:127], a[0:3], v[92:95]
    buffer_load_dwordx4 a[136:139], v19, s[12:15], s33 offen offset:0
    v_mfma_f32_16x16x32_bf16 v[96:99], v[124:127], a[8:11], v[96:99]
    v_mfma_f32_16x16x32_bf16 v[100:103], v[124:127], a[16:19], v[100:103]
    buffer_load_dwordx4 a[140:143], v19, s[12:15], s33 offen offset:1024
    v_mfma_f32_16x16x32_bf16 v[104:107], v[124:127], a[24:27], v[104:107]
    v_mfma_f32_16x16x32_bf16 v[108:111], v[124:127], a[32:35], v[108:111]
    s_add_u32 m0, s34, 27648
    s_nop 0
    buffer_load_dwordx4 v11, s[16:19], s31 offen lds
    s_waitcnt lgkmcnt(6)
    v_mfma_f32_16x16x32_bf16 v[32:35], v[128:131], a[4:7], v[32:35]
    v_mfma_f32_16x16x32_bf16 v[36:39], v[128:131], a[12:15], v[36:39]
    buffer_load_dwordx4 a[144:147], v20, s[12:15], s33 offen offset:0
    v_mfma_f32_16x16x32_bf16 v[40:43], v[128:131], a[20:23], v[40:43]
    v_mfma_f32_16x16x32_bf16 v[44:47], v[128:131], a[28:31], v[44:47]
    buffer_load_dwordx4 a[148:151], v20, s[12:15], s33 offen offset:1024
    v_mfma_f32_16x16x32_bf16 v[48:51], v[128:131], a[36:39], v[48:51]
    s_waitcnt lgkmcnt(4)
    v_mfma_f32_16x16x32_bf16 v[52:55], v[132:135], a[4:7], v[52:55]
    s_add_u32 m0, s34, 28672
    s_nop 0
    buffer_load_dwordx4 v12, s[16:19], s31 offen lds
    v_mfma_f32_16x16x32_bf16 v[56:59], v[132:135], a[12:15], v[56:59]
    v_mfma_f32_16x16x32_bf16 v[60:63], v[132:135], a[20:23], v[60:63]
    buffer_load_dwordx4 a[152:155], v21, s[12:15], s33 offen offset:0
    v_mfma_f32_16x16x32_bf16 v[64:67], v[132:135], a[28:31], v[64:67]
    v_mfma_f32_16x16x32_bf16 v[68:71], v[132:135], a[36:39], v[68:71]
    buffer_load_dwordx4 a[156:159], v21, s[12:15], s33 offen offset:1024
    s_waitcnt lgkmcnt(2)
    v_mfma_f32_16x16x32_bf16 v[72:75], v[136:139], a[4:7], v[72:75]
    v_mfma_f32_16x16x32_bf16 v[76:79], v[136:139], a[12:15], v[76:79]
    s_add_u32 m0, s34, 29696
    s_nop 0
    buffer_load_dwordx4 v13, s[16:19], s31 offen lds
    v_mfma_f32_16x16x32_bf16 v[80:83], v[136:139], a[20:23], v[80:83]
    v_mfma_f32_16x16x32_bf16 v[84:87], v[136:139], a[28:31], v[84:87]
    s_add_u32 m0, s34, 30720
    s_nop 0
    buffer_load_dwordx4 v14, s[16:19], s31 offen lds
    v_mfma_f32_16x16x32_bf16 v[88:91], v[136:139], a[36:39], v[88:91]
    s_waitcnt lgkmcnt(0)
    v_mfma_f32_16x16x32_bf16 v[92:95], v[140:143], a[4:7], v[92:95]
    s_add_u32 m0, s34, 31744
    s_nop 0
    buffer_load_dwordx4 v15, s[16:19], s31 offen lds
    s_add_u32 s31, s31, 73728
    s_add_u32 s33, s33, 2048
    v_mfma_f32_16x16x32_bf16 v[96:99], v[140:143], a[12:15], v[96:99]
    v_mfma_f32_16x16x32_bf16 v[100:103], v[140:143], a[20:23], v[100:103]
    v_mfma_f32_16x16x32_bf16 v[104:107], v[140:143], a[28:31], v[104:107]
    v_mfma_f32_16x16x32_bf16 v[108:111], v[140:143], a[36:39], v[108:111]
    s_waitcnt vmcnt(36)
    ds_read_b64_tr_b16 v[112:113], v144 offset:8192
    ds_read_b64_tr_b16 v[114:115], v144 offset:8704
    ds_read_b64_tr_b16 v[116:117], v145 offset:8192
    ds_read_b64_tr_b16 v[118:119], v145 offset:8704
    ds_read_b64_tr_b16 v[120:121], v146 offset:8192
    ds_read_b64_tr_b16 v[122:123], v146 offset:8704
    ds_read_b64_tr_b16 v[124:125], v147 offset:8192
    ds_read_b64_tr_b16 v[126:127], v147 offset:8704
    ds_read_b64_tr_b16 v[128:129], v144 offset:12288
    ds_read_b64_tr_b16 v[130:131], v144 offset:12800
    ds_read_b64_tr_b16 v[132:133], v145 offset:12288
    ds_read_b64_tr_b16 v[134:135], v145 offset:12800
    ds_read_b64_tr_b16 v[136:137], v146 offset:12288
    ds_read_b64_tr_b16 v[138:139], v146 offset:12800
    ds_read_b64_tr_b16 v[140:141], v147 offset:12288
    ds_read_b64_tr_b16 v[142:143], v147 offset:12800
    s_waitcnt lgkmcnt(14)
    v_mfma_f32_16x16x32_bf16 v[32:35], v[112:115], a[40:43], v[32:35]
    v_mfma_f32_16x16x32_bf16 v[36:39], v[112:115], a[48:51], v[36:39]
    s_add_u32 m0, s34, 0
    s_nop 0
    buffer_load_dwordx4 v8, s[16:19], s31 offen lds
    v_mfma_f32_16x16x32_bf16 v[40:43], v[112:115], a[56:59], v[40:43]
    v_mfma_f32_16x16x32_bf16 v[44:47], v[112:115], a[64:67], v[44:47]
    buffer_load_dwordx4 a[0:3], v17, s[12:15], s33 offen offset:0
    v_mfma_f32_16x16x32_bf16 v[48:51], v[112:115], a[72:75], v[48:51]
    s_waitcnt lgkmcnt(12)
    v_mfma_f32_16x16x32_bf16 v[52:55], v[116:119], a[40:43], v[52:55]
    buffer_load_dwordx4 a[4:7], v17, s[12:15], s33 offen offset:1024
    v_mfma_f32_16x16x32_bf16 v[56:59], v[116:119], a[48:51], v[56:59]
    v_mfma_f32_16x16x32_bf16 v[60:63], v[116:119], a[56:59], v[60:63]
    s_add_u32 m0, s34, 1024
    s_nop 0
    buffer_load_dwordx4 v9, s[16:19], s31 offen lds
    v_mfma_f32_16x16x32_bf16 v[64:67], v[116:119], a[64:67], v[64:67]
    v_mfma_f32_16x16x32_bf16 v[68:71], v[116:119], a[72:75], v[68:71]
    buffer_load_dwordx4 a[8:11], v18, s[12:15], s33 offen offset:0
    s_waitcnt lgkmcnt(10)
    v_mfma_f32_16x16x32_bf16 v[72:75], v[120:123], a[40:43], v[72:75]
    v_mfma_f32_16x16x32_bf16 v[76:79], v[120:123], a[48:51], v[76:79]
    buffer_load_dwordx4 a[12:15], v18, s[12:15], s33 offen offset:1024
    v_mfma_f32_16x16x32_bf16 v[80:83], v[120:123], a[56:59], v[80:83]
    v_mfma_f32_16x16x32_bf16 v[84:87], v[120:123], a[64:67], v[84:87]
    s_add_u32 m0, s34, 2048
    s_nop 0
    buffer_load_dwordx4 v10, s[16:19], s31 offen lds
    v_mfma_f32_16x16x32_bf16 v[88:91], v[120:123], a[72:75], v[88:91]
    s_waitcnt lgkmcnt(8)
    v_mfma_f32_16x16x32_bf16 v[92:95], v[124:127], a[40:43], v[92:95]
    buffer_load_dwordx4 a[16:19], v19, s[12:15], s33 offen offset:0
    v_mfma_f32_16x16x32_bf16 v[96:99], v[124:127], a[48:51], v[96:99]
    v_mfma_f32_16x16x32_bf16 v[100:103], v[124:127], a[56:59], v[100:103]
    buffer_load_dwordx4 a[20:23], v19, s[12:15], s33 offen offset:1024
    v_mfma_f32_16x16x32_bf16 v[104:107], v[124:127], a[64:67], v[104:107]
    v_mfma_f32_16x16x32_bf16 v[108:111], v[124:127], a[72:75], v[108:111]
    s_add_u32 m0, s34, 3072
    s_nop 0
    buffer_load_dwordx4 v11, s[16:19], s31 offen lds
    s_waitcnt lgkmcnt(6)
    v_mfma_f32_16x16x32_bf16 v[32:35], v[128:131], a[44:47], v[32:35]
    v_mfma_f32_16x16x32_bf16 v[36:39], v[128:131], a[52:55], v[36:39]
    buffer_load_dwordx4 a[24:27], v20, s[12:15], s33 offen offset:0
    v_mfma_f32_16x16x32_bf16 v[40:43], v[128:131], a[60:63], v[40:43]
    v_mfma_f32_16x16x32_bf16 v[44:47], v[128:131], a[68:71], v[44:47]
    buffer_load_dwordx4 a[28:31], v20, s[12:15], s33 offen offset:1024
    v_mfma_f32_16x16x32_bf16 v[48:51], v[128:131], a[76:79], v[48:51]
    s_waitcnt lgkmcnt(4)
    v_mfma_f32_16x16x32_bf16 v[52:55], v[132:135], a[44:47], v[52:55]
    s_add_u32 m0, s34, 4096
    s_nop 0
    buffer_load_dwordx4 v12, s[16:19], s31 offen lds
    v_mfma_f32_16x16x32_bf16 v[56:59], v[132:135], a[52:55], v[56:59]
    v_mfma_f32_16x16x32_bf16 v[60:63], v[132:135], a[60:63], v[60:63]
    buffer_load_dwordx4 a[32:35], v21, s[12:15], s33 offen offset:0
    v_mfma_f32_16x16x32_bf16 v[64:67], v[132:135], a[68:71], v[64:67]
    v_mfma_f32_16x16x32_bf16 v[68:71], v[132:135], a[76:79], v[68:71]
    buffer_load_dwordx4 a[36:39], v21, s[12:15], s33 offen offset:1024
    s_waitcnt lgkmcnt(2)
    v_mfma_f32_16x16x32_bf16 v[72:75], v[136:139], a[44:47], v[72:75]
    v_mfma_f32_16x16x32_bf16 v[76:79], v[136:139], a[52:55], v[76:79]
    s_add_u32 m0, s34, 5120
    s_nop 0
    buffer_load_dwordx4 v13, s[16:19], s31 offen lds
    v_mfma_f32_16x16x32_bf16 v[80:83], v[136:139], a[60:63], v[80:83]
    v_mfma_f32_16x16x32_bf16 v[84:87], v[136:139], a[68:71], v[84:87]
    s_add_u32 m0, s34, 6144
    s_nop 0
    buffer_load_dwordx4 v14, s[16:19], s31 offen lds
    v_mfma_f32_16x16x32_bf16 v[88:91], v[136:139], a[76:79], v[88:91]
    s_waitcnt lgkmcnt(0)
    v_mfma_f32_16x16x32_bf16 v[92:95], v[140:143], a[44:47], v[92:95]
    s_add_u32 m0, s34, 7168
    s_nop 0
    buffer_load_dwordx4 v15, s[16:19], s31 offen lds
    s_add_u32 s31, s31, 73728
    s_add_u32 s33, s33, 2048
    v_mfma_f32_16x16x32_bf16 v[96:99], v[140:143], a[52:55], v[96:99]
    v_mfma_f32_16x16x32_bf16 v[100:103], v[140:143], a[60:63], v[100:103]
    v_mfma_f32_16x16x32_bf16 v[104:107], v[140:143], a[68:71], v[104:107]
    v_mfma_f32_16x16x32_bf16 v[108:111], v[140:143], a[76:79], v[108:111]
    s_waitcnt vmcnt(36)
    ds_read_b64_tr_b16 v[112:113], v144 offset:16384
    ds_read_b64_tr_b16 v[114:115], v144 offset:16896
    ds_read_b64_tr_b16 v[116:117], v145 offset:16384
    ds_read_b64_tr_b16 v[118:119], v145 offset:16896
    ds_read_b64_tr_b16 v[120:121], v146 offset:16384
    ds_read_b64_tr_b16 v[122:123], v146 offset:16896
    ds_read_b64_tr_b16 v[124:125], v147 offset:16384
    ds_read_b64_tr_b16 v[126:127], v147 offset:16896
    ds_read_b64_tr_b16 v[128:129], v144 offset:20480
    ds_read_b64_tr_b16 v[130:131], v144 offset:20992
    ds_read_b64_tr_b16 v[132:133], v145 offset:20480
    ds_read_b64_tr_b16 v[134:135], v145 offset:20992
    ds_read_b64_tr_b16 v[136:137], v146 offset:20480
    ds_read_b64_tr_b16 v[138:139], v146 offset:20992
    ds_read_b64_tr_b16 v[140:141], v147 offset:20480
    ds_read_b64_tr_b16 v[142:143], v147 offset:20992
    s_waitcnt lgkmcnt(14)
    v_mfma_f32_16x16x32_bf16 v[32:35], v[112:115], a[80:83], v[32:35]
    v_mfma_f32_16x16x32_bf16 v[36:39], v[112:115], a[88:91], v[36:39]
    buffer_load_dwordx4 v[172:175], v26, s[40:43], s38 offen
    v_mfma_f32_16x16x32_bf16 v[40:43], v[112:115], a[96:99], v[40:43]
    v_mfma_f32_16x16x32_bf16 v[44:47], v[112:115], a[104:107], v[44:47]
    s_add_u32 s39, s37, 0
    buffer_load_dwordx2 v[160:161], v25, s[20:23], s39 offen
    v_mfma_f32_16x16x32_bf16 v[48:51], v[112:115], a[112:115], v[48:51]
    s_waitcnt lgkmcnt(12)
    v_mfma_f32_16x16x32_bf16 v[52:55], v[116:119], a[80:83], v[52:55]
    s_add_u32 s39, s37, 18432
    buffer_load_dwordx2 v[162:163], v25, s[20:23], s39 offen
    v_mfma_f32_16x16x32_bf16 v[56:59], v[116:119], a[88:91], v[56:59]
    v_mfma_f32_16x16x32_bf16 v[60:63], v[116:119], a[96:99], v[60:63]
    s_add_u32 s39, s37, 36864
    buffer_load_dwordx2 v[164:165], v25, s[20:23], s39 offen
    v_mfma_f32_16x16x32_bf16 v[64:67], v[116:119], a[104:107], v[64:67]
    v_mfma_f32_16x16x32_bf16 v[68:71], v[116:119], a[112:115], v[68:71]
    s_add_u32 s39, s37, 55296
    buffer_load_dwordx2 v[166:167], v25, s[20:23], s39 offen
    s_waitcnt lgkmcnt(10)
    v_mfma_f32_16x16x32_bf16 v[72:75], v[120:123], a[80:83], v[72:75]
    v_mfma_f32_16x16x32_bf16 v[76:79], v[120:123], a[88:91], v[76:79]
    s_add_u32 s39, s37, 73728
    buffer_load_dwordx2 v[168:169], v25, s[20:23], s39 offen
    v_mfma_f32_16x16x32_bf16 v[80:83], v[120:123], a[96:99], v[80:83]
    v_mfma_f32_16x16x32_bf16 v[84:87], v[120:123], a[104:107], v[84:87]
    v_mfma_f32_16x16x32_bf16 v[88:91], v[120:123], a[112:115], v[88:91]
    s_waitcnt lgkmcnt(8)
    v_mfma_f32_16x16x32_bf16 v[92:95], v[124:127], a[80:83], v[92:95]
    v_mfma_f32_16x16x32_bf16 v[96:99], v[124:127], a[88:91], v[96:99]
    v_mfma_f32_16x16x32_bf16 v[100:103], v[124:127], a[96:99], v[100:103]
    v_mfma_f32_16x16x32_bf16 v[104:107], v[124:127], a[104:107], v[104:107]
    v_mfma_f32_16x16x32_bf16 v[108:111], v[124:127], a[112:115], v[108:111]
    s_waitcnt lgkmcnt(6)
    v_mfma_f32_16x16x32_bf16 v[32:35], v[128:131], a[84:87], v[32:35]
    v_mfma_f32_16x16x32_bf16 v[36:39], v[128:131], a[92:95], v[36:39]
    v_mfma_f32_16x16x32_bf16 v[40:43], v[128:131], a[100:103], v[40:43]
    v_mfma_f32_16x16x32_bf16 v[44:47], v[128:131], a[108:111], v[44:47]
    v_mfma_f32_16x16x32_bf16 v[48:51], v[128:131], a[116:119], v[48:51]
    s_waitcnt lgkmcnt(4)
    v_mfma_f32_16x16x32_bf16 v[52:55], v[132:135], a[84:87], v[52:55]
    v_mfma_f32_16x16x32_bf16 v[56:59], v[132:135], a[92:95], v[56:59]
    v_mfma_f32_16x16x32_bf16 v[60:63], v[132:135], a[100:103], v[60:63]
    v_mfma_f32_16x16x32_bf16 v[64:67], v[132:135], a[108:111], v[64:67]
    v_mfma_f32_16x16x32_bf16 v[68:71], v[132:135], a[116:119], v[68:71]
    s_waitcnt lgkmcnt(2)
    v_mfma_f32_16x16x32_bf16 v[72:75], v[136:139], a[84:87], v[72:75]
    v_mfma_f32_16x16x32_bf16 v[76:79], v[136:139], a[92:95], v[76:79]
    v_mfma_f32_16x16x32_bf16 v[80:83], v[136:139], a[100:103], v[80:83]
    v_mfma_f32_16x16x32_bf16 v[84:87], v[136:139], a[108:111], v[84:87]
    v_mfma_f32_16x16x32_bf16 v[88:91], v[136:139], a[116:119], v[88:91]
    s_waitcnt lgkmcnt(0)
    v_mfma_f32_16x16x32_bf16 v[92:95], v[140:143], a[84:87], v[92:95]
    v_mfma_f32_16x16x32_bf16 v[96:99], v[140:143], a[92:95], v[96:99]
    v_mfma_f32_16x16x32_bf16 v[100:103], v[140:143], a[100:103], v[100:103]
    v_mfma_f32_16x16x32_bf16 v[104:107], v[140:143], a[108:111], v[104:107]
    v_mfma_f32_16x16x32_bf16 v[108:111], v[140:143], a[116:119], v[108:111]
    s_waitcnt vmcnt(24)
    ds_read_b64_tr_b16 v[112:113], v144 offset:24576
    ds_read_b64_tr_b16 v[114:115], v144 offset:25088
    ds_read_b64_tr_b16 v[116:117], v145 offset:24576
    ds_read_b64_tr_b16 v[118:119], v145 offset:25088
    ds_read_b64_tr_b16 v[120:121], v146 offset:24576
    ds_read_b64_tr_b16 v[122:123], v146 offset:25088
    ds_read_b64_tr_b16 v[124:125], v147 offset:24576
    ds_read_b64_tr_b16 v[126:127], v147 offset:25088
    ds_read_b64_tr_b16 v[128:129], v144 offset:28672
    ds_read_b64_tr_b16 v[130:131], v144 offset:29184
    ds_read_b64_tr_b16 v[132:133], v145 offset:28672
    ds_read_b64_tr_b16 v[134:135], v145 offset:29184
    ds_read_b64_tr_b16 v[136:137], v146 offset:28672
    ds_read_b64_tr_b16 v[138:139], v146 offset:29184
    ds_read_b64_tr_b16 v[140:141], v147 offset:28672
    ds_read_b64_tr_b16 v[142:143], v147 offset:29184
    s_waitcnt lgkmcnt(14)
    v_mfma_f32_16x16x32_bf16 v[32:35], v[112:115], a[120:123], v[32:35]
    v_mfma_f32_16x16x32_bf16 v[36:39], v[112:115], a[128:131], v[36:39]
    v_mfma_f32_16x16x32_bf16 v[40:43], v[112:115], a[136:139], v[40:43]
    v_mfma_f32_16x16x32_bf16 v[44:47], v[112:115], a[144:147], v[44:47]
    v_mfma_f32_16x16x32_bf16 v[48:51], v[112:115], a[152:155], v[48:51]
    s_waitcnt lgkmcnt(12)
    v_mfma_f32_16x16x32_bf16 v[52:55], v[116:119], a[120:123], v[52:55]
    v_mfma_f32_16x16x32_bf16 v[56:59], v[116:119], a[128:131], v[56:59]
    v_mfma_f32_16x16x32_bf16 v[60:63], v[116:119], a[136:139], v[60:63]
    v_mfma_f32_16x16x32_bf16 v[64:67], v[116:119], a[144:147], v[64:67]
    v_mfma_f32_16x16x32_bf16 v[68:71], v[116:119], a[152:155], v[68:71]
    s_waitcnt lgkmcnt(10)
    v_mfma_f32_16x16x32_bf16 v[72:75], v[120:123], a[120:123], v[72:75]
    v_mfma_f32_16x16x32_bf16 v[76:79], v[120:123], a[128:131], v[76:79]
    v_mfma_f32_16x16x32_bf16 v[80:83], v[120:123], a[136:139], v[80:83]
    v_mfma_f32_16x16x32_bf16 v[84:87], v[120:123], a[144:147], v[84:87]
    v_mfma_f32_16x16x32_bf16 v[88:91], v[120:123], a[152:155], v[88:91]
    s_waitcnt lgkmcnt(8)
    v_mfma_f32_16x16x32_bf16 v[92:95], v[124:127], a[120:123], v[92:95]
    v_mfma_f32_16x16x32_bf16 v[96:99], v[124:127], a[128:131], v[96:99]
    v_mfma_f32_16x16x32_bf16 v[100:103], v[124:127], a[136:139], v[100:103]
    v_mfma_f32_16x16x32_bf16 v[104:107], v[124:127], a[144:147], v[104:107]
    v_mfma_f32_16x16x32_bf16 v[108:111], v[124:127], a[152:155], v[108:111]
    s_waitcnt lgkmcnt(6)
    v_mfma_f32_16x16x32_bf16 v[32:35], v[128:131], a[124:127], v[32:35]
    v_mfma_f32_16x16x32_bf16 v[36:39], v[128:131], a[132:135], v[36:39]
    v_mfma_f32_16x16x32_bf16 v[40:43], v[128:131], a[140:143], v[40:43]
    v_mfma_f32_16x16x32_bf16 v[44:47], v[128:131], a[148:151], v[44:47]
    v_mfma_f32_16x16x32_bf16 v[48:51], v[128:131], a[156:159], v[48:51]
    s_waitcnt lgkmcnt(4)
    v_mfma_f32_16x16x32_bf16 v[52:55], v[132:135], a[124:127], v[52:55]
    v_mfma_f32_16x16x32_bf16 v[56:59], v[132:135], a[132:135], v[56:59]
    v_mfma_f32_16x16x32_bf16 v[60:63], v[132:135], a[140:143], v[60:63]
    v_mfma_f32_16x16x32_bf16 v[64:67], v[132:135], a[148:151], v[64:67]
    v_mfma_f32_16x16x32_bf16 v[68:71], v[132:135], a[156:159], v[68:71]
    s_waitcnt lgkmcnt(2)
    v_mfma_f32_16x16x32_bf16 v[72:75], v[136:139], a[124:127], v[72:75]
    v_mfma_f32_16x16x32_bf16 v[76:79], v[136:139], a[132:135], v[76:79]
    v_mfma_f32_16x16x32_bf16 v[80:83], v[136:139], a[140:143], v[80:83]
    v_mfma_f32_16x16x32_bf16 v[84:87], v[136:139], a[148:151], v[84:87]
    v_mfma_f32_16x16x32_bf16 v[88:91], v[136:139], a[156:159], v[88:91]
    s_waitcnt lgkmcnt(0)
    v_mfma_f32_16x16x32_bf16 v[92:95], v[140:143], a[124:127], v[92:95]
    v_mfma_f32_16x16x32_bf16 v[96:99], v[140:143], a[132:135], v[96:99]
    v_mfma_f32_16x16x32_bf16 v[100:103], v[140:143], a[140:143], v[100:103]
    v_mfma_f32_16x16x32_bf16 v[104:107], v[140:143], a[148:151], v[104:107]
    v_mfma_f32_16x16x32_bf16 v[108:111], v[140:143], a[156:159], v[108:111]
    s_waitcnt vmcnt(6)
    ds_read_b64_tr_b16 v[112:113], v144 offset:0
    ds_read_b64_tr_b16 v[114:115], v144 offset:512
    ds_read_b64_tr_b16 v[116:117], v145 offset:0
    ds_read_b64_tr_b16 v[118:119], v145 offset:512
    ds_read_b64_tr_b16 v[120:121], v146 offset:0
    ds_read_b64_tr_b16 v[122:123], v146 offset:512
    ds_read_b64_tr_b16 v[124:125], v147 offset:0
    ds_read_b64_tr_b16 v[126:127], v147 offset:512
    ds_read_b64_tr_b16 v[128:129], v144 offset:4096
    ds_read_b64_tr_b16 v[130:131], v144 offset:4608
    ds_read_b64_tr_b16 v[132:133], v145 offset:4096
    ds_read_b64_tr_b16 v[134:135], v145 offset:4608
    ds_read_b64_tr_b16 v[136:137], v146 offset:4096
    ds_read_b64_tr_b16 v[138:139], v146 offset:4608
    ds_read_b64_tr_b16 v[140:141], v147 offset:4096
    ds_read_b64_tr_b16 v[142:143], v147 offset:4608
    s_waitcnt lgkmcnt(14)
    v_mfma_f32_16x16x32_bf16 v[32:35], v[112:115], a[0:3], v[32:35]
    v_mfma_f32_16x16x32_bf16 v[36:39], v[112:115], a[8:11], v[36:39]
    v_mfma_f32_16x16x32_bf16 v[40:43], v[112:115], a[16:19], v[40:43]
    v_mfma_f32_16x16x32_bf16 v[44:47], v[112:115], a[24:27], v[44:47]
    v_mfma_f32_16x16x32_bf16 v[48:51], v[112:115], a[32:35], v[48:51]
    s_waitcnt lgkmcnt(12)
    v_mfma_f32_16x16x32_bf16 v[52:55], v[116:119], a[0:3], v[52:55]
    v_mfma_f32_16x16x32_bf16 v[56:59], v[116:119], a[8:11], v[56:59]
    v_mfma_f32_16x16x32_bf16 v[60:63], v[116:119], a[16:19], v[60:63]
    v_mfma_f32_16x16x32_bf16 v[64:67], v[116:119], a[24:27], v[64:67]
    v_mfma_f32_16x16x32_bf16 v[68:71], v[116:119], a[32:35], v[68:71]
    s_waitcnt lgkmcnt(10)
    v_mfma_f32_16x16x32_bf16 v[72:75], v[120:123], a[0:3], v[72:75]
    v_mfma_f32_16x16x32_bf16 v[76:79], v[120:123], a[8:11], v[76:79]
    v_mfma_f32_16x16x32_bf16 v[80:83], v[120:123], a[16:19], v[80:83]
    v_mfma_f32_16x16x32_bf16 v[84:87], v[120:123], a[24:27], v[84:87]
    v_mfma_f32_16x16x32_bf16 v[88:91], v[120:123], a[32:35], v[88:91]
    s_waitcnt lgkmcnt(8)
    v_mfma_f32_16x16x32_bf16 v[92:95], v[124:127], a[0:3], v[92:95]
    v_mfma_f32_16x16x32_bf16 v[96:99], v[124:127], a[8:11], v[96:99]
    v_mfma_f32_16x16x32_bf16 v[100:103], v[124:127], a[16:19], v[100:103]
    v_mfma_f32_16x16x32_bf16 v[104:107], v[124:127], a[24:27], v[104:107]
    v_mfma_f32_16x16x32_bf16 v[108:111], v[124:127], a[32:35], v[108:111]
    s_waitcnt lgkmcnt(6)
    v_mfma_f32_16x16x32_bf16 v[32:35], v[128:131], a[4:7], v[32:35]
    v_mfma_f32_16x16x32_bf16 v[36:39], v[128:131], a[12:15], v[36:39]
    v_mfma_f32_16x16x32_bf16 v[40:43], v[128:131], a[20:23], v[40:43]
    v_mfma_f32_16x16x32_bf16 v[44:47], v[128:131], a[28:31], v[44:47]
    v_mfma_f32_16x16x32_bf16 v[48:51], v[128:131], a[36:39], v[48:51]
    s_waitcnt lgkmcnt(4)
    v_mfma_f32_16x16x32_bf16 v[52:55], v[132:135], a[4:7], v[52:55]
    v_mfma_f32_16x16x32_bf16 v[56:59], v[132:135], a[12:15], v[56:59]
    v_mfma_f32_16x16x32_bf16 v[60:63], v[132:135], a[20:23], v[60:63]
    v_mfma_f32_16x16x32_bf16 v[64:67], v[132:135], a[28:31], v[64:67]
    v_mfma_f32_16x16x32_bf16 v[68:71], v[132:135], a[36:39], v[68:71]
    s_waitcnt lgkmcnt(2)
    v_mfma_f32_16x16x32_bf16 v[72:75], v[136:139], a[4:7], v[72:75]
    v_mfma_f32_16x16x32_bf16 v[76:79], v[136:139], a[12:15], v[76:79]
    v_mfma_f32_16x16x32_bf16 v[80:83], v[136:139], a[20:23], v[80:83]
    v_mfma_f32_16x16x32_bf16 v[84:87], v[136:139], a[28:31], v[84:87]
    v_mfma_f32_16x16x32_bf16 v[88:91], v[136:139], a[36:39], v[88:91]
    s_waitcnt lgkmcnt(0)
    v_mfma_f32_16x16x32_bf16 v[92:95], v[140:143], a[4:7], v[92:95]
    v_mfma_f32_16x16x32_bf16 v[96:99], v[140:143], a[12:15], v[96:99]
    v_mfma_f32_16x16x32_bf16 v[100:103], v[140:143], a[20:23], v[100:103]
    v_mfma_f32_16x16x32_bf16 v[104:107], v[140:143], a[28:31], v[104:107]
    v_mfma_f32_16x16x32_bf16 v[108:111], v[140:143], a[36:39], v[108:111]
    v_lshlrev_b32 v3, 4, v1
    v_add_u32 v4, s34, v3
    s_nop 7
    ds_write_b128 v4, v[32:35] offset:0
    ds_write_b128 v4, v[36:39] offset:1024
    ds_write_b128 v4, v[40:43] offset:2048
    ds_write_b128 v4, v[44:47] offset:3072
    ds_write_b128 v4, v[48:51] offset:4096
    ds_write_b128 v4, v[52:55] offset:5120
    ds_write_b128 v4, v[56:59] offset:6144
    ds_write_b128 v4, v[60:63] offset:7168
    ds_write_b128 v4, v[64:67] offset:8192
    ds_write_b128 v4, v[68:71] offset:9216
    ds_write_b128 v4, v[72:75] offset:10240
    ds_write_b128 v4, v[76:79] offset:11264
    ds_write_b128 v4, v[80:83] offset:12288
    ds_write_b128 v4, v[84:87] offset:13312
    ds_write_b128 v4, v[88:91] offset:14336
    ds_write_b128 v4, v[92:95] offset:15360
    ds_write_b128 v4, v[96:99] offset:16384
    ds_write_b128 v4, v[100:103] offset:17408
    ds_write_b128 v4, v[104:107] offset:18432
    ds_write_b128 v4, v[108:111] offset:19456
    s_mul_i32 s39, s3, 5120
    v_add_u32 v4, s39, v3
    v_add_u32 v5, 65536, v4
    s_waitcnt lgkmcnt(0)
    s_barrier
    ds_read_b128 v[32:35], v4 offset:0
    ds_read_b128 v[36:39], v4 offset:32768
    ds_read_b128 v[40:43], v5 offset:0
    ds_read_b128 v[44:47], v5 offset:32768
    ds_read_b128 v[48:51], v4 offset:1024
    ds_read_b128 v[52:55], v4 offset:33792
    ds_read_b128 v[56:59], v5 offset:1024
    ds_read_b128 v[60:63], v5 offset:33792
    ds_read_b128 v[64:67], v4 offset:2048
    ds_read_b128 v[68:71], v4 offset:34816
    ds_read_b128 v[72:75], v5 offset:2048
    ds_read_b128 v[76:79], v5 offset:34816
    ds_read_b128 v[80:83], v4 offset:3072
    ds_read_b128 v[84:87], v4 offset:35840
    ds_read_b128 v[88:91], v5 offset:3072
    ds_read_b128 v[92:95], v5 offset:35840
    ds_read_b128 v[96:99], v4 offset:4096
    ds_read_b128 v[100:103], v4 offset:36864
    ds_read_b128 v[104:107], v5 offset:4096
    ds_read_b128 v[108:111], v5 offset:36864
    s_waitcnt lgkmcnt(0) vmcnt(0)
    v_add_f32 v32, v32, v36
    v_add_f32 v40, v40, v44
    v_add_f32 v33, v33, v37
    v_add_f32 v41, v41, v45
    v_add_f32 v34, v34, v38
    v_add_f32 v42, v42, v46
    v_add_f32 v35, v35, v39
    v_add_f32 v43, v43, v47
    v_add_f32 v32, v32, v40
    v_add_f32 v33, v33, v41
    v_add_f32 v34, v34, v42
    v_add_f32 v35, v35, v43
    v_cvt_pk_bf16_f32 v36, v32, v33
    v_cvt_pk_bf16_f32 v37, v34, v35
    v_lshlrev_b32 v32, 16, v36
    v_and_b32 v33, 0xffff0000, v36
    v_lshlrev_b32 v34, 16, v37
    v_and_b32 v35, 0xffff0000, v37
    v_mul_f32 v32, v32, v172
    v_mul_f32 v33, v33, v173
    v_mul_f32 v34, v34, v174
    v_mul_f32 v35, v35, v175
    v_cvt_pk_bf16_f32 v36, v32, v33
    v_cvt_pk_bf16_f32 v37, v34, v35
    v_lshlrev_b32 v32, 16, v36
    v_and_b32 v33, 0xffff0000, v36
    v_lshlrev_b32 v34, 16, v37
    v_and_b32 v35, 0xffff0000, v37
    v_lshlrev_b32 v40, 16, v160
    v_and_b32 v41, 0xffff0000, v160
    v_lshlrev_b32 v42, 16, v161
    v_and_b32 v43, 0xffff0000, v161
    v_add_f32 v32, v32, v40
    v_add_f32 v33, v33, v41
    v_add_f32 v34, v34, v42
    v_add_f32 v35, v35, v43
    v_cvt_pk_bf16_f32 v36, v32, v33
    v_cvt_pk_bf16_f32 v37, v34, v35
    s_add_u32 s39, s36, 0
    buffer_store_dwordx2 v[36:37], v24, s[24:27], s39 offen sc0 sc1
    v_add_f32 v48, v48, v52
    v_add_f32 v56, v56, v60
    v_add_f32 v49, v49, v53
    v_add_f32 v57, v57, v61
    v_add_f32 v50, v50, v54
    v_add_f32 v58, v58, v62
    v_add_f32 v51, v51, v55
    v_add_f32 v59, v59, v63
    v_add_f32 v48, v48, v56
    v_add_f32 v49, v49, v57
    v_add_f32 v50, v50, v58
    v_add_f32 v51, v51, v59
    v_cvt_pk_bf16_f32 v52, v48, v49
    v_cvt_pk_bf16_f32 v53, v50, v51
    v_lshlrev_b32 v48, 16, v52
    v_and_b32 v49, 0xffff0000, v52
    v_lshlrev_b32 v50, 16, v53
    v_and_b32 v51, 0xffff0000, v53
    v_mul_f32 v48, v48, v172
    v_mul_f32 v49, v49, v173
    v_mul_f32 v50, v50, v174
    v_mul_f32 v51, v51, v175
    v_cvt_pk_bf16_f32 v52, v48, v49
    v_cvt_pk_bf16_f32 v53, v50, v51
    v_lshlrev_b32 v48, 16, v52
    v_and_b32 v49, 0xffff0000, v52
    v_lshlrev_b32 v50, 16, v53
    v_and_b32 v51, 0xffff0000, v53
    v_lshlrev_b32 v56, 16, v162
    v_and_b32 v57, 0xffff0000, v162
    v_lshlrev_b32 v58, 16, v163
    v_and_b32 v59, 0xffff0000, v163
    v_add_f32 v48, v48, v56
    v_add_f32 v49, v49, v57
    v_add_f32 v50, v50, v58
    v_add_f32 v51, v51, v59
    v_cvt_pk_bf16_f32 v52, v48, v49
    v_cvt_pk_bf16_f32 v53, v50, v51
    s_add_u32 s39, s36, 18432
    buffer_store_dwordx2 v[52:53], v24, s[24:27], s39 offen sc0 sc1
    v_add_f32 v64, v64, v68
    v_add_f32 v72, v72, v76
    v_add_f32 v65, v65, v69
    v_add_f32 v73, v73, v77
    v_add_f32 v66, v66, v70
    v_add_f32 v74, v74, v78
    v_add_f32 v67, v67, v71
    v_add_f32 v75, v75, v79
    v_add_f32 v64, v64, v72
    v_add_f32 v65, v65, v73
    v_add_f32 v66, v66, v74
    v_add_f32 v67, v67, v75
    v_cvt_pk_bf16_f32 v68, v64, v65
    v_cvt_pk_bf16_f32 v69, v66, v67
    v_lshlrev_b32 v64, 16, v68
    v_and_b32 v65, 0xffff0000, v68
    v_lshlrev_b32 v66, 16, v69
    v_and_b32 v67, 0xffff0000, v69
    v_mul_f32 v64, v64, v172
    v_mul_f32 v65, v65, v173
    v_mul_f32 v66, v66, v174
    v_mul_f32 v67, v67, v175
    v_cvt_pk_bf16_f32 v68, v64, v65
    v_cvt_pk_bf16_f32 v69, v66, v67
    v_lshlrev_b32 v64, 16, v68
    v_and_b32 v65, 0xffff0000, v68
    v_lshlrev_b32 v66, 16, v69
    v_and_b32 v67, 0xffff0000, v69
    v_lshlrev_b32 v72, 16, v164
    v_and_b32 v73, 0xffff0000, v164
    v_lshlrev_b32 v74, 16, v165
    v_and_b32 v75, 0xffff0000, v165
    v_add_f32 v64, v64, v72
    v_add_f32 v65, v65, v73
    v_add_f32 v66, v66, v74
    v_add_f32 v67, v67, v75
    v_cvt_pk_bf16_f32 v68, v64, v65
    v_cvt_pk_bf16_f32 v69, v66, v67
    s_add_u32 s39, s36, 36864
    buffer_store_dwordx2 v[68:69], v24, s[24:27], s39 offen sc0 sc1
    v_add_f32 v80, v80, v84
    v_add_f32 v88, v88, v92
    v_add_f32 v81, v81, v85
    v_add_f32 v89, v89, v93
    v_add_f32 v82, v82, v86
    v_add_f32 v90, v90, v94
    v_add_f32 v83, v83, v87
    v_add_f32 v91, v91, v95
    v_add_f32 v80, v80, v88
    v_add_f32 v81, v81, v89
    v_add_f32 v82, v82, v90
    v_add_f32 v83, v83, v91
    v_cvt_pk_bf16_f32 v84, v80, v81
    v_cvt_pk_bf16_f32 v85, v82, v83
    v_lshlrev_b32 v80, 16, v84
    v_and_b32 v81, 0xffff0000, v84
    v_lshlrev_b32 v82, 16, v85
    v_and_b32 v83, 0xffff0000, v85
    v_mul_f32 v80, v80, v172
    v_mul_f32 v81, v81, v173
    v_mul_f32 v82, v82, v174
    v_mul_f32 v83, v83, v175
    v_cvt_pk_bf16_f32 v84, v80, v81
    v_cvt_pk_bf16_f32 v85, v82, v83
    v_lshlrev_b32 v80, 16, v84
    v_and_b32 v81, 0xffff0000, v84
    v_lshlrev_b32 v82, 16, v85
    v_and_b32 v83, 0xffff0000, v85
    v_lshlrev_b32 v88, 16, v166
    v_and_b32 v89, 0xffff0000, v166
    v_lshlrev_b32 v90, 16, v167
    v_and_b32 v91, 0xffff0000, v167
    v_add_f32 v80, v80, v88
    v_add_f32 v81, v81, v89
    v_add_f32 v82, v82, v90
    v_add_f32 v83, v83, v91
    v_cvt_pk_bf16_f32 v84, v80, v81
    v_cvt_pk_bf16_f32 v85, v82, v83
    s_add_u32 s39, s36, 55296
    buffer_store_dwordx2 v[84:85], v24, s[24:27], s39 offen sc0 sc1
    v_add_f32 v96, v96, v100
    v_add_f32 v104, v104, v108
    v_add_f32 v97, v97, v101
    v_add_f32 v105, v105, v109
    v_add_f32 v98, v98, v102
    v_add_f32 v106, v106, v110
    v_add_f32 v99, v99, v103
    v_add_f32 v107, v107, v111
    v_add_f32 v96, v96, v104
    v_add_f32 v97, v97, v105
    v_add_f32 v98, v98, v106
    v_add_f32 v99, v99, v107
    v_cvt_pk_bf16_f32 v100, v96, v97
    v_cvt_pk_bf16_f32 v101, v98, v99
    v_lshlrev_b32 v96, 16, v100
    v_and_b32 v97, 0xffff0000, v100
    v_lshlrev_b32 v98, 16, v101
    v_and_b32 v99, 0xffff0000, v101
    v_mul_f32 v96, v96, v172
    v_mul_f32 v97, v97, v173
    v_mul_f32 v98, v98, v174
    v_mul_f32 v99, v99, v175
    v_cvt_pk_bf16_f32 v100, v96, v97
    v_cvt_pk_bf16_f32 v101, v98, v99
    v_lshlrev_b32 v96, 16, v100
    v_and_b32 v97, 0xffff0000, v100
    v_lshlrev_b32 v98, 16, v101
    v_and_b32 v99, 0xffff0000, v101
    v_lshlrev_b32 v104, 16, v168
    v_and_b32 v105, 0xffff0000, v168
    v_lshlrev_b32 v106, 16, v169
    v_and_b32 v107, 0xffff0000, v169
    v_add_f32 v96, v96, v104
    v_add_f32 v97, v97, v105
    v_add_f32 v98, v98, v106
    v_add_f32 v99, v99, v107
    v_cvt_pk_bf16_f32 v100, v96, v97
    v_cvt_pk_bf16_f32 v101, v98, v99
    s_add_u32 s39, s36, 73728
    buffer_store_dwordx2 v[100:101], v24, s[24:27], s39 offen sc0 sc1
    s_waitcnt vmcnt(0)
K5_end:
    s_endpgm
CODE_END:
.section .rodata,"a"
.p2align 6
.amdhsa_kernel k0_mod_kernel
  .amdhsa_next_free_vgpr 72
  .amdhsa_next_free_sgpr 102
  .amdhsa_accum_offset 72
  .amdhsa_group_segment_fixed_size 0
  .amdhsa_kernarg_size 120
  .amdhsa_user_sgpr_count 2
  .amdhsa_user_sgpr_kernarg_segment_ptr 1
  .amdhsa_system_sgpr_workgroup_id_x 1
.end_amdhsa_kernel
.section .rodata,"a"
.p2align 6
.amdhsa_kernel k1_attn_kernel
  .amdhsa_next_free_vgpr 512
  .amdhsa_next_free_sgpr 102
  .amdhsa_accum_offset 256
  .amdhsa_group_segment_fixed_size 0
  .amdhsa_kernarg_size 120
  .amdhsa_user_sgpr_count 2
  .amdhsa_user_sgpr_kernarg_segment_ptr 1
  .amdhsa_system_sgpr_workgroup_id_x 1
.end_amdhsa_kernel
.section .rodata,"a"
.p2align 6
.amdhsa_kernel k2_oproj_kernel
  .amdhsa_next_free_vgpr 340
  .amdhsa_next_free_sgpr 102
  .amdhsa_accum_offset 180
  .amdhsa_group_segment_fixed_size 0
  .amdhsa_kernarg_size 120
  .amdhsa_user_sgpr_count 2
  .amdhsa_user_sgpr_kernarg_segment_ptr 1
  .amdhsa_system_sgpr_workgroup_id_x 1
.end_amdhsa_kernel
.section .rodata,"a"
.p2align 6
.amdhsa_kernel k3_win_kernel
  .amdhsa_next_free_vgpr 256
  .amdhsa_next_free_sgpr 102
  .amdhsa_accum_offset 120
  .amdhsa_group_segment_fixed_size 0
  .amdhsa_kernarg_size 120
  .amdhsa_user_sgpr_count 2
  .amdhsa_user_sgpr_kernarg_segment_ptr 1
  .amdhsa_system_sgpr_workgroup_id_x 1
.end_amdhsa_kernel
.section .rodata,"a"
.p2align 6
.amdhsa_kernel k4_sp_kernel
  .amdhsa_next_free_vgpr 252
  .amdhsa_next_free_sgpr 102
  .amdhsa_accum_offset 116
  .amdhsa_group_segment_fixed_size 0
  .amdhsa_kernarg_size 120
  .amdhsa_user_sgpr_count 2
  .amdhsa_user_sgpr_kernarg_segment_ptr 1
  .amdhsa_system_sgpr_workgroup_id_x 1
.end_amdhsa_kernel
.section .rodata,"a"
.p2align 6
.amdhsa_kernel k5_oproj_kernel
  .amdhsa_next_free_vgpr 340
  .amdhsa_next_free_sgpr 102
  .amdhsa_accum_offset 180
  .amdhsa_group_segment_fixed_size 0
  .amdhsa_kernarg_size 120
  .amdhsa_user_sgpr_count 2
  .amdhsa_user_sgpr_kernarg_segment_ptr 1
  .amdhsa_system_sgpr_workgroup_id_x 1
.end_amdhsa_kernel
```
